```python
import torch

def _softmax(x, axis=-1):
    return torch.softmax(x, dim=axis)
def _gelu(x):
    return torch.nn.functional.gelu(x, approximate="tanh")
def _silu(x):
    return torch.nn.functional.silu(x)
def _sigmoid(x):
    return torch.sigmoid(x)
def _layernorm(x, axis=-1, eps=1e-5):
    m = x.mean(dim=axis, keepdim=True)
    v = x.var(dim=axis, keepdim=True, unbiased=False)
    return (x - m) / torch.sqrt(v + eps)
def _scatter_add(tgt, idx, src, axis=0):
    return tgt.clone().index_add_(axis, idx, src)
def _segment_sum(src, seg, n):
    out = torch.zeros((n,) + src.shape[1:], dtype=src.dtype)
    return out.index_add_(0, seg, src)
def _pad(x, pw):
    flat = tuple(v for pair in reversed(pw) for v in pair)
    return torch.nn.functional.pad(x, flat)

kernel_name = 'sequential_preLN__compressed_kv_cla__mixer_channel_mlp__prompt'

def setup_inputs():

    _w = (lambda a: (lambda t: t.to(torch.bfloat16) if t.is_floating_point() else t)(torch.as_tensor(a)))
    def _A_setup():
        B, H, Sq, Sk, D, M = 1, 32, 2048, 2048, 128, 512
        Dc = 4 * D
        return {
            "x": _w((lambda *s: torch.randn(*s, dtype=torch.bfloat16) * 0.05)(B, Sq, M)),
            "c_kv": _w((lambda *s: torch.randn(*s, dtype=torch.bfloat16) * 0.4)(B, Sk, Dc)),
            "w_q": _w((lambda *s: torch.randn(*s, dtype=torch.bfloat16) * 3.2)(M, H, D) * (M ** -0.5)),
            "w_uk": _w((lambda *s: torch.randn(*s, dtype=torch.bfloat16) * 3.2)(Dc, H, D) * (Dc ** -0.5)),
            "w_uv": _w((lambda *s: torch.randn(*s, dtype=torch.bfloat16) * 0.4)(Dc, H, D) * (Dc ** -0.5)),
            "w_o": _w((lambda *s: torch.randn(*s, dtype=torch.bfloat16) * 0.4)(H, D, M) * ((H * D) ** -0.5)),
        }
    _A_in = _A_setup()

    def _B_setup():
        B, S, D, F = 1, 2048, 512, 1376
        return {
            "x": _w((lambda *s: torch.randn(*s, dtype=torch.bfloat16) * 0.05)(B, S, D)),
            "w1": _w((lambda *s: torch.randn(*s, dtype=torch.bfloat16) * 0.8)(D, F) * (D ** -0.5)),
            "b1": _w((lambda *s: torch.randn(*s, dtype=torch.bfloat16) * 0.4)(F)),
            "w2": _w((lambda *s: torch.randn(*s, dtype=torch.bfloat16) * 0.05)(F, D) * (F ** -0.5)),
            "b2": _w((lambda *s: torch.randn(*s, dtype=torch.bfloat16) * 0.05)(D)),
        }
    _B_in = _B_setup()

    return {
        "A_x": _A_in["x"],
        "A_c_kv": _A_in["c_kv"],
        "A_w_q": _A_in["w_q"],
        "A_w_uk": _A_in["w_uk"],
        "A_w_uv": _A_in["w_uv"],
        "A_w_o": _A_in["w_o"],
        "B_x": _B_in["x"],
        "B_w1": _B_in["w1"],
        "B_b1": _B_in["b1"],
        "B_w2": _B_in["w2"],
        "B_b2": _B_in["b2"],
    }

def reference(A_x, A_c_kv, A_w_q, A_w_uk, A_w_uv, A_w_o, B_x, B_w1, B_b1, B_w2, B_b2):
    def _A_ref(x, c_kv, w_q, w_uk, w_uv, w_o):
        B, Sq, M = x.shape[0], x.shape[1], x.shape[2]
        Sk = c_kv.shape[1]
        H, D = w_q.shape[1], w_q.shape[2]
        q = torch.einsum("bqm,mhd->bhqd", x, w_q)
        k = torch.einsum("bkc,chd->bhkd", c_kv, w_uk)
        v = torch.einsum("bkc,chd->bhkd", c_kv, w_uv)
        scores = torch.einsum("bhqd,bhkd->bhqk", q, k) * (D ** -0.5)
        off = Sk - Sq
        qi = torch.arange(Sq)[:, None]
        kj = torch.arange(Sk)[None, :]
        cmask = kj <= (qi + off)
        scores = torch.where(cmask[None, None], scores, -1e9)
        p = _softmax(scores, axis=-1)
        ctx = torch.einsum("bhqk,bhkd->bhqd", p, v)
        return torch.einsum("bhqd,hdm->bqm", ctx, w_o)

    def _B_ref(x, w1, b1, w2, b2):
        y = _layernorm(x, axis=-1)
        h = _gelu(torch.einsum("bsd,df->bsf", y, w1) + b1)
        return torch.einsum("bsf,fd->bsd", h, w2) + b2

    x = A_x
    h = x + _A_ref(_layernorm(x, axis=-1), A_c_kv, A_w_q, A_w_uk, A_w_uv, A_w_o)
    h2 = h + _B_ref(_layernorm(h, axis=-1), B_w1, B_b1, B_w2, B_b2)
    return h2
```

```asm
; @launch grid=(256,1,1) block=(256,1,1) lds=163840
.amdgcn_target "amdgcn-amd-amdhsa--gfx950"
.text
.globl sequential_preLN__compressed_kv_cla__mixer_channel_mlp__prompt_kernel
.p2align 8
.type sequential_preLN__compressed_kv_cla__mixer_channel_mlp__prompt_kernel,@function
sequential_preLN__compressed_kv_cla__mixer_channel_mlp__prompt_kernel:
    s_cmp_ge_u32 s2, 256
    s_cbranch_scc1 L_end
    s_load_dwordx4 s[84:87], s[0:1], 0
    s_load_dwordx4 s[88:91], s[0:1], 16
    s_load_dwordx4 s[92:95], s[0:1], 32
    s_load_dwordx2 s[82:83], s[0:1], 56
    s_load_dwordx2 s[96:97], s[0:1], 72
    s_load_dwordx2 s[60:61], s[0:1], 96
    s_load_dwordx2 s[14:15], s[0:1], 104
    v_lshrrev_b32 v4, 6, v0
    v_and_b32 v1, 63, v0
    v_readfirstlane_b32 s3, v4
    v_lshlrev_b32 v2, 4, v1
    s_and_b32 s6, s2, 7
    s_lshl_b32 s6, s6, 2
    s_lshr_b32 s4, s2, 6
    s_add_u32 s4, s4, s6
    s_bfe_u32 s5, s2, 0x30003
    s_getpc_b64 s[68:69]
L_pc:
    s_lshr_b32 s11, s2, 3
    s_lshl_b32 s11, s11, 2
    s_add_u32 s11, s11, s3
    v_lshl_add_u32 v4, v1, 7, s11
    v_lshlrev_b32 v4, 7, v4
    v_min_u32 v4, L_codeend-L_pc-4, v4
    v_mov_b32 v221, s69
    v_add_co_u32 v220, vcc, s68, v4
    s_nop 1
    v_addc_co_u32 v221, vcc, 0, v221, vcc
    s_mov_b64 exec, 63
    global_load_dword v9, v[220:221], off
    s_mov_b64 exec, -1
    v_lshrrev_b32 v4, 4, v1
    v_and_b32 v5, 15, v1
    v_lshlrev_b32 v6, 1, v4
    v_xor_b32 v5, v5, v6
    v_lshlrev_b32 v5, 4, v5
    s_lshl_b32 s6, s3, 18
    v_lshl_add_u32 v4, v4, 13, s6
    v_add_u32 v6, v4, v5
    v_xor_b32 v5, 128, v5
    v_add_u32 v5, v4, v5
    v_add_u32 v16, 0, v6
    v_add_u32 v17, 31744, v6
    v_add_u32 v18, 63488, v5
    v_add_u32 v19, 95232, v5
    v_add_u32 v20, 131072, v6
    v_add_u32 v21, 162816, v6
    v_add_u32 v22, 194560, v5
    v_add_u32 v23, 226304, v5
    v_lshrrev_b32 v4, 4, v1
    v_bfe_u32 v5, v1, 2, 2
    v_and_b32 v6, 3, v1
    v_lshlrev_b32 v11, 3, v6
    v_lshl_add_u32 v11, v4, 11, v11
    v_lshl_add_u32 v11, v5, 8, v11
    v_lshl_add_u32 v11, v5, 5, v11
    v_and_b32 v4, 1, v4
    v_lshl_add_u32 v11, v4, 7, v11
    v_and_b32 v4, 15, v1
    v_lshrrev_b32 v5, 4, v1
    s_lshl_b32 s29, s3, 14
    s_add_u32 s29, s29, 98304
    v_xor_b32 v6, v4, v5
    v_lshlrev_b32 v6, 4, v6
    v_lshl_add_u32 v24, v5, 10, v6
    v_lshl_add_u32 v28, v4, 8, v6
    v_add_u32 v28, s29, v28
    v_xor_b32 v25, 64, v24
    v_add_u32 v25, 3072, v25
    v_xor_b32 v29, 64, v28
    v_xor_b32 v26, 128, v24
    v_add_u32 v26, 6144, v26
    v_xor_b32 v30, 128, v28
    v_xor_b32 v27, 192, v24
    v_add_u32 v27, 9216, v27
    v_xor_b32 v31, 192, v28
    s_lshl_b32 s6, s5, 2
    s_add_u32 s12, s6, s3
    s_sub_u32 s13, 60, s6
    s_add_u32 s13, s13, s3
    s_add_u32 s42, s2, s5
    s_and_b32 s42, s42, 3
    s_lshl_b32 s7, s42, 8
    s_lshl_b32 s42, s42, 20
    s_lshl_b32 s30, s12, 16
    s_add_u32 s30, s30, s7
    s_add_u32 s31, s30, 16384
    s_add_u32 s32, s30, 32768
    s_add_u32 s33, s30, 49152
    s_lshl_b32 s10, s3, 13
    s_lshl_b32 s28, s2, 2
    s_add_u32 s28, s28, s3
    s_lshl_b32 s28, s28, 11
    s_lshl_b32 s6, s4, 8
    s_sub_u32 s7, 4194304, s6
    s_waitcnt lgkmcnt(0)
    s_mov_b32 s24, s84
    s_mov_b32 s25, s85
    s_mov_b32 s26, 2097152
    s_mov_b32 s27, 0x20000
    s_mov_b32 s44, s86
    s_mov_b32 s45, s87
    s_mov_b32 s46, 2097152
    s_mov_b32 s47, 0x20000
    s_add_u32 s48, s90, s6
    s_addc_u32 s49, s91, 0
    s_mov_b32 s50, s7
    s_mov_b32 s51, 0x20000
    s_add_u32 s16, s14, 73400320
    s_addc_u32 s17, s15, 0
    s_mov_b32 s18, 65536
    s_mov_b32 s19, 0x20000
    s_cmp_ge_u32 s2, 11
    s_cselect_b32 s11, 1, 0
    s_cbranch_scc1 L_nz
    v_mov_b32 v200, 0
    v_mov_b32 v201, 0
    v_mov_b32 v202, 0
    v_mov_b32 v203, 0
    s_lshr_b32 s9, s28, 1
    buffer_store_dwordx4 v[200:203], v2, s[16:19], s9 offen sc1
L_nz:
    v_add_u32 v12, s28, v2
    s_xor_b32 s9, s42, 0
    s_add_u32 m0, s10, 0
    s_nop 0
    buffer_load_dwordx4 v16, s[48:51], s9 offen offset:0 lds
    buffer_load_dwordx4 v17, s[48:51], s9 offen offset:1024 lds
    buffer_load_dwordx4 v18, s[48:51], s9 offen offset:2048 lds
    buffer_load_dwordx4 v19, s[48:51], s9 offen offset:3072 lds
    s_add_u32 m0, s10, 4096
    s_nop 0
    buffer_load_dwordx4 v20, s[48:51], s9 offen offset:0 lds
    buffer_load_dwordx4 v21, s[48:51], s9 offen offset:1024 lds
    buffer_load_dwordx4 v22, s[48:51], s9 offen offset:2048 lds
    buffer_load_dwordx4 v23, s[48:51], s9 offen offset:3072 lds
    s_add_u32 s52, s92, s6
    s_addc_u32 s53, s93, 0
    s_mov_b32 s54, s7
    s_mov_b32 s55, 0x20000
    s_add_u32 s56, s88, s6
    s_addc_u32 s57, s89, 0
    s_mov_b32 s58, s7
    s_mov_b32 s59, 0x20000
    s_lshl_b32 s7, s4, 20
    s_add_u32 s20, s14, s7
    s_addc_u32 s21, s15, 0
    s_mov_b32 s22, 1048576
    s_mov_b32 s23, 0x20000
    s_mov_b32 s62, 256
    s_mov_b32 s63, 0x20000
    v_add_u32 v3, 4096, v2
    v_mov_b32 v8, 1
    v_cmp_eq_u32 vcc, 0, v1
    v_mov_b32 v4, 0x80000000
    v_mov_b32 v5, 0
    v_cndmask_b32 v7, v4, v5, vcc
    s_lshl_b32 s34, s12, 14
    s_add_u32 s35, s34, 4096
    s_add_u32 s36, s34, 8192
    s_add_u32 s37, s34, 12288
    s_lshl_b32 s38, s12, 15
    s_and_b32 s6, s4, 3
    s_lshl_b32 s6, s6, 10
    s_add_u32 s38, s38, s6
    s_add_u32 s39, s38, 16384
    s_lshl_b32 s40, s13, 15
    s_and_b32 s6, s4, 3
    s_lshl_b32 s6, s6, 10
    s_add_u32 s40, s40, s6
    s_add_u32 s41, s40, 16384
    s_mul_i32 s8, s4, 7
    s_add_u32 s8, s8, s5
    s_lshl_b32 s8, s8, 2
    s_add_u32 s8, s8, s3
    s_sub_u32 s8, s8, 4
    s_cmp_eq_u32 s5, 0
    s_cselect_b32 s8, 1000, s8
    s_cmp_ge_u32 s8, 684
    s_cbranch_scc1 L_pw1
    s_mov_b32 s66, 4194304
    s_mov_b32 s77, 262144
    s_mov_b32 s43, 524288
    s_cmp_ge_u32 s8, 512
    s_cselect_b32 s64, s96, s94
    s_cselect_b32 s65, s97, s95
    s_cselect_b32 s66, 1409024, s66
    s_cselect_b32 s77, 2048, s77
    s_cselect_b32 s43, 176128, s43
    s_cselect_b32 s75, 4194304, 0
    s_cselect_b32 s73, 12, 11
    s_and_b32 s6, s8, 511
    s_lshr_b32 s72, s6, 2
    s_and_b32 s6, s6, 3
    s_lshl_b32 s7, s72, s73
    s_add_u32 s75, s75, s7
    s_mul_i32 s7, s6, s43
    s_lshl_b32 s7, s7, 1
    s_add_u32 s75, s75, s7
    s_lshl_b32 s72, s72, 15
    s_lshl_b32 s6, s6, 8
    s_add_u32 s72, s72, s6
    s_mov_b32 s73, 16384
    s_mov_b32 s74, 4096
    s_mov_b32 s76, 1024
    s_mov_b32 s78, 1024
    s_mov_b32 s79, 16
    s_mov_b32 s80, 8
    s_mov_b32 s70, 8388608
    s_branch L_pdone
L_pw1:
    s_mov_b32 s64, s82
    s_mov_b32 s65, s83
    s_cmp_ge_u32 s8, 860
    s_cselect_b32 s66, 0, 1409024
    s_cselect_b32 s70, 0, 8388608
    s_sub_u32 s6, s8, 684
    s_and_b32 s72, s6, 15
    s_lshr_b32 s6, s6, 4
    s_lshl_b32 s75, s6, 17
    s_lshl_b32 s7, s72, 10
    s_add_u32 s75, s75, s7
    s_add_u32 s75, s75, 6291456
    s_mul_i32 s72, s72, 88064
    s_lshl_b32 s6, s6, 8
    s_add_u32 s72, s72, s6
    s_mov_b32 s73, 11008
    s_mov_b32 s74, 22016
    s_mov_b32 s76, 16384
    s_mov_b32 s77, 32768
    s_mov_b32 s43, 65536
    s_mov_b32 s78, 2752
    s_mov_b32 s79, 8
    s_mov_b32 s80, 32
L_pdone:
    s_mov_b32 s67, 0x20000
    s_add_u32 s68, s14, 52428800
    s_addc_u32 s69, s15, 0
    s_mov_b32 s71, 0x20000
    v_lshrrev_b32 v4, 4, v1
    v_and_b32 v5, 15, v1
    v_lshlrev_b32 v5, 7, v5
    v_lshl_add_u32 v13, v4, 13, v5
    s_lshl_b32 s6, s3, 5
    s_add_u32 s6, s6, 65536
    v_lshrrev_b32 v4, 3, v1
    v_and_b32 v5, 7, v1
    v_lshlrev_b32 v5, 4, v5
    v_or_b32 v13, v13, v5
    v_xor_b32 v13, s6, v13
    s_add_u32 s6, s10, 65536
    v_lshlrev_b32 v14, 4, v4
    v_xor_b32 v14, v14, v2
    v_add_u32 v14, s6, v14
    v_lshl_add_u32 v15, v4, 8, v5
    s_lshr_b32 s81, s2, 1
    s_lshl_b32 s81, s81, 14
    s_and_b32 s6, s2, 1
    s_lshl_b32 s6, s6, 7
    s_add_u32 s81, s81, s6
    s_lshl_b32 s6, s3, 12
    s_add_u32 s81, s81, s6
    s_branch L_wuP1
L_wbP1:
    s_branch L_wuD1
L_wbD1:
    s_branch L_wuT
L_wbT:
    s_branch L_wuTE
L_wbTE:
    s_branch L_wuDM
L_wbDM:
    s_branch L_wuDMP
L_wbDMP:
    s_branch L_wuDM7
L_wbDM7:
    s_xor_b32 s28, s30, 0
    s_add_u32 m0, s29, 0
    s_nop 0
    buffer_load_dwordx4 v24, s[44:47], s28 offen offset:0 lds
    buffer_load_dwordx4 v25, s[44:47], s28 offen offset:1024 lds
    buffer_load_dwordx4 v26, s[44:47], s28 offen offset:2048 lds
    buffer_load_dwordx4 v27, s[44:47], s28 offen offset:3072 lds
    s_xor_b32 s28, s31, 0
    s_add_u32 m0, s29, 4096
    s_nop 0
    buffer_load_dwordx4 v24, s[44:47], s28 offen offset:0 lds
    buffer_load_dwordx4 v25, s[44:47], s28 offen offset:1024 lds
    buffer_load_dwordx4 v26, s[44:47], s28 offen offset:2048 lds
    buffer_load_dwordx4 v27, s[44:47], s28 offen offset:3072 lds
    s_xor_b32 s28, s32, 0
    s_add_u32 m0, s29, 8192
    s_nop 0
    buffer_load_dwordx4 v24, s[44:47], s28 offen offset:0 lds
    buffer_load_dwordx4 v25, s[44:47], s28 offen offset:1024 lds
    buffer_load_dwordx4 v26, s[44:47], s28 offen offset:2048 lds
    buffer_load_dwordx4 v27, s[44:47], s28 offen offset:3072 lds
    s_xor_b32 s28, s33, 0
    s_add_u32 m0, s29, 12288
    s_nop 0
    buffer_load_dwordx4 v24, s[44:47], s28 offen offset:0 lds
    buffer_load_dwordx4 v25, s[44:47], s28 offen offset:1024 lds
    buffer_load_dwordx4 v26, s[44:47], s28 offen offset:2048 lds
    buffer_load_dwordx4 v27, s[44:47], s28 offen offset:3072 lds
    buffer_load_dwordx4 v[192:195], v12, s[24:27], 0 offen offset:0
    buffer_load_dwordx4 v[196:199], v12, s[24:27], 0 offen offset:1024
    s_add_u32 s24, s14, 33554432
    s_addc_u32 s25, s15, 0
    s_mov_b32 s26, 2097152
    s_mov_b32 s27, 0x20000
    s_xor_b32 s9, s42, 1048576
    s_add_u32 m0, s10, 32768
    s_nop 0
    buffer_load_dwordx4 v16, s[48:51], s9 offen offset:0 lds
    buffer_load_dwordx4 v17, s[48:51], s9 offen offset:1024 lds
    s_waitcnt vmcnt(16)
    ds_read_b128 a[0:3], v28 offset:0
    ds_read_b128 a[16:19], v29 offset:0
    ds_read_b128 a[32:35], v30 offset:0
    ds_read_b128 a[48:51], v31 offset:0
    buffer_load_dwordx4 v18, s[48:51], s9 offen offset:2048 lds
    buffer_load_dwordx4 v19, s[48:51], s9 offen offset:3072 lds
    s_waitcnt vmcnt(14)
    ds_read_b128 a[4:7], v28 offset:4096
    ds_read_b128 a[20:23], v29 offset:4096
    ds_read_b128 a[36:39], v30 offset:4096
    ds_read_b128 a[52:55], v31 offset:4096
    s_add_u32 m0, s10, 36864
    s_nop 0
    buffer_load_dwordx4 v20, s[48:51], s9 offen offset:0 lds
    buffer_load_dwordx4 v21, s[48:51], s9 offen offset:1024 lds
    s_waitcnt vmcnt(12)
    ds_read_b128 a[8:11], v28 offset:8192
    ds_read_b128 a[24:27], v29 offset:8192
    ds_read_b128 a[40:43], v30 offset:8192
    ds_read_b128 a[56:59], v31 offset:8192
    buffer_load_dwordx4 v22, s[48:51], s9 offen offset:2048 lds
    buffer_load_dwordx4 v23, s[48:51], s9 offen offset:3072 lds
    s_waitcnt vmcnt(10) lgkmcnt(4)
    ds_read_b128 a[12:15], v28 offset:12288
    ds_read_b128 a[28:31], v29 offset:12288
    ds_read_b128 a[44:47], v30 offset:12288
    ds_read_b128 a[60:63], v31 offset:12288
    s_cmp_lg_u32 s11, 0
    s_cbranch_scc1 L_sg1
    buffer_atomic_add v8, v7, s[60:63], 0 offen
L_sg1:
    s_barrier
    s_waitcnt lgkmcnt(4)
    v_xor_b32 v10, 0, v11
    ds_read_b64_tr_b16 v[160:161], v10 offset:0
    ds_read_b64_tr_b16 v[162:163], v10 offset:1024
    ds_read_b64_tr_b16 v[164:165], v10 offset:8192
    ds_read_b64_tr_b16 v[166:167], v10 offset:9216
    ds_read_b64_tr_b16 v[168:169], v10 offset:16384
    ds_read_b64_tr_b16 v[170:171], v10 offset:17408
    ds_read_b64_tr_b16 v[172:173], v10 offset:24576
    ds_read_b64_tr_b16 v[174:175], v10 offset:25600
    s_lshr_b32 s8, s2, 4
    s_lshl_b32 s8, s8, 7
    s_add_u32 s8, s8, 40960
    s_lshl_b32 s6, s5, 1
    s_sub_u32 s6, 15, s6
    v_and_b32 v6, 1, v1
    v_mul_u32_u24 v6, s6, v6
    v_add_u32 v6, s5, v6
    v_mov_b32 v12, 0
    s_waitcnt lgkmcnt(0)
    v_xor_b32 v10, 32, v11
    s_xor_b32 s28, s30, 256
    s_add_u32 m0, s29, 0
    v_mfma_f32_16x16x32_bf16 v[32:35], v[160:163], a[0:3], 0
    ds_read_b64_tr_b16 v[176:177], v10 offset:0
    v_mfma_f32_16x16x32_bf16 v[32:35], v[164:167], a[16:19], v[32:35]
    buffer_load_dwordx4 v24, s[44:47], s28 offen offset:0 lds
    v_mfma_f32_16x16x32_bf16 v[32:35], v[168:171], a[32:35], v[32:35]
    ds_read_b64_tr_b16 v[178:179], v10 offset:1024
    v_mfma_f32_16x16x32_bf16 v[32:35], v[172:175], a[48:51], v[32:35]
    ds_read_b64_tr_b16 v[180:181], v10 offset:8192
    v_mfma_f32_16x16x32_bf16 v[36:39], v[160:163], a[4:7], 0
    ds_read_b64_tr_b16 v[182:183], v10 offset:9216
    v_mfma_f32_16x16x32_bf16 v[36:39], v[164:167], a[20:23], v[36:39]
    ds_read_b64_tr_b16 v[184:185], v10 offset:16384
    v_mfma_f32_16x16x32_bf16 v[36:39], v[168:171], a[36:39], v[36:39]
    buffer_load_dwordx4 v25, s[44:47], s28 offen offset:1024 lds
    v_mfma_f32_16x16x32_bf16 v[36:39], v[172:175], a[52:55], v[36:39]
    ds_read_b64_tr_b16 v[186:187], v10 offset:17408
    v_mfma_f32_16x16x32_bf16 v[40:43], v[160:163], a[8:11], 0
    ds_read_b64_tr_b16 v[188:189], v10 offset:24576
    v_mfma_f32_16x16x32_bf16 v[40:43], v[164:167], a[24:27], v[40:43]
    ds_read_b64_tr_b16 v[190:191], v10 offset:25600
    v_mfma_f32_16x16x32_bf16 v[40:43], v[168:171], a[40:43], v[40:43]
    buffer_load_dwordx4 v26, s[44:47], s28 offen offset:2048 lds
    v_mfma_f32_16x16x32_bf16 v[40:43], v[172:175], a[56:59], v[40:43]
    v_mfma_f32_16x16x32_bf16 v[44:47], v[160:163], a[12:15], 0
    v_mfma_f32_16x16x32_bf16 v[44:47], v[164:167], a[28:31], v[44:47]
    v_mfma_f32_16x16x32_bf16 v[44:47], v[168:171], a[44:47], v[44:47]
    v_mfma_f32_16x16x32_bf16 v[44:47], v[172:175], a[60:63], v[44:47]
    v_xor_b32 v10, 64, v11
    s_waitcnt lgkmcnt(0)
    v_mfma_f32_16x16x32_bf16 v[48:51], v[176:179], a[0:3], 0
    buffer_load_dwordx4 v27, s[44:47], s28 offen offset:3072 lds
    v_mfma_f32_16x16x32_bf16 v[48:51], v[180:183], a[16:19], v[48:51]
    ds_read_b64_tr_b16 v[160:161], v10 offset:0
    s_xor_b32 s28, s31, 256
    v_mfma_f32_16x16x32_bf16 v[48:51], v[184:187], a[32:35], v[48:51]
    ds_read_b64_tr_b16 v[162:163], v10 offset:1024
    s_add_u32 m0, s29, 4096
    v_mfma_f32_16x16x32_bf16 v[48:51], v[188:191], a[48:51], v[48:51]
    ds_read_b64_tr_b16 v[164:165], v10 offset:8192
    v_mfma_f32_16x16x32_bf16 v[52:55], v[176:179], a[4:7], 0
    buffer_load_dwordx4 v24, s[44:47], s28 offen offset:0 lds
    v_mfma_f32_16x16x32_bf16 v[52:55], v[180:183], a[20:23], v[52:55]
    ds_read_b64_tr_b16 v[166:167], v10 offset:9216
    v_mfma_f32_16x16x32_bf16 v[52:55], v[184:187], a[36:39], v[52:55]
    ds_read_b64_tr_b16 v[168:169], v10 offset:16384
    v_mfma_f32_16x16x32_bf16 v[52:55], v[188:191], a[52:55], v[52:55]
    ds_read_b64_tr_b16 v[170:171], v10 offset:17408
    v_mfma_f32_16x16x32_bf16 v[56:59], v[176:179], a[8:11], 0
    buffer_load_dwordx4 v25, s[44:47], s28 offen offset:1024 lds
    v_mfma_f32_16x16x32_bf16 v[56:59], v[180:183], a[24:27], v[56:59]
    ds_read_b64_tr_b16 v[172:173], v10 offset:24576
    v_mfma_f32_16x16x32_bf16 v[56:59], v[184:187], a[40:43], v[56:59]
    ds_read_b64_tr_b16 v[174:175], v10 offset:25600
    v_mfma_f32_16x16x32_bf16 v[56:59], v[188:191], a[56:59], v[56:59]
    v_mfma_f32_16x16x32_bf16 v[60:63], v[176:179], a[12:15], 0
    v_mfma_f32_16x16x32_bf16 v[60:63], v[180:183], a[28:31], v[60:63]
    buffer_load_dwordx4 v26, s[44:47], s28 offen offset:2048 lds
    v_mfma_f32_16x16x32_bf16 v[60:63], v[184:187], a[44:47], v[60:63]
    v_mfma_f32_16x16x32_bf16 v[60:63], v[188:191], a[60:63], v[60:63]
    v_xor_b32 v10, 96, v11
    s_waitcnt lgkmcnt(0)
    v_mfma_f32_16x16x32_bf16 v[64:67], v[160:163], a[0:3], 0
    ds_read_b64_tr_b16 v[176:177], v10 offset:0
    s_waitcnt vmcnt(15)
    v_lshlrev_b32 v200, 16, v192
    v_mfma_f32_16x16x32_bf16 v[64:67], v[164:167], a[16:19], v[64:67]
    buffer_load_dwordx4 v27, s[44:47], s28 offen offset:3072 lds
    v_and_b32 v201, 0xffff0000, v192
    v_lshlrev_b32 v202, 16, v193
    v_mfma_f32_16x16x32_bf16 v[64:67], v[168:171], a[32:35], v[64:67]
    ds_read_b64_tr_b16 v[178:179], v10 offset:1024
    s_xor_b32 s28, s32, 256
    v_and_b32 v203, 0xffff0000, v193
    v_lshlrev_b32 v204, 16, v194
    v_mfma_f32_16x16x32_bf16 v[64:67], v[172:175], a[48:51], v[64:67]
    ds_read_b64_tr_b16 v[180:181], v10 offset:8192
    s_add_u32 m0, s29, 8192
    v_and_b32 v205, 0xffff0000, v194
    v_lshlrev_b32 v206, 16, v195
    v_mfma_f32_16x16x32_bf16 v[68:71], v[160:163], a[4:7], 0
    ds_read_b64_tr_b16 v[182:183], v10 offset:9216
    v_and_b32 v207, 0xffff0000, v195
    v_add_f32 v216, v200, v201
    v_mfma_f32_16x16x32_bf16 v[68:71], v[164:167], a[20:23], v[68:71]
    ds_read_b64_tr_b16 v[184:185], v10 offset:16384
    v_add_f32 v216, v216, v202
    v_add_f32 v216, v216, v203
    v_mfma_f32_16x16x32_bf16 v[68:71], v[168:171], a[36:39], v[68:71]
    buffer_load_dwordx4 v24, s[44:47], s28 offen offset:0 lds
    v_add_f32 v216, v216, v204
    v_add_f32 v216, v216, v205
    v_mfma_f32_16x16x32_bf16 v[68:71], v[172:175], a[52:55], v[68:71]
    ds_read_b64_tr_b16 v[186:187], v10 offset:17408
    v_add_f32 v216, v216, v206
    v_mfma_f32_16x16x32_bf16 v[72:75], v[160:163], a[8:11], 0
    ds_read_b64_tr_b16 v[188:189], v10 offset:24576
    v_add_f32 v216, v216, v207
    v_lshlrev_b32 v208, 16, v196
    v_mfma_f32_16x16x32_bf16 v[72:75], v[164:167], a[24:27], v[72:75]
    ds_read_b64_tr_b16 v[190:191], v10 offset:25600
    v_and_b32 v209, 0xffff0000, v196
    v_lshlrev_b32 v210, 16, v197
    v_mfma_f32_16x16x32_bf16 v[72:75], v[168:171], a[40:43], v[72:75]
    buffer_load_dwordx4 v25, s[44:47], s28 offen offset:1024 lds
    v_and_b32 v211, 0xffff0000, v197
    v_lshlrev_b32 v212, 16, v198
    v_mfma_f32_16x16x32_bf16 v[72:75], v[172:175], a[56:59], v[72:75]
    v_and_b32 v213, 0xffff0000, v198
    v_lshlrev_b32 v214, 16, v199
    v_mfma_f32_16x16x32_bf16 v[76:79], v[160:163], a[12:15], 0
    v_and_b32 v215, 0xffff0000, v199
    v_add_f32 v217, v208, v209
    v_mfma_f32_16x16x32_bf16 v[76:79], v[164:167], a[28:31], v[76:79]
    v_add_f32 v217, v217, v210
    v_add_f32 v217, v217, v211
    v_mfma_f32_16x16x32_bf16 v[76:79], v[168:171], a[44:47], v[76:79]
    v_add_f32 v217, v217, v212
    v_mfma_f32_16x16x32_bf16 v[76:79], v[172:175], a[60:63], v[76:79]
    v_xor_b32 v10, 128, v11
    s_waitcnt lgkmcnt(0)
    v_mfma_f32_16x16x32_bf16 v[80:83], v[176:179], a[0:3], 0
    buffer_load_dwordx4 v26, s[44:47], s28 offen offset:2048 lds
    v_add_f32 v217, v217, v213
    v_add_f32 v217, v217, v214
    v_mfma_f32_16x16x32_bf16 v[80:83], v[180:183], a[16:19], v[80:83]
    ds_read_b64_tr_b16 v[160:161], v10 offset:0
    v_add_f32 v217, v217, v215
    v_add_f32_dpp v216, v216, v216 quad_perm:[1,0,3,2] row_mask:0xf bank_mask:0xf
    v_mfma_f32_16x16x32_bf16 v[80:83], v[184:187], a[32:35], v[80:83]
    ds_read_b64_tr_b16 v[162:163], v10 offset:1024
    v_add_f32_dpp v217, v217, v217 quad_perm:[1,0,3,2] row_mask:0xf bank_mask:0xf
    v_add_f32_dpp v216, v216, v216 quad_perm:[2,3,0,1] row_mask:0xf bank_mask:0xf
    v_mfma_f32_16x16x32_bf16 v[80:83], v[188:191], a[48:51], v[80:83]
    ds_read_b64_tr_b16 v[164:165], v10 offset:8192
    v_add_f32_dpp v217, v217, v217 quad_perm:[2,3,0,1] row_mask:0xf bank_mask:0xf
    v_add_f32_dpp v216, v216, v216 row_half_mirror row_mask:0xf bank_mask:0xf
    v_mfma_f32_16x16x32_bf16 v[84:87], v[176:179], a[4:7], 0
    buffer_load_dwordx4 v27, s[44:47], s28 offen offset:3072 lds
    v_add_f32_dpp v217, v217, v217 row_half_mirror row_mask:0xf bank_mask:0xf
    v_add_f32_dpp v216, v216, v216 row_mirror row_mask:0xf bank_mask:0xf
    v_mfma_f32_16x16x32_bf16 v[84:87], v[180:183], a[20:23], v[84:87]
    ds_read_b64_tr_b16 v[166:167], v10 offset:9216
    s_xor_b32 s28, s33, 256
    v_add_f32_dpp v217, v217, v217 row_mirror row_mask:0xf bank_mask:0xf
    v_mov_b32 v218, v216
    v_mfma_f32_16x16x32_bf16 v[84:87], v[184:187], a[36:39], v[84:87]
    ds_read_b64_tr_b16 v[168:169], v10 offset:16384
    s_add_u32 m0, s29, 12288
    v_mov_b32 v219, v217
    v_permlane16_swap_b32 v216, v218
    v_mfma_f32_16x16x32_bf16 v[84:87], v[188:191], a[52:55], v[84:87]
    ds_read_b64_tr_b16 v[170:171], v10 offset:17408
    v_permlane16_swap_b32 v217, v219
    v_mfma_f32_16x16x32_bf16 v[88:91], v[176:179], a[8:11], 0
    buffer_load_dwordx4 v24, s[44:47], s28 offen offset:0 lds
    v_add_f32 v216, v216, v218
    v_add_f32 v217, v217, v219
    v_mfma_f32_16x16x32_bf16 v[88:91], v[180:183], a[24:27], v[88:91]
    ds_read_b64_tr_b16 v[172:173], v10 offset:24576
    v_mov_b32 v218, v216
    v_mov_b32 v219, v217
    v_mfma_f32_16x16x32_bf16 v[88:91], v[184:187], a[40:43], v[88:91]
    ds_read_b64_tr_b16 v[174:175], v10 offset:25600
    v_permlane32_swap_b32 v216, v218
    v_permlane32_swap_b32 v217, v219
    v_mfma_f32_16x16x32_bf16 v[88:91], v[188:191], a[56:59], v[88:91]
    v_add_f32 v216, v216, v218
    v_add_f32 v217, v217, v219
    v_mfma_f32_16x16x32_bf16 v[92:95], v[176:179], a[12:15], 0
    v_mul_f32 v216, 0x3b000000, v216
    v_sub_f32 v200, v200, v216
    v_mfma_f32_16x16x32_bf16 v[92:95], v[180:183], a[28:31], v[92:95]
    buffer_load_dwordx4 v25, s[44:47], s28 offen offset:1024 lds
    v_sub_f32 v201, v201, v216
    v_sub_f32 v202, v202, v216
    v_mfma_f32_16x16x32_bf16 v[92:95], v[184:187], a[44:47], v[92:95]
    v_sub_f32 v203, v203, v216
    v_mfma_f32_16x16x32_bf16 v[92:95], v[188:191], a[60:63], v[92:95]
    v_xor_b32 v10, 160, v11
    s_waitcnt lgkmcnt(0)
    v_mfma_f32_16x16x32_bf16 v[96:99], v[160:163], a[0:3], 0
    ds_read_b64_tr_b16 v[176:177], v10 offset:0
    ds_read_b64_tr_b16 v[178:179], v10 offset:1024
    v_sub_f32 v204, v204, v216
    v_sub_f32 v205, v205, v216
    v_mfma_f32_16x16x32_bf16 v[96:99], v[164:167], a[16:19], v[96:99]
    buffer_load_dwordx4 v26, s[44:47], s28 offen offset:2048 lds
    v_sub_f32 v206, v206, v216
    v_sub_f32 v207, v207, v216
    v_mfma_f32_16x16x32_bf16 v[96:99], v[168:171], a[32:35], v[96:99]
    ds_read_b64_tr_b16 v[180:181], v10 offset:8192
    ds_read_b64_tr_b16 v[182:183], v10 offset:9216
    v_mul_f32 v216, v200, v200
    v_fmac_f32 v216, v201, v201
    v_mfma_f32_16x16x32_bf16 v[96:99], v[172:175], a[48:51], v[96:99]
    ds_read_b64_tr_b16 v[184:185], v10 offset:16384
    v_fmac_f32 v216, v202, v202
    v_fmac_f32 v216, v203, v203
    v_mfma_f32_16x16x32_bf16 v[100:103], v[160:163], a[4:7], 0
    ds_read_b64_tr_b16 v[186:187], v10 offset:17408
    v_fmac_f32 v216, v204, v204
    v_fmac_f32 v216, v205, v205
    v_mfma_f32_16x16x32_bf16 v[100:103], v[164:167], a[20:23], v[100:103]
    ds_read_b64_tr_b16 v[188:189], v10 offset:24576
    v_fmac_f32 v216, v206, v206
    v_fmac_f32 v216, v207, v207
    v_mfma_f32_16x16x32_bf16 v[100:103], v[168:171], a[36:39], v[100:103]
    buffer_load_dwordx4 v27, s[44:47], s28 offen offset:3072 lds
    v_mul_f32 v217, 0x3b000000, v217
    v_sub_f32 v208, v208, v217
    v_mfma_f32_16x16x32_bf16 v[100:103], v[172:175], a[52:55], v[100:103]
    ds_read_b64_tr_b16 v[190:191], v10 offset:25600
    s_waitcnt vmcnt(12)
    v_sub_f32 v209, v209, v217
    v_mfma_f32_16x16x32_bf16 v[104:107], v[160:163], a[8:11], 0
    ds_read_b128 a[64:67], v28 offset:0
    v_lshrrev_b32 v4, 1, v1
    v_sub_f32 v210, v210, v217
    v_sub_f32 v211, v211, v217
    v_mfma_f32_16x16x32_bf16 v[104:107], v[164:167], a[24:27], v[104:107]
    ds_read_b128 a[80:83], v29 offset:0
    v_and_b32 v5, 1, v1
    v_lshlrev_b32 v5, 7, v5
    v_lshl_add_u32 v5, v4, 13, v5
    v_and_b32 v4, 16, v4
    v_lshl_or_b32 v5, v4, 26, v5
    s_mul_i32 s11, s12, 131072
    s_add_u32 s11, s11, 0
    v_sub_f32 v212, v212, v217
    v_sub_f32 v213, v213, v217
    v_mfma_f32_16x16x32_bf16 v[104:107], v[168:171], a[40:43], v[104:107]
    buffer_load_dword v9, v5, s[52:55], s11 offen
    v_sub_f32 v214, v214, v217
    v_sub_f32 v215, v215, v217
    v_mfma_f32_16x16x32_bf16 v[104:107], v[172:175], a[56:59], v[104:107]
    ds_read_b128 a[96:99], v30 offset:0
    s_xor_b32 s28, s30, 512
    v_mul_f32 v217, v208, v208
    v_fmac_f32 v217, v209, v209
    v_mfma_f32_16x16x32_bf16 v[108:111], v[160:163], a[12:15], 0
    ds_read_b128 a[112:115], v31 offset:0
    s_add_u32 m0, s29, 0
    v_fmac_f32 v217, v210, v210
    v_fmac_f32 v217, v211, v211
    v_mfma_f32_16x16x32_bf16 v[108:111], v[164:167], a[28:31], v[108:111]
    v_fmac_f32 v217, v212, v212
    v_fmac_f32 v217, v213, v213
    v_mfma_f32_16x16x32_bf16 v[108:111], v[168:171], a[44:47], v[108:111]
    v_fmac_f32 v217, v214, v214
    v_mfma_f32_16x16x32_bf16 v[108:111], v[172:175], a[60:63], v[108:111]
    v_xor_b32 v10, 192, v11
    s_waitcnt lgkmcnt(0)
    v_mfma_f32_16x16x32_bf16 v[112:115], v[176:179], a[0:3], 0
    ds_read_b64_tr_b16 v[160:161], v10 offset:0
    ds_read_b64_tr_b16 v[162:163], v10 offset:1024
    v_fmac_f32 v217, v215, v215
    v_add_f32_dpp v216, v216, v216 quad_perm:[1,0,3,2] row_mask:0xf bank_mask:0xf
    v_mfma_f32_16x16x32_bf16 v[112:115], v[180:183], a[16:19], v[112:115]
    ds_read_b64_tr_b16 v[164:165], v10 offset:8192
    ds_read_b64_tr_b16 v[166:167], v10 offset:9216
    v_add_f32_dpp v217, v217, v217 quad_perm:[1,0,3,2] row_mask:0xf bank_mask:0xf
    v_add_f32_dpp v216, v216, v216 quad_perm:[2,3,0,1] row_mask:0xf bank_mask:0xf
    v_mfma_f32_16x16x32_bf16 v[112:115], v[184:187], a[32:35], v[112:115]
    buffer_load_dwordx4 v24, s[44:47], s28 offen offset:0 lds
    v_add_f32_dpp v217, v217, v217 quad_perm:[2,3,0,1] row_mask:0xf bank_mask:0xf
    v_add_f32_dpp v216, v216, v216 row_half_mirror row_mask:0xf bank_mask:0xf
    v_mfma_f32_16x16x32_bf16 v[112:115], v[188:191], a[48:51], v[112:115]
    ds_read_b64_tr_b16 v[168:169], v10 offset:16384
    v_add_f32_dpp v217, v217, v217 row_half_mirror row_mask:0xf bank_mask:0xf
    v_add_f32_dpp v216, v216, v216 row_mirror row_mask:0xf bank_mask:0xf
    v_mfma_f32_16x16x32_bf16 v[116:119], v[176:179], a[4:7], 0
    ds_read_b64_tr_b16 v[170:171], v10 offset:17408
    v_add_f32_dpp v217, v217, v217 row_mirror row_mask:0xf bank_mask:0xf
    v_mov_b32 v218, v216
    v_mfma_f32_16x16x32_bf16 v[116:119], v[180:183], a[20:23], v[116:119]
    ds_read_b64_tr_b16 v[172:173], v10 offset:24576
    v_mov_b32 v219, v217
    v_permlane16_swap_b32 v216, v218
    v_mfma_f32_16x16x32_bf16 v[116:119], v[184:187], a[36:39], v[116:119]
    ds_read_b64_tr_b16 v[174:175], v10 offset:25600
    s_waitcnt vmcnt(10)
    v_permlane16_swap_b32 v217, v219
    v_add_f32 v216, v216, v218
    v_mfma_f32_16x16x32_bf16 v[116:119], v[188:191], a[52:55], v[116:119]
    buffer_load_dwordx4 v25, s[44:47], s28 offen offset:1024 lds
    v_add_f32 v217, v217, v219
    v_mfma_f32_16x16x32_bf16 v[120:123], v[176:179], a[8:11], 0
    ds_read_b128 a[68:71], v28 offset:4096
    v_mov_b32 v218, v216
    v_mov_b32 v219, v217
    v_mfma_f32_16x16x32_bf16 v[120:123], v[180:183], a[24:27], v[120:123]
    ds_read_b128 a[84:87], v29 offset:4096
    v_permlane32_swap_b32 v216, v218
    v_permlane32_swap_b32 v217, v219
    v_mfma_f32_16x16x32_bf16 v[120:123], v[184:187], a[40:43], v[120:123]
    ds_read_b128 a[100:103], v30 offset:4096
    v_add_f32 v216, v216, v218
    v_add_f32 v217, v217, v219
    v_mfma_f32_16x16x32_bf16 v[120:123], v[188:191], a[56:59], v[120:123]
    buffer_load_dwordx4 v26, s[44:47], s28 offen offset:2048 lds
    v_mov_b32 v218, 0x3727c5ac
    v_fmac_f32 v218, 0x3b000000, v216
    v_mfma_f32_16x16x32_bf16 v[124:127], v[176:179], a[12:15], 0
    ds_read_b128 a[116:119], v31 offset:4096
    v_rsq_f32 v216, v218
    v_mov_b32 v219, 0x3727c5ac
    v_mfma_f32_16x16x32_bf16 v[124:127], v[180:183], a[28:31], v[124:127]
    v_fmac_f32 v219, 0x3b000000, v217
    v_rsq_f32 v217, v219
    v_mfma_f32_16x16x32_bf16 v[124:127], v[184:187], a[44:47], v[124:127]
    v_mul_f32 v216, 0x3e0293ee, v216
    v_mfma_f32_16x16x32_bf16 v[124:127], v[188:191], a[60:63], v[124:127]
    v_xor_b32 v10, 224, v11
    s_waitcnt lgkmcnt(0)
    v_mfma_f32_16x16x32_bf16 v[128:131], v[160:163], a[0:3], 0
    buffer_load_dwordx4 v27, s[44:47], s28 offen offset:3072 lds
    v_mul_f32 v200, v200, v216
    v_mul_f32 v201, v201, v216
    v_mfma_f32_16x16x32_bf16 v[128:131], v[164:167], a[16:19], v[128:131]
    ds_read_b64_tr_b16 v[176:177], v10 offset:0
    ds_read_b64_tr_b16 v[178:179], v10 offset:1024
    v_mul_f32 v202, v202, v216
    v_mul_f32 v203, v203, v216
    v_mfma_f32_16x16x32_bf16 v[128:131], v[168:171], a[32:35], v[128:131]
    ds_read_b64_tr_b16 v[180:181], v10 offset:8192
    ds_read_b64_tr_b16 v[182:183], v10 offset:9216
    v_mul_f32 v204, v204, v216
    v_mul_f32 v205, v205, v216
    v_mfma_f32_16x16x32_bf16 v[128:131], v[172:175], a[48:51], v[128:131]
    ds_read_b64_tr_b16 v[184:185], v10 offset:16384
    s_xor_b32 s28, s31, 512
    s_add_u32 m0, s29, 4096
    v_mul_f32 v206, v206, v216
    v_mul_f32 v207, v207, v216
    v_mfma_f32_16x16x32_bf16 v[132:135], v[160:163], a[4:7], 0
    buffer_load_dwordx4 v24, s[44:47], s28 offen offset:0 lds
    v_cvt_pk_bf16_f32 v192, v200, v201
    v_cvt_pk_bf16_f32 v193, v202, v203
    v_mfma_f32_16x16x32_bf16 v[132:135], v[164:167], a[20:23], v[132:135]
    ds_read_b64_tr_b16 v[186:187], v10 offset:17408
    v_cvt_pk_bf16_f32 v194, v204, v205
    v_cvt_pk_bf16_f32 v195, v206, v207
    v_mfma_f32_16x16x32_bf16 v[132:135], v[168:171], a[36:39], v[132:135]
    ds_read_b64_tr_b16 v[188:189], v10 offset:24576
    ds_write_b128 v13, v[192:195]
    v_mul_f32 v217, 0x3e0293ee, v217
    v_mfma_f32_16x16x32_bf16 v[132:135], v[172:175], a[52:55], v[132:135]
    ds_read_b64_tr_b16 v[190:191], v10 offset:25600
    s_waitcnt vmcnt(10)
    v_mul_f32 v208, v208, v217
    v_mfma_f32_16x16x32_bf16 v[136:139], v[160:163], a[8:11], 0
    ds_read_b128 a[72:75], v28 offset:8192
    v_mul_f32 v209, v209, v217
    v_mul_f32 v210, v210, v217
    v_mfma_f32_16x16x32_bf16 v[136:139], v[164:167], a[24:27], v[136:139]
    buffer_load_dwordx4 v25, s[44:47], s28 offen offset:1024 lds
    v_mul_f32 v211, v211, v217
    v_mul_f32 v212, v212, v217
    v_mfma_f32_16x16x32_bf16 v[136:139], v[168:171], a[40:43], v[136:139]
    ds_read_b128 a[88:91], v29 offset:8192
    v_mul_f32 v213, v213, v217
    v_mul_f32 v214, v214, v217
    v_mfma_f32_16x16x32_bf16 v[136:139], v[172:175], a[56:59], v[136:139]
    ds_read_b128 a[104:107], v30 offset:8192
    v_mul_f32 v215, v215, v217
    v_cvt_pk_bf16_f32 v196, v208, v209
    v_mfma_f32_16x16x32_bf16 v[140:143], v[160:163], a[12:15], 0
    ds_read_b128 a[120:123], v31 offset:8192
    v_cvt_pk_bf16_f32 v197, v210, v211
    v_cvt_pk_bf16_f32 v198, v212, v213
    v_mfma_f32_16x16x32_bf16 v[140:143], v[164:167], a[28:31], v[140:143]
    buffer_load_dwordx4 v26, s[44:47], s28 offen offset:2048 lds
    v_cvt_pk_bf16_f32 v199, v214, v215
    v_xor_b32 v13, 16, v13
    v_mfma_f32_16x16x32_bf16 v[140:143], v[168:171], a[44:47], v[140:143]
    ds_write_b128 v13, v[196:199]
    v_mfma_f32_16x16x32_bf16 v[140:143], v[172:175], a[60:63], v[140:143]
    v_xor_b32 v10, 32768, v11
    s_waitcnt lgkmcnt(0)
    s_nop 0
    s_barrier
    v_mfma_f32_16x16x32_bf16 v[144:147], v[176:179], a[0:3], 0
    ds_read_b64_tr_b16 v[160:161], v10 offset:0
    ds_read_b64_tr_b16 v[162:163], v10 offset:1024
    v_mfma_f32_16x16x32_bf16 v[144:147], v[180:183], a[16:19], v[144:147]
    ds_read_b64_tr_b16 v[164:165], v10 offset:8192
    ds_read_b64_tr_b16 v[166:167], v10 offset:9216
    v_mfma_f32_16x16x32_bf16 v[144:147], v[184:187], a[32:35], v[144:147]
    buffer_load_dwordx4 v27, s[44:47], s28 offen offset:3072 lds
    v_mfma_f32_16x16x32_bf16 v[144:147], v[188:191], a[48:51], v[144:147]
    ds_read_b64_tr_b16 v[168:169], v10 offset:16384
    s_xor_b32 s28, s32, 512
    v_mfma_f32_16x16x32_bf16 v[148:151], v[176:179], a[4:7], 0
    ds_read_b64_tr_b16 v[170:171], v10 offset:17408
    s_add_u32 m0, s29, 8192
    v_mfma_f32_16x16x32_bf16 v[148:151], v[180:183], a[20:23], v[148:151]
    ds_read_b64_tr_b16 v[172:173], v10 offset:24576
    v_mfma_f32_16x16x32_bf16 v[148:151], v[184:187], a[36:39], v[148:151]
    buffer_load_dwordx4 v24, s[44:47], s28 offen offset:0 lds
    v_mfma_f32_16x16x32_bf16 v[148:151], v[188:191], a[52:55], v[148:151]
    ds_read_b64_tr_b16 v[174:175], v10 offset:25600
    s_waitcnt vmcnt(10)
    v_mfma_f32_16x16x32_bf16 v[152:155], v[176:179], a[8:11], 0
    ds_read_b128 a[76:79], v28 offset:12288
    v_mfma_f32_16x16x32_bf16 v[152:155], v[180:183], a[24:27], v[152:155]
    ds_read_b128 a[92:95], v29 offset:12288
    v_mfma_f32_16x16x32_bf16 v[152:155], v[184:187], a[40:43], v[152:155]
    ds_read_b128 a[108:111], v30 offset:12288
    v_mfma_f32_16x16x32_bf16 v[152:155], v[188:191], a[56:59], v[152:155]
    buffer_load_dwordx4 v25, s[44:47], s28 offen offset:1024 lds
    v_mfma_f32_16x16x32_bf16 v[156:159], v[176:179], a[12:15], 0
    ds_read_b128 a[124:127], v31 offset:12288
    ds_read_b128 v[200:203], v14 offset:0
    v_mfma_f32_16x16x32_bf16 v[156:159], v[180:183], a[28:31], v[156:159]
    ds_read_b128 v[204:207], v14 offset:1024
    v_mfma_f32_16x16x32_bf16 v[156:159], v[184:187], a[44:47], v[156:159]
    v_mfma_f32_16x16x32_bf16 v[156:159], v[188:191], a[60:63], v[156:159]
    v_xor_b32 v10, 32800, v11
    s_waitcnt lgkmcnt(0)
    v_mfma_f32_16x16x32_bf16 v[32:35], v[160:163], a[64:67], v[32:35]
    buffer_load_dwordx4 v26, s[44:47], s28 offen offset:2048 lds
    v_mfma_f32_16x16x32_bf16 v[32:35], v[164:167], a[80:83], v[32:35]
    ds_read_b64_tr_b16 v[176:177], v10 offset:0
    v_lshlrev_b32 v14, 7, v6
    v_mfma_f32_16x16x32_bf16 v[32:35], v[168:171], a[96:99], v[32:35]
    ds_read_b64_tr_b16 v[178:179], v10 offset:1024
    v_add_u32 v14, 40960, v14
    v_mfma_f32_16x16x32_bf16 v[32:35], v[172:175], a[112:115], v[32:35]
    ds_read_b64_tr_b16 v[180:181], v10 offset:8192
    v_mfma_f32_16x16x32_bf16 v[36:39], v[160:163], a[68:71], v[36:39]
    buffer_load_dwordx4 v27, s[44:47], s28 offen offset:3072 lds
    v_mfma_f32_16x16x32_bf16 v[36:39], v[164:167], a[84:87], v[36:39]
    ds_read_b64_tr_b16 v[182:183], v10 offset:9216
    s_xor_b32 s9, s42, 2097152
    v_mfma_f32_16x16x32_bf16 v[36:39], v[168:171], a[100:103], v[36:39]
    ds_read_b64_tr_b16 v[184:185], v10 offset:16384
    s_add_u32 m0, s10, 65536
    v_mfma_f32_16x16x32_bf16 v[36:39], v[172:175], a[116:119], v[36:39]
    ds_read_b64_tr_b16 v[186:187], v10 offset:17408
    v_mfma_f32_16x16x32_bf16 v[40:43], v[160:163], a[72:75], v[40:43]
    buffer_load_dwordx4 v16, s[48:51], s9 offen offset:0 lds
    v_mfma_f32_16x16x32_bf16 v[40:43], v[164:167], a[88:91], v[40:43]
    ds_read_b64_tr_b16 v[188:189], v10 offset:24576
    v_mfma_f32_16x16x32_bf16 v[40:43], v[168:171], a[104:107], v[40:43]
    ds_read_b64_tr_b16 v[190:191], v10 offset:25600
    v_mfma_f32_16x16x32_bf16 v[40:43], v[172:175], a[120:123], v[40:43]
    v_mfma_f32_16x16x32_bf16 v[44:47], v[160:163], a[76:79], v[44:47]
    v_mfma_f32_16x16x32_bf16 v[44:47], v[164:167], a[92:95], v[44:47]
    buffer_load_dwordx4 v17, s[48:51], s9 offen offset:1024 lds
    v_mfma_f32_16x16x32_bf16 v[44:47], v[168:171], a[108:111], v[44:47]
    v_mfma_f32_16x16x32_bf16 v[44:47], v[172:175], a[124:127], v[44:47]
    v_xor_b32 v10, 32832, v11
    s_waitcnt lgkmcnt(0)
    v_mfma_f32_16x16x32_bf16 v[48:51], v[176:179], a[64:67], v[48:51]
    ds_read_b64_tr_b16 v[160:161], v10 offset:0
    v_mfma_f32_16x16x32_bf16 v[48:51], v[180:183], a[80:83], v[48:51]
    buffer_load_dwordx4 v18, s[48:51], s9 offen offset:2048 lds
    v_mfma_f32_16x16x32_bf16 v[48:51], v[184:187], a[96:99], v[48:51]
    ds_read_b64_tr_b16 v[162:163], v10 offset:1024
    v_mfma_f32_16x16x32_bf16 v[48:51], v[188:191], a[112:115], v[48:51]
    ds_read_b64_tr_b16 v[164:165], v10 offset:8192
    v_mfma_f32_16x16x32_bf16 v[52:55], v[176:179], a[68:71], v[52:55]
    ds_read_b64_tr_b16 v[166:167], v10 offset:9216
    v_mfma_f32_16x16x32_bf16 v[52:55], v[180:183], a[84:87], v[52:55]
    ds_read_b64_tr_b16 v[168:169], v10 offset:16384
    v_mfma_f32_16x16x32_bf16 v[52:55], v[184:187], a[100:103], v[52:55]
    buffer_load_dwordx4 v19, s[48:51], s9 offen offset:3072 lds
    v_mfma_f32_16x16x32_bf16 v[52:55], v[188:191], a[116:119], v[52:55]
    ds_read_b64_tr_b16 v[170:171], v10 offset:17408
    s_add_u32 m0, s10, 69632
    v_mfma_f32_16x16x32_bf16 v[56:59], v[176:179], a[72:75], v[56:59]
    ds_read_b64_tr_b16 v[172:173], v10 offset:24576
    v_mfma_f32_16x16x32_bf16 v[56:59], v[180:183], a[88:91], v[56:59]
    ds_read_b64_tr_b16 v[174:175], v10 offset:25600
    v_mfma_f32_16x16x32_bf16 v[56:59], v[184:187], a[104:107], v[56:59]
    buffer_load_dwordx4 v20, s[48:51], s9 offen offset:0 lds
    v_mfma_f32_16x16x32_bf16 v[56:59], v[188:191], a[120:123], v[56:59]
    v_mfma_f32_16x16x32_bf16 v[60:63], v[176:179], a[76:79], v[60:63]
    v_mfma_f32_16x16x32_bf16 v[60:63], v[180:183], a[92:95], v[60:63]
    v_mfma_f32_16x16x32_bf16 v[60:63], v[184:187], a[108:111], v[60:63]
    v_mfma_f32_16x16x32_bf16 v[60:63], v[188:191], a[124:127], v[60:63]
    v_xor_b32 v10, 32864, v11
    s_waitcnt lgkmcnt(0)
    v_mfma_f32_16x16x32_bf16 v[64:67], v[160:163], a[64:67], v[64:67]
    buffer_load_dwordx4 v21, s[48:51], s9 offen offset:1024 lds
    v_mfma_f32_16x16x32_bf16 v[64:67], v[164:167], a[80:83], v[64:67]
    ds_read_b64_tr_b16 v[176:177], v10 offset:0
    v_mfma_f32_16x16x32_bf16 v[64:67], v[168:171], a[96:99], v[64:67]
    ds_read_b64_tr_b16 v[178:179], v10 offset:1024
    v_mfma_f32_16x16x32_bf16 v[64:67], v[172:175], a[112:115], v[64:67]
    ds_read_b64_tr_b16 v[180:181], v10 offset:8192
    v_mfma_f32_16x16x32_bf16 v[68:71], v[160:163], a[68:71], v[68:71]
    buffer_load_dwordx4 v22, s[48:51], s9 offen offset:2048 lds
    v_mfma_f32_16x16x32_bf16 v[68:71], v[164:167], a[84:87], v[68:71]
    ds_read_b64_tr_b16 v[182:183], v10 offset:9216
    v_mfma_f32_16x16x32_bf16 v[68:71], v[168:171], a[100:103], v[68:71]
    ds_read_b64_tr_b16 v[184:185], v10 offset:16384
    v_mfma_f32_16x16x32_bf16 v[68:71], v[172:175], a[116:119], v[68:71]
    ds_read_b64_tr_b16 v[186:187], v10 offset:17408
    v_mfma_f32_16x16x32_bf16 v[72:75], v[160:163], a[72:75], v[72:75]
    buffer_load_dwordx4 v23, s[48:51], s9 offen offset:3072 lds
    v_mfma_f32_16x16x32_bf16 v[72:75], v[164:167], a[88:91], v[72:75]
    ds_read_b64_tr_b16 v[188:189], v10 offset:24576
    s_xor_b32 s28, s33, 512
    v_mfma_f32_16x16x32_bf16 v[72:75], v[168:171], a[104:107], v[72:75]
    ds_read_b64_tr_b16 v[190:191], v10 offset:25600
    s_add_u32 m0, s29, 12288
    v_mfma_f32_16x16x32_bf16 v[72:75], v[172:175], a[120:123], v[72:75]
    v_mfma_f32_16x16x32_bf16 v[76:79], v[160:163], a[76:79], v[76:79]
    v_mfma_f32_16x16x32_bf16 v[76:79], v[164:167], a[92:95], v[76:79]
    buffer_load_dwordx4 v24, s[44:47], s28 offen offset:0 lds
    v_mfma_f32_16x16x32_bf16 v[76:79], v[168:171], a[108:111], v[76:79]
    v_mfma_f32_16x16x32_bf16 v[76:79], v[172:175], a[124:127], v[76:79]
    v_xor_b32 v10, 32896, v11
    s_waitcnt lgkmcnt(0)
    v_mfma_f32_16x16x32_bf16 v[80:83], v[176:179], a[64:67], v[80:83]
    ds_read_b64_tr_b16 v[160:161], v10 offset:0
    v_mfma_f32_16x16x32_bf16 v[80:83], v[180:183], a[80:83], v[80:83]
    buffer_load_dwordx4 v25, s[44:47], s28 offen offset:1024 lds
    v_mfma_f32_16x16x32_bf16 v[80:83], v[184:187], a[96:99], v[80:83]
    ds_read_b64_tr_b16 v[162:163], v10 offset:1024
    v_mfma_f32_16x16x32_bf16 v[80:83], v[188:191], a[112:115], v[80:83]
    ds_read_b64_tr_b16 v[164:165], v10 offset:8192
    v_mfma_f32_16x16x32_bf16 v[84:87], v[176:179], a[68:71], v[84:87]
    ds_read_b64_tr_b16 v[166:167], v10 offset:9216
    v_mfma_f32_16x16x32_bf16 v[84:87], v[180:183], a[84:87], v[84:87]
    ds_read_b64_tr_b16 v[168:169], v10 offset:16384
    v_mfma_f32_16x16x32_bf16 v[84:87], v[184:187], a[100:103], v[84:87]
    buffer_load_dwordx4 v26, s[44:47], s28 offen offset:2048 lds
    v_mfma_f32_16x16x32_bf16 v[84:87], v[188:191], a[116:119], v[84:87]
    ds_read_b64_tr_b16 v[170:171], v10 offset:17408
    v_mfma_f32_16x16x32_bf16 v[88:91], v[176:179], a[72:75], v[88:91]
    ds_read_b64_tr_b16 v[172:173], v10 offset:24576
    v_mfma_f32_16x16x32_bf16 v[88:91], v[180:183], a[88:91], v[88:91]
    ds_read_b64_tr_b16 v[174:175], v10 offset:25600
    v_mfma_f32_16x16x32_bf16 v[88:91], v[184:187], a[104:107], v[88:91]
    buffer_load_dwordx4 v27, s[44:47], s28 offen offset:3072 lds
    v_mfma_f32_16x16x32_bf16 v[88:91], v[188:191], a[120:123], v[88:91]
    v_lshrrev_b32 v4, 1, v1
    v_and_b32 v5, 1, v1
    v_mfma_f32_16x16x32_bf16 v[92:95], v[176:179], a[76:79], v[92:95]
    v_lshlrev_b32 v5, 7, v5
    v_lshl_add_u32 v5, v4, 13, v5
    v_mfma_f32_16x16x32_bf16 v[92:95], v[180:183], a[92:95], v[92:95]
    v_and_b32 v4, 16, v4
    v_lshl_or_b32 v5, v4, 26, v5
    v_mfma_f32_16x16x32_bf16 v[92:95], v[184:187], a[108:111], v[92:95]
    s_mul_i32 s11, s12, 131072
    s_add_u32 s11, s11, 0
    v_mfma_f32_16x16x32_bf16 v[92:95], v[188:191], a[124:127], v[92:95]
    v_xor_b32 v10, 32928, v11
    s_waitcnt lgkmcnt(0)
    v_mfma_f32_16x16x32_bf16 v[96:99], v[160:163], a[64:67], v[96:99]
    buffer_load_dword v9, v5, s[56:59], s11 offen
    v_mfma_f32_16x16x32_bf16 v[96:99], v[164:167], a[80:83], v[96:99]
    ds_read_b64_tr_b16 v[176:177], v10 offset:0
    ds_read_b64_tr_b16 v[178:179], v10 offset:1024
    v_mfma_f32_16x16x32_bf16 v[96:99], v[168:171], a[96:99], v[96:99]
    ds_read_b64_tr_b16 v[180:181], v10 offset:8192
    ds_read_b64_tr_b16 v[182:183], v10 offset:9216
    v_mfma_f32_16x16x32_bf16 v[96:99], v[172:175], a[112:115], v[96:99]
    ds_read_b64_tr_b16 v[184:185], v10 offset:16384
    v_mfma_f32_16x16x32_bf16 v[100:103], v[160:163], a[68:71], v[100:103]
    ds_read_b64_tr_b16 v[186:187], v10 offset:17408
    v_mfma_f32_16x16x32_bf16 v[100:103], v[164:167], a[84:87], v[100:103]
    ds_read_b64_tr_b16 v[188:189], v10 offset:24576
    v_mfma_f32_16x16x32_bf16 v[100:103], v[168:171], a[100:103], v[100:103]
    ds_read_b64_tr_b16 v[190:191], v10 offset:25600
    s_waitcnt vmcnt(21)
    v_mfma_f32_16x16x32_bf16 v[100:103], v[172:175], a[116:119], v[100:103]
    buffer_store_dwordx4 v[200:203], v15, s[24:27], s81 offen offset:0 sc1
    v_mfma_f32_16x16x32_bf16 v[104:107], v[160:163], a[72:75], v[104:107]
    ds_read_b128 a[128:131], v28 offset:0
    s_xor_b32 s9, s42, 3145728
    v_mfma_f32_16x16x32_bf16 v[104:107], v[164:167], a[88:91], v[104:107]
    ds_read_b128 a[144:147], v29 offset:0
    s_add_u32 m0, s10, 0
    v_mfma_f32_16x16x32_bf16 v[104:107], v[168:171], a[104:107], v[104:107]
    ds_read_b128 a[160:163], v30 offset:0
    v_mfma_f32_16x16x32_bf16 v[104:107], v[172:175], a[120:123], v[104:107]
    ds_read_b128 a[176:179], v31 offset:0
    v_mfma_f32_16x16x32_bf16 v[108:111], v[160:163], a[76:79], v[108:111]
    v_mfma_f32_16x16x32_bf16 v[108:111], v[164:167], a[92:95], v[108:111]
    v_mfma_f32_16x16x32_bf16 v[108:111], v[168:171], a[108:111], v[108:111]
    v_mfma_f32_16x16x32_bf16 v[108:111], v[172:175], a[124:127], v[108:111]
    v_xor_b32 v10, 32960, v11
    s_waitcnt lgkmcnt(0)
    v_mfma_f32_16x16x32_bf16 v[112:115], v[176:179], a[64:67], v[112:115]
    ds_read_b64_tr_b16 v[160:161], v10 offset:0
    ds_read_b64_tr_b16 v[162:163], v10 offset:1024
    v_mfma_f32_16x16x32_bf16 v[112:115], v[180:183], a[80:83], v[112:115]
    ds_read_b64_tr_b16 v[164:165], v10 offset:8192
    ds_read_b64_tr_b16 v[166:167], v10 offset:9216
    v_mfma_f32_16x16x32_bf16 v[112:115], v[184:187], a[96:99], v[112:115]
    ds_read_b64_tr_b16 v[168:169], v10 offset:16384
    v_mfma_f32_16x16x32_bf16 v[112:115], v[188:191], a[112:115], v[112:115]
    buffer_load_dwordx4 v16, s[48:51], s9 offen offset:0 lds
    v_mfma_f32_16x16x32_bf16 v[116:119], v[176:179], a[68:71], v[116:119]
    ds_read_b64_tr_b16 v[170:171], v10 offset:17408
    v_mfma_f32_16x16x32_bf16 v[116:119], v[180:183], a[84:87], v[116:119]
    ds_read_b64_tr_b16 v[172:173], v10 offset:24576
    v_mfma_f32_16x16x32_bf16 v[116:119], v[184:187], a[100:103], v[116:119]
    ds_read_b64_tr_b16 v[174:175], v10 offset:25600
    s_waitcnt vmcnt(19)
    v_mfma_f32_16x16x32_bf16 v[116:119], v[188:191], a[116:119], v[116:119]
    buffer_store_dwordx4 v[204:207], v15, s[24:27], s81 offen offset:2048 sc1
    v_mfma_f32_16x16x32_bf16 v[120:123], v[176:179], a[72:75], v[120:123]
    ds_read_b128 a[132:135], v28 offset:4096
    v_mfma_f32_16x16x32_bf16 v[120:123], v[180:183], a[88:91], v[120:123]
    ds_read_b128 a[148:151], v29 offset:4096
    v_mfma_f32_16x16x32_bf16 v[120:123], v[184:187], a[104:107], v[120:123]
    ds_read_b128 a[164:167], v30 offset:4096
    v_mfma_f32_16x16x32_bf16 v[120:123], v[188:191], a[120:123], v[120:123]
    ds_read_b128 a[180:183], v31 offset:4096
    v_mfma_f32_16x16x32_bf16 v[124:127], v[176:179], a[76:79], v[124:127]
    v_mfma_f32_16x16x32_bf16 v[124:127], v[180:183], a[92:95], v[124:127]
    v_mfma_f32_16x16x32_bf16 v[124:127], v[184:187], a[108:111], v[124:127]
    v_mfma_f32_16x16x32_bf16 v[124:127], v[188:191], a[124:127], v[124:127]
    v_xor_b32 v10, 32992, v11
    s_waitcnt lgkmcnt(0)
    v_mfma_f32_16x16x32_bf16 v[128:131], v[160:163], a[64:67], v[128:131]
    ds_read_b64_tr_b16 v[176:177], v10 offset:0
    ds_read_b64_tr_b16 v[178:179], v10 offset:1024
    v_mfma_f32_16x16x32_bf16 v[128:131], v[164:167], a[80:83], v[128:131]
    ds_read_b64_tr_b16 v[180:181], v10 offset:8192
    ds_read_b64_tr_b16 v[182:183], v10 offset:9216
    v_mfma_f32_16x16x32_bf16 v[128:131], v[168:171], a[96:99], v[128:131]
    ds_read_b64_tr_b16 v[184:185], v10 offset:16384
    v_mfma_f32_16x16x32_bf16 v[128:131], v[172:175], a[112:115], v[128:131]
    buffer_load_dwordx4 v17, s[48:51], s9 offen offset:1024 lds
    v_mfma_f32_16x16x32_bf16 v[132:135], v[160:163], a[68:71], v[132:135]
    ds_read_b64_tr_b16 v[186:187], v10 offset:17408
    v_mfma_f32_16x16x32_bf16 v[132:135], v[164:167], a[84:87], v[132:135]
    ds_read_b64_tr_b16 v[188:189], v10 offset:24576
    v_mfma_f32_16x16x32_bf16 v[132:135], v[168:171], a[100:103], v[132:135]
    ds_read_b64_tr_b16 v[190:191], v10 offset:25600
    s_waitcnt vmcnt(17)
    v_mfma_f32_16x16x32_bf16 v[132:135], v[172:175], a[116:119], v[132:135]
    buffer_load_dwordx4 v18, s[48:51], s9 offen offset:2048 lds
    v_mfma_f32_16x16x32_bf16 v[136:139], v[160:163], a[72:75], v[136:139]
    ds_read_b128 a[136:139], v28 offset:8192
    v_mfma_f32_16x16x32_bf16 v[136:139], v[164:167], a[88:91], v[136:139]
    ds_read_b128 a[152:155], v29 offset:8192
    v_mfma_f32_16x16x32_bf16 v[136:139], v[168:171], a[104:107], v[136:139]
    ds_read_b128 a[168:171], v30 offset:8192
    v_mfma_f32_16x16x32_bf16 v[136:139], v[172:175], a[120:123], v[136:139]
    ds_read_b128 a[184:187], v31 offset:8192
    v_mfma_f32_16x16x32_bf16 v[140:143], v[160:163], a[76:79], v[140:143]
    buffer_load_dwordx4 v19, s[48:51], s9 offen offset:3072 lds
    v_mfma_f32_16x16x32_bf16 v[140:143], v[164:167], a[92:95], v[140:143]
    s_add_u32 m0, s10, 4096
    v_mfma_f32_16x16x32_bf16 v[140:143], v[168:171], a[108:111], v[140:143]
    v_mfma_f32_16x16x32_bf16 v[140:143], v[172:175], a[124:127], v[140:143]
    v_xor_b32 v10, 65536, v11
    s_waitcnt lgkmcnt(0)
    s_waitcnt vmcnt(11)
    s_barrier
    v_mfma_f32_16x16x32_bf16 v[144:147], v[176:179], a[64:67], v[144:147]
    buffer_load_dwordx4 v20, s[48:51], s9 offen offset:0 lds
    v_mfma_f32_16x16x32_bf16 v[144:147], v[180:183], a[80:83], v[144:147]
    ds_read_b64_tr_b16 v[160:161], v10 offset:0
    ds_read_b64_tr_b16 v[162:163], v10 offset:1024
    v_mfma_f32_16x16x32_bf16 v[144:147], v[184:187], a[96:99], v[144:147]
    ds_read_b64_tr_b16 v[164:165], v10 offset:8192
    ds_read_b64_tr_b16 v[166:167], v10 offset:9216
    v_mfma_f32_16x16x32_bf16 v[144:147], v[188:191], a[112:115], v[144:147]
    ds_read_b64_tr_b16 v[168:169], v10 offset:16384
    v_mfma_f32_16x16x32_bf16 v[148:151], v[176:179], a[68:71], v[148:151]
    ds_read_b64_tr_b16 v[170:171], v10 offset:17408
    v_mfma_f32_16x16x32_bf16 v[148:151], v[180:183], a[84:87], v[148:151]
    buffer_load_dwordx4 v21, s[48:51], s9 offen offset:1024 lds
    v_mfma_f32_16x16x32_bf16 v[148:151], v[184:187], a[100:103], v[148:151]
    ds_read_b64_tr_b16 v[172:173], v10 offset:24576
    v_mfma_f32_16x16x32_bf16 v[148:151], v[188:191], a[116:119], v[148:151]
    ds_read_b64_tr_b16 v[174:175], v10 offset:25600
    s_waitcnt vmcnt(9)
    v_mfma_f32_16x16x32_bf16 v[152:155], v[176:179], a[72:75], v[152:155]
    ds_read_b128 a[140:143], v28 offset:12288
    v_mfma_f32_16x16x32_bf16 v[152:155], v[180:183], a[88:91], v[152:155]
    buffer_load_dwordx4 v22, s[48:51], s9 offen offset:2048 lds
    v_mfma_f32_16x16x32_bf16 v[152:155], v[184:187], a[104:107], v[152:155]
    ds_read_b128 a[156:159], v29 offset:12288
    v_mfma_f32_16x16x32_bf16 v[152:155], v[188:191], a[120:123], v[152:155]
    ds_read_b128 a[172:175], v30 offset:12288
    v_mfma_f32_16x16x32_bf16 v[156:159], v[176:179], a[76:79], v[156:159]
    ds_read_b128 a[188:191], v31 offset:12288
    v_mfma_f32_16x16x32_bf16 v[156:159], v[180:183], a[92:95], v[156:159]
    v_mfma_f32_16x16x32_bf16 v[156:159], v[184:187], a[108:111], v[156:159]
    buffer_load_dwordx4 v23, s[48:51], s9 offen offset:3072 lds
    v_mfma_f32_16x16x32_bf16 v[156:159], v[188:191], a[124:127], v[156:159]
    v_xor_b32 v10, 65568, v11
    s_waitcnt lgkmcnt(0)
    v_mfma_f32_16x16x32_bf16 v[32:35], v[160:163], a[128:131], v[32:35]
    ds_read_b64_tr_b16 v[176:177], v10 offset:0
    v_mfma_f32_16x16x32_bf16 v[32:35], v[164:167], a[144:147], v[32:35]
    ds_read_b64_tr_b16 v[178:179], v10 offset:1024
    v_mfma_f32_16x16x32_bf16 v[32:35], v[168:171], a[160:163], v[32:35]
    buffer_load_dword v9, v12, s[60:63], 0 offen offset:0 sc1
    v_mfma_f32_16x16x32_bf16 v[32:35], v[172:175], a[176:179], v[32:35]
    ds_read_b64_tr_b16 v[180:181], v10 offset:8192
    s_xor_b32 s28, s30, 768
    s_add_u32 m0, s29, 0
    v_mfma_f32_16x16x32_bf16 v[36:39], v[160:163], a[132:135], v[36:39]
    buffer_load_dwordx4 v24, s[44:47], s28 offen offset:0 lds
    v_mfma_f32_16x16x32_bf16 v[36:39], v[164:167], a[148:151], v[36:39]
    ds_read_b64_tr_b16 v[182:183], v10 offset:9216
    v_mfma_f32_16x16x32_bf16 v[36:39], v[168:171], a[164:167], v[36:39]
    ds_read_b64_tr_b16 v[184:185], v10 offset:16384
    v_mfma_f32_16x16x32_bf16 v[36:39], v[172:175], a[180:183], v[36:39]
    ds_read_b64_tr_b16 v[186:187], v10 offset:17408
    v_mfma_f32_16x16x32_bf16 v[40:43], v[160:163], a[136:139], v[40:43]
    ds_read_b64_tr_b16 v[188:189], v10 offset:24576
    v_mfma_f32_16x16x32_bf16 v[40:43], v[164:167], a[152:155], v[40:43]
    buffer_load_dwordx4 v25, s[44:47], s28 offen offset:1024 lds
    v_mfma_f32_16x16x32_bf16 v[40:43], v[168:171], a[168:171], v[40:43]
    ds_read_b64_tr_b16 v[190:191], v10 offset:25600
    v_mfma_f32_16x16x32_bf16 v[40:43], v[172:175], a[184:187], v[40:43]
    v_mfma_f32_16x16x32_bf16 v[44:47], v[160:163], a[140:143], v[44:47]
    v_mfma_f32_16x16x32_bf16 v[44:47], v[164:167], a[156:159], v[44:47]
    buffer_load_dwordx4 v26, s[44:47], s28 offen offset:2048 lds
    v_mfma_f32_16x16x32_bf16 v[44:47], v[168:171], a[172:175], v[44:47]
    v_mfma_f32_16x16x32_bf16 v[44:47], v[172:175], a[188:191], v[44:47]
    v_xor_b32 v10, 65600, v11
    s_waitcnt lgkmcnt(0)
    v_mfma_f32_16x16x32_bf16 v[48:51], v[176:179], a[128:131], v[48:51]
    ds_read_b64_tr_b16 v[160:161], v10 offset:0
    v_mfma_f32_16x16x32_bf16 v[48:51], v[180:183], a[144:147], v[48:51]
    ds_read_b64_tr_b16 v[162:163], v10 offset:1024
    v_mfma_f32_16x16x32_bf16 v[48:51], v[184:187], a[160:163], v[48:51]
    buffer_load_dwordx4 v27, s[44:47], s28 offen offset:3072 lds
    v_mfma_f32_16x16x32_bf16 v[48:51], v[188:191], a[176:179], v[48:51]
    ds_read_b64_tr_b16 v[164:165], v10 offset:8192
    s_xor_b32 s28, s31, 768
    v_mfma_f32_16x16x32_bf16 v[52:55], v[176:179], a[132:135], v[52:55]
    ds_read_b64_tr_b16 v[166:167], v10 offset:9216
    s_add_u32 m0, s29, 4096
    v_mfma_f32_16x16x32_bf16 v[52:55], v[180:183], a[148:151], v[52:55]
    ds_read_b64_tr_b16 v[168:169], v10 offset:16384
    v_mfma_f32_16x16x32_bf16 v[52:55], v[184:187], a[164:167], v[52:55]
    buffer_load_dwordx4 v24, s[44:47], s28 offen offset:0 lds
    v_mfma_f32_16x16x32_bf16 v[52:55], v[188:191], a[180:183], v[52:55]
    ds_read_b64_tr_b16 v[170:171], v10 offset:17408
    v_mfma_f32_16x16x32_bf16 v[56:59], v[176:179], a[136:139], v[56:59]
    ds_read_b64_tr_b16 v[172:173], v10 offset:24576
    v_mfma_f32_16x16x32_bf16 v[56:59], v[180:183], a[152:155], v[56:59]
    ds_read_b64_tr_b16 v[174:175], v10 offset:25600
    v_mfma_f32_16x16x32_bf16 v[56:59], v[184:187], a[168:171], v[56:59]
    v_mfma_f32_16x16x32_bf16 v[56:59], v[188:191], a[184:187], v[56:59]
    buffer_load_dwordx4 v25, s[44:47], s28 offen offset:1024 lds
    v_mfma_f32_16x16x32_bf16 v[60:63], v[176:179], a[140:143], v[60:63]
    v_mfma_f32_16x16x32_bf16 v[60:63], v[180:183], a[156:159], v[60:63]
    v_mfma_f32_16x16x32_bf16 v[60:63], v[184:187], a[172:175], v[60:63]
    v_mfma_f32_16x16x32_bf16 v[60:63], v[188:191], a[188:191], v[60:63]
    v_xor_b32 v10, 65632, v11
    s_waitcnt lgkmcnt(0)
    v_mfma_f32_16x16x32_bf16 v[64:67], v[160:163], a[128:131], v[64:67]
    buffer_load_dwordx4 v26, s[44:47], s28 offen offset:2048 lds
    v_mfma_f32_16x16x32_bf16 v[64:67], v[164:167], a[144:147], v[64:67]
    ds_read_b64_tr_b16 v[176:177], v10 offset:0
    v_mfma_f32_16x16x32_bf16 v[64:67], v[168:171], a[160:163], v[64:67]
    ds_read_b64_tr_b16 v[178:179], v10 offset:1024
    v_mfma_f32_16x16x32_bf16 v[64:67], v[172:175], a[176:179], v[64:67]
    ds_read_b64_tr_b16 v[180:181], v10 offset:8192
    v_mfma_f32_16x16x32_bf16 v[68:71], v[160:163], a[132:135], v[68:71]
    buffer_load_dwordx4 v27, s[44:47], s28 offen offset:3072 lds
    v_mfma_f32_16x16x32_bf16 v[68:71], v[164:167], a[148:151], v[68:71]
    ds_read_b64_tr_b16 v[182:183], v10 offset:9216
    s_xor_b32 s28, s32, 768
    v_mfma_f32_16x16x32_bf16 v[68:71], v[168:171], a[164:167], v[68:71]
    ds_read_b64_tr_b16 v[184:185], v10 offset:16384
    s_add_u32 m0, s29, 8192
    v_mfma_f32_16x16x32_bf16 v[68:71], v[172:175], a[180:183], v[68:71]
    ds_read_b64_tr_b16 v[186:187], v10 offset:17408
    v_mfma_f32_16x16x32_bf16 v[72:75], v[160:163], a[136:139], v[72:75]
    buffer_load_dwordx4 v24, s[44:47], s28 offen offset:0 lds
    v_mfma_f32_16x16x32_bf16 v[72:75], v[164:167], a[152:155], v[72:75]
    ds_read_b64_tr_b16 v[188:189], v10 offset:24576
    v_mfma_f32_16x16x32_bf16 v[72:75], v[168:171], a[168:171], v[72:75]
    ds_read_b64_tr_b16 v[190:191], v10 offset:25600
    v_mfma_f32_16x16x32_bf16 v[72:75], v[172:175], a[184:187], v[72:75]
    v_mfma_f32_16x16x32_bf16 v[76:79], v[160:163], a[140:143], v[76:79]
    v_mfma_f32_16x16x32_bf16 v[76:79], v[164:167], a[156:159], v[76:79]
    buffer_load_dwordx4 v25, s[44:47], s28 offen offset:1024 lds
    v_mfma_f32_16x16x32_bf16 v[76:79], v[168:171], a[172:175], v[76:79]
    v_mfma_f32_16x16x32_bf16 v[76:79], v[172:175], a[188:191], v[76:79]
    v_xor_b32 v10, 65664, v11
    s_waitcnt lgkmcnt(0)
    v_mfma_f32_16x16x32_bf16 v[80:83], v[176:179], a[128:131], v[80:83]
    ds_read_b64_tr_b16 v[160:161], v10 offset:0
    v_mfma_f32_16x16x32_bf16 v[80:83], v[180:183], a[144:147], v[80:83]
    buffer_load_dwordx4 v26, s[44:47], s28 offen offset:2048 lds
    v_mfma_f32_16x16x32_bf16 v[80:83], v[184:187], a[160:163], v[80:83]
    ds_read_b64_tr_b16 v[162:163], v10 offset:1024
    v_mfma_f32_16x16x32_bf16 v[80:83], v[188:191], a[176:179], v[80:83]
    ds_read_b64_tr_b16 v[164:165], v10 offset:8192
    v_mfma_f32_16x16x32_bf16 v[84:87], v[176:179], a[132:135], v[84:87]
    ds_read_b64_tr_b16 v[166:167], v10 offset:9216
    v_mfma_f32_16x16x32_bf16 v[84:87], v[180:183], a[148:151], v[84:87]
    ds_read_b64_tr_b16 v[168:169], v10 offset:16384
    v_mfma_f32_16x16x32_bf16 v[84:87], v[184:187], a[164:167], v[84:87]
    buffer_load_dwordx4 v27, s[44:47], s28 offen offset:3072 lds
    v_mfma_f32_16x16x32_bf16 v[84:87], v[188:191], a[180:183], v[84:87]
    ds_read_b64_tr_b16 v[170:171], v10 offset:17408
    s_xor_b32 s28, s33, 768
    v_mfma_f32_16x16x32_bf16 v[88:91], v[176:179], a[136:139], v[88:91]
    ds_read_b64_tr_b16 v[172:173], v10 offset:24576
    s_add_u32 m0, s29, 12288
    v_mfma_f32_16x16x32_bf16 v[88:91], v[180:183], a[152:155], v[88:91]
    ds_read_b64_tr_b16 v[174:175], v10 offset:25600
    v_mfma_f32_16x16x32_bf16 v[88:91], v[184:187], a[168:171], v[88:91]
    buffer_load_dwordx4 v24, s[44:47], s28 offen offset:0 lds
    v_mfma_f32_16x16x32_bf16 v[88:91], v[188:191], a[184:187], v[88:91]
    v_mfma_f32_16x16x32_bf16 v[92:95], v[176:179], a[140:143], v[92:95]
    v_mfma_f32_16x16x32_bf16 v[92:95], v[180:183], a[156:159], v[92:95]
    v_mfma_f32_16x16x32_bf16 v[92:95], v[184:187], a[172:175], v[92:95]
    v_mfma_f32_16x16x32_bf16 v[92:95], v[188:191], a[188:191], v[92:95]
    v_xor_b32 v10, 65696, v11
    s_waitcnt lgkmcnt(0)
    v_mfma_f32_16x16x32_bf16 v[96:99], v[160:163], a[128:131], v[96:99]
    buffer_load_dwordx4 v25, s[44:47], s28 offen offset:1024 lds
    v_mfma_f32_16x16x32_bf16 v[96:99], v[164:167], a[144:147], v[96:99]
    ds_read_b64_tr_b16 v[176:177], v10 offset:0
    ds_read_b64_tr_b16 v[178:179], v10 offset:1024
    v_mfma_f32_16x16x32_bf16 v[96:99], v[168:171], a[160:163], v[96:99]
    ds_read_b64_tr_b16 v[180:181], v10 offset:8192
    ds_read_b64_tr_b16 v[182:183], v10 offset:9216
    v_mfma_f32_16x16x32_bf16 v[96:99], v[172:175], a[176:179], v[96:99]
    ds_read_b64_tr_b16 v[184:185], v10 offset:16384
    v_mfma_f32_16x16x32_bf16 v[100:103], v[160:163], a[132:135], v[100:103]
    buffer_load_dwordx4 v26, s[44:47], s28 offen offset:2048 lds
    v_mfma_f32_16x16x32_bf16 v[100:103], v[164:167], a[148:151], v[100:103]
    ds_read_b64_tr_b16 v[186:187], v10 offset:17408
    v_mfma_f32_16x16x32_bf16 v[100:103], v[168:171], a[164:167], v[100:103]
    ds_read_b64_tr_b16 v[188:189], v10 offset:24576
    v_mfma_f32_16x16x32_bf16 v[100:103], v[172:175], a[180:183], v[100:103]
    ds_read_b64_tr_b16 v[190:191], v10 offset:25600
    s_waitcnt vmcnt(11)
    v_mfma_f32_16x16x32_bf16 v[104:107], v[160:163], a[136:139], v[104:107]
    buffer_load_dwordx4 v27, s[44:47], s28 offen offset:3072 lds
    v_mfma_f32_16x16x32_bf16 v[104:107], v[164:167], a[152:155], v[104:107]
    ds_read_b128 a[192:195], v28 offset:0
    s_xor_b32 s9, s42, 0
    v_mfma_f32_16x16x32_bf16 v[104:107], v[168:171], a[168:171], v[104:107]
    ds_read_b128 a[208:211], v29 offset:0
    s_add_u32 m0, s10, 32768
    v_mfma_f32_16x16x32_bf16 v[104:107], v[172:175], a[184:187], v[104:107]
    ds_read_b128 a[224:227], v30 offset:0
    v_mfma_f32_16x16x32_bf16 v[108:111], v[160:163], a[140:143], v[108:111]
    ds_read_b128 a[240:243], v31 offset:0
    v_mfma_f32_16x16x32_bf16 v[108:111], v[164:167], a[156:159], v[108:111]
    buffer_load_dwordx4 v16, s[52:55], s9 offen offset:0 lds
    v_mfma_f32_16x16x32_bf16 v[108:111], v[168:171], a[172:175], v[108:111]
    v_mfma_f32_16x16x32_bf16 v[108:111], v[172:175], a[188:191], v[108:111]
    v_xor_b32 v10, 65728, v11
    s_waitcnt lgkmcnt(0)
    v_mfma_f32_16x16x32_bf16 v[112:115], v[176:179], a[128:131], v[112:115]
    ds_read_b64_tr_b16 v[160:161], v10 offset:0
    ds_read_b64_tr_b16 v[162:163], v10 offset:1024
    v_mfma_f32_16x16x32_bf16 v[112:115], v[180:183], a[144:147], v[112:115]
    buffer_load_dwordx4 v17, s[52:55], s9 offen offset:1024 lds
    v_mfma_f32_16x16x32_bf16 v[112:115], v[184:187], a[160:163], v[112:115]
    ds_read_b64_tr_b16 v[164:165], v10 offset:8192
    ds_read_b64_tr_b16 v[166:167], v10 offset:9216
    v_mfma_f32_16x16x32_bf16 v[112:115], v[188:191], a[176:179], v[112:115]
    ds_read_b64_tr_b16 v[168:169], v10 offset:16384
    v_mfma_f32_16x16x32_bf16 v[116:119], v[176:179], a[132:135], v[116:119]
    ds_read_b64_tr_b16 v[170:171], v10 offset:17408
    v_mfma_f32_16x16x32_bf16 v[116:119], v[180:183], a[148:151], v[116:119]
    ds_read_b64_tr_b16 v[172:173], v10 offset:24576
    v_mfma_f32_16x16x32_bf16 v[116:119], v[184:187], a[164:167], v[116:119]
    buffer_load_dwordx4 v18, s[52:55], s9 offen offset:2048 lds
    v_mfma_f32_16x16x32_bf16 v[116:119], v[188:191], a[180:183], v[116:119]
    ds_read_b64_tr_b16 v[174:175], v10 offset:25600
    s_waitcnt vmcnt(11)
    v_mfma_f32_16x16x32_bf16 v[120:123], v[176:179], a[136:139], v[120:123]
    ds_read_b128 a[196:199], v28 offset:4096
    v_mfma_f32_16x16x32_bf16 v[120:123], v[180:183], a[152:155], v[120:123]
    ds_read_b128 a[212:215], v29 offset:4096
    v_mfma_f32_16x16x32_bf16 v[120:123], v[184:187], a[168:171], v[120:123]
    buffer_load_dwordx4 v19, s[52:55], s9 offen offset:3072 lds
    v_mfma_f32_16x16x32_bf16 v[120:123], v[188:191], a[184:187], v[120:123]
    ds_read_b128 a[228:231], v30 offset:4096
    s_add_u32 m0, s10, 36864
    v_mfma_f32_16x16x32_bf16 v[124:127], v[176:179], a[140:143], v[124:127]
    ds_read_b128 a[244:247], v31 offset:4096
    v_mfma_f32_16x16x32_bf16 v[124:127], v[180:183], a[156:159], v[124:127]
    v_mfma_f32_16x16x32_bf16 v[124:127], v[184:187], a[172:175], v[124:127]
    v_mfma_f32_16x16x32_bf16 v[124:127], v[188:191], a[188:191], v[124:127]
    v_xor_b32 v10, 65760, v11
    s_waitcnt lgkmcnt(0)
    v_mfma_f32_16x16x32_bf16 v[128:131], v[160:163], a[128:131], v[128:131]
    buffer_load_dwordx4 v20, s[52:55], s9 offen offset:0 lds
    v_mfma_f32_16x16x32_bf16 v[128:131], v[164:167], a[144:147], v[128:131]
    ds_read_b64_tr_b16 v[176:177], v10 offset:0
    ds_read_b64_tr_b16 v[178:179], v10 offset:1024
    v_mfma_f32_16x16x32_bf16 v[128:131], v[168:171], a[160:163], v[128:131]
    ds_read_b64_tr_b16 v[180:181], v10 offset:8192
    ds_read_b64_tr_b16 v[182:183], v10 offset:9216
    v_mfma_f32_16x16x32_bf16 v[128:131], v[172:175], a[176:179], v[128:131]
    ds_read_b64_tr_b16 v[184:185], v10 offset:16384
    v_mfma_f32_16x16x32_bf16 v[132:135], v[160:163], a[132:135], v[132:135]
    buffer_load_dwordx4 v21, s[52:55], s9 offen offset:1024 lds
    v_mfma_f32_16x16x32_bf16 v[132:135], v[164:167], a[148:151], v[132:135]
    ds_read_b64_tr_b16 v[186:187], v10 offset:17408
    v_mfma_f32_16x16x32_bf16 v[132:135], v[168:171], a[164:167], v[132:135]
    ds_read_b64_tr_b16 v[188:189], v10 offset:24576
    v_mfma_f32_16x16x32_bf16 v[132:135], v[172:175], a[180:183], v[132:135]
    ds_read_b64_tr_b16 v[190:191], v10 offset:25600
    s_waitcnt vmcnt(10)
    v_mfma_f32_16x16x32_bf16 v[136:139], v[160:163], a[136:139], v[136:139]
    buffer_load_dwordx4 v22, s[52:55], s9 offen offset:2048 lds
    v_mfma_f32_16x16x32_bf16 v[136:139], v[164:167], a[152:155], v[136:139]
    ds_read_b128 a[200:203], v28 offset:8192
    v_mfma_f32_16x16x32_bf16 v[136:139], v[168:171], a[168:171], v[136:139]
    ds_read_b128 a[216:219], v29 offset:8192
    v_mfma_f32_16x16x32_bf16 v[136:139], v[172:175], a[184:187], v[136:139]
    ds_read_b128 a[232:235], v30 offset:8192
    v_mfma_f32_16x16x32_bf16 v[140:143], v[160:163], a[140:143], v[140:143]
    ds_read_b128 a[248:251], v31 offset:8192
    v_mfma_f32_16x16x32_bf16 v[140:143], v[164:167], a[156:159], v[140:143]
    buffer_load_dwordx4 v23, s[52:55], s9 offen offset:3072 lds
    v_mfma_f32_16x16x32_bf16 v[140:143], v[168:171], a[172:175], v[140:143]
    s_xor_b32 s9, s42, 1048576
    s_add_u32 m0, s10, 65536
    v_mfma_f32_16x16x32_bf16 v[140:143], v[172:175], a[188:191], v[140:143]
    v_xor_b32 v10, 0, v11
    s_waitcnt lgkmcnt(0)
    s_nop 0
    s_barrier
    v_mfma_f32_16x16x32_bf16 v[144:147], v[176:179], a[128:131], v[144:147]
    ds_read_b64_tr_b16 v[160:161], v10 offset:0
    ds_read_b64_tr_b16 v[162:163], v10 offset:1024
    v_mfma_f32_16x16x32_bf16 v[144:147], v[180:183], a[144:147], v[144:147]
    buffer_load_dwordx4 v16, s[52:55], s9 offen offset:0 lds
    v_mfma_f32_16x16x32_bf16 v[144:147], v[184:187], a[160:163], v[144:147]
    ds_read_b64_tr_b16 v[164:165], v10 offset:8192
    ds_read_b64_tr_b16 v[166:167], v10 offset:9216
    v_mfma_f32_16x16x32_bf16 v[144:147], v[188:191], a[176:179], v[144:147]
    ds_read_b64_tr_b16 v[168:169], v10 offset:16384
    s_nop 0
    v_mfma_f32_16x16x32_bf16 v[148:151], v[176:179], a[132:135], v[148:151]
    ds_read_b64_tr_b16 v[170:171], v10 offset:17408
    v_cmp_gt_u32 vcc, 44, v9
    v_mfma_f32_16x16x32_bf16 v[148:151], v[180:183], a[148:151], v[148:151]
    ds_read_b64_tr_b16 v[172:173], v10 offset:24576
    s_nop 0
    v_mfma_f32_16x16x32_bf16 v[148:151], v[184:187], a[164:167], v[148:151]
    buffer_load_dwordx4 v17, s[52:55], s9 offen offset:1024 lds
    v_mfma_f32_16x16x32_bf16 v[148:151], v[188:191], a[180:183], v[148:151]
    ds_read_b64_tr_b16 v[174:175], v10 offset:25600
    s_waitcnt vmcnt(10)
    v_mfma_f32_16x16x32_bf16 v[152:155], v[176:179], a[136:139], v[152:155]
    ds_read_b128 a[204:207], v28 offset:12288
    s_cbranch_vccnz L_spinpz
L_backpz:
    v_mfma_f32_16x16x32_bf16 v[152:155], v[180:183], a[152:155], v[152:155]
    ds_read_b128 a[220:223], v29 offset:12288
    s_cmp_lg_u32 s3, 0
    s_cbranch_scc1 L_sg3
    buffer_atomic_add v8, v7, s[16:19], s8 offen
L_sg3:
    v_mfma_f32_16x16x32_bf16 v[152:155], v[184:187], a[168:171], v[152:155]
    buffer_load_dwordx4 v18, s[52:55], s9 offen offset:2048 lds
    v_mfma_f32_16x16x32_bf16 v[152:155], v[188:191], a[184:187], v[152:155]
    ds_read_b128 a[236:239], v30 offset:12288
    v_mfma_f32_16x16x32_bf16 v[156:159], v[176:179], a[140:143], v[156:159]
    ds_read_b128 a[252:255], v31 offset:12288
    v_mfma_f32_16x16x32_bf16 v[156:159], v[180:183], a[156:159], v[156:159]
    v_mfma_f32_16x16x32_bf16 v[156:159], v[184:187], a[172:175], v[156:159]
    v_mfma_f32_16x16x32_bf16 v[156:159], v[188:191], a[188:191], v[156:159]
    v_xor_b32 v10, 32, v11
    s_waitcnt lgkmcnt(0)
    v_mfma_f32_16x16x32_bf16 v[32:35], v[160:163], a[192:195], v[32:35]
    buffer_load_dwordx4 v19, s[52:55], s9 offen offset:3072 lds
    v_mfma_f32_16x16x32_bf16 v[32:35], v[164:167], a[208:211], v[32:35]
    ds_read_b64_tr_b16 v[176:177], v10 offset:0
    s_add_u32 m0, s10, 69632
    v_mfma_f32_16x16x32_bf16 v[32:35], v[168:171], a[224:227], v[32:35]
    ds_read_b64_tr_b16 v[178:179], v10 offset:1024
    v_mfma_f32_16x16x32_bf16 v[32:35], v[172:175], a[240:243], v[32:35]
    ds_read_b64_tr_b16 v[180:181], v10 offset:8192
    v_mfma_f32_16x16x32_bf16 v[36:39], v[160:163], a[196:199], v[36:39]
    buffer_load_dwordx4 v20, s[52:55], s9 offen offset:0 lds
    v_mfma_f32_16x16x32_bf16 v[36:39], v[164:167], a[212:215], v[36:39]
    ds_read_b64_tr_b16 v[182:183], v10 offset:9216
    v_mfma_f32_16x16x32_bf16 v[36:39], v[168:171], a[228:231], v[36:39]
    ds_read_b64_tr_b16 v[184:185], v10 offset:16384
    v_mfma_f32_16x16x32_bf16 v[36:39], v[172:175], a[244:247], v[36:39]
    ds_read_b64_tr_b16 v[186:187], v10 offset:17408
    v_mfma_f32_16x16x32_bf16 v[40:43], v[160:163], a[200:203], v[40:43]
    buffer_load_dwordx4 v21, s[52:55], s9 offen offset:1024 lds
    v_mfma_f32_16x16x32_bf16 v[40:43], v[164:167], a[216:219], v[40:43]
    ds_read_b64_tr_b16 v[188:189], v10 offset:24576
    v_mfma_f32_16x16x32_bf16 v[40:43], v[168:171], a[232:235], v[40:43]
    ds_read_b64_tr_b16 v[190:191], v10 offset:25600
    v_mfma_f32_16x16x32_bf16 v[40:43], v[172:175], a[248:251], v[40:43]
    v_mfma_f32_16x16x32_bf16 v[44:47], v[160:163], a[204:207], v[44:47]
    v_mfma_f32_16x16x32_bf16 v[44:47], v[164:167], a[220:223], v[44:47]
    buffer_load_dwordx4 v22, s[52:55], s9 offen offset:2048 lds
    v_mfma_f32_16x16x32_bf16 v[44:47], v[168:171], a[236:239], v[44:47]
    v_mfma_f32_16x16x32_bf16 v[44:47], v[172:175], a[252:255], v[44:47]
    v_xor_b32 v10, 64, v11
    s_waitcnt lgkmcnt(0)
    v_mfma_f32_16x16x32_bf16 v[48:51], v[176:179], a[192:195], v[48:51]
    ds_read_b64_tr_b16 v[160:161], v10 offset:0
    v_mfma_f32_16x16x32_bf16 v[48:51], v[180:183], a[208:211], v[48:51]
    buffer_load_dwordx4 v23, s[52:55], s9 offen offset:3072 lds
    v_mfma_f32_16x16x32_bf16 v[48:51], v[184:187], a[224:227], v[48:51]
    ds_read_b64_tr_b16 v[162:163], v10 offset:1024
    v_mfma_f32_16x16x32_bf16 v[48:51], v[188:191], a[240:243], v[48:51]
    ds_read_b64_tr_b16 v[164:165], v10 offset:8192
    v_mfma_f32_16x16x32_bf16 v[52:55], v[176:179], a[196:199], v[52:55]
    ds_read_b64_tr_b16 v[166:167], v10 offset:9216
    v_mfma_f32_16x16x32_bf16 v[52:55], v[180:183], a[212:215], v[52:55]
    ds_read_b64_tr_b16 v[168:169], v10 offset:16384
    v_mfma_f32_16x16x32_bf16 v[52:55], v[184:187], a[228:231], v[52:55]
    ds_read_b64_tr_b16 v[170:171], v10 offset:17408
    v_mfma_f32_16x16x32_bf16 v[52:55], v[188:191], a[244:247], v[52:55]
    ds_read_b64_tr_b16 v[172:173], v10 offset:24576
    v_mfma_f32_16x16x32_bf16 v[56:59], v[176:179], a[200:203], v[56:59]
    ds_read_b64_tr_b16 v[174:175], v10 offset:25600
    v_mfma_f32_16x16x32_bf16 v[56:59], v[180:183], a[216:219], v[56:59]
    v_mfma_f32_16x16x32_bf16 v[56:59], v[184:187], a[232:235], v[56:59]
    v_mfma_f32_16x16x32_bf16 v[56:59], v[188:191], a[248:251], v[56:59]
    v_mfma_f32_16x16x32_bf16 v[60:63], v[176:179], a[204:207], v[60:63]
    v_mfma_f32_16x16x32_bf16 v[60:63], v[180:183], a[220:223], v[60:63]
    v_mfma_f32_16x16x32_bf16 v[60:63], v[184:187], a[236:239], v[60:63]
    v_mfma_f32_16x16x32_bf16 v[60:63], v[188:191], a[252:255], v[60:63]
    v_xor_b32 v10, 96, v11
    s_waitcnt lgkmcnt(0)
    v_mfma_f32_16x16x32_bf16 v[64:67], v[160:163], a[192:195], v[64:67]
    ds_read_b64_tr_b16 v[176:177], v10 offset:0
    v_mfma_f32_16x16x32_bf16 v[64:67], v[164:167], a[208:211], v[64:67]
    ds_read_b64_tr_b16 v[178:179], v10 offset:1024
    v_cvt_pk_bf16_f32 v192, v32, v33
    v_mfma_f32_16x16x32_bf16 v[64:67], v[168:171], a[224:227], v[64:67]
    ds_read_b64_tr_b16 v[180:181], v10 offset:8192
    v_cvt_pk_bf16_f32 v193, v34, v35
    v_mfma_f32_16x16x32_bf16 v[64:67], v[172:175], a[240:243], v[64:67]
    ds_read_b64_tr_b16 v[182:183], v10 offset:9216
    v_cvt_pk_bf16_f32 v194, v48, v49
    v_mfma_f32_16x16x32_bf16 v[68:71], v[160:163], a[196:199], v[68:71]
    ds_read_b64_tr_b16 v[184:185], v10 offset:16384
    v_cvt_pk_bf16_f32 v195, v50, v51
    v_mfma_f32_16x16x32_bf16 v[68:71], v[164:167], a[212:215], v[68:71]
    ds_read_b64_tr_b16 v[186:187], v10 offset:17408
    v_cvt_pk_bf16_f32 v196, v36, v37
    v_mfma_f32_16x16x32_bf16 v[68:71], v[168:171], a[228:231], v[68:71]
    ds_read_b64_tr_b16 v[188:189], v10 offset:24576
    v_cvt_pk_bf16_f32 v197, v38, v39
    v_mfma_f32_16x16x32_bf16 v[68:71], v[172:175], a[244:247], v[68:71]
    ds_read_b64_tr_b16 v[190:191], v10 offset:25600
    v_cvt_pk_bf16_f32 v198, v52, v53
    v_mfma_f32_16x16x32_bf16 v[72:75], v[160:163], a[200:203], v[72:75]
    v_cvt_pk_bf16_f32 v199, v54, v55
    v_cvt_pk_bf16_f32 v200, v40, v41
    v_mfma_f32_16x16x32_bf16 v[72:75], v[164:167], a[216:219], v[72:75]
    v_cvt_pk_bf16_f32 v201, v42, v43
    v_cvt_pk_bf16_f32 v202, v56, v57
    v_mfma_f32_16x16x32_bf16 v[72:75], v[168:171], a[232:235], v[72:75]
    v_cvt_pk_bf16_f32 v203, v58, v59
    v_cvt_pk_bf16_f32 v204, v44, v45
    v_mfma_f32_16x16x32_bf16 v[72:75], v[172:175], a[248:251], v[72:75]
    v_cvt_pk_bf16_f32 v205, v46, v47
    v_cvt_pk_bf16_f32 v206, v60, v61
    v_mfma_f32_16x16x32_bf16 v[76:79], v[160:163], a[204:207], v[76:79]
    v_cvt_pk_bf16_f32 v207, v62, v63
    v_mfma_f32_16x16x32_bf16 v[76:79], v[164:167], a[220:223], v[76:79]
    v_mfma_f32_16x16x32_bf16 v[76:79], v[168:171], a[236:239], v[76:79]
    v_mfma_f32_16x16x32_bf16 v[76:79], v[172:175], a[252:255], v[76:79]
    v_xor_b32 v10, 128, v11
    s_waitcnt lgkmcnt(0)
    v_mfma_f32_16x16x32_bf16 v[80:83], v[176:179], a[192:195], v[80:83]
    ds_read_b64_tr_b16 v[160:161], v10 offset:0
    v_mfma_f32_16x16x32_bf16 v[80:83], v[180:183], a[208:211], v[80:83]
    ds_read_b64_tr_b16 v[162:163], v10 offset:1024
    v_mfma_f32_16x16x32_bf16 v[80:83], v[184:187], a[224:227], v[80:83]
    ds_read_b64_tr_b16 v[164:165], v10 offset:8192
    v_mfma_f32_16x16x32_bf16 v[80:83], v[188:191], a[240:243], v[80:83]
    ds_read_b64_tr_b16 v[166:167], v10 offset:9216
    v_mfma_f32_16x16x32_bf16 v[84:87], v[176:179], a[196:199], v[84:87]
    buffer_store_dwordx4 v[192:195], v2, s[20:23], s34 offen offset:0 sc1
    v_mfma_f32_16x16x32_bf16 v[84:87], v[180:183], a[212:215], v[84:87]
    ds_read_b64_tr_b16 v[168:169], v10 offset:16384
    v_mfma_f32_16x16x32_bf16 v[84:87], v[184:187], a[228:231], v[84:87]
    ds_read_b64_tr_b16 v[170:171], v10 offset:17408
    v_mfma_f32_16x16x32_bf16 v[84:87], v[188:191], a[244:247], v[84:87]
    ds_read_b64_tr_b16 v[172:173], v10 offset:24576
    v_mfma_f32_16x16x32_bf16 v[88:91], v[176:179], a[200:203], v[88:91]
    ds_read_b64_tr_b16 v[174:175], v10 offset:25600
    v_mfma_f32_16x16x32_bf16 v[88:91], v[180:183], a[216:219], v[88:91]
    v_mfma_f32_16x16x32_bf16 v[88:91], v[184:187], a[232:235], v[88:91]
    v_mfma_f32_16x16x32_bf16 v[88:91], v[188:191], a[248:251], v[88:91]
    v_mfma_f32_16x16x32_bf16 v[92:95], v[176:179], a[204:207], v[92:95]
    v_mfma_f32_16x16x32_bf16 v[92:95], v[180:183], a[220:223], v[92:95]
    v_mfma_f32_16x16x32_bf16 v[92:95], v[184:187], a[236:239], v[92:95]
    v_mfma_f32_16x16x32_bf16 v[92:95], v[188:191], a[252:255], v[92:95]
    v_xor_b32 v10, 160, v11
    s_waitcnt lgkmcnt(0)
    v_mfma_f32_16x16x32_bf16 v[96:99], v[160:163], a[192:195], v[96:99]
    ds_read_b64_tr_b16 v[176:177], v10 offset:0
    v_mfma_f32_16x16x32_bf16 v[96:99], v[164:167], a[208:211], v[96:99]
    ds_read_b64_tr_b16 v[178:179], v10 offset:1024
    v_cvt_pk_bf16_f32 v208, v64, v65
    v_mfma_f32_16x16x32_bf16 v[96:99], v[168:171], a[224:227], v[96:99]
    buffer_store_dwordx4 v[196:199], v2, s[20:23], s35 offen offset:0 sc1
    v_mfma_f32_16x16x32_bf16 v[96:99], v[172:175], a[240:243], v[96:99]
    ds_read_b64_tr_b16 v[180:181], v10 offset:8192
    v_cvt_pk_bf16_f32 v209, v66, v67
    v_mfma_f32_16x16x32_bf16 v[100:103], v[160:163], a[196:199], v[100:103]
    ds_read_b64_tr_b16 v[182:183], v10 offset:9216
    v_cvt_pk_bf16_f32 v210, v80, v81
    v_mfma_f32_16x16x32_bf16 v[100:103], v[164:167], a[212:215], v[100:103]
    ds_read_b64_tr_b16 v[184:185], v10 offset:16384
    v_cvt_pk_bf16_f32 v211, v82, v83
    v_mfma_f32_16x16x32_bf16 v[100:103], v[168:171], a[228:231], v[100:103]
    ds_read_b64_tr_b16 v[186:187], v10 offset:17408
    v_cvt_pk_bf16_f32 v212, v68, v69
    v_mfma_f32_16x16x32_bf16 v[100:103], v[172:175], a[244:247], v[100:103]
    ds_read_b64_tr_b16 v[188:189], v10 offset:24576
    v_cvt_pk_bf16_f32 v213, v70, v71
    v_mfma_f32_16x16x32_bf16 v[104:107], v[160:163], a[200:203], v[104:107]
    ds_read_b64_tr_b16 v[190:191], v10 offset:25600
    v_cvt_pk_bf16_f32 v214, v84, v85
    v_mfma_f32_16x16x32_bf16 v[104:107], v[164:167], a[216:219], v[104:107]
    v_cvt_pk_bf16_f32 v215, v86, v87
    v_cvt_pk_bf16_f32 v216, v72, v73
    v_mfma_f32_16x16x32_bf16 v[104:107], v[168:171], a[232:235], v[104:107]
    v_cvt_pk_bf16_f32 v217, v74, v75
    v_cvt_pk_bf16_f32 v218, v88, v89
    v_mfma_f32_16x16x32_bf16 v[104:107], v[172:175], a[248:251], v[104:107]
    v_cvt_pk_bf16_f32 v219, v90, v91
    v_cvt_pk_bf16_f32 v220, v76, v77
    v_mfma_f32_16x16x32_bf16 v[108:111], v[160:163], a[204:207], v[108:111]
    v_cvt_pk_bf16_f32 v221, v78, v79
    v_cvt_pk_bf16_f32 v222, v92, v93
    v_mfma_f32_16x16x32_bf16 v[108:111], v[164:167], a[220:223], v[108:111]
    v_cvt_pk_bf16_f32 v223, v94, v95
    v_mfma_f32_16x16x32_bf16 v[108:111], v[168:171], a[236:239], v[108:111]
    v_mfma_f32_16x16x32_bf16 v[108:111], v[172:175], a[252:255], v[108:111]
    v_xor_b32 v10, 192, v11
    s_waitcnt lgkmcnt(0)
    v_mfma_f32_16x16x32_bf16 v[112:115], v[176:179], a[192:195], v[112:115]
    buffer_store_dwordx4 v[200:203], v2, s[20:23], s36 offen offset:0 sc1
    v_mfma_f32_16x16x32_bf16 v[112:115], v[180:183], a[208:211], v[112:115]
    ds_read_b64_tr_b16 v[160:161], v10 offset:0
    v_mfma_f32_16x16x32_bf16 v[112:115], v[184:187], a[224:227], v[112:115]
    ds_read_b64_tr_b16 v[162:163], v10 offset:1024
    v_mfma_f32_16x16x32_bf16 v[112:115], v[188:191], a[240:243], v[112:115]
    ds_read_b64_tr_b16 v[164:165], v10 offset:8192
    v_mfma_f32_16x16x32_bf16 v[116:119], v[176:179], a[196:199], v[116:119]
    ds_read_b64_tr_b16 v[166:167], v10 offset:9216
    v_mfma_f32_16x16x32_bf16 v[116:119], v[180:183], a[212:215], v[116:119]
    ds_read_b64_tr_b16 v[168:169], v10 offset:16384
    v_mfma_f32_16x16x32_bf16 v[116:119], v[184:187], a[228:231], v[116:119]
    ds_read_b64_tr_b16 v[170:171], v10 offset:17408
    v_mfma_f32_16x16x32_bf16 v[116:119], v[188:191], a[244:247], v[116:119]
    ds_read_b64_tr_b16 v[172:173], v10 offset:24576
    v_mfma_f32_16x16x32_bf16 v[120:123], v[176:179], a[200:203], v[120:123]
    ds_read_b64_tr_b16 v[174:175], v10 offset:25600
    v_mfma_f32_16x16x32_bf16 v[120:123], v[180:183], a[216:219], v[120:123]
    v_mfma_f32_16x16x32_bf16 v[120:123], v[184:187], a[232:235], v[120:123]
    v_mfma_f32_16x16x32_bf16 v[120:123], v[188:191], a[248:251], v[120:123]
    v_mfma_f32_16x16x32_bf16 v[124:127], v[176:179], a[204:207], v[124:127]
    v_mfma_f32_16x16x32_bf16 v[124:127], v[180:183], a[220:223], v[124:127]
    v_mfma_f32_16x16x32_bf16 v[124:127], v[184:187], a[236:239], v[124:127]
    buffer_store_dwordx4 v[204:207], v2, s[20:23], s37 offen offset:0 sc1
    v_mfma_f32_16x16x32_bf16 v[124:127], v[188:191], a[252:255], v[124:127]
    v_xor_b32 v10, 224, v11
    s_waitcnt lgkmcnt(0)
    v_mfma_f32_16x16x32_bf16 v[128:131], v[160:163], a[192:195], v[128:131]
    ds_read_b64_tr_b16 v[176:177], v10 offset:0
    v_mfma_f32_16x16x32_bf16 v[128:131], v[164:167], a[208:211], v[128:131]
    ds_read_b64_tr_b16 v[178:179], v10 offset:1024
    v_cvt_pk_bf16_f32 v224, v96, v97
    v_mfma_f32_16x16x32_bf16 v[128:131], v[168:171], a[224:227], v[128:131]
    ds_read_b64_tr_b16 v[180:181], v10 offset:8192
    v_cvt_pk_bf16_f32 v225, v98, v99
    v_mfma_f32_16x16x32_bf16 v[128:131], v[172:175], a[240:243], v[128:131]
    ds_read_b64_tr_b16 v[182:183], v10 offset:9216
    v_cvt_pk_bf16_f32 v226, v112, v113
    v_mfma_f32_16x16x32_bf16 v[132:135], v[160:163], a[196:199], v[132:135]
    ds_read_b64_tr_b16 v[184:185], v10 offset:16384
    v_cvt_pk_bf16_f32 v227, v114, v115
    v_mfma_f32_16x16x32_bf16 v[132:135], v[164:167], a[212:215], v[132:135]
    ds_read_b64_tr_b16 v[186:187], v10 offset:17408
    v_cvt_pk_bf16_f32 v228, v100, v101
    v_mfma_f32_16x16x32_bf16 v[132:135], v[168:171], a[228:231], v[132:135]
    ds_read_b64_tr_b16 v[188:189], v10 offset:24576
    v_cvt_pk_bf16_f32 v229, v102, v103
    v_mfma_f32_16x16x32_bf16 v[132:135], v[172:175], a[244:247], v[132:135]
    ds_read_b64_tr_b16 v[190:191], v10 offset:25600
    v_cvt_pk_bf16_f32 v230, v116, v117
    v_mfma_f32_16x16x32_bf16 v[136:139], v[160:163], a[200:203], v[136:139]
    v_cvt_pk_bf16_f32 v231, v118, v119
    v_cvt_pk_bf16_f32 v232, v104, v105
    v_mfma_f32_16x16x32_bf16 v[136:139], v[164:167], a[216:219], v[136:139]
    v_cvt_pk_bf16_f32 v233, v106, v107
    v_cvt_pk_bf16_f32 v234, v120, v121
    v_mfma_f32_16x16x32_bf16 v[136:139], v[168:171], a[232:235], v[136:139]
    v_cvt_pk_bf16_f32 v235, v122, v123
    v_cvt_pk_bf16_f32 v236, v108, v109
    v_mfma_f32_16x16x32_bf16 v[136:139], v[172:175], a[248:251], v[136:139]
    v_cvt_pk_bf16_f32 v237, v110, v111
    v_cvt_pk_bf16_f32 v238, v124, v125
    v_mfma_f32_16x16x32_bf16 v[140:143], v[160:163], a[204:207], v[140:143]
    buffer_store_dwordx4 v[208:211], v2, s[20:23], s34 offen offset:1024 sc1
    v_mfma_f32_16x16x32_bf16 v[140:143], v[164:167], a[220:223], v[140:143]
    s_xor_b32 s9, s42, 2097152
    s_add_u32 m0, s10, 98304
    v_mfma_f32_16x16x32_bf16 v[140:143], v[168:171], a[236:239], v[140:143]
    v_cvt_pk_bf16_f32 v239, v126, v127
    v_mfma_f32_16x16x32_bf16 v[140:143], v[172:175], a[252:255], v[140:143]
    v_xor_b32 v10, 32768, v11
    s_waitcnt lgkmcnt(0)
    s_waitcnt vmcnt(13)
    s_barrier
    v_mfma_f32_16x16x32_bf16 v[144:147], v[176:179], a[192:195], v[144:147]
    ds_read_b64_tr_b16 v[160:161], v10 offset:0
    v_mfma_f32_16x16x32_bf16 v[144:147], v[180:183], a[208:211], v[144:147]
    ds_read_b64_tr_b16 v[162:163], v10 offset:1024
    v_mfma_f32_16x16x32_bf16 v[144:147], v[184:187], a[224:227], v[144:147]
    ds_read_b64_tr_b16 v[164:165], v10 offset:8192
    v_mfma_f32_16x16x32_bf16 v[144:147], v[188:191], a[240:243], v[144:147]
    ds_read_b64_tr_b16 v[166:167], v10 offset:9216
    v_mfma_f32_16x16x32_bf16 v[148:151], v[176:179], a[196:199], v[148:151]
    ds_read_b64_tr_b16 v[168:169], v10 offset:16384
    v_mfma_f32_16x16x32_bf16 v[148:151], v[180:183], a[212:215], v[148:151]
    ds_read_b64_tr_b16 v[170:171], v10 offset:17408
    v_mfma_f32_16x16x32_bf16 v[148:151], v[184:187], a[228:231], v[148:151]
    ds_read_b64_tr_b16 v[172:173], v10 offset:24576
    v_mfma_f32_16x16x32_bf16 v[148:151], v[188:191], a[244:247], v[148:151]
    ds_read_b64_tr_b16 v[174:175], v10 offset:25600
    v_mfma_f32_16x16x32_bf16 v[152:155], v[176:179], a[200:203], v[152:155]
    buffer_load_dwordx4 v16, s[52:55], s9 offen offset:0 lds
    v_mfma_f32_16x16x32_bf16 v[152:155], v[180:183], a[216:219], v[152:155]
    v_mfma_f32_16x16x32_bf16 v[152:155], v[184:187], a[232:235], v[152:155]
    v_mfma_f32_16x16x32_bf16 v[152:155], v[188:191], a[248:251], v[152:155]
    v_mfma_f32_16x16x32_bf16 v[156:159], v[176:179], a[204:207], v[156:159]
    buffer_store_dwordx4 v[212:215], v2, s[20:23], s35 offen offset:1024 sc1
    v_mfma_f32_16x16x32_bf16 v[156:159], v[180:183], a[220:223], v[156:159]
    v_mfma_f32_16x16x32_bf16 v[156:159], v[184:187], a[236:239], v[156:159]
    v_mfma_f32_16x16x32_bf16 v[156:159], v[188:191], a[252:255], v[156:159]
    v_xor_b32 v10, 32800, v11
    s_waitcnt lgkmcnt(0)
    v_mfma_f32_16x16x32_bf16 v[32:35], a[0:3], v[160:163], 0
    ds_read_b64_tr_b16 v[176:177], v10 offset:0
    v_mfma_f32_16x16x32_bf16 v[32:35], a[16:19], v[164:167], v[32:35]
    ds_read_b64_tr_b16 v[178:179], v10 offset:1024
    v_cvt_pk_bf16_f32 v240, v128, v129
    v_mfma_f32_16x16x32_bf16 v[32:35], a[32:35], v[168:171], v[32:35]
    ds_read_b64_tr_b16 v[180:181], v10 offset:8192
    v_cvt_pk_bf16_f32 v241, v130, v131
    v_mfma_f32_16x16x32_bf16 v[32:35], a[48:51], v[172:175], v[32:35]
    ds_read_b64_tr_b16 v[182:183], v10 offset:9216
    v_cvt_pk_bf16_f32 v242, v144, v145
    v_mfma_f32_16x16x32_bf16 v[36:39], a[4:7], v[160:163], 0
    ds_read_b64_tr_b16 v[184:185], v10 offset:16384
    v_cvt_pk_bf16_f32 v243, v146, v147
    v_mfma_f32_16x16x32_bf16 v[36:39], a[20:23], v[164:167], v[36:39]
    ds_read_b64_tr_b16 v[186:187], v10 offset:17408
    v_cvt_pk_bf16_f32 v244, v132, v133
    v_mfma_f32_16x16x32_bf16 v[36:39], a[36:39], v[168:171], v[36:39]
    ds_read_b64_tr_b16 v[188:189], v10 offset:24576
    v_cvt_pk_bf16_f32 v245, v134, v135
    v_mfma_f32_16x16x32_bf16 v[36:39], a[52:55], v[172:175], v[36:39]
    ds_read_b64_tr_b16 v[190:191], v10 offset:25600
    v_cvt_pk_bf16_f32 v246, v148, v149
    v_mfma_f32_16x16x32_bf16 v[40:43], a[8:11], v[160:163], 0
    buffer_load_dwordx4 v17, s[52:55], s9 offen offset:1024 lds
    v_mfma_f32_16x16x32_bf16 v[40:43], a[24:27], v[164:167], v[40:43]
    v_cvt_pk_bf16_f32 v247, v150, v151
    v_cvt_pk_bf16_f32 v248, v136, v137
    v_mfma_f32_16x16x32_bf16 v[40:43], a[40:43], v[168:171], v[40:43]
    v_cvt_pk_bf16_f32 v249, v138, v139
    v_cvt_pk_bf16_f32 v250, v152, v153
    v_mfma_f32_16x16x32_bf16 v[40:43], a[56:59], v[172:175], v[40:43]
    v_cvt_pk_bf16_f32 v251, v154, v155
    v_cvt_pk_bf16_f32 v252, v140, v141
    v_mfma_f32_16x16x32_bf16 v[44:47], a[12:15], v[160:163], 0
    buffer_store_dwordx4 v[216:219], v2, s[20:23], s36 offen offset:1024 sc1
    v_mfma_f32_16x16x32_bf16 v[44:47], a[28:31], v[164:167], v[44:47]
    v_cvt_pk_bf16_f32 v253, v142, v143
    v_cvt_pk_bf16_f32 v254, v156, v157
    v_mfma_f32_16x16x32_bf16 v[44:47], a[44:47], v[168:171], v[44:47]
    v_cvt_pk_bf16_f32 v255, v158, v159
    v_mfma_f32_16x16x32_bf16 v[44:47], a[60:63], v[172:175], v[44:47]
    v_xor_b32 v10, 32832, v11
    s_waitcnt lgkmcnt(0)
    v_mfma_f32_16x16x32_bf16 v[48:51], a[0:3], v[176:179], 0
    ds_read_b64_tr_b16 v[160:161], v10 offset:0
    v_mfma_f32_16x16x32_bf16 v[48:51], a[16:19], v[180:183], v[48:51]
    ds_read_b64_tr_b16 v[162:163], v10 offset:1024
    v_mfma_f32_16x16x32_bf16 v[48:51], a[32:35], v[184:187], v[48:51]
    ds_read_b64_tr_b16 v[164:165], v10 offset:8192
    v_mfma_f32_16x16x32_bf16 v[48:51], a[48:51], v[188:191], v[48:51]
    ds_read_b64_tr_b16 v[166:167], v10 offset:9216
    v_mfma_f32_16x16x32_bf16 v[52:55], a[4:7], v[176:179], 0
    ds_read_b64_tr_b16 v[168:169], v10 offset:16384
    v_mfma_f32_16x16x32_bf16 v[52:55], a[20:23], v[180:183], v[52:55]
    ds_read_b64_tr_b16 v[170:171], v10 offset:17408
    v_mfma_f32_16x16x32_bf16 v[52:55], a[36:39], v[184:187], v[52:55]
    ds_read_b64_tr_b16 v[172:173], v10 offset:24576
    v_mfma_f32_16x16x32_bf16 v[52:55], a[52:55], v[188:191], v[52:55]
    ds_read_b64_tr_b16 v[174:175], v10 offset:25600
    v_mfma_f32_16x16x32_bf16 v[56:59], a[8:11], v[176:179], 0
    buffer_load_dword v9, v14, s[16:19], 0 offen offset:0 sc1
    v_mfma_f32_16x16x32_bf16 v[56:59], a[24:27], v[180:183], v[56:59]
    v_mfma_f32_16x16x32_bf16 v[56:59], a[40:43], v[184:187], v[56:59]
    buffer_load_dwordx4 v18, s[52:55], s9 offen offset:2048 lds
    v_mfma_f32_16x16x32_bf16 v[56:59], a[56:59], v[188:191], v[56:59]
    v_mfma_f32_16x16x32_bf16 v[60:63], a[12:15], v[176:179], 0
    v_mfma_f32_16x16x32_bf16 v[60:63], a[28:31], v[180:183], v[60:63]
    v_mfma_f32_16x16x32_bf16 v[60:63], a[44:47], v[184:187], v[60:63]
    buffer_store_dwordx4 v[220:223], v2, s[20:23], s37 offen offset:1024 sc1
    v_mfma_f32_16x16x32_bf16 v[60:63], a[60:63], v[188:191], v[60:63]
    v_xor_b32 v10, 32864, v11
    s_waitcnt lgkmcnt(0)
    v_mfma_f32_16x16x32_bf16 v[64:67], a[0:3], v[160:163], 0
    ds_read_b64_tr_b16 v[176:177], v10 offset:0
    v_mfma_f32_16x16x32_bf16 v[64:67], a[16:19], v[164:167], v[64:67]
    ds_read_b64_tr_b16 v[178:179], v10 offset:1024
    v_mfma_f32_16x16x32_bf16 v[64:67], a[32:35], v[168:171], v[64:67]
    ds_read_b64_tr_b16 v[180:181], v10 offset:8192
    v_mfma_f32_16x16x32_bf16 v[64:67], a[48:51], v[172:175], v[64:67]
    ds_read_b64_tr_b16 v[182:183], v10 offset:9216
    v_mfma_f32_16x16x32_bf16 v[68:71], a[4:7], v[160:163], 0
    ds_read_b64_tr_b16 v[184:185], v10 offset:16384
    v_mfma_f32_16x16x32_bf16 v[68:71], a[20:23], v[164:167], v[68:71]
    ds_read_b64_tr_b16 v[186:187], v10 offset:17408
    v_mfma_f32_16x16x32_bf16 v[68:71], a[36:39], v[168:171], v[68:71]
    ds_read_b64_tr_b16 v[188:189], v10 offset:24576
    v_mfma_f32_16x16x32_bf16 v[68:71], a[52:55], v[172:175], v[68:71]
    ds_read_b64_tr_b16 v[190:191], v10 offset:25600
    v_mfma_f32_16x16x32_bf16 v[72:75], a[8:11], v[160:163], 0
    v_mfma_f32_16x16x32_bf16 v[72:75], a[24:27], v[164:167], v[72:75]
    v_mfma_f32_16x16x32_bf16 v[72:75], a[40:43], v[168:171], v[72:75]
    buffer_load_dwordx4 v19, s[52:55], s9 offen offset:3072 lds
    v_mfma_f32_16x16x32_bf16 v[72:75], a[56:59], v[172:175], v[72:75]
    v_mfma_f32_16x16x32_bf16 v[76:79], a[12:15], v[160:163], 0
    v_mfma_f32_16x16x32_bf16 v[76:79], a[28:31], v[164:167], v[76:79]
    v_mfma_f32_16x16x32_bf16 v[76:79], a[44:47], v[168:171], v[76:79]
    buffer_store_dwordx4 v[224:227], v2, s[20:23], s34 offen offset:2048 sc1
    v_mfma_f32_16x16x32_bf16 v[76:79], a[60:63], v[172:175], v[76:79]
    v_xor_b32 v10, 32896, v11
    s_waitcnt lgkmcnt(0)
    v_mfma_f32_16x16x32_bf16 v[80:83], a[0:3], v[176:179], 0
    ds_read_b64_tr_b16 v[160:161], v10 offset:0
    s_add_u32 m0, s10, 102400
    v_mfma_f32_16x16x32_bf16 v[80:83], a[16:19], v[180:183], v[80:83]
    ds_read_b64_tr_b16 v[162:163], v10 offset:1024
    v_mfma_f32_16x16x32_bf16 v[80:83], a[32:35], v[184:187], v[80:83]
    ds_read_b64_tr_b16 v[164:165], v10 offset:8192
    v_mfma_f32_16x16x32_bf16 v[80:83], a[48:51], v[188:191], v[80:83]
    ds_read_b64_tr_b16 v[166:167], v10 offset:9216
    v_mfma_f32_16x16x32_bf16 v[84:87], a[4:7], v[176:179], 0
    ds_read_b64_tr_b16 v[168:169], v10 offset:16384
    v_mfma_f32_16x16x32_bf16 v[84:87], a[20:23], v[180:183], v[84:87]
    ds_read_b64_tr_b16 v[170:171], v10 offset:17408
    v_mfma_f32_16x16x32_bf16 v[84:87], a[36:39], v[184:187], v[84:87]
    ds_read_b64_tr_b16 v[172:173], v10 offset:24576
    v_mfma_f32_16x16x32_bf16 v[84:87], a[52:55], v[188:191], v[84:87]
    ds_read_b64_tr_b16 v[174:175], v10 offset:25600
    v_mfma_f32_16x16x32_bf16 v[88:91], a[8:11], v[176:179], 0
    v_mfma_f32_16x16x32_bf16 v[88:91], a[24:27], v[180:183], v[88:91]
    v_mfma_f32_16x16x32_bf16 v[88:91], a[40:43], v[184:187], v[88:91]
    buffer_load_dwordx4 v20, s[52:55], s9 offen offset:0 lds
    v_mfma_f32_16x16x32_bf16 v[88:91], a[56:59], v[188:191], v[88:91]
    v_mfma_f32_16x16x32_bf16 v[92:95], a[12:15], v[176:179], 0
    v_mfma_f32_16x16x32_bf16 v[92:95], a[28:31], v[180:183], v[92:95]
    v_mfma_f32_16x16x32_bf16 v[92:95], a[44:47], v[184:187], v[92:95]
    buffer_store_dwordx4 v[228:231], v2, s[20:23], s35 offen offset:2048 sc1
    v_mfma_f32_16x16x32_bf16 v[92:95], a[60:63], v[188:191], v[92:95]
    v_xor_b32 v10, 32928, v11
    s_waitcnt lgkmcnt(0)
    v_mfma_f32_16x16x32_bf16 v[96:99], a[0:3], v[160:163], 0
    ds_read_b64_tr_b16 v[176:177], v10 offset:0
    v_mfma_f32_16x16x32_bf16 v[96:99], a[16:19], v[164:167], v[96:99]
    ds_read_b64_tr_b16 v[178:179], v10 offset:1024
    v_mfma_f32_16x16x32_bf16 v[96:99], a[32:35], v[168:171], v[96:99]
    ds_read_b64_tr_b16 v[180:181], v10 offset:8192
    v_mfma_f32_16x16x32_bf16 v[96:99], a[48:51], v[172:175], v[96:99]
    ds_read_b64_tr_b16 v[182:183], v10 offset:9216
    v_mfma_f32_16x16x32_bf16 v[100:103], a[4:7], v[160:163], 0
    ds_read_b64_tr_b16 v[184:185], v10 offset:16384
    v_mfma_f32_16x16x32_bf16 v[100:103], a[20:23], v[164:167], v[100:103]
    ds_read_b64_tr_b16 v[186:187], v10 offset:17408
    v_mfma_f32_16x16x32_bf16 v[100:103], a[36:39], v[168:171], v[100:103]
    ds_read_b64_tr_b16 v[188:189], v10 offset:24576
    v_mfma_f32_16x16x32_bf16 v[100:103], a[52:55], v[172:175], v[100:103]
    ds_read_b64_tr_b16 v[190:191], v10 offset:25600
    v_mfma_f32_16x16x32_bf16 v[104:107], a[8:11], v[160:163], 0
    v_mfma_f32_16x16x32_bf16 v[104:107], a[24:27], v[164:167], v[104:107]
    v_mfma_f32_16x16x32_bf16 v[104:107], a[40:43], v[168:171], v[104:107]
    buffer_load_dwordx4 v21, s[52:55], s9 offen offset:1024 lds
    v_mfma_f32_16x16x32_bf16 v[104:107], a[56:59], v[172:175], v[104:107]
    v_mfma_f32_16x16x32_bf16 v[108:111], a[12:15], v[160:163], 0
    v_mfma_f32_16x16x32_bf16 v[108:111], a[28:31], v[164:167], v[108:111]
    v_mfma_f32_16x16x32_bf16 v[108:111], a[44:47], v[168:171], v[108:111]
    buffer_store_dwordx4 v[232:235], v2, s[20:23], s36 offen offset:2048 sc1
    v_mfma_f32_16x16x32_bf16 v[108:111], a[60:63], v[172:175], v[108:111]
    v_xor_b32 v10, 32960, v11
    s_waitcnt lgkmcnt(0)
    v_mfma_f32_16x16x32_bf16 v[112:115], a[0:3], v[176:179], 0
    ds_read_b64_tr_b16 v[160:161], v10 offset:0
    v_mfma_f32_16x16x32_bf16 v[112:115], a[16:19], v[180:183], v[112:115]
    ds_read_b64_tr_b16 v[162:163], v10 offset:1024
    v_mfma_f32_16x16x32_bf16 v[112:115], a[32:35], v[184:187], v[112:115]
    ds_read_b64_tr_b16 v[164:165], v10 offset:8192
    v_mfma_f32_16x16x32_bf16 v[112:115], a[48:51], v[188:191], v[112:115]
    ds_read_b64_tr_b16 v[166:167], v10 offset:9216
    v_mfma_f32_16x16x32_bf16 v[116:119], a[4:7], v[176:179], 0
    ds_read_b64_tr_b16 v[168:169], v10 offset:16384
    v_mfma_f32_16x16x32_bf16 v[116:119], a[20:23], v[180:183], v[116:119]
    ds_read_b64_tr_b16 v[170:171], v10 offset:17408
    v_mfma_f32_16x16x32_bf16 v[116:119], a[36:39], v[184:187], v[116:119]
    ds_read_b64_tr_b16 v[172:173], v10 offset:24576
    v_mfma_f32_16x16x32_bf16 v[116:119], a[52:55], v[188:191], v[116:119]
    ds_read_b64_tr_b16 v[174:175], v10 offset:25600
    v_mfma_f32_16x16x32_bf16 v[120:123], a[8:11], v[176:179], 0
    v_mfma_f32_16x16x32_bf16 v[120:123], a[24:27], v[180:183], v[120:123]
    v_mfma_f32_16x16x32_bf16 v[120:123], a[40:43], v[184:187], v[120:123]
    buffer_load_dwordx4 v22, s[52:55], s9 offen offset:2048 lds
    v_mfma_f32_16x16x32_bf16 v[120:123], a[56:59], v[188:191], v[120:123]
    v_mfma_f32_16x16x32_bf16 v[124:127], a[12:15], v[176:179], 0
    v_mfma_f32_16x16x32_bf16 v[124:127], a[28:31], v[180:183], v[124:127]
    v_mfma_f32_16x16x32_bf16 v[124:127], a[44:47], v[184:187], v[124:127]
    buffer_store_dwordx4 v[236:239], v2, s[20:23], s37 offen offset:2048 sc1
    v_mfma_f32_16x16x32_bf16 v[124:127], a[60:63], v[188:191], v[124:127]
    v_xor_b32 v10, 32992, v11
    s_waitcnt lgkmcnt(0)
    v_mfma_f32_16x16x32_bf16 v[128:131], a[0:3], v[160:163], 0
    ds_read_b64_tr_b16 v[176:177], v10 offset:0
    s_waitcnt vmcnt(10)
    v_mfma_f32_16x16x32_bf16 v[128:131], a[16:19], v[164:167], v[128:131]
    ds_read_b64_tr_b16 v[178:179], v10 offset:1024
    v_cmp_gt_u32 vcc, 16, v9
    v_mfma_f32_16x16x32_bf16 v[128:131], a[32:35], v[168:171], v[128:131]
    ds_read_b64_tr_b16 v[180:181], v10 offset:8192
    s_nop 0
    v_mfma_f32_16x16x32_bf16 v[128:131], a[48:51], v[172:175], v[128:131]
    ds_read_b64_tr_b16 v[182:183], v10 offset:9216
    s_cbranch_vccnz L_spinp0
L_backp0:
    v_mfma_f32_16x16x32_bf16 v[132:135], a[4:7], v[160:163], 0
    ds_read_b64_tr_b16 v[184:185], v10 offset:16384
    v_mfma_f32_16x16x32_bf16 v[132:135], a[20:23], v[164:167], v[132:135]
    ds_read_b64_tr_b16 v[186:187], v10 offset:17408
    v_mfma_f32_16x16x32_bf16 v[132:135], a[36:39], v[168:171], v[132:135]
    ds_read_b64_tr_b16 v[188:189], v10 offset:24576
    v_mfma_f32_16x16x32_bf16 v[132:135], a[52:55], v[172:175], v[132:135]
    ds_read_b64_tr_b16 v[190:191], v10 offset:25600
    v_mfma_f32_16x16x32_bf16 v[136:139], a[8:11], v[160:163], 0
    v_mfma_f32_16x16x32_bf16 v[136:139], a[24:27], v[164:167], v[136:139]
    v_mfma_f32_16x16x32_bf16 v[136:139], a[40:43], v[168:171], v[136:139]
    buffer_load_dwordx4 v23, s[52:55], s9 offen offset:3072 lds
    v_mfma_f32_16x16x32_bf16 v[136:139], a[56:59], v[172:175], v[136:139]
    v_mfma_f32_16x16x32_bf16 v[140:143], a[12:15], v[160:163], 0
    v_mfma_f32_16x16x32_bf16 v[140:143], a[28:31], v[164:167], v[140:143]
    v_mfma_f32_16x16x32_bf16 v[140:143], a[44:47], v[168:171], v[140:143]
    buffer_store_dwordx4 v[240:243], v2, s[20:23], s34 offen offset:3072 sc1
    v_mfma_f32_16x16x32_bf16 v[140:143], a[60:63], v[172:175], v[140:143]
    v_xor_b32 v10, 65536, v11
    s_waitcnt lgkmcnt(0)
    s_nop 0
    s_barrier
    v_mfma_f32_16x16x32_bf16 v[144:147], a[0:3], v[176:179], 0
    ds_read_b64_tr_b16 v[160:161], v10 offset:0
    s_xor_b32 s9, s42, 3145728
    v_mfma_f32_16x16x32_bf16 v[144:147], a[16:19], v[180:183], v[144:147]
    ds_read_b64_tr_b16 v[162:163], v10 offset:1024
    s_add_u32 m0, s10, 0
    v_mfma_f32_16x16x32_bf16 v[144:147], a[32:35], v[184:187], v[144:147]
    ds_read_b64_tr_b16 v[164:165], v10 offset:8192
    v_mfma_f32_16x16x32_bf16 v[144:147], a[48:51], v[188:191], v[144:147]
    ds_read_b64_tr_b16 v[166:167], v10 offset:9216
    v_mfma_f32_16x16x32_bf16 v[148:151], a[4:7], v[176:179], 0
    ds_read_b64_tr_b16 v[168:169], v10 offset:16384
    v_mfma_f32_16x16x32_bf16 v[148:151], a[20:23], v[180:183], v[148:151]
    ds_read_b64_tr_b16 v[170:171], v10 offset:17408
    v_mfma_f32_16x16x32_bf16 v[148:151], a[36:39], v[184:187], v[148:151]
    ds_read_b64_tr_b16 v[172:173], v10 offset:24576
    v_mfma_f32_16x16x32_bf16 v[148:151], a[52:55], v[188:191], v[148:151]
    ds_read_b64_tr_b16 v[174:175], v10 offset:25600
    v_mfma_f32_16x16x32_bf16 v[152:155], a[8:11], v[176:179], 0
    v_mfma_f32_16x16x32_bf16 v[152:155], a[24:27], v[180:183], v[152:155]
    v_mfma_f32_16x16x32_bf16 v[152:155], a[40:43], v[184:187], v[152:155]
    buffer_load_dwordx4 v16, s[52:55], s9 offen offset:0 lds
    v_mfma_f32_16x16x32_bf16 v[152:155], a[56:59], v[188:191], v[152:155]
    v_mfma_f32_16x16x32_bf16 v[156:159], a[12:15], v[176:179], 0
    v_mfma_f32_16x16x32_bf16 v[156:159], a[28:31], v[180:183], v[156:159]
    v_mfma_f32_16x16x32_bf16 v[156:159], a[44:47], v[184:187], v[156:159]
    buffer_store_dwordx4 v[244:247], v2, s[20:23], s35 offen offset:3072 sc1
    v_mfma_f32_16x16x32_bf16 v[156:159], a[60:63], v[188:191], v[156:159]
    v_xor_b32 v10, 65568, v11
    s_waitcnt lgkmcnt(0)
    v_mfma_f32_16x16x32_bf16 v[32:35], a[64:67], v[160:163], v[32:35]
    ds_read_b64_tr_b16 v[176:177], v10 offset:0
    v_lshrrev_b32 v4, 4, v1
    v_mfma_f32_16x16x32_bf16 v[32:35], a[80:83], v[164:167], v[32:35]
    ds_read_b64_tr_b16 v[178:179], v10 offset:1024
    v_bfe_u32 v5, v1, 2, 2
    v_mfma_f32_16x16x32_bf16 v[32:35], a[96:99], v[168:171], v[32:35]
    ds_read_b64_tr_b16 v[180:181], v10 offset:8192
    v_and_b32 v6, 3, v1
    v_mfma_f32_16x16x32_bf16 v[32:35], a[112:115], v[172:175], v[32:35]
    ds_read_b64_tr_b16 v[182:183], v10 offset:9216
    v_mul_u32_u24 v28, s79, v6
    v_mfma_f32_16x16x32_bf16 v[36:39], a[68:71], v[160:163], v[36:39]
    ds_read_b64_tr_b16 v[184:185], v10 offset:16384
    v_add_u32 v29, s80, v28
    v_mfma_f32_16x16x32_bf16 v[36:39], a[84:87], v[164:167], v[36:39]
    ds_read_b64_tr_b16 v[186:187], v10 offset:17408
    v_and_b32 v6, 1, v4
    v_mfma_f32_16x16x32_bf16 v[36:39], a[100:103], v[168:171], v[36:39]
    ds_read_b64_tr_b16 v[188:189], v10 offset:24576
    v_lshl_or_b32 v6, v6, 2, v5
    v_mfma_f32_16x16x32_bf16 v[36:39], a[116:119], v[172:175], v[36:39]
    ds_read_b64_tr_b16 v[190:191], v10 offset:25600
    v_lshlrev_b32 v6, 5, v6
    v_mfma_f32_16x16x32_bf16 v[40:43], a[72:75], v[160:163], v[40:43]
    v_lshl_or_b32 v6, v5, 8, v6
    v_lshl_or_b32 v6, v4, 11, v6
    v_mfma_f32_16x16x32_bf16 v[40:43], a[88:91], v[164:167], v[40:43]
    s_add_u32 s29, s10, 131072
    v_or_b32 v6, s29, v6
    v_mfma_f32_16x16x32_bf16 v[40:43], a[104:107], v[168:171], v[40:43]
    buffer_load_dwordx4 v17, s[52:55], s9 offen offset:1024 lds
    v_mfma_f32_16x16x32_bf16 v[40:43], a[120:123], v[172:175], v[40:43]
    v_xor_b32 v28, v28, v6
    v_xor_b32 v29, v29, v6
    v_mfma_f32_16x16x32_bf16 v[44:47], a[76:79], v[160:163], v[44:47]
    v_and_b32 v5, 15, v1
    v_lshlrev_b32 v6, 1, v4
    v_mfma_f32_16x16x32_bf16 v[44:47], a[92:95], v[164:167], v[44:47]
    v_xor_b32 v5, v5, v6
    v_lshlrev_b32 v5, 4, v5
    v_mfma_f32_16x16x32_bf16 v[44:47], a[108:111], v[168:171], v[44:47]
    v_mad_u32_u24 v24, v4, s78, v5
    v_xor_b32 v5, 128, v5
    v_mfma_f32_16x16x32_bf16 v[44:47], a[124:127], v[172:175], v[44:47]
    v_xor_b32 v10, 65600, v11
    s_waitcnt lgkmcnt(0)
    v_mfma_f32_16x16x32_bf16 v[48:51], a[64:67], v[176:179], v[48:51]
    buffer_store_dwordx4 v[248:251], v2, s[20:23], s36 offen offset:3072 sc1
    v_mfma_f32_16x16x32_bf16 v[48:51], a[80:83], v[180:183], v[48:51]
    ds_read_b64_tr_b16 v[160:161], v10 offset:0
    v_mad_u32_u24 v25, v4, s78, v5
    v_mfma_f32_16x16x32_bf16 v[48:51], a[96:99], v[184:187], v[48:51]
    ds_read_b64_tr_b16 v[162:163], v10 offset:1024
    v_mfma_f32_16x16x32_bf16 v[48:51], a[112:115], v[188:191], v[48:51]
    ds_read_b64_tr_b16 v[164:165], v10 offset:8192
    v_mfma_f32_16x16x32_bf16 v[52:55], a[68:71], v[176:179], v[52:55]
    ds_read_b64_tr_b16 v[166:167], v10 offset:9216
    v_mfma_f32_16x16x32_bf16 v[52:55], a[84:87], v[180:183], v[52:55]
    ds_read_b64_tr_b16 v[168:169], v10 offset:16384
    v_mfma_f32_16x16x32_bf16 v[52:55], a[100:103], v[184:187], v[52:55]
    ds_read_b64_tr_b16 v[170:171], v10 offset:17408
    v_mfma_f32_16x16x32_bf16 v[52:55], a[116:119], v[188:191], v[52:55]
    ds_read_b64_tr_b16 v[172:173], v10 offset:24576
    v_mfma_f32_16x16x32_bf16 v[56:59], a[72:75], v[176:179], v[56:59]
    ds_read_b64_tr_b16 v[174:175], v10 offset:25600
    v_mfma_f32_16x16x32_bf16 v[56:59], a[88:91], v[180:183], v[56:59]
    v_mfma_f32_16x16x32_bf16 v[56:59], a[104:107], v[184:187], v[56:59]
    v_mfma_f32_16x16x32_bf16 v[56:59], a[120:123], v[188:191], v[56:59]
    buffer_load_dwordx4 v18, s[52:55], s9 offen offset:2048 lds
    v_mfma_f32_16x16x32_bf16 v[60:63], a[76:79], v[176:179], v[60:63]
    v_mfma_f32_16x16x32_bf16 v[60:63], a[92:95], v[180:183], v[60:63]
    v_mfma_f32_16x16x32_bf16 v[60:63], a[108:111], v[184:187], v[60:63]
    v_mfma_f32_16x16x32_bf16 v[60:63], a[124:127], v[188:191], v[60:63]
    v_xor_b32 v10, 65632, v11
    s_waitcnt lgkmcnt(0)
    v_mfma_f32_16x16x32_bf16 v[64:67], a[64:67], v[160:163], v[64:67]
    buffer_store_dwordx4 v[252:255], v2, s[20:23], s37 offen offset:3072 sc1
    v_mfma_f32_16x16x32_bf16 v[64:67], a[80:83], v[164:167], v[64:67]
    ds_read_b64_tr_b16 v[176:177], v10 offset:0
    s_xor_b32 s28, s38, 0
    v_mfma_f32_16x16x32_bf16 v[64:67], a[96:99], v[168:171], v[64:67]
    ds_read_b64_tr_b16 v[178:179], v10 offset:1024
    v_mfma_f32_16x16x32_bf16 v[64:67], a[112:115], v[172:175], v[64:67]
    ds_read_b64_tr_b16 v[180:181], v10 offset:8192
    v_mfma_f32_16x16x32_bf16 v[68:71], a[68:71], v[160:163], v[68:71]
    ds_read_b64_tr_b16 v[182:183], v10 offset:9216
    v_mfma_f32_16x16x32_bf16 v[68:71], a[84:87], v[164:167], v[68:71]
    ds_read_b64_tr_b16 v[184:185], v10 offset:16384
    v_mfma_f32_16x16x32_bf16 v[68:71], a[100:103], v[168:171], v[68:71]
    ds_read_b64_tr_b16 v[186:187], v10 offset:17408
    v_mfma_f32_16x16x32_bf16 v[68:71], a[116:119], v[172:175], v[68:71]
    ds_read_b64_tr_b16 v[188:189], v10 offset:24576
    v_mfma_f32_16x16x32_bf16 v[72:75], a[72:75], v[160:163], v[72:75]
    ds_read_b64_tr_b16 v[190:191], v10 offset:25600
    v_mfma_f32_16x16x32_bf16 v[72:75], a[88:91], v[164:167], v[72:75]
    v_mfma_f32_16x16x32_bf16 v[72:75], a[104:107], v[168:171], v[72:75]
    v_mfma_f32_16x16x32_bf16 v[72:75], a[120:123], v[172:175], v[72:75]
    buffer_load_dwordx4 a[0:3], v2, s[24:27], s28 offen sc1
    v_mfma_f32_16x16x32_bf16 v[76:79], a[76:79], v[160:163], v[76:79]
    s_xor_b32 s28, s39, 0
    v_mfma_f32_16x16x32_bf16 v[76:79], a[92:95], v[164:167], v[76:79]
    v_mfma_f32_16x16x32_bf16 v[76:79], a[108:111], v[168:171], v[76:79]
    v_mfma_f32_16x16x32_bf16 v[76:79], a[124:127], v[172:175], v[76:79]
    v_xor_b32 v10, 65664, v11
    s_waitcnt lgkmcnt(0)
    v_mfma_f32_16x16x32_bf16 v[80:83], a[64:67], v[176:179], v[80:83]
    buffer_load_dwordx4 a[4:7], v2, s[24:27], s28 offen sc1
    v_mfma_f32_16x16x32_bf16 v[80:83], a[80:83], v[180:183], v[80:83]
    ds_read_b64_tr_b16 v[160:161], v10 offset:0
    v_mfma_f32_16x16x32_bf16 v[80:83], a[96:99], v[184:187], v[80:83]
    ds_read_b64_tr_b16 v[162:163], v10 offset:1024
    v_mfma_f32_16x16x32_bf16 v[80:83], a[112:115], v[188:191], v[80:83]
    ds_read_b64_tr_b16 v[164:165], v10 offset:8192
    v_mfma_f32_16x16x32_bf16 v[84:87], a[68:71], v[176:179], v[84:87]
    ds_read_b64_tr_b16 v[166:167], v10 offset:9216
    v_mfma_f32_16x16x32_bf16 v[84:87], a[84:87], v[180:183], v[84:87]
    buffer_load_dwordx4 v19, s[52:55], s9 offen offset:3072 lds
    v_mfma_f32_16x16x32_bf16 v[84:87], a[100:103], v[184:187], v[84:87]
    ds_read_b64_tr_b16 v[168:169], v10 offset:16384
    s_xor_b32 s28, s40, 0
    v_mfma_f32_16x16x32_bf16 v[84:87], a[116:119], v[188:191], v[84:87]
    ds_read_b64_tr_b16 v[170:171], v10 offset:17408
    v_mfma_f32_16x16x32_bf16 v[88:91], a[72:75], v[176:179], v[88:91]
    ds_read_b64_tr_b16 v[172:173], v10 offset:24576
    v_mfma_f32_16x16x32_bf16 v[88:91], a[88:91], v[180:183], v[88:91]
    ds_read_b64_tr_b16 v[174:175], v10 offset:25600
    v_mfma_f32_16x16x32_bf16 v[88:91], a[104:107], v[184:187], v[88:91]
    buffer_load_dwordx4 a[8:11], v2, s[24:27], s28 offen sc1
    v_mfma_f32_16x16x32_bf16 v[88:91], a[120:123], v[188:191], v[88:91]
    s_xor_b32 s28, s41, 0
    v_mfma_f32_16x16x32_bf16 v[92:95], a[76:79], v[176:179], v[92:95]
    v_mfma_f32_16x16x32_bf16 v[92:95], a[92:95], v[180:183], v[92:95]
    v_mfma_f32_16x16x32_bf16 v[92:95], a[108:111], v[184:187], v[92:95]
    v_mfma_f32_16x16x32_bf16 v[92:95], a[124:127], v[188:191], v[92:95]
    v_xor_b32 v10, 65696, v11
    s_waitcnt lgkmcnt(0)
    v_mfma_f32_16x16x32_bf16 v[96:99], a[64:67], v[160:163], v[96:99]
    buffer_load_dwordx4 a[12:15], v2, s[24:27], s28 offen sc1
    v_mfma_f32_16x16x32_bf16 v[96:99], a[80:83], v[164:167], v[96:99]
    ds_read_b64_tr_b16 v[176:177], v10 offset:0
    s_add_u32 m0, s10, 4096
    v_mfma_f32_16x16x32_bf16 v[96:99], a[96:99], v[168:171], v[96:99]
    ds_read_b64_tr_b16 v[178:179], v10 offset:1024
    v_mfma_f32_16x16x32_bf16 v[96:99], a[112:115], v[172:175], v[96:99]
    ds_read_b64_tr_b16 v[180:181], v10 offset:8192
    v_mfma_f32_16x16x32_bf16 v[100:103], a[68:71], v[160:163], v[100:103]
    buffer_load_dwordx4 v20, s[52:55], s9 offen offset:0 lds
    v_mfma_f32_16x16x32_bf16 v[100:103], a[84:87], v[164:167], v[100:103]
    ds_read_b64_tr_b16 v[182:183], v10 offset:9216
    s_xor_b32 s28, s38, 1024
    v_mfma_f32_16x16x32_bf16 v[100:103], a[100:103], v[168:171], v[100:103]
    ds_read_b64_tr_b16 v[184:185], v10 offset:16384
    v_mfma_f32_16x16x32_bf16 v[100:103], a[116:119], v[172:175], v[100:103]
    ds_read_b64_tr_b16 v[186:187], v10 offset:17408
    v_mfma_f32_16x16x32_bf16 v[104:107], a[72:75], v[160:163], v[104:107]
    ds_read_b64_tr_b16 v[188:189], v10 offset:24576
    v_mfma_f32_16x16x32_bf16 v[104:107], a[88:91], v[164:167], v[104:107]
    buffer_load_dwordx4 a[16:19], v2, s[24:27], s28 offen sc1
    v_mfma_f32_16x16x32_bf16 v[104:107], a[104:107], v[168:171], v[104:107]
    ds_read_b64_tr_b16 v[190:191], v10 offset:25600
    s_xor_b32 s28, s39, 1024
    v_mfma_f32_16x16x32_bf16 v[104:107], a[120:123], v[172:175], v[104:107]
    v_mfma_f32_16x16x32_bf16 v[108:111], a[76:79], v[160:163], v[108:111]
    v_mfma_f32_16x16x32_bf16 v[108:111], a[92:95], v[164:167], v[108:111]
    v_mfma_f32_16x16x32_bf16 v[108:111], a[108:111], v[168:171], v[108:111]
    buffer_load_dwordx4 a[20:23], v2, s[24:27], s28 offen sc1
    v_mfma_f32_16x16x32_bf16 v[108:111], a[124:127], v[172:175], v[108:111]
    v_xor_b32 v10, 65728, v11
    s_waitcnt lgkmcnt(0)
    v_mfma_f32_16x16x32_bf16 v[112:115], a[64:67], v[176:179], v[112:115]
    ds_read_b64_tr_b16 v[160:161], v10 offset:0
    v_mfma_f32_16x16x32_bf16 v[112:115], a[80:83], v[180:183], v[112:115]
    ds_read_b64_tr_b16 v[162:163], v10 offset:1024
    v_mfma_f32_16x16x32_bf16 v[112:115], a[96:99], v[184:187], v[112:115]
    ds_read_b64_tr_b16 v[164:165], v10 offset:8192
    v_mfma_f32_16x16x32_bf16 v[112:115], a[112:115], v[188:191], v[112:115]
    buffer_load_dwordx4 v21, s[52:55], s9 offen offset:1024 lds
    v_mfma_f32_16x16x32_bf16 v[116:119], a[68:71], v[176:179], v[116:119]
    ds_read_b64_tr_b16 v[166:167], v10 offset:9216
    s_xor_b32 s28, s40, 1024
    v_mfma_f32_16x16x32_bf16 v[116:119], a[84:87], v[180:183], v[116:119]
    ds_read_b64_tr_b16 v[168:169], v10 offset:16384
    v_mfma_f32_16x16x32_bf16 v[116:119], a[100:103], v[184:187], v[116:119]
    ds_read_b64_tr_b16 v[170:171], v10 offset:17408
    v_mfma_f32_16x16x32_bf16 v[116:119], a[116:119], v[188:191], v[116:119]
    ds_read_b64_tr_b16 v[172:173], v10 offset:24576
    v_mfma_f32_16x16x32_bf16 v[120:123], a[72:75], v[176:179], v[120:123]
    buffer_load_dwordx4 a[24:27], v2, s[24:27], s28 offen sc1
    v_mfma_f32_16x16x32_bf16 v[120:123], a[88:91], v[180:183], v[120:123]
    ds_read_b64_tr_b16 v[174:175], v10 offset:25600
    s_xor_b32 s28, s41, 1024
    v_mfma_f32_16x16x32_bf16 v[120:123], a[104:107], v[184:187], v[120:123]
    v_mfma_f32_16x16x32_bf16 v[120:123], a[120:123], v[188:191], v[120:123]
    v_mfma_f32_16x16x32_bf16 v[124:127], a[76:79], v[176:179], v[124:127]
    v_mfma_f32_16x16x32_bf16 v[124:127], a[92:95], v[180:183], v[124:127]
    buffer_load_dwordx4 a[28:31], v2, s[24:27], s28 offen sc1
    v_mfma_f32_16x16x32_bf16 v[124:127], a[108:111], v[184:187], v[124:127]
    v_mfma_f32_16x16x32_bf16 v[124:127], a[124:127], v[188:191], v[124:127]
    v_xor_b32 v10, 65760, v11
    s_waitcnt lgkmcnt(0)
    v_mfma_f32_16x16x32_bf16 v[128:131], a[64:67], v[160:163], v[128:131]
    ds_read_b64_tr_b16 v[176:177], v10 offset:0
    v_mfma_f32_16x16x32_bf16 v[128:131], a[80:83], v[164:167], v[128:131]
    ds_read_b64_tr_b16 v[178:179], v10 offset:1024
    v_mfma_f32_16x16x32_bf16 v[128:131], a[96:99], v[168:171], v[128:131]
    buffer_load_dwordx4 v22, s[52:55], s9 offen offset:2048 lds
    v_mfma_f32_16x16x32_bf16 v[128:131], a[112:115], v[172:175], v[128:131]
    ds_read_b64_tr_b16 v[180:181], v10 offset:8192
    s_xor_b32 s28, s38, 2048
    v_mfma_f32_16x16x32_bf16 v[132:135], a[68:71], v[160:163], v[132:135]
    ds_read_b64_tr_b16 v[182:183], v10 offset:9216
    v_mfma_f32_16x16x32_bf16 v[132:135], a[84:87], v[164:167], v[132:135]
    ds_read_b64_tr_b16 v[184:185], v10 offset:16384
    v_mfma_f32_16x16x32_bf16 v[132:135], a[100:103], v[168:171], v[132:135]
    ds_read_b64_tr_b16 v[186:187], v10 offset:17408
    v_mfma_f32_16x16x32_bf16 v[132:135], a[116:119], v[172:175], v[132:135]
    buffer_load_dwordx4 a[32:35], v2, s[24:27], s28 offen sc1
    v_mfma_f32_16x16x32_bf16 v[136:139], a[72:75], v[160:163], v[136:139]
    ds_read_b64_tr_b16 v[188:189], v10 offset:24576
    s_xor_b32 s28, s39, 2048
    v_mfma_f32_16x16x32_bf16 v[136:139], a[88:91], v[164:167], v[136:139]
    ds_read_b64_tr_b16 v[190:191], v10 offset:25600
    v_mfma_f32_16x16x32_bf16 v[136:139], a[104:107], v[168:171], v[136:139]
    v_mfma_f32_16x16x32_bf16 v[136:139], a[120:123], v[172:175], v[136:139]
    v_mfma_f32_16x16x32_bf16 v[140:143], a[76:79], v[160:163], v[140:143]
    buffer_load_dwordx4 a[36:39], v2, s[24:27], s28 offen sc1
    v_mfma_f32_16x16x32_bf16 v[140:143], a[92:95], v[164:167], v[140:143]
    v_mfma_f32_16x16x32_bf16 v[140:143], a[108:111], v[168:171], v[140:143]
    v_mfma_f32_16x16x32_bf16 v[140:143], a[124:127], v[172:175], v[140:143]
    v_xor_b32 v10, 98304, v11
    s_waitcnt lgkmcnt(0)
    s_waitcnt vmcnt(21)
    s_barrier
    v_mfma_f32_16x16x32_bf16 v[144:147], a[64:67], v[176:179], v[144:147]
    ds_read_b64_tr_b16 v[160:161], v10 offset:0
    v_mfma_f32_16x16x32_bf16 v[144:147], a[80:83], v[180:183], v[144:147]
    buffer_load_dwordx4 v23, s[52:55], s9 offen offset:3072 lds
    v_mfma_f32_16x16x32_bf16 v[144:147], a[96:99], v[184:187], v[144:147]
    ds_read_b64_tr_b16 v[162:163], v10 offset:1024
    s_xor_b32 s28, s40, 2048
    v_mfma_f32_16x16x32_bf16 v[144:147], a[112:115], v[188:191], v[144:147]
    ds_read_b64_tr_b16 v[164:165], v10 offset:8192
    v_mfma_f32_16x16x32_bf16 v[148:151], a[68:71], v[176:179], v[148:151]
    ds_read_b64_tr_b16 v[166:167], v10 offset:9216
    v_mfma_f32_16x16x32_bf16 v[148:151], a[84:87], v[180:183], v[148:151]
    ds_read_b64_tr_b16 v[168:169], v10 offset:16384
    v_mfma_f32_16x16x32_bf16 v[148:151], a[100:103], v[184:187], v[148:151]
    buffer_load_dwordx4 a[40:43], v2, s[24:27], s28 offen sc1
    v_mfma_f32_16x16x32_bf16 v[148:151], a[116:119], v[188:191], v[148:151]
    ds_read_b64_tr_b16 v[170:171], v10 offset:17408
    s_xor_b32 s28, s41, 2048
    v_mfma_f32_16x16x32_bf16 v[152:155], a[72:75], v[176:179], v[152:155]
    ds_read_b64_tr_b16 v[172:173], v10 offset:24576
    v_mfma_f32_16x16x32_bf16 v[152:155], a[88:91], v[180:183], v[152:155]
    ds_read_b64_tr_b16 v[174:175], v10 offset:25600
    v_mfma_f32_16x16x32_bf16 v[152:155], a[104:107], v[184:187], v[152:155]
    v_mfma_f32_16x16x32_bf16 v[152:155], a[120:123], v[188:191], v[152:155]
    buffer_load_dwordx4 a[44:47], v2, s[24:27], s28 offen sc1
    v_mfma_f32_16x16x32_bf16 v[156:159], a[76:79], v[176:179], v[156:159]
    s_and_b32 s42, s4, 3
    s_lshl_b32 s42, s42, 18
    v_mfma_f32_16x16x32_bf16 v[156:159], a[92:95], v[180:183], v[156:159]
    v_xor_b32 v16, s42, v16
    v_xor_b32 v17, s42, v17
    v_mfma_f32_16x16x32_bf16 v[156:159], a[108:111], v[184:187], v[156:159]
    v_xor_b32 v18, s42, v18
    v_xor_b32 v19, s42, v19
    v_mfma_f32_16x16x32_bf16 v[156:159], a[124:127], v[188:191], v[156:159]
    v_xor_b32 v10, 98336, v11
    s_waitcnt lgkmcnt(0)
    v_xor_b32 v20, s42, v20
    v_xor_b32 v21, s42, v21
    v_xor_b32 v22, s42, v22
    v_xor_b32 v23, s42, v23
    s_mov_b32 s9, 0
    s_add_u32 m0, s10, 131072
    v_mfma_f32_16x16x32_bf16 v[32:35], a[128:131], v[160:163], v[32:35]
    buffer_load_dwordx4 v16, s[56:59], s9 offen offset:0 lds
    v_mfma_f32_16x16x32_bf16 v[32:35], a[144:147], v[164:167], v[32:35]
    ds_read_b64_tr_b16 v[176:177], v10 offset:0
    s_xor_b32 s28, s38, 3072
    v_mfma_f32_16x16x32_bf16 v[32:35], a[160:163], v[168:171], v[32:35]
    ds_read_b64_tr_b16 v[178:179], v10 offset:1024
    v_mfma_f32_16x16x32_bf16 v[32:35], a[176:179], v[172:175], v[32:35]
    ds_read_b64_tr_b16 v[180:181], v10 offset:8192
    v_mfma_f32_16x16x32_bf16 v[36:39], a[132:135], v[160:163], v[36:39]
    ds_read_b64_tr_b16 v[182:183], v10 offset:9216
    v_mfma_f32_16x16x32_bf16 v[36:39], a[148:151], v[164:167], v[36:39]
    buffer_load_dwordx4 a[48:51], v2, s[24:27], s28 offen sc1
    v_mfma_f32_16x16x32_bf16 v[36:39], a[164:167], v[168:171], v[36:39]
    ds_read_b64_tr_b16 v[184:185], v10 offset:16384
    s_xor_b32 s28, s39, 3072
    v_mfma_f32_16x16x32_bf16 v[36:39], a[180:183], v[172:175], v[36:39]
    ds_read_b64_tr_b16 v[186:187], v10 offset:17408
    v_mfma_f32_16x16x32_bf16 v[40:43], a[136:139], v[160:163], v[40:43]
    ds_read_b64_tr_b16 v[188:189], v10 offset:24576
    v_mfma_f32_16x16x32_bf16 v[40:43], a[152:155], v[164:167], v[40:43]
    ds_read_b64_tr_b16 v[190:191], v10 offset:25600
    v_mfma_f32_16x16x32_bf16 v[40:43], a[168:171], v[168:171], v[40:43]
    buffer_load_dwordx4 a[52:55], v2, s[24:27], s28 offen sc1
    v_mfma_f32_16x16x32_bf16 v[40:43], a[184:187], v[172:175], v[40:43]
    v_mfma_f32_16x16x32_bf16 v[44:47], a[140:143], v[160:163], v[44:47]
    v_mfma_f32_16x16x32_bf16 v[44:47], a[156:159], v[164:167], v[44:47]
    v_mfma_f32_16x16x32_bf16 v[44:47], a[172:175], v[168:171], v[44:47]
    v_mfma_f32_16x16x32_bf16 v[44:47], a[188:191], v[172:175], v[44:47]
    v_xor_b32 v10, 98368, v11
    s_waitcnt lgkmcnt(0)
    v_mfma_f32_16x16x32_bf16 v[48:51], a[128:131], v[176:179], v[48:51]
    buffer_load_dwordx4 v17, s[56:59], s9 offen offset:1024 lds
    v_mfma_f32_16x16x32_bf16 v[48:51], a[144:147], v[180:183], v[48:51]
    ds_read_b64_tr_b16 v[160:161], v10 offset:0
    s_xor_b32 s28, s40, 3072
    v_mfma_f32_16x16x32_bf16 v[48:51], a[160:163], v[184:187], v[48:51]
    ds_read_b64_tr_b16 v[162:163], v10 offset:1024
    v_mfma_f32_16x16x32_bf16 v[48:51], a[176:179], v[188:191], v[48:51]
    ds_read_b64_tr_b16 v[164:165], v10 offset:8192
    v_mfma_f32_16x16x32_bf16 v[52:55], a[132:135], v[176:179], v[52:55]
    buffer_load_dwordx4 a[56:59], v2, s[24:27], s28 offen sc1
    v_mfma_f32_16x16x32_bf16 v[52:55], a[148:151], v[180:183], v[52:55]
    ds_read_b64_tr_b16 v[166:167], v10 offset:9216
    s_xor_b32 s28, s41, 3072
    v_mfma_f32_16x16x32_bf16 v[52:55], a[164:167], v[184:187], v[52:55]
    ds_read_b64_tr_b16 v[168:169], v10 offset:16384
    v_mfma_f32_16x16x32_bf16 v[52:55], a[180:183], v[188:191], v[52:55]
    ds_read_b64_tr_b16 v[170:171], v10 offset:17408
    v_mfma_f32_16x16x32_bf16 v[56:59], a[136:139], v[176:179], v[56:59]
    ds_read_b64_tr_b16 v[172:173], v10 offset:24576
    v_mfma_f32_16x16x32_bf16 v[56:59], a[152:155], v[180:183], v[56:59]
    buffer_load_dwordx4 a[60:63], v2, s[24:27], s28 offen sc1
    v_mfma_f32_16x16x32_bf16 v[56:59], a[168:171], v[184:187], v[56:59]
    ds_read_b64_tr_b16 v[174:175], v10 offset:25600
    v_mfma_f32_16x16x32_bf16 v[56:59], a[184:187], v[188:191], v[56:59]
    v_mfma_f32_16x16x32_bf16 v[60:63], a[140:143], v[176:179], v[60:63]
    v_mfma_f32_16x16x32_bf16 v[60:63], a[156:159], v[180:183], v[60:63]
    v_mfma_f32_16x16x32_bf16 v[60:63], a[172:175], v[184:187], v[60:63]
    buffer_load_dwordx4 v18, s[56:59], s9 offen offset:2048 lds
    v_mfma_f32_16x16x32_bf16 v[60:63], a[188:191], v[188:191], v[60:63]
    v_xor_b32 v10, 98400, v11
    s_waitcnt lgkmcnt(0)
    v_mfma_f32_16x16x32_bf16 v[64:67], a[128:131], v[160:163], v[64:67]
    ds_read_b64_tr_b16 v[176:177], v10 offset:0
    s_xor_b32 s28, s38, 4096
    v_mfma_f32_16x16x32_bf16 v[64:67], a[144:147], v[164:167], v[64:67]
    ds_read_b64_tr_b16 v[178:179], v10 offset:1024
    v_mfma_f32_16x16x32_bf16 v[64:67], a[160:163], v[168:171], v[64:67]
    ds_read_b64_tr_b16 v[180:181], v10 offset:8192
    v_mfma_f32_16x16x32_bf16 v[64:67], a[176:179], v[172:175], v[64:67]
    buffer_load_dwordx4 a[64:67], v2, s[24:27], s28 offen sc1
    v_mfma_f32_16x16x32_bf16 v[68:71], a[132:135], v[160:163], v[68:71]
    ds_read_b64_tr_b16 v[182:183], v10 offset:9216
    s_xor_b32 s28, s39, 4096
    v_mfma_f32_16x16x32_bf16 v[68:71], a[148:151], v[164:167], v[68:71]
    ds_read_b64_tr_b16 v[184:185], v10 offset:16384
    v_mfma_f32_16x16x32_bf16 v[68:71], a[164:167], v[168:171], v[68:71]
    ds_read_b64_tr_b16 v[186:187], v10 offset:17408
    v_mfma_f32_16x16x32_bf16 v[68:71], a[180:183], v[172:175], v[68:71]
    ds_read_b64_tr_b16 v[188:189], v10 offset:24576
    v_mfma_f32_16x16x32_bf16 v[72:75], a[136:139], v[160:163], v[72:75]
    buffer_load_dwordx4 a[68:71], v2, s[24:27], s28 offen sc1
    v_mfma_f32_16x16x32_bf16 v[72:75], a[152:155], v[164:167], v[72:75]
    ds_read_b64_tr_b16 v[190:191], v10 offset:25600
    v_mfma_f32_16x16x32_bf16 v[72:75], a[168:171], v[168:171], v[72:75]
    v_mfma_f32_16x16x32_bf16 v[72:75], a[184:187], v[172:175], v[72:75]
    v_mfma_f32_16x16x32_bf16 v[76:79], a[140:143], v[160:163], v[76:79]
    v_mfma_f32_16x16x32_bf16 v[76:79], a[156:159], v[164:167], v[76:79]
    buffer_load_dwordx4 v19, s[56:59], s9 offen offset:3072 lds
    v_mfma_f32_16x16x32_bf16 v[76:79], a[172:175], v[168:171], v[76:79]
    s_xor_b32 s28, s40, 4096
    v_mfma_f32_16x16x32_bf16 v[76:79], a[188:191], v[172:175], v[76:79]
    v_xor_b32 v10, 98432, v11
    s_waitcnt lgkmcnt(0)
    v_mfma_f32_16x16x32_bf16 v[80:83], a[128:131], v[176:179], v[80:83]
    ds_read_b64_tr_b16 v[160:161], v10 offset:0
    v_mfma_f32_16x16x32_bf16 v[80:83], a[144:147], v[180:183], v[80:83]
    ds_read_b64_tr_b16 v[162:163], v10 offset:1024
    v_mfma_f32_16x16x32_bf16 v[80:83], a[160:163], v[184:187], v[80:83]
    buffer_load_dwordx4 a[72:75], v2, s[24:27], s28 offen sc1
    v_mfma_f32_16x16x32_bf16 v[80:83], a[176:179], v[188:191], v[80:83]
    ds_read_b64_tr_b16 v[164:165], v10 offset:8192
    s_xor_b32 s28, s41, 4096
    v_mfma_f32_16x16x32_bf16 v[84:87], a[132:135], v[176:179], v[84:87]
    ds_read_b64_tr_b16 v[166:167], v10 offset:9216
    v_mfma_f32_16x16x32_bf16 v[84:87], a[148:151], v[180:183], v[84:87]
    ds_read_b64_tr_b16 v[168:169], v10 offset:16384
    v_mfma_f32_16x16x32_bf16 v[84:87], a[164:167], v[184:187], v[84:87]
    ds_read_b64_tr_b16 v[170:171], v10 offset:17408
    v_mfma_f32_16x16x32_bf16 v[84:87], a[180:183], v[188:191], v[84:87]
    buffer_load_dwordx4 a[76:79], v2, s[24:27], s28 offen sc1
    v_mfma_f32_16x16x32_bf16 v[88:91], a[136:139], v[176:179], v[88:91]
    ds_read_b64_tr_b16 v[172:173], v10 offset:24576
    s_add_u32 m0, s10, 135168
    v_mfma_f32_16x16x32_bf16 v[88:91], a[152:155], v[180:183], v[88:91]
    ds_read_b64_tr_b16 v[174:175], v10 offset:25600
    v_mfma_f32_16x16x32_bf16 v[88:91], a[168:171], v[184:187], v[88:91]
    v_mfma_f32_16x16x32_bf16 v[88:91], a[184:187], v[188:191], v[88:91]
    v_mfma_f32_16x16x32_bf16 v[92:95], a[140:143], v[176:179], v[92:95]
    buffer_load_dwordx4 v20, s[56:59], s9 offen offset:0 lds
    v_mfma_f32_16x16x32_bf16 v[92:95], a[156:159], v[180:183], v[92:95]
    s_xor_b32 s28, s38, 5120
    v_mfma_f32_16x16x32_bf16 v[92:95], a[172:175], v[184:187], v[92:95]
    v_mfma_f32_16x16x32_bf16 v[92:95], a[188:191], v[188:191], v[92:95]
    v_xor_b32 v10, 98464, v11
    s_waitcnt lgkmcnt(0)
    v_mfma_f32_16x16x32_bf16 v[96:99], a[128:131], v[160:163], v[96:99]
    ds_read_b64_tr_b16 v[176:177], v10 offset:0
    v_mfma_f32_16x16x32_bf16 v[96:99], a[144:147], v[164:167], v[96:99]
    buffer_load_dwordx4 a[80:83], v2, s[24:27], s28 offen sc1
    v_mfma_f32_16x16x32_bf16 v[96:99], a[160:163], v[168:171], v[96:99]
    ds_read_b64_tr_b16 v[178:179], v10 offset:1024
    s_xor_b32 s28, s39, 5120
    v_mfma_f32_16x16x32_bf16 v[96:99], a[176:179], v[172:175], v[96:99]
    ds_read_b64_tr_b16 v[180:181], v10 offset:8192
    v_mfma_f32_16x16x32_bf16 v[100:103], a[132:135], v[160:163], v[100:103]
    ds_read_b64_tr_b16 v[182:183], v10 offset:9216
    v_mfma_f32_16x16x32_bf16 v[100:103], a[148:151], v[164:167], v[100:103]
    ds_read_b64_tr_b16 v[184:185], v10 offset:16384
    v_mfma_f32_16x16x32_bf16 v[100:103], a[164:167], v[168:171], v[100:103]
    buffer_load_dwordx4 a[84:87], v2, s[24:27], s28 offen sc1
    v_mfma_f32_16x16x32_bf16 v[100:103], a[180:183], v[172:175], v[100:103]
    ds_read_b64_tr_b16 v[186:187], v10 offset:17408
    v_mfma_f32_16x16x32_bf16 v[104:107], a[136:139], v[160:163], v[104:107]
    ds_read_b64_tr_b16 v[188:189], v10 offset:24576
    v_mfma_f32_16x16x32_bf16 v[104:107], a[152:155], v[164:167], v[104:107]
    ds_read_b64_tr_b16 v[190:191], v10 offset:25600
    v_mfma_f32_16x16x32_bf16 v[104:107], a[168:171], v[168:171], v[104:107]
    v_mfma_f32_16x16x32_bf16 v[104:107], a[184:187], v[172:175], v[104:107]
    buffer_load_dwordx4 v21, s[56:59], s9 offen offset:1024 lds
    v_mfma_f32_16x16x32_bf16 v[108:111], a[140:143], v[160:163], v[108:111]
    s_xor_b32 s28, s40, 5120
    v_mfma_f32_16x16x32_bf16 v[108:111], a[156:159], v[164:167], v[108:111]
    v_mfma_f32_16x16x32_bf16 v[108:111], a[172:175], v[168:171], v[108:111]
    v_mfma_f32_16x16x32_bf16 v[108:111], a[188:191], v[172:175], v[108:111]
    v_xor_b32 v10, 98496, v11
    s_waitcnt lgkmcnt(0)
    v_mfma_f32_16x16x32_bf16 v[112:115], a[128:131], v[176:179], v[112:115]
    buffer_load_dwordx4 a[88:91], v2, s[24:27], s28 offen sc1
    v_mfma_f32_16x16x32_bf16 v[112:115], a[144:147], v[180:183], v[112:115]
    ds_read_b64_tr_b16 v[160:161], v10 offset:0
    s_xor_b32 s28, s41, 5120
    v_mfma_f32_16x16x32_bf16 v[112:115], a[160:163], v[184:187], v[112:115]
    ds_read_b64_tr_b16 v[162:163], v10 offset:1024
    v_mfma_f32_16x16x32_bf16 v[112:115], a[176:179], v[188:191], v[112:115]
    ds_read_b64_tr_b16 v[164:165], v10 offset:8192
    v_mfma_f32_16x16x32_bf16 v[116:119], a[132:135], v[176:179], v[116:119]
    ds_read_b64_tr_b16 v[166:167], v10 offset:9216
    v_mfma_f32_16x16x32_bf16 v[116:119], a[148:151], v[180:183], v[116:119]
    buffer_load_dwordx4 a[92:95], v2, s[24:27], s28 offen sc1
    v_mfma_f32_16x16x32_bf16 v[116:119], a[164:167], v[184:187], v[116:119]
    ds_read_b64_tr_b16 v[168:169], v10 offset:16384
    v_mfma_f32_16x16x32_bf16 v[116:119], a[180:183], v[188:191], v[116:119]
    ds_read_b64_tr_b16 v[170:171], v10 offset:17408
    v_mfma_f32_16x16x32_bf16 v[120:123], a[136:139], v[176:179], v[120:123]
    ds_read_b64_tr_b16 v[172:173], v10 offset:24576
    v_mfma_f32_16x16x32_bf16 v[120:123], a[152:155], v[180:183], v[120:123]
    ds_read_b64_tr_b16 v[174:175], v10 offset:25600
    v_mfma_f32_16x16x32_bf16 v[120:123], a[168:171], v[184:187], v[120:123]
    buffer_load_dwordx4 v22, s[56:59], s9 offen offset:2048 lds
    v_mfma_f32_16x16x32_bf16 v[120:123], a[184:187], v[188:191], v[120:123]
    s_xor_b32 s28, s38, 6144
    v_mfma_f32_16x16x32_bf16 v[124:127], a[140:143], v[176:179], v[124:127]
    v_mfma_f32_16x16x32_bf16 v[124:127], a[156:159], v[180:183], v[124:127]
    v_mfma_f32_16x16x32_bf16 v[124:127], a[172:175], v[184:187], v[124:127]
    v_mfma_f32_16x16x32_bf16 v[124:127], a[188:191], v[188:191], v[124:127]
    v_xor_b32 v10, 98528, v11
    s_waitcnt lgkmcnt(0)
    v_mfma_f32_16x16x32_bf16 v[128:131], a[128:131], v[160:163], v[128:131]
    buffer_load_dwordx4 a[96:99], v2, s[24:27], s28 offen sc1
    v_mfma_f32_16x16x32_bf16 v[128:131], a[144:147], v[164:167], v[128:131]
    ds_read_b64_tr_b16 v[176:177], v10 offset:0
    s_xor_b32 s28, s39, 6144
    v_mfma_f32_16x16x32_bf16 v[128:131], a[160:163], v[168:171], v[128:131]
    ds_read_b64_tr_b16 v[178:179], v10 offset:1024
    v_mfma_f32_16x16x32_bf16 v[128:131], a[176:179], v[172:175], v[128:131]
    ds_read_b64_tr_b16 v[180:181], v10 offset:8192
    v_mfma_f32_16x16x32_bf16 v[132:135], a[132:135], v[160:163], v[132:135]
    buffer_load_dwordx4 a[100:103], v2, s[24:27], s28 offen sc1
    v_mfma_f32_16x16x32_bf16 v[132:135], a[148:151], v[164:167], v[132:135]
    ds_read_b64_tr_b16 v[182:183], v10 offset:9216
    v_mfma_f32_16x16x32_bf16 v[132:135], a[164:167], v[168:171], v[132:135]
    ds_read_b64_tr_b16 v[184:185], v10 offset:16384
    v_mfma_f32_16x16x32_bf16 v[132:135], a[180:183], v[172:175], v[132:135]
    ds_read_b64_tr_b16 v[186:187], v10 offset:17408
    v_mfma_f32_16x16x32_bf16 v[136:139], a[136:139], v[160:163], v[136:139]
    ds_read_b64_tr_b16 v[188:189], v10 offset:24576
    v_mfma_f32_16x16x32_bf16 v[136:139], a[152:155], v[164:167], v[136:139]
    buffer_load_dwordx4 v23, s[56:59], s9 offen offset:3072 lds
    v_mfma_f32_16x16x32_bf16 v[136:139], a[168:171], v[168:171], v[136:139]
    ds_read_b64_tr_b16 v[190:191], v10 offset:25600
    s_xor_b32 s28, s40, 6144
    v_mfma_f32_16x16x32_bf16 v[136:139], a[184:187], v[172:175], v[136:139]
    v_mfma_f32_16x16x32_bf16 v[140:143], a[140:143], v[160:163], v[140:143]
    v_mfma_f32_16x16x32_bf16 v[140:143], a[156:159], v[164:167], v[140:143]
    v_mfma_f32_16x16x32_bf16 v[140:143], a[172:175], v[168:171], v[140:143]
    buffer_load_dwordx4 a[104:107], v2, s[24:27], s28 offen sc1
    v_mfma_f32_16x16x32_bf16 v[140:143], a[188:191], v[172:175], v[140:143]
    v_xor_b32 v10, 0, v11
    s_waitcnt lgkmcnt(0)
    s_waitcnt vmcnt(25)
    s_barrier
    v_mfma_f32_16x16x32_bf16 v[144:147], a[128:131], v[176:179], v[144:147]
    ds_read_b64_tr_b16 v[160:161], v10 offset:0
    s_xor_b32 s28, s41, 6144
    v_mfma_f32_16x16x32_bf16 v[144:147], a[144:147], v[180:183], v[144:147]
    ds_read_b64_tr_b16 v[162:163], v10 offset:1024
    v_mfma_f32_16x16x32_bf16 v[144:147], a[160:163], v[184:187], v[144:147]
    ds_read_b64_tr_b16 v[164:165], v10 offset:8192
    v_mfma_f32_16x16x32_bf16 v[144:147], a[176:179], v[188:191], v[144:147]
    buffer_load_dwordx4 a[108:111], v2, s[24:27], s28 offen sc1
    v_mfma_f32_16x16x32_bf16 v[148:151], a[132:135], v[176:179], v[148:151]
    ds_read_b64_tr_b16 v[166:167], v10 offset:9216
    s_mov_b32 s9, 1048576
    v_mfma_f32_16x16x32_bf16 v[148:151], a[148:151], v[180:183], v[148:151]
    ds_read_b64_tr_b16 v[168:169], v10 offset:16384
    s_add_u32 m0, s10, 32768
    v_mfma_f32_16x16x32_bf16 v[148:151], a[164:167], v[184:187], v[148:151]
    ds_read_b64_tr_b16 v[170:171], v10 offset:17408
    v_mfma_f32_16x16x32_bf16 v[148:151], a[180:183], v[188:191], v[148:151]
    ds_read_b64_tr_b16 v[172:173], v10 offset:24576
    v_mfma_f32_16x16x32_bf16 v[152:155], a[136:139], v[176:179], v[152:155]
    buffer_load_dwordx4 v16, s[56:59], s9 offen offset:0 lds
    v_mfma_f32_16x16x32_bf16 v[152:155], a[152:155], v[180:183], v[152:155]
    ds_read_b64_tr_b16 v[174:175], v10 offset:25600
    s_xor_b32 s28, s38, 7168
    v_mfma_f32_16x16x32_bf16 v[152:155], a[168:171], v[184:187], v[152:155]
    v_mfma_f32_16x16x32_bf16 v[152:155], a[184:187], v[188:191], v[152:155]
    v_mfma_f32_16x16x32_bf16 v[156:159], a[140:143], v[176:179], v[156:159]
    v_mfma_f32_16x16x32_bf16 v[156:159], a[156:159], v[180:183], v[156:159]
    buffer_load_dwordx4 a[112:115], v2, s[24:27], s28 offen sc1
    v_mfma_f32_16x16x32_bf16 v[156:159], a[172:175], v[184:187], v[156:159]
    s_xor_b32 s28, s39, 7168
    v_mfma_f32_16x16x32_bf16 v[156:159], a[188:191], v[188:191], v[156:159]
    v_xor_b32 v10, 32, v11
    s_waitcnt lgkmcnt(0)
    v_mfma_f32_16x16x32_bf16 v[32:35], a[192:195], v[160:163], v[32:35]
    ds_read_b64_tr_b16 v[176:177], v10 offset:0
    v_mfma_f32_16x16x32_bf16 v[32:35], a[208:211], v[164:167], v[32:35]
    ds_read_b64_tr_b16 v[178:179], v10 offset:1024
    v_mfma_f32_16x16x32_bf16 v[32:35], a[224:227], v[168:171], v[32:35]
    buffer_load_dwordx4 a[116:119], v2, s[24:27], s28 offen sc1
    v_mfma_f32_16x16x32_bf16 v[32:35], a[240:243], v[172:175], v[32:35]
    ds_read_b64_tr_b16 v[180:181], v10 offset:8192
    v_mfma_f32_16x16x32_bf16 v[36:39], a[196:199], v[160:163], v[36:39]
    ds_read_b64_tr_b16 v[182:183], v10 offset:9216
    v_mfma_f32_16x16x32_bf16 v[36:39], a[212:215], v[164:167], v[36:39]
    ds_read_b64_tr_b16 v[184:185], v10 offset:16384
    v_mfma_f32_16x16x32_bf16 v[36:39], a[228:231], v[168:171], v[36:39]
    ds_read_b64_tr_b16 v[186:187], v10 offset:17408
    v_mfma_f32_16x16x32_bf16 v[36:39], a[244:247], v[172:175], v[36:39]
    buffer_load_dwordx4 v17, s[56:59], s9 offen offset:1024 lds
    v_mfma_f32_16x16x32_bf16 v[40:43], a[200:203], v[160:163], v[40:43]
    ds_read_b64_tr_b16 v[188:189], v10 offset:24576
    s_xor_b32 s28, s40, 7168
    v_mfma_f32_16x16x32_bf16 v[40:43], a[216:219], v[164:167], v[40:43]
    ds_read_b64_tr_b16 v[190:191], v10 offset:25600
    v_mfma_f32_16x16x32_bf16 v[40:43], a[232:235], v[168:171], v[40:43]
    v_mfma_f32_16x16x32_bf16 v[40:43], a[248:251], v[172:175], v[40:43]
    v_mfma_f32_16x16x32_bf16 v[44:47], a[204:207], v[160:163], v[44:47]
    buffer_load_dwordx4 a[120:123], v2, s[24:27], s28 offen sc1
    v_mfma_f32_16x16x32_bf16 v[44:47], a[220:223], v[164:167], v[44:47]
    s_xor_b32 s28, s41, 7168
    v_mfma_f32_16x16x32_bf16 v[44:47], a[236:239], v[168:171], v[44:47]
    v_mfma_f32_16x16x32_bf16 v[44:47], a[252:255], v[172:175], v[44:47]
    v_xor_b32 v10, 64, v11
    s_waitcnt lgkmcnt(0)
    v_mfma_f32_16x16x32_bf16 v[48:51], a[192:195], v[176:179], v[48:51]
    ds_read_b64_tr_b16 v[160:161], v10 offset:0
    v_mfma_f32_16x16x32_bf16 v[48:51], a[208:211], v[180:183], v[48:51]
    buffer_load_dwordx4 a[124:127], v2, s[24:27], s28 offen sc1
    v_mfma_f32_16x16x32_bf16 v[48:51], a[224:227], v[184:187], v[48:51]
    ds_read_b64_tr_b16 v[162:163], v10 offset:1024
    v_cvt_pk_bf16_f32 v192, v32, v33
    v_mfma_f32_16x16x32_bf16 v[48:51], a[240:243], v[188:191], v[48:51]
    ds_read_b64_tr_b16 v[164:165], v10 offset:8192
    v_cvt_pk_bf16_f32 v193, v34, v35
    v_mfma_f32_16x16x32_bf16 v[52:55], a[196:199], v[176:179], v[52:55]
    ds_read_b64_tr_b16 v[166:167], v10 offset:9216
    v_cvt_pk_bf16_f32 v194, v36, v37
    v_mfma_f32_16x16x32_bf16 v[52:55], a[212:215], v[180:183], v[52:55]
    ds_read_b64_tr_b16 v[168:169], v10 offset:16384
    v_cvt_pk_bf16_f32 v195, v38, v39
    v_mfma_f32_16x16x32_bf16 v[52:55], a[228:231], v[184:187], v[52:55]
    buffer_load_dwordx4 v18, s[56:59], s9 offen offset:2048 lds
    v_mfma_f32_16x16x32_bf16 v[52:55], a[244:247], v[188:191], v[52:55]
    ds_read_b64_tr_b16 v[170:171], v10 offset:17408
    s_xor_b32 s28, s38, 8192
    v_mfma_f32_16x16x32_bf16 v[56:59], a[200:203], v[176:179], v[56:59]
    ds_read_b64_tr_b16 v[172:173], v10 offset:24576
    v_cvt_pk_bf16_f32 v196, v40, v41
    v_mfma_f32_16x16x32_bf16 v[56:59], a[216:219], v[180:183], v[56:59]
    ds_read_b64_tr_b16 v[174:175], v10 offset:25600
    v_cvt_pk_bf16_f32 v197, v42, v43
    v_mfma_f32_16x16x32_bf16 v[56:59], a[232:235], v[184:187], v[56:59]
    v_cvt_pk_bf16_f32 v198, v44, v45
    v_cvt_pk_bf16_f32 v199, v46, v47
    v_mfma_f32_16x16x32_bf16 v[56:59], a[248:251], v[188:191], v[56:59]
    buffer_load_dwordx4 a[128:131], v2, s[24:27], s28 offen sc1
    v_mfma_f32_16x16x32_bf16 v[60:63], a[204:207], v[176:179], v[60:63]
    v_mfma_f32_16x16x32_bf16 v[60:63], a[220:223], v[180:183], v[60:63]
    v_mfma_f32_16x16x32_bf16 v[60:63], a[236:239], v[184:187], v[60:63]
    v_mfma_f32_16x16x32_bf16 v[60:63], a[252:255], v[188:191], v[60:63]
    v_xor_b32 v10, 96, v11
    s_waitcnt lgkmcnt(0)
    v_mfma_f32_16x16x32_bf16 v[64:67], a[192:195], v[160:163], v[64:67]
    buffer_load_dwordx4 v19, s[56:59], s9 offen offset:3072 lds
    v_mfma_f32_16x16x32_bf16 v[64:67], a[208:211], v[164:167], v[64:67]
    ds_read_b64_tr_b16 v[176:177], v10 offset:0
    s_add_u32 s34, s34, 524288
    v_mfma_f32_16x16x32_bf16 v[64:67], a[224:227], v[168:171], v[64:67]
    ds_read_b64_tr_b16 v[178:179], v10 offset:1024
    s_add_u32 s35, s35, 524288
    v_mfma_f32_16x16x32_bf16 v[64:67], a[240:243], v[172:175], v[64:67]
    ds_read_b64_tr_b16 v[180:181], v10 offset:8192
    s_add_u32 s36, s36, 524288
    v_mfma_f32_16x16x32_bf16 v[68:71], a[196:199], v[160:163], v[68:71]
    ds_read_b64_tr_b16 v[182:183], v10 offset:9216
    s_add_u32 s37, s37, 524288
    v_mfma_f32_16x16x32_bf16 v[68:71], a[212:215], v[164:167], v[68:71]
    buffer_store_dwordx4 v[192:195], v2, s[20:23], s34 offen offset:0 sc1
    v_mfma_f32_16x16x32_bf16 v[68:71], a[228:231], v[168:171], v[68:71]
    ds_read_b64_tr_b16 v[184:185], v10 offset:16384
    s_xor_b32 s28, s39, 8192
    v_mfma_f32_16x16x32_bf16 v[68:71], a[244:247], v[172:175], v[68:71]
    ds_read_b64_tr_b16 v[186:187], v10 offset:17408
    v_cvt_pk_bf16_f32 v200, v48, v49
    v_mfma_f32_16x16x32_bf16 v[72:75], a[200:203], v[160:163], v[72:75]
    ds_read_b64_tr_b16 v[188:189], v10 offset:24576
    v_cvt_pk_bf16_f32 v201, v50, v51
    v_mfma_f32_16x16x32_bf16 v[72:75], a[216:219], v[164:167], v[72:75]
    ds_read_b64_tr_b16 v[190:191], v10 offset:25600
    v_cvt_pk_bf16_f32 v202, v52, v53
    v_mfma_f32_16x16x32_bf16 v[72:75], a[232:235], v[168:171], v[72:75]
    v_cvt_pk_bf16_f32 v203, v54, v55
    v_cvt_pk_bf16_f32 v204, v56, v57
    v_mfma_f32_16x16x32_bf16 v[72:75], a[248:251], v[172:175], v[72:75]
    v_cvt_pk_bf16_f32 v205, v58, v59
    v_cvt_pk_bf16_f32 v206, v60, v61
    v_mfma_f32_16x16x32_bf16 v[76:79], a[204:207], v[160:163], v[76:79]
    v_cvt_pk_bf16_f32 v207, v62, v63
    v_mfma_f32_16x16x32_bf16 v[76:79], a[220:223], v[164:167], v[76:79]
    v_mfma_f32_16x16x32_bf16 v[76:79], a[236:239], v[168:171], v[76:79]
    v_mfma_f32_16x16x32_bf16 v[76:79], a[252:255], v[172:175], v[76:79]
    v_xor_b32 v10, 128, v11
    s_waitcnt lgkmcnt(0)
    v_mfma_f32_16x16x32_bf16 v[80:83], a[192:195], v[176:179], v[80:83]
    ds_read_b64_tr_b16 v[160:161], v10 offset:0
    v_mfma_f32_16x16x32_bf16 v[80:83], a[208:211], v[180:183], v[80:83]
    buffer_load_dwordx4 a[132:135], v2, s[24:27], s28 offen sc1
    v_mfma_f32_16x16x32_bf16 v[80:83], a[224:227], v[184:187], v[80:83]
    ds_read_b64_tr_b16 v[162:163], v10 offset:1024
    v_cvt_pk_bf16_f32 v208, v64, v65
    v_mfma_f32_16x16x32_bf16 v[80:83], a[240:243], v[188:191], v[80:83]
    ds_read_b64_tr_b16 v[164:165], v10 offset:8192
    v_cvt_pk_bf16_f32 v209, v66, v67
    v_mfma_f32_16x16x32_bf16 v[84:87], a[196:199], v[176:179], v[84:87]
    ds_read_b64_tr_b16 v[166:167], v10 offset:9216
    v_cvt_pk_bf16_f32 v210, v68, v69
    v_mfma_f32_16x16x32_bf16 v[84:87], a[212:215], v[180:183], v[84:87]
    ds_read_b64_tr_b16 v[168:169], v10 offset:16384
    v_cvt_pk_bf16_f32 v211, v70, v71
    v_mfma_f32_16x16x32_bf16 v[84:87], a[228:231], v[184:187], v[84:87]
    buffer_store_dwordx4 v[196:199], v2, s[20:23], s36 offen offset:0 sc1
    v_mfma_f32_16x16x32_bf16 v[84:87], a[244:247], v[188:191], v[84:87]
    ds_read_b64_tr_b16 v[170:171], v10 offset:17408
    s_add_u32 m0, s10, 36864
    v_mfma_f32_16x16x32_bf16 v[88:91], a[200:203], v[176:179], v[88:91]
    ds_read_b64_tr_b16 v[172:173], v10 offset:24576
    v_cvt_pk_bf16_f32 v212, v72, v73
    v_mfma_f32_16x16x32_bf16 v[88:91], a[216:219], v[180:183], v[88:91]
    ds_read_b64_tr_b16 v[174:175], v10 offset:25600
    v_cvt_pk_bf16_f32 v213, v74, v75
    v_mfma_f32_16x16x32_bf16 v[88:91], a[232:235], v[184:187], v[88:91]
    v_cvt_pk_bf16_f32 v214, v76, v77
    v_cvt_pk_bf16_f32 v215, v78, v79
    v_mfma_f32_16x16x32_bf16 v[88:91], a[248:251], v[188:191], v[88:91]
    v_mfma_f32_16x16x32_bf16 v[92:95], a[204:207], v[176:179], v[92:95]
    v_mfma_f32_16x16x32_bf16 v[92:95], a[220:223], v[180:183], v[92:95]
    v_mfma_f32_16x16x32_bf16 v[92:95], a[236:239], v[184:187], v[92:95]
    v_mfma_f32_16x16x32_bf16 v[92:95], a[252:255], v[188:191], v[92:95]
    v_xor_b32 v10, 160, v11
    s_waitcnt lgkmcnt(0)
    v_mfma_f32_16x16x32_bf16 v[96:99], a[192:195], v[160:163], v[96:99]
    ds_read_b64_tr_b16 v[176:177], v10 offset:0
    v_mfma_f32_16x16x32_bf16 v[96:99], a[208:211], v[164:167], v[96:99]
    buffer_load_dwordx4 v20, s[56:59], s9 offen offset:0 lds
    v_mfma_f32_16x16x32_bf16 v[96:99], a[224:227], v[168:171], v[96:99]
    ds_read_b64_tr_b16 v[178:179], v10 offset:1024
    s_xor_b32 s28, s40, 8192
    v_mfma_f32_16x16x32_bf16 v[96:99], a[240:243], v[172:175], v[96:99]
    ds_read_b64_tr_b16 v[180:181], v10 offset:8192
    v_cvt_pk_bf16_f32 v216, v80, v81
    v_mfma_f32_16x16x32_bf16 v[100:103], a[196:199], v[160:163], v[100:103]
    ds_read_b64_tr_b16 v[182:183], v10 offset:9216
    v_cvt_pk_bf16_f32 v217, v82, v83
    v_mfma_f32_16x16x32_bf16 v[100:103], a[212:215], v[164:167], v[100:103]
    ds_read_b64_tr_b16 v[184:185], v10 offset:16384
    v_cvt_pk_bf16_f32 v218, v84, v85
    v_mfma_f32_16x16x32_bf16 v[100:103], a[228:231], v[168:171], v[100:103]
    buffer_load_dwordx4 a[136:139], v2, s[24:27], s28 offen sc1
    v_mfma_f32_16x16x32_bf16 v[100:103], a[244:247], v[172:175], v[100:103]
    ds_read_b64_tr_b16 v[186:187], v10 offset:17408
    v_cvt_pk_bf16_f32 v219, v86, v87
    v_mfma_f32_16x16x32_bf16 v[104:107], a[200:203], v[160:163], v[104:107]
    ds_read_b64_tr_b16 v[188:189], v10 offset:24576
    v_cvt_pk_bf16_f32 v220, v88, v89
    v_mfma_f32_16x16x32_bf16 v[104:107], a[216:219], v[164:167], v[104:107]
    ds_read_b64_tr_b16 v[190:191], v10 offset:25600
    v_cvt_pk_bf16_f32 v221, v90, v91
    v_mfma_f32_16x16x32_bf16 v[104:107], a[232:235], v[168:171], v[104:107]
    v_cvt_pk_bf16_f32 v222, v92, v93
    v_cvt_pk_bf16_f32 v223, v94, v95
    v_mfma_f32_16x16x32_bf16 v[104:107], a[248:251], v[172:175], v[104:107]
    buffer_store_dwordx4 v[200:203], v2, s[20:23], s34 offen offset:1024 sc1
    v_mfma_f32_16x16x32_bf16 v[108:111], a[204:207], v[160:163], v[108:111]
    v_mfma_f32_16x16x32_bf16 v[108:111], a[220:223], v[164:167], v[108:111]
    v_mfma_f32_16x16x32_bf16 v[108:111], a[236:239], v[168:171], v[108:111]
    v_mfma_f32_16x16x32_bf16 v[108:111], a[252:255], v[172:175], v[108:111]
    v_xor_b32 v10, 192, v11
    s_waitcnt lgkmcnt(0)
    v_mfma_f32_16x16x32_bf16 v[112:115], a[192:195], v[176:179], v[112:115]
    ds_read_b64_tr_b16 v[160:161], v10 offset:0
    v_mfma_f32_16x16x32_bf16 v[112:115], a[208:211], v[180:183], v[112:115]
    ds_read_b64_tr_b16 v[162:163], v10 offset:1024
    v_cvt_pk_bf16_f32 v224, v96, v97
    v_mfma_f32_16x16x32_bf16 v[112:115], a[224:227], v[184:187], v[112:115]
    ds_read_b64_tr_b16 v[164:165], v10 offset:8192
    v_cvt_pk_bf16_f32 v225, v98, v99
    v_mfma_f32_16x16x32_bf16 v[112:115], a[240:243], v[188:191], v[112:115]
    ds_read_b64_tr_b16 v[166:167], v10 offset:9216
    v_cvt_pk_bf16_f32 v226, v100, v101
    v_mfma_f32_16x16x32_bf16 v[116:119], a[196:199], v[176:179], v[116:119]
    ds_read_b64_tr_b16 v[168:169], v10 offset:16384
    v_cvt_pk_bf16_f32 v227, v102, v103
    v_mfma_f32_16x16x32_bf16 v[116:119], a[212:215], v[180:183], v[116:119]
    ds_read_b64_tr_b16 v[170:171], v10 offset:17408
    v_cvt_pk_bf16_f32 v228, v104, v105
    v_mfma_f32_16x16x32_bf16 v[116:119], a[228:231], v[184:187], v[116:119]
    ds_read_b64_tr_b16 v[172:173], v10 offset:24576
    v_cvt_pk_bf16_f32 v229, v106, v107
    v_mfma_f32_16x16x32_bf16 v[116:119], a[244:247], v[188:191], v[116:119]
    buffer_load_dwordx4 v21, s[56:59], s9 offen offset:1024 lds
    v_mfma_f32_16x16x32_bf16 v[120:123], a[200:203], v[176:179], v[120:123]
    ds_read_b64_tr_b16 v[174:175], v10 offset:25600
    s_xor_b32 s28, s41, 8192
    v_mfma_f32_16x16x32_bf16 v[120:123], a[216:219], v[180:183], v[120:123]
    v_cvt_pk_bf16_f32 v230, v108, v109
    v_cvt_pk_bf16_f32 v231, v110, v111
    v_mfma_f32_16x16x32_bf16 v[120:123], a[232:235], v[184:187], v[120:123]
    v_mfma_f32_16x16x32_bf16 v[120:123], a[248:251], v[188:191], v[120:123]
    v_mfma_f32_16x16x32_bf16 v[124:127], a[204:207], v[176:179], v[124:127]
    buffer_load_dwordx4 a[140:143], v2, s[24:27], s28 offen sc1
    v_mfma_f32_16x16x32_bf16 v[124:127], a[220:223], v[180:183], v[124:127]
    v_mfma_f32_16x16x32_bf16 v[124:127], a[236:239], v[184:187], v[124:127]
    v_mfma_f32_16x16x32_bf16 v[124:127], a[252:255], v[188:191], v[124:127]
    v_xor_b32 v10, 224, v11
    s_waitcnt lgkmcnt(0)
    v_mfma_f32_16x16x32_bf16 v[128:131], a[192:195], v[160:163], v[128:131]
    ds_read_b64_tr_b16 v[176:177], v10 offset:0
    v_mfma_f32_16x16x32_bf16 v[128:131], a[208:211], v[164:167], v[128:131]
    buffer_store_dwordx4 v[204:207], v2, s[20:23], s36 offen offset:1024 sc1
    v_mfma_f32_16x16x32_bf16 v[128:131], a[224:227], v[168:171], v[128:131]
    ds_read_b64_tr_b16 v[178:179], v10 offset:1024
    v_cvt_pk_bf16_f32 v232, v112, v113
    v_mfma_f32_16x16x32_bf16 v[128:131], a[240:243], v[172:175], v[128:131]
    ds_read_b64_tr_b16 v[180:181], v10 offset:8192
    v_cvt_pk_bf16_f32 v233, v114, v115
    v_mfma_f32_16x16x32_bf16 v[132:135], a[196:199], v[160:163], v[132:135]
    ds_read_b64_tr_b16 v[182:183], v10 offset:9216
    v_cvt_pk_bf16_f32 v234, v116, v117
    v_mfma_f32_16x16x32_bf16 v[132:135], a[212:215], v[164:167], v[132:135]
    ds_read_b64_tr_b16 v[184:185], v10 offset:16384
    v_cvt_pk_bf16_f32 v235, v118, v119
    v_mfma_f32_16x16x32_bf16 v[132:135], a[228:231], v[168:171], v[132:135]
    ds_read_b64_tr_b16 v[186:187], v10 offset:17408
    v_cvt_pk_bf16_f32 v236, v120, v121
    v_mfma_f32_16x16x32_bf16 v[132:135], a[244:247], v[172:175], v[132:135]
    ds_read_b64_tr_b16 v[188:189], v10 offset:24576
    v_cvt_pk_bf16_f32 v237, v122, v123
    v_mfma_f32_16x16x32_bf16 v[136:139], a[200:203], v[160:163], v[136:139]
    ds_read_b64_tr_b16 v[190:191], v10 offset:25600
    v_cvt_pk_bf16_f32 v238, v124, v125
    v_mfma_f32_16x16x32_bf16 v[136:139], a[216:219], v[164:167], v[136:139]
    v_cvt_pk_bf16_f32 v239, v126, v127
    v_mfma_f32_16x16x32_bf16 v[136:139], a[232:235], v[168:171], v[136:139]
    v_mfma_f32_16x16x32_bf16 v[136:139], a[248:251], v[172:175], v[136:139]
    v_mfma_f32_16x16x32_bf16 v[140:143], a[204:207], v[160:163], v[140:143]
    buffer_load_dwordx4 v22, s[56:59], s9 offen offset:2048 lds
    v_mfma_f32_16x16x32_bf16 v[140:143], a[220:223], v[164:167], v[140:143]
    s_xor_b32 s28, s38, 9216
    v_mfma_f32_16x16x32_bf16 v[140:143], a[236:239], v[168:171], v[140:143]
    v_mfma_f32_16x16x32_bf16 v[140:143], a[252:255], v[172:175], v[140:143]
    v_xor_b32 v10, 131072, v11
    s_waitcnt lgkmcnt(0)
    s_waitcnt vmcnt(21)
    s_barrier
    v_mfma_f32_16x16x32_bf16 v[144:147], a[192:195], v[176:179], v[144:147]
    ds_read_b64_tr_b16 v[160:161], v10 offset:0
    v_mfma_f32_16x16x32_bf16 v[144:147], a[208:211], v[180:183], v[144:147]
    buffer_load_dwordx4 a[144:147], v2, s[24:27], s28 offen sc1
    v_mfma_f32_16x16x32_bf16 v[144:147], a[224:227], v[184:187], v[144:147]
    ds_read_b64_tr_b16 v[162:163], v10 offset:1024
    v_cvt_pk_bf16_f32 v240, v128, v129
    v_mfma_f32_16x16x32_bf16 v[144:147], a[240:243], v[188:191], v[144:147]
    ds_read_b64_tr_b16 v[164:165], v10 offset:8192
    v_cvt_pk_bf16_f32 v241, v130, v131
    v_mfma_f32_16x16x32_bf16 v[148:151], a[196:199], v[176:179], v[148:151]
    ds_read_b64_tr_b16 v[166:167], v10 offset:9216
    v_cvt_pk_bf16_f32 v242, v132, v133
    v_mfma_f32_16x16x32_bf16 v[148:151], a[212:215], v[180:183], v[148:151]
    ds_read_b64_tr_b16 v[168:169], v10 offset:16384
    v_cvt_pk_bf16_f32 v243, v134, v135
    v_mfma_f32_16x16x32_bf16 v[148:151], a[228:231], v[184:187], v[148:151]
    buffer_store_dwordx4 v[208:211], v2, s[20:23], s34 offen offset:2048 sc1
    v_mfma_f32_16x16x32_bf16 v[148:151], a[244:247], v[188:191], v[148:151]
    ds_read_b64_tr_b16 v[170:171], v10 offset:17408
    v_cvt_pk_bf16_f32 v244, v136, v137
    v_mfma_f32_16x16x32_bf16 v[152:155], a[200:203], v[176:179], v[152:155]
    ds_read_b64_tr_b16 v[172:173], v10 offset:24576
    v_cvt_pk_bf16_f32 v245, v138, v139
    v_mfma_f32_16x16x32_bf16 v[152:155], a[216:219], v[180:183], v[152:155]
    ds_read_b64_tr_b16 v[174:175], v10 offset:25600
    v_cvt_pk_bf16_f32 v246, v140, v141
    v_mfma_f32_16x16x32_bf16 v[152:155], a[232:235], v[184:187], v[152:155]
    v_cvt_pk_bf16_f32 v247, v142, v143
    v_mfma_f32_16x16x32_bf16 v[152:155], a[248:251], v[188:191], v[152:155]
    v_mfma_f32_16x16x32_bf16 v[156:159], a[204:207], v[176:179], v[156:159]
    v_mfma_f32_16x16x32_bf16 v[156:159], a[220:223], v[180:183], v[156:159]
    v_mfma_f32_16x16x32_bf16 v[156:159], a[236:239], v[184:187], v[156:159]
    v_mfma_f32_16x16x32_bf16 v[156:159], a[252:255], v[188:191], v[156:159]
    v_xor_b32 v10, 131104, v11
    s_waitcnt lgkmcnt(0)
    v_mfma_f32_16x16x32_bf16 v[32:35], v[160:163], a[0:3], 0
    ds_read_b64_tr_b16 v[176:177], v10 offset:0
    v_mfma_f32_16x16x32_bf16 v[32:35], v[164:167], a[16:19], v[32:35]
    ds_read_b64_tr_b16 v[178:179], v10 offset:1024
    v_cvt_pk_bf16_f32 v248, v144, v145
    v_mfma_f32_16x16x32_bf16 v[32:35], v[168:171], a[32:35], v[32:35]
    buffer_load_dwordx4 v23, s[56:59], s9 offen offset:3072 lds
    v_mfma_f32_16x16x32_bf16 v[32:35], v[172:175], a[48:51], v[32:35]
    ds_read_b64_tr_b16 v[180:181], v10 offset:8192
    s_xor_b32 s28, s39, 9216
    v_mfma_f32_16x16x32_bf16 v[36:39], v[160:163], a[4:7], 0
    ds_read_b64_tr_b16 v[182:183], v10 offset:9216
    v_cvt_pk_bf16_f32 v249, v146, v147
    v_mfma_f32_16x16x32_bf16 v[36:39], v[164:167], a[20:23], v[36:39]
    ds_read_b64_tr_b16 v[184:185], v10 offset:16384
    v_cvt_pk_bf16_f32 v250, v148, v149
    v_mfma_f32_16x16x32_bf16 v[36:39], v[168:171], a[36:39], v[36:39]
    ds_read_b64_tr_b16 v[186:187], v10 offset:17408
    v_cvt_pk_bf16_f32 v251, v150, v151
    v_mfma_f32_16x16x32_bf16 v[36:39], v[172:175], a[52:55], v[36:39]
    buffer_load_dwordx4 a[148:151], v2, s[24:27], s28 offen sc1
    v_mfma_f32_16x16x32_bf16 v[40:43], v[160:163], a[8:11], 0
    ds_read_b64_tr_b16 v[188:189], v10 offset:24576
    v_cvt_pk_bf16_f32 v252, v152, v153
    v_mfma_f32_16x16x32_bf16 v[40:43], v[164:167], a[24:27], v[40:43]
    ds_read_b64_tr_b16 v[190:191], v10 offset:25600
    v_cvt_pk_bf16_f32 v253, v154, v155
    v_mfma_f32_16x16x32_bf16 v[40:43], v[168:171], a[40:43], v[40:43]
    v_cvt_pk_bf16_f32 v254, v156, v157
    v_cvt_pk_bf16_f32 v255, v158, v159
    v_mfma_f32_16x16x32_bf16 v[40:43], v[172:175], a[56:59], v[40:43]
    v_mfma_f32_16x16x32_bf16 v[44:47], v[160:163], a[12:15], 0
    buffer_store_dwordx4 v[212:215], v2, s[20:23], s36 offen offset:2048 sc1
    v_mfma_f32_16x16x32_bf16 v[44:47], v[164:167], a[28:31], v[44:47]
    s_mov_b32 s9, 2097152
    s_add_u32 m0, s10, 65536
    v_mfma_f32_16x16x32_bf16 v[44:47], v[168:171], a[44:47], v[44:47]
    v_mfma_f32_16x16x32_bf16 v[44:47], v[172:175], a[60:63], v[44:47]
    v_xor_b32 v10, 131136, v11
    s_waitcnt lgkmcnt(0)
    v_mfma_f32_16x16x32_bf16 v[48:51], v[176:179], a[0:3], 0
    ds_read_b64_tr_b16 v[160:161], v10 offset:0
    v_mfma_f32_16x16x32_bf16 v[48:51], v[180:183], a[16:19], v[48:51]
    ds_read_b64_tr_b16 v[162:163], v10 offset:1024
    v_mfma_f32_16x16x32_bf16 v[48:51], v[184:187], a[32:35], v[48:51]
    ds_read_b64_tr_b16 v[164:165], v10 offset:8192
    v_mfma_f32_16x16x32_bf16 v[48:51], v[188:191], a[48:51], v[48:51]
    ds_read_b64_tr_b16 v[166:167], v10 offset:9216
    v_mfma_f32_16x16x32_bf16 v[52:55], v[176:179], a[4:7], 0
    ds_read_b64_tr_b16 v[168:169], v10 offset:16384
    v_mfma_f32_16x16x32_bf16 v[52:55], v[180:183], a[20:23], v[52:55]
    ds_read_b64_tr_b16 v[170:171], v10 offset:17408
    v_mfma_f32_16x16x32_bf16 v[52:55], v[184:187], a[36:39], v[52:55]
    ds_read_b64_tr_b16 v[172:173], v10 offset:24576
    v_mfma_f32_16x16x32_bf16 v[52:55], v[188:191], a[52:55], v[52:55]
    buffer_load_dwordx4 v16, s[56:59], s9 offen offset:0 lds
    v_mfma_f32_16x16x32_bf16 v[56:59], v[176:179], a[8:11], 0
    ds_read_b64_tr_b16 v[174:175], v10 offset:25600
    s_xor_b32 s28, s40, 9216
    v_mfma_f32_16x16x32_bf16 v[56:59], v[180:183], a[24:27], v[56:59]
    v_mfma_f32_16x16x32_bf16 v[56:59], v[184:187], a[40:43], v[56:59]
    v_mfma_f32_16x16x32_bf16 v[56:59], v[188:191], a[56:59], v[56:59]
    v_mfma_f32_16x16x32_bf16 v[60:63], v[176:179], a[12:15], 0
    buffer_load_dwordx4 a[152:155], v2, s[24:27], s28 offen sc1
    v_mfma_f32_16x16x32_bf16 v[60:63], v[180:183], a[28:31], v[60:63]
    v_mfma_f32_16x16x32_bf16 v[60:63], v[184:187], a[44:47], v[60:63]
    v_mfma_f32_16x16x32_bf16 v[60:63], v[188:191], a[60:63], v[60:63]
    v_xor_b32 v10, 131168, v11
    s_waitcnt lgkmcnt(0)
    v_mfma_f32_16x16x32_bf16 v[64:67], v[160:163], a[0:3], 0
    ds_read_b64_tr_b16 v[176:177], v10 offset:0
    v_mfma_f32_16x16x32_bf16 v[64:67], v[164:167], a[16:19], v[64:67]
    buffer_load_dwordx4 v17, s[56:59], s9 offen offset:1024 lds
    v_mfma_f32_16x16x32_bf16 v[64:67], v[168:171], a[32:35], v[64:67]
    ds_read_b64_tr_b16 v[178:179], v10 offset:1024
    s_xor_b32 s28, s41, 9216
    v_mfma_f32_16x16x32_bf16 v[64:67], v[172:175], a[48:51], v[64:67]
    ds_read_b64_tr_b16 v[180:181], v10 offset:8192
    v_mfma_f32_16x16x32_bf16 v[68:71], v[160:163], a[4:7], 0
    ds_read_b64_tr_b16 v[182:183], v10 offset:9216
    v_mfma_f32_16x16x32_bf16 v[68:71], v[164:167], a[20:23], v[68:71]
    ds_read_b64_tr_b16 v[184:185], v10 offset:16384
    v_mfma_f32_16x16x32_bf16 v[68:71], v[168:171], a[36:39], v[68:71]
    buffer_load_dwordx4 a[156:159], v2, s[24:27], s28 offen sc1
    v_mfma_f32_16x16x32_bf16 v[68:71], v[172:175], a[52:55], v[68:71]
    ds_read_b64_tr_b16 v[186:187], v10 offset:17408
    v_mfma_f32_16x16x32_bf16 v[72:75], v[160:163], a[8:11], 0
    ds_read_b64_tr_b16 v[188:189], v10 offset:24576
    v_mfma_f32_16x16x32_bf16 v[72:75], v[164:167], a[24:27], v[72:75]
    ds_read_b64_tr_b16 v[190:191], v10 offset:25600
    v_mfma_f32_16x16x32_bf16 v[72:75], v[168:171], a[40:43], v[72:75]
    v_mfma_f32_16x16x32_bf16 v[72:75], v[172:175], a[56:59], v[72:75]
    buffer_store_dwordx4 v[216:219], v2, s[20:23], s34 offen offset:3072 sc1
    v_mfma_f32_16x16x32_bf16 v[76:79], v[160:163], a[12:15], 0
    v_mfma_f32_16x16x32_bf16 v[76:79], v[164:167], a[28:31], v[76:79]
    v_mfma_f32_16x16x32_bf16 v[76:79], v[168:171], a[44:47], v[76:79]
    v_mfma_f32_16x16x32_bf16 v[76:79], v[172:175], a[60:63], v[76:79]
    v_xor_b32 v10, 131200, v11
    s_waitcnt lgkmcnt(0)
    v_mfma_f32_16x16x32_bf16 v[80:83], v[176:179], a[0:3], 0
    ds_read_b64_tr_b16 v[160:161], v10 offset:0
    v_mfma_f32_16x16x32_bf16 v[80:83], v[180:183], a[16:19], v[80:83]
    ds_read_b64_tr_b16 v[162:163], v10 offset:1024
    v_mfma_f32_16x16x32_bf16 v[80:83], v[184:187], a[32:35], v[80:83]
    ds_read_b64_tr_b16 v[164:165], v10 offset:8192
    v_mfma_f32_16x16x32_bf16 v[80:83], v[188:191], a[48:51], v[80:83]
    ds_read_b64_tr_b16 v[166:167], v10 offset:9216
    v_mfma_f32_16x16x32_bf16 v[84:87], v[176:179], a[4:7], 0
    ds_read_b64_tr_b16 v[168:169], v10 offset:16384
    v_mfma_f32_16x16x32_bf16 v[84:87], v[180:183], a[20:23], v[84:87]
    ds_read_b64_tr_b16 v[170:171], v10 offset:17408
    v_mfma_f32_16x16x32_bf16 v[84:87], v[184:187], a[36:39], v[84:87]
    ds_read_b64_tr_b16 v[172:173], v10 offset:24576
    v_mfma_f32_16x16x32_bf16 v[84:87], v[188:191], a[52:55], v[84:87]
    buffer_load_dwordx4 v18, s[56:59], s9 offen offset:2048 lds
    v_mfma_f32_16x16x32_bf16 v[88:91], v[176:179], a[8:11], 0
    ds_read_b64_tr_b16 v[174:175], v10 offset:25600
    s_xor_b32 s28, s38, 10240
    v_mfma_f32_16x16x32_bf16 v[88:91], v[180:183], a[24:27], v[88:91]
    v_mfma_f32_16x16x32_bf16 v[88:91], v[184:187], a[40:43], v[88:91]
    v_mfma_f32_16x16x32_bf16 v[88:91], v[188:191], a[56:59], v[88:91]
    v_mfma_f32_16x16x32_bf16 v[92:95], v[176:179], a[12:15], 0
    buffer_load_dwordx4 a[160:163], v2, s[24:27], s28 offen sc1
    v_mfma_f32_16x16x32_bf16 v[92:95], v[180:183], a[28:31], v[92:95]
    v_mfma_f32_16x16x32_bf16 v[92:95], v[184:187], a[44:47], v[92:95]
    v_mfma_f32_16x16x32_bf16 v[92:95], v[188:191], a[60:63], v[92:95]
    v_xor_b32 v10, 131232, v11
    s_waitcnt lgkmcnt(0)
    v_mfma_f32_16x16x32_bf16 v[96:99], v[160:163], a[0:3], 0
    ds_read_b64_tr_b16 v[176:177], v10 offset:0
    v_mfma_f32_16x16x32_bf16 v[96:99], v[164:167], a[16:19], v[96:99]
    buffer_store_dwordx4 v[220:223], v2, s[20:23], s36 offen offset:3072 sc1
    v_mfma_f32_16x16x32_bf16 v[96:99], v[168:171], a[32:35], v[96:99]
    ds_read_b64_tr_b16 v[178:179], v10 offset:1024
    v_mfma_f32_16x16x32_bf16 v[96:99], v[172:175], a[48:51], v[96:99]
    ds_read_b64_tr_b16 v[180:181], v10 offset:8192
    v_mfma_f32_16x16x32_bf16 v[100:103], v[160:163], a[4:7], 0
    ds_read_b64_tr_b16 v[182:183], v10 offset:9216
    v_mfma_f32_16x16x32_bf16 v[100:103], v[164:167], a[20:23], v[100:103]
    ds_read_b64_tr_b16 v[184:185], v10 offset:16384
    v_mfma_f32_16x16x32_bf16 v[100:103], v[168:171], a[36:39], v[100:103]
    ds_read_b64_tr_b16 v[186:187], v10 offset:17408
    v_mfma_f32_16x16x32_bf16 v[100:103], v[172:175], a[52:55], v[100:103]
    ds_read_b64_tr_b16 v[188:189], v10 offset:24576
    v_mfma_f32_16x16x32_bf16 v[104:107], v[160:163], a[8:11], 0
    ds_read_b64_tr_b16 v[190:191], v10 offset:25600
    v_mfma_f32_16x16x32_bf16 v[104:107], v[164:167], a[24:27], v[104:107]
    v_mfma_f32_16x16x32_bf16 v[104:107], v[168:171], a[40:43], v[104:107]
    v_mfma_f32_16x16x32_bf16 v[104:107], v[172:175], a[56:59], v[104:107]
    v_mfma_f32_16x16x32_bf16 v[108:111], v[160:163], a[12:15], 0
    buffer_load_dwordx4 v19, s[56:59], s9 offen offset:3072 lds
    v_mfma_f32_16x16x32_bf16 v[108:111], v[164:167], a[28:31], v[108:111]
    s_xor_b32 s28, s39, 10240
    v_mfma_f32_16x16x32_bf16 v[108:111], v[168:171], a[44:47], v[108:111]
    v_mfma_f32_16x16x32_bf16 v[108:111], v[172:175], a[60:63], v[108:111]
    v_xor_b32 v10, 131264, v11
    s_waitcnt lgkmcnt(0)
    v_mfma_f32_16x16x32_bf16 v[112:115], v[176:179], a[0:3], 0
    ds_read_b64_tr_b16 v[160:161], v10 offset:0
    v_mfma_f32_16x16x32_bf16 v[112:115], v[180:183], a[16:19], v[112:115]
    buffer_load_dwordx4 a[164:167], v2, s[24:27], s28 offen sc1
    v_mfma_f32_16x16x32_bf16 v[112:115], v[184:187], a[32:35], v[112:115]
    ds_read_b64_tr_b16 v[162:163], v10 offset:1024
    v_mfma_f32_16x16x32_bf16 v[112:115], v[188:191], a[48:51], v[112:115]
    ds_read_b64_tr_b16 v[164:165], v10 offset:8192
    v_mfma_f32_16x16x32_bf16 v[116:119], v[176:179], a[4:7], 0
    ds_read_b64_tr_b16 v[166:167], v10 offset:9216
    v_mfma_f32_16x16x32_bf16 v[116:119], v[180:183], a[20:23], v[116:119]
    ds_read_b64_tr_b16 v[168:169], v10 offset:16384
    v_mfma_f32_16x16x32_bf16 v[116:119], v[184:187], a[36:39], v[116:119]
    buffer_store_dwordx4 v[224:227], v2, s[20:23], s35 offen offset:0 sc1
    v_mfma_f32_16x16x32_bf16 v[116:119], v[188:191], a[52:55], v[116:119]
    ds_read_b64_tr_b16 v[170:171], v10 offset:17408
    s_add_u32 m0, s10, 69632
    v_mfma_f32_16x16x32_bf16 v[120:123], v[176:179], a[8:11], 0
    ds_read_b64_tr_b16 v[172:173], v10 offset:24576
    v_mfma_f32_16x16x32_bf16 v[120:123], v[180:183], a[24:27], v[120:123]
    ds_read_b64_tr_b16 v[174:175], v10 offset:25600
    v_mfma_f32_16x16x32_bf16 v[120:123], v[184:187], a[40:43], v[120:123]
    v_mfma_f32_16x16x32_bf16 v[120:123], v[188:191], a[56:59], v[120:123]
    v_mfma_f32_16x16x32_bf16 v[124:127], v[176:179], a[12:15], 0
    v_mfma_f32_16x16x32_bf16 v[124:127], v[180:183], a[28:31], v[124:127]
    v_mfma_f32_16x16x32_bf16 v[124:127], v[184:187], a[44:47], v[124:127]
    v_mfma_f32_16x16x32_bf16 v[124:127], v[188:191], a[60:63], v[124:127]
    v_xor_b32 v10, 131296, v11
    s_waitcnt lgkmcnt(0)
    v_mfma_f32_16x16x32_bf16 v[128:131], v[160:163], a[0:3], 0
    ds_read_b64_tr_b16 v[176:177], v10 offset:0
    v_mfma_f32_16x16x32_bf16 v[128:131], v[164:167], a[16:19], v[128:131]
    ds_read_b64_tr_b16 v[178:179], v10 offset:1024
    v_mfma_f32_16x16x32_bf16 v[128:131], v[168:171], a[32:35], v[128:131]
    buffer_load_dwordx4 v20, s[56:59], s9 offen offset:0 lds
    v_mfma_f32_16x16x32_bf16 v[128:131], v[172:175], a[48:51], v[128:131]
    ds_read_b64_tr_b16 v[180:181], v10 offset:8192
    s_xor_b32 s28, s40, 10240
    v_mfma_f32_16x16x32_bf16 v[132:135], v[160:163], a[4:7], 0
    ds_read_b64_tr_b16 v[182:183], v10 offset:9216
    v_mfma_f32_16x16x32_bf16 v[132:135], v[164:167], a[20:23], v[132:135]
    ds_read_b64_tr_b16 v[184:185], v10 offset:16384
    v_mfma_f32_16x16x32_bf16 v[132:135], v[168:171], a[36:39], v[132:135]
    ds_read_b64_tr_b16 v[186:187], v10 offset:17408
    v_mfma_f32_16x16x32_bf16 v[132:135], v[172:175], a[52:55], v[132:135]
    buffer_load_dwordx4 a[168:171], v2, s[24:27], s28 offen sc1
    v_mfma_f32_16x16x32_bf16 v[136:139], v[160:163], a[8:11], 0
    ds_read_b64_tr_b16 v[188:189], v10 offset:24576
    v_mfma_f32_16x16x32_bf16 v[136:139], v[164:167], a[24:27], v[136:139]
    ds_read_b64_tr_b16 v[190:191], v10 offset:25600
    v_mfma_f32_16x16x32_bf16 v[136:139], v[168:171], a[40:43], v[136:139]
    v_mfma_f32_16x16x32_bf16 v[136:139], v[172:175], a[56:59], v[136:139]
    v_mfma_f32_16x16x32_bf16 v[140:143], v[160:163], a[12:15], 0
    buffer_store_dwordx4 v[228:231], v2, s[20:23], s37 offen offset:0 sc1
    v_mfma_f32_16x16x32_bf16 v[140:143], v[164:167], a[28:31], v[140:143]
    v_mfma_f32_16x16x32_bf16 v[140:143], v[168:171], a[44:47], v[140:143]
    v_mfma_f32_16x16x32_bf16 v[140:143], v[172:175], a[60:63], v[140:143]
    v_xor_b32 v10, 32768, v11
    s_waitcnt lgkmcnt(0)
    s_waitcnt vmcnt(16)
    s_barrier
    v_mfma_f32_16x16x32_bf16 v[144:147], v[176:179], a[0:3], 0
    ds_read_b64_tr_b16 v[160:161], v10 offset:0
    v_mfma_f32_16x16x32_bf16 v[144:147], v[180:183], a[16:19], v[144:147]
    ds_read_b64_tr_b16 v[162:163], v10 offset:1024
    v_mfma_f32_16x16x32_bf16 v[144:147], v[184:187], a[32:35], v[144:147]
    ds_read_b64_tr_b16 v[164:165], v10 offset:8192
    v_mfma_f32_16x16x32_bf16 v[144:147], v[188:191], a[48:51], v[144:147]
    ds_read_b64_tr_b16 v[166:167], v10 offset:9216
    v_mfma_f32_16x16x32_bf16 v[148:151], v[176:179], a[4:7], 0
    ds_read_b64_tr_b16 v[168:169], v10 offset:16384
    v_mfma_f32_16x16x32_bf16 v[148:151], v[180:183], a[20:23], v[148:151]
    ds_read_b64_tr_b16 v[170:171], v10 offset:17408
    v_mfma_f32_16x16x32_bf16 v[148:151], v[184:187], a[36:39], v[148:151]
    ds_read_b64_tr_b16 v[172:173], v10 offset:24576
    v_mfma_f32_16x16x32_bf16 v[148:151], v[188:191], a[52:55], v[148:151]
    buffer_load_dwordx4 v21, s[56:59], s9 offen offset:1024 lds
    v_mfma_f32_16x16x32_bf16 v[152:155], v[176:179], a[8:11], 0
    ds_read_b64_tr_b16 v[174:175], v10 offset:25600
    s_xor_b32 s28, s41, 10240
    v_mfma_f32_16x16x32_bf16 v[152:155], v[180:183], a[24:27], v[152:155]
    v_mfma_f32_16x16x32_bf16 v[152:155], v[184:187], a[40:43], v[152:155]
    v_mfma_f32_16x16x32_bf16 v[152:155], v[188:191], a[56:59], v[152:155]
    v_mfma_f32_16x16x32_bf16 v[156:159], v[176:179], a[12:15], 0
    buffer_load_dwordx4 a[172:175], v2, s[24:27], s28 offen sc1
    v_mfma_f32_16x16x32_bf16 v[156:159], v[180:183], a[28:31], v[156:159]
    v_mfma_f32_16x16x32_bf16 v[156:159], v[184:187], a[44:47], v[156:159]
    v_mfma_f32_16x16x32_bf16 v[156:159], v[188:191], a[60:63], v[156:159]
    v_xor_b32 v10, 32800, v11
    s_waitcnt lgkmcnt(0)
    v_mfma_f32_16x16x32_bf16 v[32:35], v[160:163], a[64:67], v[32:35]
    ds_read_b64_tr_b16 v[176:177], v10 offset:0
    s_lshl_b32 s8, s4, 10
    v_mfma_f32_16x16x32_bf16 v[32:35], v[164:167], a[80:83], v[32:35]
    buffer_store_dwordx4 v[232:235], v2, s[20:23], s35 offen offset:1024 sc1
    v_mfma_f32_16x16x32_bf16 v[32:35], v[168:171], a[96:99], v[32:35]
    ds_read_b64_tr_b16 v[178:179], v10 offset:1024
    s_lshl_b32 s42, s5, 7
    v_mfma_f32_16x16x32_bf16 v[32:35], v[172:175], a[112:115], v[32:35]
    ds_read_b64_tr_b16 v[180:181], v10 offset:8192
    s_add_u32 s42, s42, s8
    v_mfma_f32_16x16x32_bf16 v[36:39], v[160:163], a[68:71], v[36:39]
    ds_read_b64_tr_b16 v[182:183], v10 offset:9216
    v_and_b32 v14, 56, v1
    v_mfma_f32_16x16x32_bf16 v[36:39], v[164:167], a[84:87], v[36:39]
    ds_read_b64_tr_b16 v[184:185], v10 offset:16384
    v_lshlrev_b32 v14, 25, v14
    v_mfma_f32_16x16x32_bf16 v[36:39], v[168:171], a[100:103], v[36:39]
    ds_read_b64_tr_b16 v[186:187], v10 offset:17408
    v_lshl_or_b32 v14, v1, 7, v14
    v_mfma_f32_16x16x32_bf16 v[36:39], v[172:175], a[116:119], v[36:39]
    ds_read_b64_tr_b16 v[188:189], v10 offset:24576
    s_cmp_eq_u32 s3, 0
    s_cselect_b32 s81, 8, 0
    v_mfma_f32_16x16x32_bf16 v[40:43], v[160:163], a[72:75], v[40:43]
    ds_read_b64_tr_b16 v[190:191], v10 offset:25600
    s_lshr_b32 s83, s12, 1
    v_mfma_f32_16x16x32_bf16 v[40:43], v[164:167], a[88:91], v[40:43]
    s_lshl_b32 s83, s83, 2
    s_lshr_b32 s6, s4, 3
    v_mfma_f32_16x16x32_bf16 v[40:43], v[168:171], a[104:107], v[40:43]
    s_add_u32 s83, s83, s6
    s_lshl_b32 s83, s83, 9
    v_mfma_f32_16x16x32_bf16 v[40:43], v[172:175], a[120:123], v[40:43]
    s_bfe_u32 s96, s2, 0x20001
    s_lshl_b32 s96, s96, 2
    v_mfma_f32_16x16x32_bf16 v[44:47], v[160:163], a[76:79], v[44:47]
    s_and_b32 s7, s5, 3
    s_add_u32 s96, s96, s7
    v_mfma_f32_16x16x32_bf16 v[44:47], v[164:167], a[92:95], v[44:47]
    buffer_load_dwordx4 v22, s[56:59], s9 offen offset:2048 lds
    v_mfma_f32_16x16x32_bf16 v[44:47], v[168:171], a[108:111], v[44:47]
    s_xor_b32 s28, s38, 11264
    s_and_b32 s7, s2, 0xe0
    v_mfma_f32_16x16x32_bf16 v[44:47], v[172:175], a[124:127], v[44:47]
    v_xor_b32 v10, 32832, v11
    s_waitcnt lgkmcnt(0)
    v_mfma_f32_16x16x32_bf16 v[48:51], v[176:179], a[64:67], v[48:51]
    ds_read_b64_tr_b16 v[160:161], v10 offset:0
    s_add_u32 s96, s96, s7
    v_mfma_f32_16x16x32_bf16 v[48:51], v[180:183], a[80:83], v[48:51]
    ds_read_b64_tr_b16 v[162:163], v10 offset:1024
    s_and_b32 s7, s2, 1
    v_mfma_f32_16x16x32_bf16 v[48:51], v[184:187], a[96:99], v[48:51]
    buffer_load_dwordx4 a[176:179], v2, s[24:27], s28 offen sc1
    v_mfma_f32_16x16x32_bf16 v[48:51], v[188:191], a[112:115], v[48:51]
    ds_read_b64_tr_b16 v[164:165], v10 offset:8192
    s_lshl_b32 s7, s7, 4
    v_mfma_f32_16x16x32_bf16 v[52:55], v[176:179], a[68:71], v[52:55]
    ds_read_b64_tr_b16 v[166:167], v10 offset:9216
    s_add_u32 s96, s96, s7
    v_mfma_f32_16x16x32_bf16 v[52:55], v[180:183], a[84:87], v[52:55]
    ds_read_b64_tr_b16 v[168:169], v10 offset:16384
    s_lshl_b32 s96, s96, 7
    v_mfma_f32_16x16x32_bf16 v[52:55], v[184:187], a[100:103], v[52:55]
    ds_read_b64_tr_b16 v[170:171], v10 offset:17408
    s_lshr_b32 s7, s3, 1
    v_mfma_f32_16x16x32_bf16 v[52:55], v[188:191], a[116:119], v[52:55]
    buffer_load_dwordx4 v23, s[56:59], s9 offen offset:3072 lds
    v_mfma_f32_16x16x32_bf16 v[56:59], v[176:179], a[72:75], v[56:59]
    ds_read_b64_tr_b16 v[172:173], v10 offset:24576
    s_xor_b32 s28, s39, 11264
    v_mfma_f32_16x16x32_bf16 v[56:59], v[180:183], a[88:91], v[56:59]
    ds_read_b64_tr_b16 v[174:175], v10 offset:25600
    s_lshl_b32 s7, s7, 30
    v_mfma_f32_16x16x32_bf16 v[56:59], v[184:187], a[104:107], v[56:59]
    s_add_u32 s96, s96, s7
    v_mfma_f32_16x16x32_bf16 v[56:59], v[188:191], a[120:123], v[56:59]
    v_mfma_f32_16x16x32_bf16 v[60:63], v[176:179], a[76:79], v[60:63]
    buffer_load_dwordx4 a[180:183], v2, s[24:27], s28 offen sc1
    v_mfma_f32_16x16x32_bf16 v[60:63], v[180:183], a[92:95], v[60:63]
    v_mfma_f32_16x16x32_bf16 v[60:63], v[184:187], a[108:111], v[60:63]
    v_mfma_f32_16x16x32_bf16 v[60:63], v[188:191], a[124:127], v[60:63]
    v_xor_b32 v10, 32864, v11
    s_waitcnt lgkmcnt(0)
    v_mfma_f32_16x16x32_bf16 v[64:67], v[160:163], a[64:67], v[64:67]
    ds_read_b64_tr_b16 v[176:177], v10 offset:0
    v_mfma_f32_16x16x32_bf16 v[64:67], v[164:167], a[80:83], v[64:67]
    buffer_store_dwordx4 v[236:239], v2, s[20:23], s37 offen offset:1024 sc1
    v_mfma_f32_16x16x32_bf16 v[64:67], v[168:171], a[96:99], v[64:67]
    ds_read_b64_tr_b16 v[178:179], v10 offset:1024
    s_mov_b32 s9, 3145728
    v_mfma_f32_16x16x32_bf16 v[64:67], v[172:175], a[112:115], v[64:67]
    ds_read_b64_tr_b16 v[180:181], v10 offset:8192
    s_add_u32 m0, s10, 98304
    v_mfma_f32_16x16x32_bf16 v[68:71], v[160:163], a[68:71], v[68:71]
    ds_read_b64_tr_b16 v[182:183], v10 offset:9216
    v_mfma_f32_16x16x32_bf16 v[68:71], v[164:167], a[84:87], v[68:71]
    ds_read_b64_tr_b16 v[184:185], v10 offset:16384
    v_mfma_f32_16x16x32_bf16 v[68:71], v[168:171], a[100:103], v[68:71]
    ds_read_b64_tr_b16 v[186:187], v10 offset:17408
    v_mfma_f32_16x16x32_bf16 v[68:71], v[172:175], a[116:119], v[68:71]
    ds_read_b64_tr_b16 v[188:189], v10 offset:24576
    v_mfma_f32_16x16x32_bf16 v[72:75], v[160:163], a[72:75], v[72:75]
    ds_read_b64_tr_b16 v[190:191], v10 offset:25600
    v_mfma_f32_16x16x32_bf16 v[72:75], v[164:167], a[88:91], v[72:75]
    v_mfma_f32_16x16x32_bf16 v[72:75], v[168:171], a[104:107], v[72:75]
    v_mfma_f32_16x16x32_bf16 v[72:75], v[172:175], a[120:123], v[72:75]
    v_mfma_f32_16x16x32_bf16 v[76:79], v[160:163], a[76:79], v[76:79]
    buffer_load_dwordx4 v16, s[56:59], s9 offen offset:0 lds
    v_mfma_f32_16x16x32_bf16 v[76:79], v[164:167], a[92:95], v[76:79]
    s_xor_b32 s28, s40, 11264
    v_mfma_f32_16x16x32_bf16 v[76:79], v[168:171], a[108:111], v[76:79]
    v_mfma_f32_16x16x32_bf16 v[76:79], v[172:175], a[124:127], v[76:79]
    v_xor_b32 v10, 32896, v11
    s_waitcnt lgkmcnt(0)
    v_mfma_f32_16x16x32_bf16 v[80:83], v[176:179], a[64:67], v[80:83]
    ds_read_b64_tr_b16 v[160:161], v10 offset:0
    v_mfma_f32_16x16x32_bf16 v[80:83], v[180:183], a[80:83], v[80:83]
    buffer_load_dwordx4 a[184:187], v2, s[24:27], s28 offen sc1
    v_mfma_f32_16x16x32_bf16 v[80:83], v[184:187], a[96:99], v[80:83]
    ds_read_b64_tr_b16 v[162:163], v10 offset:1024
    v_mfma_f32_16x16x32_bf16 v[80:83], v[188:191], a[112:115], v[80:83]
    ds_read_b64_tr_b16 v[164:165], v10 offset:8192
    v_mfma_f32_16x16x32_bf16 v[84:87], v[176:179], a[68:71], v[84:87]
    ds_read_b64_tr_b16 v[166:167], v10 offset:9216
    v_mfma_f32_16x16x32_bf16 v[84:87], v[180:183], a[84:87], v[84:87]
    ds_read_b64_tr_b16 v[168:169], v10 offset:16384
    v_mfma_f32_16x16x32_bf16 v[84:87], v[184:187], a[100:103], v[84:87]
    buffer_store_dwordx4 v[240:243], v2, s[20:23], s35 offen offset:2048 sc1
    v_mfma_f32_16x16x32_bf16 v[84:87], v[188:191], a[116:119], v[84:87]
    ds_read_b64_tr_b16 v[170:171], v10 offset:17408
    v_mfma_f32_16x16x32_bf16 v[88:91], v[176:179], a[72:75], v[88:91]
    ds_read_b64_tr_b16 v[172:173], v10 offset:24576
    v_mfma_f32_16x16x32_bf16 v[88:91], v[180:183], a[88:91], v[88:91]
    ds_read_b64_tr_b16 v[174:175], v10 offset:25600
    v_mfma_f32_16x16x32_bf16 v[88:91], v[184:187], a[104:107], v[88:91]
    v_mfma_f32_16x16x32_bf16 v[88:91], v[188:191], a[120:123], v[88:91]
    v_mfma_f32_16x16x32_bf16 v[92:95], v[176:179], a[76:79], v[92:95]
    v_mfma_f32_16x16x32_bf16 v[92:95], v[180:183], a[92:95], v[92:95]
    v_mfma_f32_16x16x32_bf16 v[92:95], v[184:187], a[108:111], v[92:95]
    v_mfma_f32_16x16x32_bf16 v[92:95], v[188:191], a[124:127], v[92:95]
    v_xor_b32 v10, 32928, v11
    s_waitcnt lgkmcnt(0)
    v_mfma_f32_16x16x32_bf16 v[96:99], v[160:163], a[64:67], v[96:99]
    ds_read_b64_tr_b16 v[176:177], v10 offset:0
    v_mfma_f32_16x16x32_bf16 v[96:99], v[164:167], a[80:83], v[96:99]
    ds_read_b64_tr_b16 v[178:179], v10 offset:1024
    v_mfma_f32_16x16x32_bf16 v[96:99], v[168:171], a[96:99], v[96:99]
    buffer_load_dwordx4 v17, s[56:59], s9 offen offset:1024 lds
    v_mfma_f32_16x16x32_bf16 v[96:99], v[172:175], a[112:115], v[96:99]
    ds_read_b64_tr_b16 v[180:181], v10 offset:8192
    s_xor_b32 s28, s41, 11264
    v_mfma_f32_16x16x32_bf16 v[100:103], v[160:163], a[68:71], v[100:103]
    ds_read_b64_tr_b16 v[182:183], v10 offset:9216
    v_mfma_f32_16x16x32_bf16 v[100:103], v[164:167], a[84:87], v[100:103]
    ds_read_b64_tr_b16 v[184:185], v10 offset:16384
    v_mfma_f32_16x16x32_bf16 v[100:103], v[168:171], a[100:103], v[100:103]
    ds_read_b64_tr_b16 v[186:187], v10 offset:17408
    v_mfma_f32_16x16x32_bf16 v[100:103], v[172:175], a[116:119], v[100:103]
    buffer_load_dwordx4 a[188:191], v2, s[24:27], s28 offen sc1
    v_mfma_f32_16x16x32_bf16 v[104:107], v[160:163], a[72:75], v[104:107]
    ds_read_b64_tr_b16 v[188:189], v10 offset:24576
    v_mfma_f32_16x16x32_bf16 v[104:107], v[164:167], a[88:91], v[104:107]
    ds_read_b64_tr_b16 v[190:191], v10 offset:25600
    v_mfma_f32_16x16x32_bf16 v[104:107], v[168:171], a[104:107], v[104:107]
    v_mfma_f32_16x16x32_bf16 v[104:107], v[172:175], a[120:123], v[104:107]
    v_mfma_f32_16x16x32_bf16 v[108:111], v[160:163], a[76:79], v[108:111]
    buffer_store_dwordx4 v[244:247], v2, s[20:23], s37 offen offset:2048 sc1
    v_mfma_f32_16x16x32_bf16 v[108:111], v[164:167], a[92:95], v[108:111]
    v_mfma_f32_16x16x32_bf16 v[108:111], v[168:171], a[108:111], v[108:111]
    v_mfma_f32_16x16x32_bf16 v[108:111], v[172:175], a[124:127], v[108:111]
    v_xor_b32 v10, 32960, v11
    s_waitcnt lgkmcnt(0)
    v_mfma_f32_16x16x32_bf16 v[112:115], v[176:179], a[64:67], v[112:115]
    ds_read_b64_tr_b16 v[160:161], v10 offset:0
    v_mfma_f32_16x16x32_bf16 v[112:115], v[180:183], a[80:83], v[112:115]
    ds_read_b64_tr_b16 v[162:163], v10 offset:1024
    v_mfma_f32_16x16x32_bf16 v[112:115], v[184:187], a[96:99], v[112:115]
    ds_read_b64_tr_b16 v[164:165], v10 offset:8192
    v_mfma_f32_16x16x32_bf16 v[112:115], v[188:191], a[112:115], v[112:115]
    ds_read_b64_tr_b16 v[166:167], v10 offset:9216
    v_mfma_f32_16x16x32_bf16 v[116:119], v[176:179], a[68:71], v[116:119]
    ds_read_b64_tr_b16 v[168:169], v10 offset:16384
    v_mfma_f32_16x16x32_bf16 v[116:119], v[180:183], a[84:87], v[116:119]
    ds_read_b64_tr_b16 v[170:171], v10 offset:17408
    v_mfma_f32_16x16x32_bf16 v[116:119], v[184:187], a[100:103], v[116:119]
    ds_read_b64_tr_b16 v[172:173], v10 offset:24576
    v_mfma_f32_16x16x32_bf16 v[116:119], v[188:191], a[116:119], v[116:119]
    buffer_load_dwordx4 v18, s[56:59], s9 offen offset:2048 lds
    v_mfma_f32_16x16x32_bf16 v[120:123], v[176:179], a[72:75], v[120:123]
    ds_read_b64_tr_b16 v[174:175], v10 offset:25600
    s_xor_b32 s28, s38, 12288
    v_mfma_f32_16x16x32_bf16 v[120:123], v[180:183], a[88:91], v[120:123]
    v_mfma_f32_16x16x32_bf16 v[120:123], v[184:187], a[104:107], v[120:123]
    v_mfma_f32_16x16x32_bf16 v[120:123], v[188:191], a[120:123], v[120:123]
    v_mfma_f32_16x16x32_bf16 v[124:127], v[176:179], a[76:79], v[124:127]
    buffer_load_dwordx4 a[192:195], v2, s[24:27], s28 offen sc1
    v_mfma_f32_16x16x32_bf16 v[124:127], v[180:183], a[92:95], v[124:127]
    s_xor_b32 s28, s39, 12288
    v_mfma_f32_16x16x32_bf16 v[124:127], v[184:187], a[108:111], v[124:127]
    v_mfma_f32_16x16x32_bf16 v[124:127], v[188:191], a[124:127], v[124:127]
    v_xor_b32 v10, 32992, v11
    s_waitcnt lgkmcnt(0)
    v_mfma_f32_16x16x32_bf16 v[128:131], v[160:163], a[64:67], v[128:131]
    ds_read_b64_tr_b16 v[176:177], v10 offset:0
    v_mfma_f32_16x16x32_bf16 v[128:131], v[164:167], a[80:83], v[128:131]
    buffer_load_dwordx4 a[196:199], v2, s[24:27], s28 offen sc1
    v_mfma_f32_16x16x32_bf16 v[128:131], v[168:171], a[96:99], v[128:131]
    ds_read_b64_tr_b16 v[178:179], v10 offset:1024
    v_mfma_f32_16x16x32_bf16 v[128:131], v[172:175], a[112:115], v[128:131]
    ds_read_b64_tr_b16 v[180:181], v10 offset:8192
    v_mfma_f32_16x16x32_bf16 v[132:135], v[160:163], a[68:71], v[132:135]
    ds_read_b64_tr_b16 v[182:183], v10 offset:9216
    v_mfma_f32_16x16x32_bf16 v[132:135], v[164:167], a[84:87], v[132:135]
    ds_read_b64_tr_b16 v[184:185], v10 offset:16384
    v_mfma_f32_16x16x32_bf16 v[132:135], v[168:171], a[100:103], v[132:135]
    buffer_store_dwordx4 v[248:251], v2, s[20:23], s35 offen offset:3072 sc1
    v_mfma_f32_16x16x32_bf16 v[132:135], v[172:175], a[116:119], v[132:135]
    ds_read_b64_tr_b16 v[186:187], v10 offset:17408
    v_mfma_f32_16x16x32_bf16 v[136:139], v[160:163], a[72:75], v[136:139]
    ds_read_b64_tr_b16 v[188:189], v10 offset:24576
    v_mfma_f32_16x16x32_bf16 v[136:139], v[164:167], a[88:91], v[136:139]
    ds_read_b64_tr_b16 v[190:191], v10 offset:25600
    v_mfma_f32_16x16x32_bf16 v[136:139], v[168:171], a[104:107], v[136:139]
    v_mfma_f32_16x16x32_bf16 v[136:139], v[172:175], a[120:123], v[136:139]
    v_mfma_f32_16x16x32_bf16 v[140:143], v[160:163], a[76:79], v[140:143]
    v_mfma_f32_16x16x32_bf16 v[140:143], v[164:167], a[92:95], v[140:143]
    v_mfma_f32_16x16x32_bf16 v[140:143], v[168:171], a[108:111], v[140:143]
    v_mfma_f32_16x16x32_bf16 v[140:143], v[172:175], a[124:127], v[140:143]
    v_xor_b32 v10, 65536, v11
    s_waitcnt lgkmcnt(0)
    s_waitcnt vmcnt(12)
    s_barrier
    v_mfma_f32_16x16x32_bf16 v[144:147], v[176:179], a[64:67], v[144:147]
    ds_read_b64_tr_b16 v[160:161], v10 offset:0
    v_mfma_f32_16x16x32_bf16 v[144:147], v[180:183], a[80:83], v[144:147]
    ds_read_b64_tr_b16 v[162:163], v10 offset:1024
    v_mfma_f32_16x16x32_bf16 v[144:147], v[184:187], a[96:99], v[144:147]
    buffer_load_dwordx4 v19, s[56:59], s9 offen offset:3072 lds
    v_mfma_f32_16x16x32_bf16 v[144:147], v[188:191], a[112:115], v[144:147]
    ds_read_b64_tr_b16 v[164:165], v10 offset:8192
    s_xor_b32 s28, s40, 12288
    v_mfma_f32_16x16x32_bf16 v[148:151], v[176:179], a[68:71], v[148:151]
    ds_read_b64_tr_b16 v[166:167], v10 offset:9216
    v_mfma_f32_16x16x32_bf16 v[148:151], v[180:183], a[84:87], v[148:151]
    ds_read_b64_tr_b16 v[168:169], v10 offset:16384
    v_mfma_f32_16x16x32_bf16 v[148:151], v[184:187], a[100:103], v[148:151]
    ds_read_b64_tr_b16 v[170:171], v10 offset:17408
    v_mfma_f32_16x16x32_bf16 v[148:151], v[188:191], a[116:119], v[148:151]
    buffer_load_dwordx4 a[200:203], v2, s[24:27], s28 offen sc1
    v_mfma_f32_16x16x32_bf16 v[152:155], v[176:179], a[72:75], v[152:155]
    ds_read_b64_tr_b16 v[172:173], v10 offset:24576
    s_xor_b32 s28, s41, 12288
    v_mfma_f32_16x16x32_bf16 v[152:155], v[180:183], a[88:91], v[152:155]
    ds_read_b64_tr_b16 v[174:175], v10 offset:25600
    v_mfma_f32_16x16x32_bf16 v[152:155], v[184:187], a[104:107], v[152:155]
    v_mfma_f32_16x16x32_bf16 v[152:155], v[188:191], a[120:123], v[152:155]
    v_mfma_f32_16x16x32_bf16 v[156:159], v[176:179], a[76:79], v[156:159]
    buffer_load_dwordx4 a[204:207], v2, s[24:27], s28 offen sc1
    v_mfma_f32_16x16x32_bf16 v[156:159], v[180:183], a[92:95], v[156:159]
    v_mfma_f32_16x16x32_bf16 v[156:159], v[184:187], a[108:111], v[156:159]
    v_mfma_f32_16x16x32_bf16 v[156:159], v[188:191], a[124:127], v[156:159]
    v_xor_b32 v10, 65568, v11
    s_waitcnt vmcnt(8) lgkmcnt(0)
    v_mfma_f32_16x16x32_bf16 v[32:35], v[160:163], a[128:131], v[32:35]
    ds_read_b64_tr_b16 v[176:177], v10 offset:0
    v_mfma_f32_16x16x32_bf16 v[32:35], v[164:167], a[144:147], v[32:35]
    buffer_store_dwordx4 v[252:255], v2, s[20:23], s37 offen offset:3072 sc1
    v_mfma_f32_16x16x32_bf16 v[32:35], v[168:171], a[160:163], v[32:35]
    ds_read_b64_tr_b16 v[178:179], v10 offset:1024
    s_add_u32 m0, s10, 102400
    v_mfma_f32_16x16x32_bf16 v[32:35], v[172:175], a[176:179], v[32:35]
    ds_read_b64_tr_b16 v[180:181], v10 offset:8192
    v_mfma_f32_16x16x32_bf16 v[36:39], v[160:163], a[132:135], v[36:39]
    ds_read_b64_tr_b16 v[182:183], v10 offset:9216
    v_mfma_f32_16x16x32_bf16 v[36:39], v[164:167], a[148:151], v[36:39]
    ds_read_b64_tr_b16 v[184:185], v10 offset:16384
    v_mfma_f32_16x16x32_bf16 v[36:39], v[168:171], a[164:167], v[36:39]
    ds_read_b64_tr_b16 v[186:187], v10 offset:17408
    v_mfma_f32_16x16x32_bf16 v[36:39], v[172:175], a[180:183], v[36:39]
    ds_read_b64_tr_b16 v[188:189], v10 offset:24576
    v_mfma_f32_16x16x32_bf16 v[40:43], v[160:163], a[136:139], v[40:43]
    ds_read_b64_tr_b16 v[190:191], v10 offset:25600
    v_mfma_f32_16x16x32_bf16 v[40:43], v[164:167], a[152:155], v[40:43]
    v_mfma_f32_16x16x32_bf16 v[40:43], v[168:171], a[168:171], v[40:43]
    v_mfma_f32_16x16x32_bf16 v[40:43], v[172:175], a[184:187], v[40:43]
    v_mfma_f32_16x16x32_bf16 v[44:47], v[160:163], a[140:143], v[44:47]
    buffer_load_dwordx4 v20, s[56:59], s9 offen offset:0 lds
    v_mfma_f32_16x16x32_bf16 v[44:47], v[164:167], a[156:159], v[44:47]
    s_xor_b32 s28, s38, 13312
    v_mfma_f32_16x16x32_bf16 v[44:47], v[168:171], a[172:175], v[44:47]
    v_mfma_f32_16x16x32_bf16 v[44:47], v[172:175], a[188:191], v[44:47]
    v_xor_b32 v10, 65600, v11
    s_waitcnt lgkmcnt(0)
    v_mfma_f32_16x16x32_bf16 v[48:51], v[176:179], a[128:131], v[48:51]
    ds_read_b64_tr_b16 v[160:161], v10 offset:0
    s_add_u32 s52, s14, 35651584
    s_addc_u32 s53, s15, 0
    v_mfma_f32_16x16x32_bf16 v[48:51], v[180:183], a[144:147], v[48:51]
    buffer_load_dwordx4 a[208:211], v2, s[24:27], s28 offen sc1
    v_mfma_f32_16x16x32_bf16 v[48:51], v[184:187], a[160:163], v[48:51]
    ds_read_b64_tr_b16 v[162:163], v10 offset:1024
    s_xor_b32 s28, s39, 13312
    v_mfma_f32_16x16x32_bf16 v[48:51], v[188:191], a[176:179], v[48:51]
    ds_read_b64_tr_b16 v[164:165], v10 offset:8192
    s_mov_b32 s54, 16777216
    v_mfma_f32_16x16x32_bf16 v[52:55], v[176:179], a[132:135], v[52:55]
    ds_read_b64_tr_b16 v[166:167], v10 offset:9216
    s_mov_b32 s55, 0x20000
    v_mfma_f32_16x16x32_bf16 v[52:55], v[180:183], a[148:151], v[52:55]
    ds_read_b64_tr_b16 v[168:169], v10 offset:16384
    v_mov_b32 v12, 0xff800000
    v_mfma_f32_16x16x32_bf16 v[52:55], v[184:187], a[164:167], v[52:55]
    buffer_load_dwordx4 a[212:215], v2, s[24:27], s28 offen sc1
    v_mfma_f32_16x16x32_bf16 v[52:55], v[188:191], a[180:183], v[52:55]
    ds_read_b64_tr_b16 v[170:171], v10 offset:17408
    s_or_b32 s6, s10, 0x10000
    v_mfma_f32_16x16x32_bf16 v[56:59], v[176:179], a[136:139], v[56:59]
    ds_read_b64_tr_b16 v[172:173], v10 offset:24576
    v_or_b32 v15, s6, v2
    v_mfma_f32_16x16x32_bf16 v[56:59], v[180:183], a[152:155], v[56:59]
    ds_read_b64_tr_b16 v[174:175], v10 offset:25600
    s_and_b32 s6, s3, 1
    v_mfma_f32_16x16x32_bf16 v[56:59], v[184:187], a[168:171], v[56:59]
    s_lshl_b32 s44, s6, 13
    s_cmp_ge_u32 s3, 2
    s_cselect_b32 s7, 507904, 0
    v_mfma_f32_16x16x32_bf16 v[56:59], v[188:191], a[184:187], v[56:59]
    buffer_load_dwordx4 v21, s[56:59], s9 offen offset:1024 lds
    v_mfma_f32_16x16x32_bf16 v[60:63], v[176:179], a[140:143], v[60:63]
    s_xor_b32 s28, s40, 13312
    s_add_u32 s44, s44, s7
    v_mfma_f32_16x16x32_bf16 v[60:63], v[180:183], a[156:159], v[60:63]
    s_add_u32 s44, s44, 8192
    s_cmp_eq_u32 s3, 2
    s_cselect_b32 s45, 0, s44
    v_mfma_f32_16x16x32_bf16 v[60:63], v[184:187], a[172:175], v[60:63]
    s_lshr_b32 s7, s12, 1
    s_lshl_b32 s48, s7, 19
    v_mfma_f32_16x16x32_bf16 v[60:63], v[188:191], a[188:191], v[60:63]
    v_xor_b32 v10, 65632, v11
    s_waitcnt lgkmcnt(0)
    v_mfma_f32_16x16x32_bf16 v[64:67], v[160:163], a[128:131], v[64:67]
    buffer_load_dwordx4 a[216:219], v2, s[24:27], s28 offen sc1
    v_mfma_f32_16x16x32_bf16 v[64:67], v[164:167], a[144:147], v[64:67]
    ds_read_b64_tr_b16 v[176:177], v10 offset:0
    s_xor_b32 s28, s41, 13312
    v_mfma_f32_16x16x32_bf16 v[64:67], v[168:171], a[160:163], v[64:67]
    ds_read_b64_tr_b16 v[178:179], v10 offset:1024
    s_lshl_b32 s7, s4, 14
    v_mfma_f32_16x16x32_bf16 v[64:67], v[172:175], a[176:179], v[64:67]
    ds_read_b64_tr_b16 v[180:181], v10 offset:8192
    s_add_u32 s48, s48, s7
    v_mfma_f32_16x16x32_bf16 v[68:71], v[160:163], a[132:135], v[68:71]
    ds_read_b64_tr_b16 v[182:183], v10 offset:9216
    s_lshl_b32 s7, s6, 11
    v_mfma_f32_16x16x32_bf16 v[68:71], v[164:167], a[148:151], v[68:71]
    buffer_load_dwordx4 a[220:223], v2, s[24:27], s28 offen sc1
    v_mfma_f32_16x16x32_bf16 v[68:71], v[168:171], a[164:167], v[68:71]
    ds_read_b64_tr_b16 v[184:185], v10 offset:16384
    s_add_u32 s48, s48, s7
    v_mfma_f32_16x16x32_bf16 v[68:71], v[172:175], a[180:183], v[68:71]
    ds_read_b64_tr_b16 v[186:187], v10 offset:17408
    s_lshr_b32 s7, s13, 1
    v_mfma_f32_16x16x32_bf16 v[72:75], v[160:163], a[136:139], v[72:75]
    ds_read_b64_tr_b16 v[188:189], v10 offset:24576
    s_lshl_b32 s49, s7, 19
    v_mfma_f32_16x16x32_bf16 v[72:75], v[164:167], a[152:155], v[72:75]
    ds_read_b64_tr_b16 v[190:191], v10 offset:25600
    s_lshl_b32 s7, s4, 14
    v_mfma_f32_16x16x32_bf16 v[72:75], v[168:171], a[168:171], v[72:75]
    buffer_load_dwordx4 v22, s[56:59], s9 offen offset:2048 lds
    v_mfma_f32_16x16x32_bf16 v[72:75], v[172:175], a[184:187], v[72:75]
    s_xor_b32 s28, s38, 14336
    s_add_u32 s49, s49, s7
    v_mfma_f32_16x16x32_bf16 v[76:79], v[160:163], a[140:143], v[76:79]
    s_lshl_b32 s7, s6, 11
    s_add_u32 s49, s49, s7
    v_mfma_f32_16x16x32_bf16 v[76:79], v[164:167], a[156:159], v[76:79]
    s_lshr_b32 s46, s12, 1
    s_add_u32 s46, s46, 1
    v_mfma_f32_16x16x32_bf16 v[76:79], v[168:171], a[172:175], v[76:79]
    s_mov_b32 s47, 0
    v_and_b32 v4, 15, v1
    v_mfma_f32_16x16x32_bf16 v[76:79], v[172:175], a[188:191], v[76:79]
    v_xor_b32 v10, 65664, v11
    s_waitcnt lgkmcnt(0)
    v_mfma_f32_16x16x32_bf16 v[80:83], v[176:179], a[128:131], v[80:83]
    buffer_load_dwordx4 a[224:227], v2, s[24:27], s28 offen sc1
    v_mfma_f32_16x16x32_bf16 v[80:83], v[180:183], a[144:147], v[80:83]
    ds_read_b64_tr_b16 v[160:161], v10 offset:0
    v_lshrrev_b32 v5, 4, v1
    v_mfma_f32_16x16x32_bf16 v[80:83], v[184:187], a[160:163], v[80:83]
    ds_read_b64_tr_b16 v[162:163], v10 offset:1024
    v_lshlrev_b32 v5, 2, v5
    v_mfma_f32_16x16x32_bf16 v[80:83], v[188:191], a[176:179], v[80:83]
    ds_read_b64_tr_b16 v[164:165], v10 offset:8192
    v_sub_u32 v4, v4, v5
    v_mfma_f32_16x16x32_bf16 v[84:87], v[176:179], a[132:135], v[84:87]
    buffer_load_dwordx4 v23, s[56:59], s9 offen offset:3072 lds
    v_mfma_f32_16x16x32_bf16 v[84:87], v[180:183], a[148:151], v[84:87]
    ds_read_b64_tr_b16 v[166:167], v10 offset:9216
    s_xor_b32 s28, s39, 14336
    v_mfma_f32_16x16x32_bf16 v[84:87], v[184:187], a[164:167], v[84:87]
    ds_read_b64_tr_b16 v[168:169], v10 offset:16384
    v_cmp_le_i32 s[88:89], 0, v4
    v_mfma_f32_16x16x32_bf16 v[84:87], v[188:191], a[180:183], v[84:87]
    ds_read_b64_tr_b16 v[170:171], v10 offset:17408
    v_cmp_le_i32 s[90:91], 1, v4
    v_mfma_f32_16x16x32_bf16 v[88:91], v[176:179], a[136:139], v[88:91]
    ds_read_b64_tr_b16 v[172:173], v10 offset:24576
    v_cmp_le_i32 s[92:93], 2, v4
    v_mfma_f32_16x16x32_bf16 v[88:91], v[180:183], a[152:155], v[88:91]
    buffer_load_dwordx4 a[228:231], v2, s[24:27], s28 offen sc1
    v_mfma_f32_16x16x32_bf16 v[88:91], v[184:187], a[168:171], v[88:91]
    ds_read_b64_tr_b16 v[174:175], v10 offset:25600
    s_xor_b32 s28, s40, 14336
    v_mfma_f32_16x16x32_bf16 v[88:91], v[188:191], a[184:187], v[88:91]
    v_cmp_le_i32 s[94:95], 3, v4
    s_cmp_eq_u32 s6, 0
    s_cselect_b64 s[50:51], 0, -1
    v_mfma_f32_16x16x32_bf16 v[92:95], v[176:179], a[140:143], v[92:95]
    s_or_b64 s[60:61], s[88:89], s[50:51]
    s_and_b64 s[34:35], s[88:89], s[50:51]
    v_mfma_f32_16x16x32_bf16 v[92:95], v[180:183], a[156:159], v[92:95]
    s_or_b64 s[62:63], s[90:91], s[50:51]
    s_and_b64 s[36:37], s[90:91], s[50:51]
    v_mfma_f32_16x16x32_bf16 v[92:95], v[184:187], a[172:175], v[92:95]
    buffer_load_dwordx4 a[232:235], v2, s[24:27], s28 offen sc1
    v_mfma_f32_16x16x32_bf16 v[92:95], v[188:191], a[188:191], v[92:95]
    v_xor_b32 v10, 65696, v11
    s_waitcnt lgkmcnt(0)
    v_mfma_f32_16x16x32_bf16 v[96:99], v[160:163], a[128:131], v[96:99]
    ds_read_b64_tr_b16 v[176:177], v10 offset:0
    s_xor_b32 s28, s41, 14336
    v_mfma_f32_16x16x32_bf16 v[96:99], v[164:167], a[144:147], v[96:99]
    ds_read_b64_tr_b16 v[178:179], v10 offset:1024
    s_or_b64 s[30:31], s[92:93], s[50:51]
    v_mfma_f32_16x16x32_bf16 v[96:99], v[168:171], a[160:163], v[96:99]
    ds_read_b64_tr_b16 v[180:181], v10 offset:8192
    s_and_b64 s[84:85], s[92:93], s[50:51]
    v_mfma_f32_16x16x32_bf16 v[96:99], v[172:175], a[176:179], v[96:99]
    buffer_load_dwordx4 a[236:239], v2, s[24:27], s28 offen sc1
    v_mfma_f32_16x16x32_bf16 v[100:103], v[160:163], a[132:135], v[100:103]
    ds_read_b64_tr_b16 v[182:183], v10 offset:9216
    s_xor_b32 s28, s38, 15360
    v_mfma_f32_16x16x32_bf16 v[100:103], v[164:167], a[148:151], v[100:103]
    ds_read_b64_tr_b16 v[184:185], v10 offset:16384
    s_or_b64 s[32:33], s[94:95], s[50:51]
    v_mfma_f32_16x16x32_bf16 v[100:103], v[168:171], a[164:167], v[100:103]
    ds_read_b64_tr_b16 v[186:187], v10 offset:17408
    s_and_b64 s[86:87], s[94:95], s[50:51]
    v_mfma_f32_16x16x32_bf16 v[100:103], v[172:175], a[180:183], v[100:103]
    ds_read_b64_tr_b16 v[188:189], v10 offset:24576
    v_mov_b32 v4, 0x3f803f80
    v_mfma_f32_16x16x32_bf16 v[104:107], v[160:163], a[136:139], v[104:107]
    buffer_load_dwordx4 a[240:243], v2, s[24:27], s28 offen sc1
    v_mfma_f32_16x16x32_bf16 v[104:107], v[164:167], a[152:155], v[104:107]
    ds_read_b64_tr_b16 v[190:191], v10 offset:25600
    s_xor_b32 s28, s39, 15360
    v_mfma_f32_16x16x32_bf16 v[104:107], v[168:171], a[168:171], v[104:107]
    v_mov_b32 v5, 0
    v_accvgpr_write_b32 a112, v4
    v_mfma_f32_16x16x32_bf16 v[104:107], v[172:175], a[184:187], v[104:107]
    v_accvgpr_write_b32 a113, v4
    v_accvgpr_write_b32 a114, v4
    v_mfma_f32_16x16x32_bf16 v[108:111], v[160:163], a[140:143], v[108:111]
    v_accvgpr_write_b32 a115, v4
    v_cndmask_b32 v240, v12, v5, s[60:61]
    v_mfma_f32_16x16x32_bf16 v[108:111], v[164:167], a[156:159], v[108:111]
    buffer_load_dwordx4 a[244:247], v2, s[24:27], s28 offen sc1
    v_mfma_f32_16x16x32_bf16 v[108:111], v[168:171], a[172:175], v[108:111]
    s_xor_b32 s28, s40, 15360
    v_cndmask_b32 v241, v12, v5, s[62:63]
    v_mfma_f32_16x16x32_bf16 v[108:111], v[172:175], a[188:191], v[108:111]
    v_xor_b32 v10, 65728, v11
    s_waitcnt lgkmcnt(0)
    s_waitcnt vmcnt(14)
    s_barrier
    s_cmp_lg_u32 s3, 0
    s_cbranch_scc1 L_sg2
    buffer_atomic_add v8, v14, s[16:19], s8 offen offset:12
L_sg2:
    s_lshl_b32 s8, s3, 28
    v_mov_b32 v14, s8
    s_lshl_b32 s8, s4, 8
    s_add_u32 s8, s8, 32768
    v_mfma_f32_16x16x32_bf16 v[112:115], v[176:179], a[128:131], v[112:115]
    ds_read_b64_tr_b16 v[160:161], v10 offset:0
    v_cndmask_b32 v242, v12, v5, s[30:31]
    v_mfma_f32_16x16x32_bf16 v[112:115], v[180:183], a[144:147], v[112:115]
    ds_read_b64_tr_b16 v[162:163], v10 offset:1024
    v_cndmask_b32 v243, v12, v5, s[32:33]
    v_mfma_f32_16x16x32_bf16 v[112:115], v[184:187], a[160:163], v[112:115]
    buffer_load_dwordx4 a[248:251], v2, s[24:27], s28 offen sc1
    v_mfma_f32_16x16x32_bf16 v[112:115], v[188:191], a[176:179], v[112:115]
    ds_read_b64_tr_b16 v[164:165], v10 offset:8192
    s_xor_b32 s28, s41, 15360
    v_mfma_f32_16x16x32_bf16 v[116:119], v[176:179], a[132:135], v[116:119]
    ds_read_b64_tr_b16 v[166:167], v10 offset:9216
    v_mov_b32 v13, 0x5d800000
    v_mfma_f32_16x16x32_bf16 v[116:119], v[180:183], a[148:151], v[116:119]
    ds_read_b64_tr_b16 v[168:169], v10 offset:16384
    v_lshrrev_b32 v5, 4, v1
    v_mfma_f32_16x16x32_bf16 v[116:119], v[184:187], a[164:167], v[116:119]
    ds_read_b64_tr_b16 v[170:171], v10 offset:17408
    v_xor_b32 v5, v5, v1
    v_mfma_f32_16x16x32_bf16 v[116:119], v[188:191], a[180:183], v[116:119]
    buffer_load_dwordx4 a[252:255], v2, s[24:27], s28 offen sc1
    v_mfma_f32_16x16x32_bf16 v[120:123], v[176:179], a[136:139], v[120:123]
    ds_read_b64_tr_b16 v[172:173], v10 offset:24576
    v_bfe_u32 v5, v5, 1, 1
    v_mfma_f32_16x16x32_bf16 v[120:123], v[180:183], a[152:155], v[120:123]
    ds_read_b64_tr_b16 v[174:175], v10 offset:25600
    v_add_u32 v5, -1, v5
    v_mfma_f32_16x16x32_bf16 v[120:123], v[184:187], a[168:171], v[120:123]
    v_and_b32 v5, v4, v5
    v_accvgpr_write_b32 a116, v5
    v_mfma_f32_16x16x32_bf16 v[120:123], v[188:191], a[184:187], v[120:123]
    v_accvgpr_write_b32 a117, v5
    v_accvgpr_write_b32 a118, v5
    v_mfma_f32_16x16x32_bf16 v[124:127], v[176:179], a[140:143], v[124:127]
    v_accvgpr_write_b32 a119, v5
    v_accvgpr_write_b32 a96, 0
    v_mfma_f32_16x16x32_bf16 v[124:127], v[180:183], a[156:159], v[124:127]
    v_accvgpr_write_b32 a97, 0
    v_accvgpr_write_b32 a98, 0
    v_mfma_f32_16x16x32_bf16 v[124:127], v[184:187], a[172:175], v[124:127]
    v_accvgpr_write_b32 a99, 0
    v_accvgpr_write_b32 a100, 0
    v_mfma_f32_16x16x32_bf16 v[124:127], v[188:191], a[188:191], v[124:127]
    v_xor_b32 v10, 65760, v11
    s_waitcnt lgkmcnt(0)
    v_mfma_f32_16x16x32_bf16 v[128:131], v[160:163], a[128:131], v[128:131]
    ds_read_b64_tr_b16 v[176:177], v10 offset:0
    v_accvgpr_write_b32 a101, 0
    v_mfma_f32_16x16x32_bf16 v[128:131], v[164:167], a[144:147], v[128:131]
    ds_read_b64_tr_b16 v[178:179], v10 offset:1024
    v_accvgpr_write_b32 a102, 0
    v_mfma_f32_16x16x32_bf16 v[128:131], v[168:171], a[160:163], v[128:131]
    ds_read_b64_tr_b16 v[180:181], v10 offset:8192
    v_accvgpr_write_b32 a103, 0
    v_mfma_f32_16x16x32_bf16 v[128:131], v[172:175], a[176:179], v[128:131]
    ds_read_b64_tr_b16 v[182:183], v10 offset:9216
    v_and_b32 v5, 1, v1
    v_mfma_f32_16x16x32_bf16 v[132:135], v[160:163], a[132:135], v[132:135]
    ds_read_b64_tr_b16 v[184:185], v10 offset:16384
    v_mul_u32_u24 v5, 0xaaaa, v5
    v_mfma_f32_16x16x32_bf16 v[132:135], v[164:167], a[148:151], v[132:135]
    ds_read_b64_tr_b16 v[186:187], v10 offset:17408
    v_add_u32 v6, 0x4444, v5
    v_mfma_f32_16x16x32_bf16 v[132:135], v[168:171], a[164:167], v[132:135]
    ds_read_b64_tr_b16 v[188:189], v10 offset:24576
    v_mfma_f32_16x16x32_bf16 v[132:135], v[172:175], a[180:183], v[132:135]
    ds_read_b64_tr_b16 v[190:191], v10 offset:25600
    v_mfma_f32_16x16x32_bf16 v[136:139], v[160:163], a[136:139], v[136:139]
    v_mfma_f32_16x16x32_bf16 v[136:139], v[164:167], a[152:155], v[136:139]
    v_mfma_f32_16x16x32_bf16 v[136:139], v[168:171], a[168:171], v[136:139]
    v_mfma_f32_16x16x32_bf16 v[136:139], v[172:175], a[184:187], v[136:139]
    v_mfma_f32_16x16x32_bf16 v[140:143], v[160:163], a[140:143], v[140:143]
    v_mfma_f32_16x16x32_bf16 v[140:143], v[164:167], a[156:159], v[140:143]
    v_mfma_f32_16x16x32_bf16 v[140:143], v[168:171], a[172:175], v[140:143]
    v_mfma_f32_16x16x32_bf16 v[140:143], v[172:175], a[188:191], v[140:143]
    v_xor_b32 v10, 98304, v11
    s_waitcnt lgkmcnt(0)
    s_waitcnt vmcnt(7)
    s_barrier
    v_mfma_f32_16x16x32_bf16 v[144:147], v[176:179], a[128:131], v[144:147]
    ds_read_b64_tr_b16 v[160:161], v10 offset:0
    v_mfma_f32_16x16x32_bf16 v[144:147], v[180:183], a[144:147], v[144:147]
    ds_read_b64_tr_b16 v[162:163], v10 offset:1024
    v_mfma_f32_16x16x32_bf16 v[144:147], v[184:187], a[160:163], v[144:147]
    ds_read_b64_tr_b16 v[164:165], v10 offset:8192
    v_mfma_f32_16x16x32_bf16 v[144:147], v[188:191], a[176:179], v[144:147]
    ds_read_b64_tr_b16 v[166:167], v10 offset:9216
    v_mfma_f32_16x16x32_bf16 v[148:151], v[176:179], a[132:135], v[148:151]
    ds_read_b64_tr_b16 v[168:169], v10 offset:16384
    v_mfma_f32_16x16x32_bf16 v[148:151], v[180:183], a[148:151], v[148:151]
    ds_read_b64_tr_b16 v[170:171], v10 offset:17408
    v_mfma_f32_16x16x32_bf16 v[148:151], v[184:187], a[164:167], v[148:151]
    ds_read_b64_tr_b16 v[172:173], v10 offset:24576
    v_mfma_f32_16x16x32_bf16 v[148:151], v[188:191], a[180:183], v[148:151]
    ds_read_b64_tr_b16 v[174:175], v10 offset:25600
    v_mfma_f32_16x16x32_bf16 v[152:155], v[176:179], a[136:139], v[152:155]
    v_mfma_f32_16x16x32_bf16 v[152:155], v[180:183], a[152:155], v[152:155]
    v_mfma_f32_16x16x32_bf16 v[152:155], v[184:187], a[168:171], v[152:155]
    v_mfma_f32_16x16x32_bf16 v[152:155], v[188:191], a[184:187], v[152:155]
    v_mfma_f32_16x16x32_bf16 v[156:159], v[176:179], a[140:143], v[156:159]
    v_mfma_f32_16x16x32_bf16 v[156:159], v[180:183], a[156:159], v[156:159]
    v_mfma_f32_16x16x32_bf16 v[156:159], v[184:187], a[172:175], v[156:159]
    v_mfma_f32_16x16x32_bf16 v[156:159], v[188:191], a[188:191], v[156:159]
    v_xor_b32 v10, 98336, v11
    s_waitcnt vmcnt(0) lgkmcnt(0)
    v_mfma_f32_16x16x32_bf16 v[32:35], v[160:163], a[192:195], v[32:35]
    buffer_load_dword v9, v14, s[16:19], s42 offen offset:12 sc1
    v_mfma_f32_16x16x32_bf16 v[32:35], v[164:167], a[208:211], v[32:35]
    ds_read_b64_tr_b16 v[176:177], v10 offset:0
    v_mfma_f32_16x16x32_bf16 v[32:35], v[168:171], a[224:227], v[32:35]
    ds_read_b64_tr_b16 v[178:179], v10 offset:1024
    v_mfma_f32_16x16x32_bf16 v[32:35], v[172:175], a[240:243], v[32:35]
    ds_read_b64_tr_b16 v[180:181], v10 offset:8192
    v_mfma_f32_16x16x32_bf16 v[36:39], v[160:163], a[196:199], v[36:39]
    ds_read_b64_tr_b16 v[182:183], v10 offset:9216
    v_mfma_f32_16x16x32_bf16 v[36:39], v[164:167], a[212:215], v[36:39]
    ds_read_b64_tr_b16 v[184:185], v10 offset:16384
    v_mfma_f32_16x16x32_bf16 v[36:39], v[168:171], a[228:231], v[36:39]
    ds_read_b64_tr_b16 v[186:187], v10 offset:17408
    v_mfma_f32_16x16x32_bf16 v[36:39], v[172:175], a[244:247], v[36:39]
    ds_read_b64_tr_b16 v[188:189], v10 offset:24576
    v_mfma_f32_16x16x32_bf16 v[40:43], v[160:163], a[200:203], v[40:43]
    ds_read_b64_tr_b16 v[190:191], v10 offset:25600
    v_mfma_f32_16x16x32_bf16 v[40:43], v[164:167], a[216:219], v[40:43]
    v_mfma_f32_16x16x32_bf16 v[40:43], v[168:171], a[232:235], v[40:43]
    v_mfma_f32_16x16x32_bf16 v[40:43], v[172:175], a[248:251], v[40:43]
    v_mfma_f32_16x16x32_bf16 v[44:47], v[160:163], a[204:207], v[44:47]
    v_mfma_f32_16x16x32_bf16 v[44:47], v[164:167], a[220:223], v[44:47]
    v_mfma_f32_16x16x32_bf16 v[44:47], v[168:171], a[236:239], v[44:47]
    v_mfma_f32_16x16x32_bf16 v[44:47], v[172:175], a[252:255], v[44:47]
    v_xor_b32 v10, 98368, v11
    s_waitcnt lgkmcnt(0)
    v_mfma_f32_16x16x32_bf16 v[48:51], v[176:179], a[192:195], v[48:51]
    ds_read_b64_tr_b16 v[160:161], v10 offset:0
    v_mfma_f32_16x16x32_bf16 v[48:51], v[180:183], a[208:211], v[48:51]
    ds_read_b64_tr_b16 v[162:163], v10 offset:1024
    v_mfma_f32_16x16x32_bf16 v[48:51], v[184:187], a[224:227], v[48:51]
    ds_read_b64_tr_b16 v[164:165], v10 offset:8192
    v_mfma_f32_16x16x32_bf16 v[48:51], v[188:191], a[240:243], v[48:51]
    ds_read_b64_tr_b16 v[166:167], v10 offset:9216
    v_mfma_f32_16x16x32_bf16 v[52:55], v[176:179], a[196:199], v[52:55]
    ds_read_b64_tr_b16 v[168:169], v10 offset:16384
    v_mfma_f32_16x16x32_bf16 v[52:55], v[180:183], a[212:215], v[52:55]
    ds_read_b64_tr_b16 v[170:171], v10 offset:17408
    v_mfma_f32_16x16x32_bf16 v[52:55], v[184:187], a[228:231], v[52:55]
    ds_read_b64_tr_b16 v[172:173], v10 offset:24576
    v_mfma_f32_16x16x32_bf16 v[52:55], v[188:191], a[244:247], v[52:55]
    ds_read_b64_tr_b16 v[174:175], v10 offset:25600
    v_mfma_f32_16x16x32_bf16 v[56:59], v[176:179], a[200:203], v[56:59]
    v_mfma_f32_16x16x32_bf16 v[56:59], v[180:183], a[216:219], v[56:59]
    v_mfma_f32_16x16x32_bf16 v[56:59], v[184:187], a[232:235], v[56:59]
    v_mfma_f32_16x16x32_bf16 v[56:59], v[188:191], a[248:251], v[56:59]
    v_mfma_f32_16x16x32_bf16 v[60:63], v[176:179], a[204:207], v[60:63]
    v_mfma_f32_16x16x32_bf16 v[60:63], v[180:183], a[220:223], v[60:63]
    v_mfma_f32_16x16x32_bf16 v[60:63], v[184:187], a[236:239], v[60:63]
    v_mfma_f32_16x16x32_bf16 v[60:63], v[188:191], a[252:255], v[60:63]
    v_xor_b32 v10, 98400, v11
    s_waitcnt lgkmcnt(0)
    v_mfma_f32_16x16x32_bf16 v[64:67], v[160:163], a[192:195], v[64:67]
    ds_read_b64_tr_b16 v[176:177], v10 offset:0
    s_waitcnt vmcnt(0)
    v_mfma_f32_16x16x32_bf16 v[64:67], v[164:167], a[208:211], v[64:67]
    ds_read_b64_tr_b16 v[178:179], v10 offset:1024
    v_cmp_gt_u32 vcc, s81, v9
    v_mfma_f32_16x16x32_bf16 v[64:67], v[168:171], a[224:227], v[64:67]
    ds_read_b64_tr_b16 v[180:181], v10 offset:8192
    s_nop 0
    v_mfma_f32_16x16x32_bf16 v[64:67], v[172:175], a[240:243], v[64:67]
    ds_read_b64_tr_b16 v[182:183], v10 offset:9216
    s_cbranch_vccnz L_spinp1
L_backp1:
    v_mfma_f32_16x16x32_bf16 v[68:71], v[160:163], a[196:199], v[68:71]
    ds_read_b64_tr_b16 v[184:185], v10 offset:16384
    s_barrier
    v_mfma_f32_16x16x32_bf16 v[68:71], v[164:167], a[212:215], v[68:71]
    ds_read_b64_tr_b16 v[186:187], v10 offset:17408
    s_add_u32 m0, s10, 0
    v_mfma_f32_16x16x32_bf16 v[68:71], v[168:171], a[228:231], v[68:71]
    ds_read_b64_tr_b16 v[188:189], v10 offset:24576
    v_cvt_pk_bf16_f32 v192, v32, v33
    v_mfma_f32_16x16x32_bf16 v[68:71], v[172:175], a[244:247], v[68:71]
    ds_read_b64_tr_b16 v[190:191], v10 offset:25600
    v_cvt_pk_bf16_f32 v193, v34, v35
    v_mfma_f32_16x16x32_bf16 v[72:75], v[160:163], a[200:203], v[72:75]
    buffer_load_dwordx4 v2, s[20:23], s45 offen offset:0 sc1 lds
    v_mfma_f32_16x16x32_bf16 v[72:75], v[164:167], a[216:219], v[72:75]
    v_cvt_pk_bf16_f32 v194, v48, v49
    v_cvt_pk_bf16_f32 v195, v50, v51
    v_mfma_f32_16x16x32_bf16 v[72:75], v[168:171], a[232:235], v[72:75]
    v_accvgpr_write_b32 a0, v192
    v_accvgpr_write_b32 a1, v193
    v_mfma_f32_16x16x32_bf16 v[72:75], v[172:175], a[248:251], v[72:75]
    v_accvgpr_write_b32 a2, v194
    v_accvgpr_write_b32 a3, v195
    v_mfma_f32_16x16x32_bf16 v[76:79], v[160:163], a[204:207], v[76:79]
    v_cvt_pk_bf16_f32 v196, v36, v37
    v_cvt_pk_bf16_f32 v197, v38, v39
    v_mfma_f32_16x16x32_bf16 v[76:79], v[164:167], a[220:223], v[76:79]
    buffer_load_dwordx4 v2, s[20:23], s45 offen offset:1024 sc1 lds
    v_mfma_f32_16x16x32_bf16 v[76:79], v[168:171], a[236:239], v[76:79]
    v_cvt_pk_bf16_f32 v198, v52, v53
    v_cvt_pk_bf16_f32 v199, v54, v55
    v_mfma_f32_16x16x32_bf16 v[76:79], v[172:175], a[252:255], v[76:79]
    v_xor_b32 v10, 98432, v11
    s_waitcnt lgkmcnt(0)
    v_mfma_f32_16x16x32_bf16 v[80:83], v[176:179], a[192:195], v[80:83]
    ds_read_b64_tr_b16 v[160:161], v10 offset:0
    s_add_u32 s24, s14, 52428800
    s_addc_u32 s25, s15, 0
    v_mfma_f32_16x16x32_bf16 v[80:83], v[180:183], a[208:211], v[80:83]
    buffer_load_dwordx4 v2, s[20:23], s45 offen offset:2048 sc1 lds
    v_mfma_f32_16x16x32_bf16 v[80:83], v[184:187], a[224:227], v[80:83]
    ds_read_b64_tr_b16 v[162:163], v10 offset:1024
    s_mov_b32 s26, 4194304
    v_mfma_f32_16x16x32_bf16 v[80:83], v[188:191], a[240:243], v[80:83]
    ds_read_b64_tr_b16 v[164:165], v10 offset:8192
    s_mov_b32 s27, 0x20000
    v_mfma_f32_16x16x32_bf16 v[84:87], v[176:179], a[196:199], v[84:87]
    ds_read_b64_tr_b16 v[166:167], v10 offset:9216
    s_and_b32 s6, s5, 3
    v_mfma_f32_16x16x32_bf16 v[84:87], v[180:183], a[212:215], v[84:87]
    ds_read_b64_tr_b16 v[168:169], v10 offset:16384
    s_lshl_b32 s6, s6, 2
    v_mfma_f32_16x16x32_bf16 v[84:87], v[184:187], a[228:231], v[84:87]
    buffer_load_dwordx4 v2, s[20:23], s45 offen offset:3072 sc1 lds
    v_mfma_f32_16x16x32_bf16 v[84:87], v[188:191], a[244:247], v[84:87]
    ds_read_b64_tr_b16 v[170:171], v10 offset:17408
    s_add_u32 m0, s10, 4096
    v_mfma_f32_16x16x32_bf16 v[88:91], v[176:179], a[200:203], v[88:91]
    ds_read_b64_tr_b16 v[172:173], v10 offset:24576
    s_add_u32 s6, s6, s3
    v_mfma_f32_16x16x32_bf16 v[88:91], v[180:183], a[216:219], v[88:91]
    ds_read_b64_tr_b16 v[174:175], v10 offset:25600
    s_lshl_b32 s28, s6, 18
    v_mfma_f32_16x16x32_bf16 v[88:91], v[184:187], a[232:235], v[88:91]
    buffer_load_dwordx4 v3, s[20:23], s45 offen offset:0 sc1 lds
    v_mfma_f32_16x16x32_bf16 v[88:91], v[188:191], a[248:251], v[88:91]
    s_bfe_u32 s6, s2, 0x20001
    s_lshl_b32 s6, s6, 16
    v_mfma_f32_16x16x32_bf16 v[92:95], v[176:179], a[204:207], v[92:95]
    s_add_u32 s28, s28, s6
    s_and_b32 s6, s5, 0
    v_mfma_f32_16x16x32_bf16 v[92:95], v[180:183], a[220:223], v[92:95]
    s_lshl_b32 s6, s6, 14
    s_add_u32 s28, s28, s6
    v_mfma_f32_16x16x32_bf16 v[92:95], v[184:187], a[236:239], v[92:95]
    v_and_b32 v14, 31, v1
    v_lshlrev_b32 v14, 8, v14
    v_mfma_f32_16x16x32_bf16 v[92:95], v[188:191], a[252:255], v[92:95]
    v_xor_b32 v10, 98464, v11
    s_waitcnt lgkmcnt(0)
    v_mfma_f32_16x16x32_bf16 v[96:99], v[160:163], a[192:195], v[96:99]
    buffer_load_dwordx4 v3, s[20:23], s45 offen offset:1024 sc1 lds
    v_mfma_f32_16x16x32_bf16 v[96:99], v[164:167], a[208:211], v[96:99]
    ds_read_b64_tr_b16 v[176:177], v10 offset:0
    v_add_u32 v14, 32768, v14
    v_mfma_f32_16x16x32_bf16 v[96:99], v[168:171], a[224:227], v[96:99]
    ds_read_b64_tr_b16 v[178:179], v10 offset:1024
    s_mov_b32 s82, 1
    v_mfma_f32_16x16x32_bf16 v[96:99], v[172:175], a[240:243], v[96:99]
    ds_read_b64_tr_b16 v[180:181], v10 offset:8192
    s_mov_b32 s97, 0
    v_mfma_f32_16x16x32_bf16 v[100:103], v[160:163], a[196:199], v[100:103]
    buffer_load_dwordx4 v3, s[20:23], s45 offen offset:2048 sc1 lds
    v_mfma_f32_16x16x32_bf16 v[100:103], v[164:167], a[212:215], v[100:103]
    ds_read_b64_tr_b16 v[182:183], v10 offset:9216
    v_accvgpr_write_b32 a16, v196
    v_mfma_f32_16x16x32_bf16 v[100:103], v[168:171], a[228:231], v[100:103]
    ds_read_b64_tr_b16 v[184:185], v10 offset:16384
    v_accvgpr_write_b32 a17, v197
    v_mfma_f32_16x16x32_bf16 v[100:103], v[172:175], a[244:247], v[100:103]
    ds_read_b64_tr_b16 v[186:187], v10 offset:17408
    v_accvgpr_write_b32 a18, v198
    v_mfma_f32_16x16x32_bf16 v[104:107], v[160:163], a[200:203], v[104:107]
    buffer_load_dwordx4 v3, s[20:23], s45 offen offset:3072 sc1 lds
    v_mfma_f32_16x16x32_bf16 v[104:107], v[164:167], a[216:219], v[104:107]
    ds_read_b64_tr_b16 v[188:189], v10 offset:24576
    s_add_u32 s44, s44, 16384
    v_mfma_f32_16x16x32_bf16 v[104:107], v[168:171], a[232:235], v[104:107]
    ds_read_b64_tr_b16 v[190:191], v10 offset:25600
    s_add_u32 m0, s10, 32768
    v_mfma_f32_16x16x32_bf16 v[104:107], v[172:175], a[248:251], v[104:107]
    v_accvgpr_write_b32 a19, v199
    v_cvt_pk_bf16_f32 v200, v40, v41
    v_mfma_f32_16x16x32_bf16 v[108:111], v[160:163], a[204:207], v[108:111]
    v_cvt_pk_bf16_f32 v201, v42, v43
    v_cvt_pk_bf16_f32 v202, v56, v57
    v_mfma_f32_16x16x32_bf16 v[108:111], v[164:167], a[220:223], v[108:111]
    buffer_load_dwordx4 v2, s[20:23], s44 offen offset:0 sc1 lds
    v_mfma_f32_16x16x32_bf16 v[108:111], v[168:171], a[236:239], v[108:111]
    v_cvt_pk_bf16_f32 v203, v58, v59
    v_accvgpr_write_b32 a32, v200
    v_mfma_f32_16x16x32_bf16 v[108:111], v[172:175], a[252:255], v[108:111]
    v_xor_b32 v10, 98496, v11
    s_waitcnt lgkmcnt(0)
    v_mfma_f32_16x16x32_bf16 v[112:115], v[176:179], a[192:195], v[112:115]
    ds_read_b64_tr_b16 v[160:161], v10 offset:0
    v_mfma_f32_16x16x32_bf16 v[112:115], v[180:183], a[208:211], v[112:115]
    buffer_load_dwordx4 v2, s[20:23], s44 offen offset:1024 sc1 lds
    v_mfma_f32_16x16x32_bf16 v[112:115], v[184:187], a[224:227], v[112:115]
    ds_read_b64_tr_b16 v[162:163], v10 offset:1024
    v_accvgpr_write_b32 a33, v201
    v_mfma_f32_16x16x32_bf16 v[112:115], v[188:191], a[240:243], v[112:115]
    ds_read_b64_tr_b16 v[164:165], v10 offset:8192
    v_accvgpr_write_b32 a34, v202
    v_mfma_f32_16x16x32_bf16 v[116:119], v[176:179], a[196:199], v[116:119]
    ds_read_b64_tr_b16 v[166:167], v10 offset:9216
    v_accvgpr_write_b32 a35, v203
    v_mfma_f32_16x16x32_bf16 v[116:119], v[180:183], a[212:215], v[116:119]
    ds_read_b64_tr_b16 v[168:169], v10 offset:16384
    v_cvt_pk_bf16_f32 v204, v44, v45
    v_mfma_f32_16x16x32_bf16 v[116:119], v[184:187], a[228:231], v[116:119]
    buffer_load_dwordx4 v2, s[20:23], s44 offen offset:2048 sc1 lds
    v_mfma_f32_16x16x32_bf16 v[116:119], v[188:191], a[244:247], v[116:119]
    ds_read_b64_tr_b16 v[170:171], v10 offset:17408
    v_cvt_pk_bf16_f32 v205, v46, v47
    v_mfma_f32_16x16x32_bf16 v[120:123], v[176:179], a[200:203], v[120:123]
    ds_read_b64_tr_b16 v[172:173], v10 offset:24576
    v_cvt_pk_bf16_f32 v206, v60, v61
    v_mfma_f32_16x16x32_bf16 v[120:123], v[180:183], a[216:219], v[120:123]
    ds_read_b64_tr_b16 v[174:175], v10 offset:25600
    v_cvt_pk_bf16_f32 v207, v62, v63
    v_mfma_f32_16x16x32_bf16 v[120:123], v[184:187], a[232:235], v[120:123]
    buffer_load_dwordx4 v2, s[20:23], s44 offen offset:3072 sc1 lds
    v_mfma_f32_16x16x32_bf16 v[120:123], v[188:191], a[248:251], v[120:123]
    s_add_u32 m0, s10, 36864
    v_accvgpr_write_b32 a48, v204
    v_mfma_f32_16x16x32_bf16 v[124:127], v[176:179], a[204:207], v[124:127]
    v_accvgpr_write_b32 a49, v205
    v_accvgpr_write_b32 a50, v206
    v_mfma_f32_16x16x32_bf16 v[124:127], v[180:183], a[220:223], v[124:127]
    v_accvgpr_write_b32 a51, v207
    v_cvt_pk_bf16_f32 v192, v64, v65
    v_mfma_f32_16x16x32_bf16 v[124:127], v[184:187], a[236:239], v[124:127]
    v_cvt_pk_bf16_f32 v193, v66, v67
    v_cvt_pk_bf16_f32 v194, v80, v81
    v_mfma_f32_16x16x32_bf16 v[124:127], v[188:191], a[252:255], v[124:127]
    v_xor_b32 v10, 98528, v11
    s_waitcnt lgkmcnt(0)
    v_mfma_f32_16x16x32_bf16 v[128:131], v[160:163], a[192:195], v[128:131]
    buffer_load_dwordx4 v3, s[20:23], s44 offen offset:0 sc1 lds
    v_mfma_f32_16x16x32_bf16 v[128:131], v[164:167], a[208:211], v[128:131]
    ds_read_b64_tr_b16 v[176:177], v10 offset:0
    v_cvt_pk_bf16_f32 v195, v82, v83
    v_mfma_f32_16x16x32_bf16 v[128:131], v[168:171], a[224:227], v[128:131]
    ds_read_b64_tr_b16 v[178:179], v10 offset:1024
    v_accvgpr_write_b32 a4, v192
    v_mfma_f32_16x16x32_bf16 v[128:131], v[172:175], a[240:243], v[128:131]
    ds_read_b64_tr_b16 v[180:181], v10 offset:8192
    v_accvgpr_write_b32 a5, v193
    v_mfma_f32_16x16x32_bf16 v[132:135], v[160:163], a[196:199], v[132:135]
    buffer_load_dwordx4 v3, s[20:23], s44 offen offset:1024 sc1 lds
    v_mfma_f32_16x16x32_bf16 v[132:135], v[164:167], a[212:215], v[132:135]
    ds_read_b64_tr_b16 v[182:183], v10 offset:9216
    v_accvgpr_write_b32 a6, v194
    v_mfma_f32_16x16x32_bf16 v[132:135], v[168:171], a[228:231], v[132:135]
    ds_read_b64_tr_b16 v[184:185], v10 offset:16384
    v_accvgpr_write_b32 a7, v195
    v_mfma_f32_16x16x32_bf16 v[132:135], v[172:175], a[244:247], v[132:135]
    ds_read_b64_tr_b16 v[186:187], v10 offset:17408
    v_cvt_pk_bf16_f32 v196, v68, v69
    v_mfma_f32_16x16x32_bf16 v[136:139], v[160:163], a[200:203], v[136:139]
    buffer_load_dwordx4 v3, s[20:23], s44 offen offset:2048 sc1 lds
    v_mfma_f32_16x16x32_bf16 v[136:139], v[164:167], a[216:219], v[136:139]
    ds_read_b64_tr_b16 v[188:189], v10 offset:24576
    v_cvt_pk_bf16_f32 v197, v70, v71
    v_mfma_f32_16x16x32_bf16 v[136:139], v[168:171], a[232:235], v[136:139]
    ds_read_b64_tr_b16 v[190:191], v10 offset:25600
    v_cvt_pk_bf16_f32 v198, v84, v85
    v_mfma_f32_16x16x32_bf16 v[136:139], v[172:175], a[248:251], v[136:139]
    v_cvt_pk_bf16_f32 v199, v86, v87
    v_accvgpr_write_b32 a20, v196
    v_mfma_f32_16x16x32_bf16 v[140:143], v[160:163], a[204:207], v[140:143]
    v_accvgpr_write_b32 a21, v197
    v_accvgpr_write_b32 a22, v198
    v_mfma_f32_16x16x32_bf16 v[140:143], v[164:167], a[220:223], v[140:143]
    buffer_load_dwordx4 v3, s[20:23], s44 offen offset:3072 sc1 lds
    v_mfma_f32_16x16x32_bf16 v[140:143], v[168:171], a[236:239], v[140:143]
    s_add_u32 s44, s44, 16384
    v_accvgpr_write_b32 a23, v199
    v_mfma_f32_16x16x32_bf16 v[140:143], v[172:175], a[252:255], v[140:143]
    s_waitcnt lgkmcnt(0)
    v_mfma_f32_16x16x32_bf16 v[144:147], v[176:179], a[192:195], v[144:147]
    v_mfma_f32_16x16x32_bf16 v[144:147], v[180:183], a[208:211], v[144:147]
    v_cvt_pk_bf16_f32 v200, v72, v73
    v_cvt_pk_bf16_f32 v201, v74, v75
    v_mfma_f32_16x16x32_bf16 v[144:147], v[184:187], a[224:227], v[144:147]
    v_cvt_pk_bf16_f32 v202, v88, v89
    v_cvt_pk_bf16_f32 v203, v90, v91
    v_mfma_f32_16x16x32_bf16 v[144:147], v[188:191], a[240:243], v[144:147]
    v_accvgpr_write_b32 a36, v200
    v_accvgpr_write_b32 a37, v201
    v_mfma_f32_16x16x32_bf16 v[148:151], v[176:179], a[196:199], v[148:151]
    v_accvgpr_write_b32 a38, v202
    v_accvgpr_write_b32 a39, v203
    v_mfma_f32_16x16x32_bf16 v[148:151], v[180:183], a[212:215], v[148:151]
    v_cvt_pk_bf16_f32 v204, v76, v77
    v_cvt_pk_bf16_f32 v205, v78, v79
    v_mfma_f32_16x16x32_bf16 v[148:151], v[184:187], a[228:231], v[148:151]
    v_cvt_pk_bf16_f32 v206, v92, v93
    v_cvt_pk_bf16_f32 v207, v94, v95
    v_mfma_f32_16x16x32_bf16 v[148:151], v[188:191], a[244:247], v[148:151]
    v_accvgpr_write_b32 a52, v204
    v_accvgpr_write_b32 a53, v205
    v_mfma_f32_16x16x32_bf16 v[152:155], v[176:179], a[200:203], v[152:155]
    v_accvgpr_write_b32 a54, v206
    v_accvgpr_write_b32 a55, v207
    v_mfma_f32_16x16x32_bf16 v[152:155], v[180:183], a[216:219], v[152:155]
    v_cvt_pk_bf16_f32 v192, v96, v97
    v_cvt_pk_bf16_f32 v193, v98, v99
    v_mfma_f32_16x16x32_bf16 v[152:155], v[184:187], a[232:235], v[152:155]
    v_cvt_pk_bf16_f32 v194, v112, v113
    v_cvt_pk_bf16_f32 v195, v114, v115
    v_mfma_f32_16x16x32_bf16 v[152:155], v[188:191], a[248:251], v[152:155]
    v_accvgpr_write_b32 a8, v192
    v_accvgpr_write_b32 a9, v193
    v_mfma_f32_16x16x32_bf16 v[156:159], v[176:179], a[204:207], v[156:159]
    v_accvgpr_write_b32 a10, v194
    v_accvgpr_write_b32 a11, v195
    v_mfma_f32_16x16x32_bf16 v[156:159], v[180:183], a[220:223], v[156:159]
    v_cvt_pk_bf16_f32 v196, v100, v101
    v_cvt_pk_bf16_f32 v197, v102, v103
    v_mfma_f32_16x16x32_bf16 v[156:159], v[184:187], a[236:239], v[156:159]
    v_cvt_pk_bf16_f32 v198, v116, v117
    v_cvt_pk_bf16_f32 v199, v118, v119
    v_mfma_f32_16x16x32_bf16 v[156:159], v[188:191], a[252:255], v[156:159]
    s_waitcnt vmcnt(8)
    s_barrier
    ds_read_b128 a[64:67], v2 offset:16384
    ds_read_b128 a[68:71], v2 offset:17408
    ds_read_b128 a[72:75], v2 offset:18432
    ds_read_b128 a[76:79], v2 offset:19456
    ds_read_b128 a[80:83], v2 offset:20480
    ds_read_b128 a[84:87], v2 offset:21504
    ds_read_b128 a[88:91], v2 offset:22528
    ds_read_b128 a[92:95], v2 offset:23552
    v_accvgpr_write_b32 a24, v196
    v_accvgpr_write_b32 a25, v197
    v_accvgpr_write_b32 a26, v198
    v_accvgpr_write_b32 a27, v199
    v_cvt_pk_bf16_f32 v200, v104, v105
    v_cvt_pk_bf16_f32 v201, v106, v107
    v_cvt_pk_bf16_f32 v202, v120, v121
    v_cvt_pk_bf16_f32 v203, v122, v123
    v_accvgpr_write_b32 a40, v200
    v_accvgpr_write_b32 a41, v201
    v_accvgpr_write_b32 a42, v202
    v_accvgpr_write_b32 a43, v203
    v_cvt_pk_bf16_f32 v204, v108, v109
    v_cvt_pk_bf16_f32 v205, v110, v111
    v_cvt_pk_bf16_f32 v206, v124, v125
    v_cvt_pk_bf16_f32 v207, v126, v127
    v_accvgpr_write_b32 a56, v204
    v_accvgpr_write_b32 a57, v205
    v_accvgpr_write_b32 a58, v206
    v_accvgpr_write_b32 a59, v207
    v_cvt_pk_bf16_f32 v192, v128, v129
    v_cvt_pk_bf16_f32 v193, v130, v131
    v_cvt_pk_bf16_f32 v194, v144, v145
    v_cvt_pk_bf16_f32 v195, v146, v147
    v_accvgpr_write_b32 a12, v192
    v_accvgpr_write_b32 a13, v193
    v_accvgpr_write_b32 a14, v194
    v_accvgpr_write_b32 a15, v195
    v_cvt_pk_bf16_f32 v196, v132, v133
    v_cvt_pk_bf16_f32 v197, v134, v135
    v_cvt_pk_bf16_f32 v198, v148, v149
    v_cvt_pk_bf16_f32 v199, v150, v151
    v_accvgpr_write_b32 a28, v196
    v_accvgpr_write_b32 a29, v197
    v_accvgpr_write_b32 a30, v198
    v_accvgpr_write_b32 a31, v199
    v_cvt_pk_bf16_f32 v200, v136, v137
    v_cvt_pk_bf16_f32 v201, v138, v139
    v_cvt_pk_bf16_f32 v202, v152, v153
    v_cvt_pk_bf16_f32 v203, v154, v155
    v_accvgpr_write_b32 a44, v200
    v_accvgpr_write_b32 a45, v201
    v_accvgpr_write_b32 a46, v202
    v_accvgpr_write_b32 a47, v203
    v_cvt_pk_bf16_f32 v204, v140, v141
    v_cvt_pk_bf16_f32 v205, v142, v143
    v_cvt_pk_bf16_f32 v206, v156, v157
    v_cvt_pk_bf16_f32 v207, v158, v159
    v_accvgpr_write_b32 a60, v204
    v_accvgpr_write_b32 a61, v205
    v_accvgpr_write_b32 a62, v206
    v_accvgpr_write_b32 a63, v207
    s_cmp_eq_u32 s46, 1
    s_cbranch_scc1 L_P1
    s_waitcnt lgkmcnt(4)
    v_mfma_f32_16x16x32_bf16 v[160:163], a[64:67], a[0:3], 0
    ds_read_b128 a[128:131], v2 offset:24576
    s_add_u32 m0, s10, 65536
    v_mfma_f32_16x16x32_bf16 v[160:163], a[68:71], a[4:7], v[160:163]
    ds_read_b128 a[132:135], v2 offset:25600
    buffer_load_dwordx4 v2, s[20:23], s44 offen offset:0 sc1 lds
    v_mfma_f32_16x16x32_bf16 v[160:163], a[72:75], a[8:11], v[160:163]
    ds_read_b128 a[136:139], v2 offset:26624
    v_mfma_f32_16x16x32_bf16 v[160:163], a[76:79], a[12:15], v[160:163]
    ds_read_b128 a[140:143], v2 offset:27648
    v_mfma_f32_16x16x32_bf16 v[164:167], a[64:67], a[16:19], 0
    ds_read_b128 a[144:147], v2 offset:28672
    v_mfma_f32_16x16x32_bf16 v[164:167], a[68:71], a[20:23], v[164:167]
    ds_read_b128 a[148:151], v2 offset:29696
    buffer_load_dwordx4 v2, s[20:23], s44 offen offset:1024 sc1 lds
    v_mfma_f32_16x16x32_bf16 v[164:167], a[72:75], a[24:27], v[164:167]
    ds_read_b128 a[152:155], v2 offset:30720
    v_max3_f32 v16, v160, v161, v162
    v_max_f32 v16, v16, v163
    v_mfma_f32_16x16x32_bf16 v[164:167], a[76:79], a[28:31], v[164:167]
    ds_read_b128 a[156:159], v2 offset:31744
    v_mov_b32 v20, v16
    v_mfma_f32_16x16x32_bf16 v[176:179], a[64:67], a[32:35], 0
    v_mfma_f32_16x16x32_bf16 v[176:179], a[68:71], a[36:39], v[176:179]
    buffer_load_dwordx4 v2, s[20:23], s44 offen offset:2048 sc1 lds
    v_permlane16_swap_b32 v16, v20
    v_max_f32 v16, v16, v20
    v_mfma_f32_16x16x32_bf16 v[176:179], a[72:75], a[40:43], v[176:179]
    v_mov_b32 v20, v16
    v_max3_f32 v17, v164, v165, v166
    v_max_f32 v17, v17, v167
    v_mfma_f32_16x16x32_bf16 v[176:179], a[76:79], a[44:47], v[176:179]
    v_mov_b32 v21, v17
    v_mfma_f32_16x16x32_bf16 v[180:183], a[64:67], a[48:51], 0
    ds_read_b128 a[64:67], v2 offset:0
    v_permlane32_swap_b32 v16, v20
    v_max_f32 v16, v16, v20
    v_mfma_f32_16x16x32_bf16 v[180:183], a[68:71], a[52:55], v[180:183]
    ds_read_b128 a[68:71], v2 offset:1024
    buffer_load_dwordx4 v2, s[20:23], s44 offen offset:3072 sc1 lds
    v_sub_f32 v224, 0, v16
    v_sub_f32 v225, 0, v16
    v_permlane16_swap_b32 v17, v21
    v_max_f32 v17, v17, v21
    v_mfma_f32_16x16x32_bf16 v[180:183], a[72:75], a[56:59], v[180:183]
    ds_read_b128 a[72:75], v2 offset:2048
    v_sub_f32 v226, 0, v16
    v_sub_f32 v227, 0, v16
    v_mov_b32 v21, v17
    v_max3_f32 v18, v176, v177, v178
    v_max_f32 v18, v18, v179
    v_mfma_f32_16x16x32_bf16 v[180:183], a[76:79], a[60:63], v[180:183]
    ds_read_b128 a[76:79], v2 offset:3072
    v_mov_b32 v22, v18
    s_waitcnt lgkmcnt(12)
    v_mfma_f32_16x16x32_bf16 v[168:171], a[80:83], a[0:3], v[224:227]
    s_add_u32 m0, s10, 69632
    v_permlane32_swap_b32 v17, v21
    v_max_f32 v17, v17, v21
    v_mfma_f32_16x16x32_bf16 v[168:171], a[84:87], a[4:7], v[168:171]
    buffer_load_dwordx4 v3, s[20:23], s44 offen offset:0 sc1 lds
    v_sub_f32 v228, 0, v17
    v_sub_f32 v229, 0, v17
    v_permlane16_swap_b32 v18, v22
    v_max_f32 v18, v18, v22
    v_mfma_f32_16x16x32_bf16 v[168:171], a[88:91], a[8:11], v[168:171]
    v_sub_f32 v230, 0, v17
    v_sub_f32 v231, 0, v17
    v_mov_b32 v22, v18
    v_max3_f32 v19, v180, v181, v182
    v_max_f32 v19, v19, v183
    v_mfma_f32_16x16x32_bf16 v[168:171], a[92:95], a[12:15], v[168:171]
    v_mov_b32 v23, v19
    v_mfma_f32_16x16x32_bf16 v[172:175], a[80:83], a[16:19], v[228:231]
    v_permlane32_swap_b32 v18, v22
    v_max_f32 v18, v18, v22
    v_mfma_f32_16x16x32_bf16 v[172:175], a[84:87], a[20:23], v[172:175]
    buffer_load_dwordx4 v3, s[20:23], s44 offen offset:1024 sc1 lds
    v_sub_f32 v232, 0, v18
    v_sub_f32 v233, 0, v18
    v_permlane16_swap_b32 v19, v23
    v_max_f32 v19, v19, v23
    v_mfma_f32_16x16x32_bf16 v[172:175], a[88:91], a[24:27], v[172:175]
    v_sub_f32 v234, 0, v18
    v_sub_f32 v235, 0, v18
    v_mov_b32 v23, v19
    v_mfma_f32_16x16x32_bf16 v[172:175], a[92:95], a[28:31], v[172:175]
    v_mfma_f32_16x16x32_bf16 v[184:187], a[80:83], a[32:35], v[232:235]
    v_permlane32_swap_b32 v19, v23
    v_max_f32 v19, v19, v23
    v_mfma_f32_16x16x32_bf16 v[184:187], a[84:87], a[36:39], v[184:187]
    buffer_load_dwordx4 v3, s[20:23], s44 offen offset:2048 sc1 lds
    v_sub_f32 v236, 0, v19
    v_sub_f32 v237, 0, v19
    v_mfma_f32_16x16x32_bf16 v[184:187], a[88:91], a[40:43], v[184:187]
    v_sub_f32 v238, 0, v19
    v_sub_f32 v239, 0, v19
    v_mfma_f32_16x16x32_bf16 v[184:187], a[92:95], a[44:47], v[184:187]
    v_sub_f32 v160, v160, v16
    v_sub_f32 v161, v161, v16
    v_mfma_f32_16x16x32_bf16 v[188:191], a[80:83], a[48:51], v[236:239]
    ds_read_b128 a[80:83], v2 offset:4096
    v_sub_f32 v162, v162, v16
    v_mfma_f32_16x16x32_bf16 v[188:191], a[84:87], a[52:55], v[188:191]
    ds_read_b128 a[84:87], v2 offset:5120
    buffer_load_dwordx4 v3, s[20:23], s44 offen offset:3072 sc1 lds
    v_mfma_f32_16x16x32_bf16 v[188:191], a[88:91], a[56:59], v[188:191]
    ds_read_b128 a[88:91], v2 offset:6144
    v_sub_f32 v163, v163, v16
    v_sub_f32 v164, v164, v17
    v_mfma_f32_16x16x32_bf16 v[188:191], a[92:95], a[60:63], v[188:191]
    ds_read_b128 a[92:95], v2 offset:7168
    v_sub_f32 v165, v165, v17
    v_sub_f32 v166, v166, v17
    v_sub_f32 v167, v167, v17
    v_sub_f32 v176, v176, v18
    v_sub_f32 v177, v177, v18
    v_sub_f32 v178, v178, v18
    v_sub_f32 v179, v179, v18
    v_sub_f32 v180, v180, v19
    v_sub_f32 v181, v181, v19
    v_sub_f32 v182, v182, v19
    v_sub_f32 v183, v183, v19
    s_waitcnt lgkmcnt(4)
    v_mfma_f32_16x16x32_bf16 v[192:195], a[64:67], a[0:3], v[224:227]
    s_add_u32 s44, s44, 16384
    v_exp_f32 v160, v160
    v_mfma_f32_16x16x32_bf16 v[192:195], a[68:71], a[4:7], v[192:195]
    v_exp_f32 v161, v161
    v_exp_f32 v162, v162
    v_mfma_f32_16x16x32_bf16 v[192:195], a[72:75], a[8:11], v[192:195]
    v_exp_f32 v163, v163
    v_exp_f32 v164, v164
    v_mfma_f32_16x16x32_bf16 v[192:195], a[76:79], a[12:15], v[192:195]
    v_exp_f32 v165, v165
    v_cvt_pk_bf16_f32 v160, v160, v161
    v_mfma_f32_16x16x32_bf16 v[196:199], a[64:67], a[16:19], v[228:231]
    v_exp_f32 v166, v166
    v_cvt_pk_bf16_f32 v161, v162, v163
    v_mfma_f32_16x16x32_bf16 v[196:199], a[68:71], a[20:23], v[196:199]
    v_exp_f32 v167, v167
    v_cvt_pk_bf16_f32 v164, v164, v165
    v_mfma_f32_16x16x32_bf16 v[196:199], a[72:75], a[24:27], v[196:199]
    v_exp_f32 v176, v176
    v_cvt_pk_bf16_f32 v165, v166, v167
    v_mfma_f32_16x16x32_bf16 v[196:199], a[76:79], a[28:31], v[196:199]
    v_exp_f32 v177, v177
    v_mfma_f32_16x16x32_bf16 v[208:211], a[64:67], a[32:35], v[232:235]
    v_exp_f32 v178, v178
    v_cvt_pk_bf16_f32 v176, v176, v177
    v_mfma_f32_16x16x32_bf16 v[208:211], a[68:71], a[36:39], v[208:211]
    v_exp_f32 v179, v179
    v_mfma_f32_16x16x32_bf16 v[208:211], a[72:75], a[40:43], v[208:211]
    v_exp_f32 v180, v180
    v_cvt_pk_bf16_f32 v177, v178, v179
    v_mfma_f32_16x16x32_bf16 v[208:211], a[76:79], a[44:47], v[208:211]
    v_exp_f32 v181, v181
    v_mfma_f32_16x16x32_bf16 v[212:215], a[64:67], a[48:51], v[236:239]
    ds_read_b128 a[64:67], v2 offset:8192
    v_exp_f32 v182, v182
    v_mfma_f32_16x16x32_bf16 v[212:215], a[68:71], a[52:55], v[212:215]
    ds_read_b128 a[68:71], v2 offset:9216
    v_exp_f32 v183, v183
    v_mfma_f32_16x16x32_bf16 v[212:215], a[72:75], a[56:59], v[212:215]
    ds_read_b128 a[72:75], v2 offset:10240
    v_exp_f32 v168, v168
    v_mfma_f32_16x16x32_bf16 v[212:215], a[76:79], a[60:63], v[212:215]
    ds_read_b128 a[76:79], v2 offset:11264
    v_cvt_pk_bf16_f32 v180, v180, v181
    s_waitcnt lgkmcnt(4)
    v_mfma_f32_16x16x32_bf16 v[200:203], a[80:83], a[0:3], v[224:227]
    v_exp_f32 v169, v169
    v_cvt_pk_bf16_f32 v181, v182, v183
    v_mfma_f32_16x16x32_bf16 v[200:203], a[84:87], a[4:7], v[200:203]
    v_exp_f32 v170, v170
    v_cvt_pk_bf16_f32 v162, v168, v169
    v_mfma_f32_16x16x32_bf16 v[200:203], a[88:91], a[8:11], v[200:203]
    v_exp_f32 v171, v171
    v_mfma_f32_16x16x32_bf16 v[200:203], a[92:95], a[12:15], v[200:203]
    v_exp_f32 v172, v172
    v_cvt_pk_bf16_f32 v163, v170, v171
    v_mfma_f32_16x16x32_bf16 v[204:207], a[80:83], a[16:19], v[228:231]
    v_exp_f32 v173, v173
    v_mfma_f32_16x16x32_bf16 v[204:207], a[84:87], a[20:23], v[204:207]
    v_exp_f32 v174, v174
    v_mfma_f32_16x16x32_bf16 v[204:207], a[88:91], a[24:27], v[204:207]
    v_exp_f32 v175, v175
    v_mfma_f32_16x16x32_bf16 v[204:207], a[92:95], a[28:31], v[204:207]
    v_exp_f32 v184, v184
    v_mfma_f32_16x16x32_bf16 v[216:219], a[80:83], a[32:35], v[232:235]
    v_exp_f32 v185, v185
    v_mfma_f32_16x16x32_bf16 v[216:219], a[84:87], a[36:39], v[216:219]
    v_exp_f32 v186, v186
    v_mfma_f32_16x16x32_bf16 v[216:219], a[88:91], a[40:43], v[216:219]
    v_exp_f32 v187, v187
    v_mfma_f32_16x16x32_bf16 v[216:219], a[92:95], a[44:47], v[216:219]
    v_exp_f32 v188, v188
    v_mfma_f32_16x16x32_bf16 v[220:223], a[80:83], a[48:51], v[236:239]
    ds_read_b128 a[80:83], v2 offset:12288
    v_exp_f32 v189, v189
    v_mfma_f32_16x16x32_bf16 v[220:223], a[84:87], a[52:55], v[220:223]
    ds_read_b128 a[84:87], v2 offset:13312
    v_exp_f32 v190, v190
    v_mfma_f32_16x16x32_bf16 v[220:223], a[88:91], a[56:59], v[220:223]
    ds_read_b128 a[88:91], v2 offset:14336
    v_exp_f32 v191, v191
    v_mfma_f32_16x16x32_bf16 v[220:223], a[92:95], a[60:63], v[220:223]
    ds_read_b128 a[92:95], v2 offset:15360
    v_cvt_pk_bf16_f32 v166, v172, v173
    v_cvt_pk_bf16_f32 v167, v174, v175
    v_cvt_pk_bf16_f32 v178, v184, v185
    v_cvt_pk_bf16_f32 v179, v186, v187
    v_cvt_pk_bf16_f32 v182, v188, v189
    v_cvt_pk_bf16_f32 v183, v190, v191
    s_add_u32 m0, s10, 98304
    s_waitcnt vmcnt(8) lgkmcnt(8)
    s_cmp_lg_u32 s46, 2
    s_cbranch_scc1 L_D1
L_DM0:
    v_mfma_f32_16x16x32_bf16 v[32:35], a[128:131], v[160:163], 0
    s_barrier
    v_xor_b32 v10, m0, v15
    v_mfma_f32_16x16x32_bf16 v[36:39], a[128:131], v[164:167], 0
    buffer_load_dwordx4 v2, s[20:23], s44 offen offset:0 sc1 lds
    v_mfma_f32_16x16x32_bf16 v[96:99], a[128:131], v[176:179], 0
    v_exp_f32 v192, v192
    v_mfma_f32_16x16x32_bf16 v[100:103], a[128:131], v[180:183], 0
    ds_read_b128 a[128:131], v10 offset:16384
    v_cndmask_b32 v240, v12, v224, s[60:61]
    v_mfma_f32_16x16x32_bf16 v[40:43], a[132:135], v[160:163], 0
    v_exp_f32 v193, v193
    v_mfma_f32_16x16x32_bf16 v[44:47], a[132:135], v[164:167], 0
    v_exp_f32 v194, v194
    v_mfma_f32_16x16x32_bf16 v[104:107], a[132:135], v[176:179], 0
    v_cvt_pk_bf16_f32 v192, v192, v193
    v_cndmask_b32 v241, v12, v225, s[62:63]
    v_mfma_f32_16x16x32_bf16 v[108:111], a[132:135], v[180:183], 0
    ds_read_b128 a[132:135], v10 offset:17408
    v_cndmask_b32 v242, v12, v226, s[30:31]
    v_mfma_f32_16x16x32_bf16 v[48:51], a[136:139], v[160:163], 0
    v_exp_f32 v195, v195
    v_mfma_f32_16x16x32_bf16 v[52:55], a[136:139], v[164:167], 0
    v_exp_f32 v196, v196
    v_mfma_f32_16x16x32_bf16 v[112:115], a[136:139], v[176:179], 0
    v_exp_f32 v197, v197
    v_mfma_f32_16x16x32_bf16 v[116:119], a[136:139], v[180:183], 0
    ds_read_b128 a[136:139], v10 offset:18432
    v_cvt_pk_bf16_f32 v193, v194, v195
    v_mfma_f32_16x16x32_bf16 v[56:59], a[140:143], v[160:163], 0
    v_cvt_pk_bf16_f32 v196, v196, v197
    v_cndmask_b32 v243, v12, v227, s[32:33]
    v_mfma_f32_16x16x32_bf16 v[60:63], a[140:143], v[164:167], 0
    v_exp_f32 v198, v198
    v_mfma_f32_16x16x32_bf16 v[120:123], a[140:143], v[176:179], 0
    v_exp_f32 v199, v199
    v_mfma_f32_16x16x32_bf16 v[124:127], a[140:143], v[180:183], 0
    ds_read_b128 a[140:143], v10 offset:19456
    v_cvt_pk_bf16_f32 v197, v198, v199
    v_mfma_f32_16x16x32_bf16 v[64:67], a[144:147], v[160:163], 0
    buffer_load_dwordx4 v2, s[20:23], s44 offen offset:1024 sc1 lds
    v_mfma_f32_16x16x32_bf16 v[68:71], a[144:147], v[164:167], 0
    v_exp_f32 v208, v208
    v_mfma_f32_16x16x32_bf16 v[128:131], a[144:147], v[176:179], 0
    v_cndmask_b32 v244, v12, v224, s[50:51]
    v_cndmask_b32 v245, v12, v225, s[50:51]
    v_mfma_f32_16x16x32_bf16 v[132:135], a[144:147], v[180:183], 0
    ds_read_b128 a[144:147], v10 offset:20480
    v_cndmask_b32 v246, v12, v226, s[50:51]
    v_mfma_f32_16x16x32_bf16 v[72:75], a[148:151], v[160:163], 0
    v_exp_f32 v209, v209
    v_mfma_f32_16x16x32_bf16 v[76:79], a[148:151], v[164:167], 0
    v_exp_f32 v210, v210
    v_mfma_f32_16x16x32_bf16 v[136:139], a[148:151], v[176:179], 0
    v_exp_f32 v211, v211
    v_mfma_f32_16x16x32_bf16 v[140:143], a[148:151], v[180:183], 0
    ds_read_b128 a[148:151], v10 offset:21504
    v_cvt_pk_bf16_f32 v208, v208, v209
    v_mfma_f32_16x16x32_bf16 v[80:83], a[152:155], v[160:163], 0
    v_cvt_pk_bf16_f32 v209, v210, v211
    v_cndmask_b32 v247, v12, v227, s[50:51]
    v_mfma_f32_16x16x32_bf16 v[84:87], a[152:155], v[164:167], 0
    v_exp_f32 v212, v212
    v_mfma_f32_16x16x32_bf16 v[144:147], a[152:155], v[176:179], 0
    v_exp_f32 v213, v213
    v_mfma_f32_16x16x32_bf16 v[148:151], a[152:155], v[180:183], 0
    ds_read_b128 a[152:155], v10 offset:22528
    v_cvt_pk_bf16_f32 v212, v212, v213
    v_mfma_f32_16x16x32_bf16 v[88:91], a[156:159], v[160:163], 0
    v_exp_f32 v214, v214
    v_mfma_f32_16x16x32_bf16 v[92:95], a[156:159], v[164:167], 0
    v_cndmask_b32 v252, v12, v228, s[60:61]
    v_cndmask_b32 v253, v12, v229, s[62:63]
    v_cndmask_b32 v254, v12, v230, s[30:31]
    v_mfma_f32_16x16x32_bf16 v[152:155], a[156:159], v[176:179], 0
    v_exp_f32 v215, v215
    v_cndmask_b32 v255, v12, v231, s[32:33]
    v_mfma_f32_16x16x32_bf16 v[156:159], a[156:159], v[180:183], 0
    ds_read_b128 a[156:159], v10 offset:23552
    v_cvt_pk_bf16_f32 v213, v214, v215
    v_smfmac_f32_16x16x64_bf16 a[96:99], a[116:119], v[160:167], v6
    v_smfmac_f32_16x16x64_bf16 a[100:103], a[116:119], v[176:183], v6
    s_waitcnt lgkmcnt(8)
    v_mfma_f32_16x16x32_bf16 v[160:163], a[64:67], a[0:3], v[240:243]
    buffer_load_dwordx4 v2, s[20:23], s44 offen offset:2048 sc1 lds
    v_mfma_f32_16x16x32_bf16 v[160:163], a[68:71], a[4:7], v[160:163]
    v_exp_f32 v200, v200
    v_mfma_f32_16x16x32_bf16 v[160:163], a[72:75], a[8:11], v[160:163]
    v_exp_f32 v201, v201
    v_mfma_f32_16x16x32_bf16 v[160:163], a[76:79], a[12:15], v[160:163]
    v_cvt_pk_bf16_f32 v194, v200, v201
    v_mfma_f32_16x16x32_bf16 v[164:167], a[64:67], a[16:19], v[228:231]
    v_exp_f32 v202, v202
    v_mfma_f32_16x16x32_bf16 v[164:167], a[68:71], a[20:23], v[164:167]
    v_exp_f32 v203, v203
    v_mfma_f32_16x16x32_bf16 v[164:167], a[72:75], a[24:27], v[164:167]
    v_exp_f32 v204, v204
    v_mfma_f32_16x16x32_bf16 v[164:167], a[76:79], a[28:31], v[164:167]
    v_cvt_pk_bf16_f32 v195, v202, v203
    v_mfma_f32_16x16x32_bf16 v[176:179], a[64:67], a[32:35], v[232:235]
    v_exp_f32 v205, v205
    v_mfma_f32_16x16x32_bf16 v[176:179], a[68:71], a[36:39], v[176:179]
    v_exp_f32 v206, v206
    v_mfma_f32_16x16x32_bf16 v[176:179], a[72:75], a[40:43], v[176:179]
    v_exp_f32 v207, v207
    v_mfma_f32_16x16x32_bf16 v[176:179], a[76:79], a[44:47], v[176:179]
    v_cvt_pk_bf16_f32 v198, v204, v205
    v_cvt_pk_bf16_f32 v199, v206, v207
    v_mfma_f32_16x16x32_bf16 v[180:183], a[64:67], a[48:51], v[236:239]
    ds_read_b128 a[64:67], v10 offset:0
    v_mfma_f32_16x16x32_bf16 v[180:183], a[68:71], a[52:55], v[180:183]
    ds_read_b128 a[68:71], v10 offset:1024
    v_mfma_f32_16x16x32_bf16 v[180:183], a[72:75], a[56:59], v[180:183]
    ds_read_b128 a[72:75], v10 offset:2048
    v_mfma_f32_16x16x32_bf16 v[180:183], a[76:79], a[60:63], v[180:183]
    ds_read_b128 a[76:79], v10 offset:3072
    v_mfma_f32_16x16x32_bf16 v[168:171], a[80:83], a[0:3], v[244:247]
    buffer_load_dwordx4 v2, s[20:23], s44 offen offset:3072 sc1 lds
    v_mfma_f32_16x16x32_bf16 v[168:171], a[84:87], a[4:7], v[168:171]
    v_exp_f32 v216, v216
    v_mfma_f32_16x16x32_bf16 v[168:171], a[88:91], a[8:11], v[168:171]
    v_exp_f32 v217, v217
    v_mfma_f32_16x16x32_bf16 v[168:171], a[92:95], a[12:15], v[168:171]
    v_exp_f32 v218, v218
    v_mfma_f32_16x16x32_bf16 v[172:175], a[80:83], a[16:19], v[252:255]
    v_cvt_pk_bf16_f32 v210, v216, v217
    s_add_u32 m0, m0, 4096
    v_mfma_f32_16x16x32_bf16 v[172:175], a[84:87], a[20:23], v[172:175]
    v_exp_f32 v219, v219
    v_mfma_f32_16x16x32_bf16 v[172:175], a[88:91], a[24:27], v[172:175]
    v_exp_f32 v220, v220
    v_mfma_f32_16x16x32_bf16 v[172:175], a[92:95], a[28:31], v[172:175]
    v_exp_f32 v221, v221
    v_mfma_f32_16x16x32_bf16 v[184:187], a[80:83], a[32:35], v[232:235]
    v_cvt_pk_bf16_f32 v211, v218, v219
    v_cvt_pk_bf16_f32 v214, v220, v221
    v_mfma_f32_16x16x32_bf16 v[184:187], a[84:87], a[36:39], v[184:187]
    v_exp_f32 v222, v222
    v_mfma_f32_16x16x32_bf16 v[184:187], a[88:91], a[40:43], v[184:187]
    v_exp_f32 v223, v223
    v_mfma_f32_16x16x32_bf16 v[184:187], a[92:95], a[44:47], v[184:187]
    v_cvt_pk_bf16_f32 v215, v222, v223
    v_mfma_f32_16x16x32_bf16 v[188:191], a[80:83], a[48:51], v[236:239]
    ds_read_b128 a[80:83], v10 offset:4096
    v_mfma_f32_16x16x32_bf16 v[188:191], a[84:87], a[52:55], v[188:191]
    ds_read_b128 a[84:87], v10 offset:5120
    v_mfma_f32_16x16x32_bf16 v[188:191], a[88:91], a[56:59], v[188:191]
    ds_read_b128 a[88:91], v10 offset:6144
    v_mfma_f32_16x16x32_bf16 v[188:191], a[92:95], a[60:63], v[188:191]
    ds_read_b128 a[92:95], v10 offset:7168
    s_waitcnt lgkmcnt(8)
    v_mfma_f32_16x16x32_bf16 v[32:35], a[128:131], v[192:195], v[32:35]
    buffer_load_dwordx4 v3, s[20:23], s44 offen offset:0 sc1 lds
    v_mfma_f32_16x16x32_bf16 v[36:39], a[128:131], v[196:199], v[36:39]
    v_exp_f32 v160, v160
    v_mfma_f32_16x16x32_bf16 v[96:99], a[128:131], v[208:211], v[96:99]
    v_exp_f32 v161, v161
    v_mfma_f32_16x16x32_bf16 v[100:103], a[128:131], v[212:215], v[100:103]
    ds_read_b128 a[128:131], v10 offset:24576
    v_cvt_pk_bf16_f32 v160, v160, v161
    v_mfma_f32_16x16x32_bf16 v[40:43], a[132:135], v[192:195], v[40:43]
    v_exp_f32 v162, v162
    v_mfma_f32_16x16x32_bf16 v[44:47], a[132:135], v[196:199], v[44:47]
    v_cndmask_b32 v240, v12, v224, s[34:35]
    v_cndmask_b32 v241, v12, v225, s[36:37]
    v_mfma_f32_16x16x32_bf16 v[104:107], a[132:135], v[208:211], v[104:107]
    v_exp_f32 v163, v163
    v_mfma_f32_16x16x32_bf16 v[108:111], a[132:135], v[212:215], v[108:111]
    ds_read_b128 a[132:135], v10 offset:25600
    v_cvt_pk_bf16_f32 v161, v162, v163
    v_mfma_f32_16x16x32_bf16 v[48:51], a[136:139], v[192:195], v[48:51]
    v_exp_f32 v164, v164
    v_mfma_f32_16x16x32_bf16 v[52:55], a[136:139], v[196:199], v[52:55]
    v_exp_f32 v165, v165
    v_mfma_f32_16x16x32_bf16 v[112:115], a[136:139], v[208:211], v[112:115]
    v_cvt_pk_bf16_f32 v164, v164, v165
    v_cndmask_b32 v242, v12, v226, s[84:85]
    v_mfma_f32_16x16x32_bf16 v[116:119], a[136:139], v[212:215], v[116:119]
    ds_read_b128 a[136:139], v10 offset:26624
    v_cndmask_b32 v243, v12, v227, s[86:87]
    v_mfma_f32_16x16x32_bf16 v[56:59], a[140:143], v[192:195], v[56:59]
    v_exp_f32 v166, v166
    v_mfma_f32_16x16x32_bf16 v[60:63], a[140:143], v[196:199], v[60:63]
    buffer_load_dwordx4 v3, s[20:23], s44 offen offset:1024 sc1 lds
    v_mfma_f32_16x16x32_bf16 v[120:123], a[140:143], v[208:211], v[120:123]
    v_exp_f32 v167, v167
    v_mfma_f32_16x16x32_bf16 v[124:127], a[140:143], v[212:215], v[124:127]
    ds_read_b128 a[140:143], v10 offset:27648
    v_cvt_pk_bf16_f32 v165, v166, v167
    v_mfma_f32_16x16x32_bf16 v[64:67], a[144:147], v[192:195], v[64:67]
    v_cndmask_b32 v248, v12, v228, s[50:51]
    v_cndmask_b32 v249, v12, v229, s[50:51]
    v_mfma_f32_16x16x32_bf16 v[68:71], a[144:147], v[196:199], v[68:71]
    v_exp_f32 v176, v176
    v_mfma_f32_16x16x32_bf16 v[128:131], a[144:147], v[208:211], v[128:131]
    v_exp_f32 v177, v177
    v_mfma_f32_16x16x32_bf16 v[132:135], a[144:147], v[212:215], v[132:135]
    ds_read_b128 a[144:147], v10 offset:28672
    v_cvt_pk_bf16_f32 v176, v176, v177
    v_mfma_f32_16x16x32_bf16 v[72:75], a[148:151], v[192:195], v[72:75]
    v_exp_f32 v178, v178
    v_mfma_f32_16x16x32_bf16 v[76:79], a[148:151], v[196:199], v[76:79]
    v_cndmask_b32 v250, v12, v230, s[50:51]
    v_cndmask_b32 v251, v12, v231, s[50:51]
    v_mfma_f32_16x16x32_bf16 v[136:139], a[148:151], v[208:211], v[136:139]
    v_exp_f32 v179, v179
    v_mfma_f32_16x16x32_bf16 v[140:143], a[148:151], v[212:215], v[140:143]
    ds_read_b128 a[148:151], v10 offset:29696
    v_cvt_pk_bf16_f32 v177, v178, v179
    v_mfma_f32_16x16x32_bf16 v[80:83], a[152:155], v[192:195], v[80:83]
    v_exp_f32 v180, v180
    v_mfma_f32_16x16x32_bf16 v[84:87], a[152:155], v[196:199], v[84:87]
    v_exp_f32 v181, v181
    v_mfma_f32_16x16x32_bf16 v[144:147], a[152:155], v[208:211], v[144:147]
    v_cvt_pk_bf16_f32 v180, v180, v181
    v_mov_b32 v244, v12
    v_mfma_f32_16x16x32_bf16 v[148:151], a[152:155], v[212:215], v[148:151]
    ds_read_b128 a[152:155], v10 offset:30720
    v_mov_b32 v245, v12
    v_mov_b32 v246, v12
    v_mfma_f32_16x16x32_bf16 v[88:91], a[156:159], v[192:195], v[88:91]
    v_exp_f32 v182, v182
    v_mov_b32 v247, v12
    v_mfma_f32_16x16x32_bf16 v[92:95], a[156:159], v[196:199], v[92:95]
    buffer_load_dwordx4 v3, s[20:23], s44 offen offset:2048 sc1 lds
    v_cndmask_b32 v252, v12, v228, s[34:35]
    v_mfma_f32_16x16x32_bf16 v[152:155], a[156:159], v[208:211], v[152:155]
    v_exp_f32 v183, v183
    v_cndmask_b32 v253, v12, v229, s[36:37]
    v_mfma_f32_16x16x32_bf16 v[156:159], a[156:159], v[212:215], v[156:159]
    ds_read_b128 a[156:159], v10 offset:31744
    v_cvt_pk_bf16_f32 v181, v182, v183
    v_cndmask_b32 v254, v12, v230, s[84:85]
    v_cndmask_b32 v255, v12, v231, s[86:87]
    v_smfmac_f32_16x16x64_bf16 a[96:99], a[116:119], v[192:199], v6
    v_smfmac_f32_16x16x64_bf16 a[100:103], a[116:119], v[208:215], v6
    s_waitcnt lgkmcnt(8)
    v_mfma_f32_16x16x32_bf16 v[192:195], a[64:67], a[0:3], v[240:243]
    v_mfma_f32_16x16x32_bf16 v[192:195], a[68:71], a[4:7], v[192:195]
    v_exp_f32 v168, v168
    v_mfma_f32_16x16x32_bf16 v[192:195], a[72:75], a[8:11], v[192:195]
    v_exp_f32 v169, v169
    v_mfma_f32_16x16x32_bf16 v[192:195], a[76:79], a[12:15], v[192:195]
    v_exp_f32 v170, v170
    v_mfma_f32_16x16x32_bf16 v[196:199], a[64:67], a[16:19], v[248:251]
    v_cvt_pk_bf16_f32 v162, v168, v169
    v_mfma_f32_16x16x32_bf16 v[196:199], a[68:71], a[20:23], v[196:199]
    v_exp_f32 v171, v171
    v_mfma_f32_16x16x32_bf16 v[196:199], a[72:75], a[24:27], v[196:199]
    v_exp_f32 v172, v172
    v_mfma_f32_16x16x32_bf16 v[196:199], a[76:79], a[28:31], v[196:199]
    v_exp_f32 v173, v173
    v_mfma_f32_16x16x32_bf16 v[208:211], a[64:67], a[32:35], v[232:235]
    v_cvt_pk_bf16_f32 v163, v170, v171
    v_cvt_pk_bf16_f32 v166, v172, v173
    v_mfma_f32_16x16x32_bf16 v[208:211], a[68:71], a[36:39], v[208:211]
    v_exp_f32 v174, v174
    v_mfma_f32_16x16x32_bf16 v[208:211], a[72:75], a[40:43], v[208:211]
    v_exp_f32 v175, v175
    v_mfma_f32_16x16x32_bf16 v[208:211], a[76:79], a[44:47], v[208:211]
    buffer_load_dwordx4 v3, s[20:23], s44 offen offset:3072 sc1 lds
    v_mfma_f32_16x16x32_bf16 v[212:215], a[64:67], a[48:51], v[236:239]
    ds_read_b128 a[64:67], v10 offset:8192
    v_cvt_pk_bf16_f32 v167, v174, v175
    v_mfma_f32_16x16x32_bf16 v[212:215], a[68:71], a[52:55], v[212:215]
    ds_read_b128 a[68:71], v10 offset:9216
    s_add_u32 s44, s44, 16384
    v_mfma_f32_16x16x32_bf16 v[212:215], a[72:75], a[56:59], v[212:215]
    ds_read_b128 a[72:75], v10 offset:10240
    s_add_u32 m0, m0, 28672
    v_mfma_f32_16x16x32_bf16 v[212:215], a[76:79], a[60:63], v[212:215]
    ds_read_b128 a[76:79], v10 offset:11264
    s_and_b32 m0, m0, 0x1ffff
    v_mfma_f32_16x16x32_bf16 v[200:203], a[80:83], a[0:3], v[244:247]
    v_mfma_f32_16x16x32_bf16 v[200:203], a[84:87], a[4:7], v[200:203]
    v_exp_f32 v184, v184
    v_mfma_f32_16x16x32_bf16 v[200:203], a[88:91], a[8:11], v[200:203]
    v_exp_f32 v185, v185
    v_mfma_f32_16x16x32_bf16 v[200:203], a[92:95], a[12:15], v[200:203]
    v_exp_f32 v186, v186
    v_mfma_f32_16x16x32_bf16 v[204:207], a[80:83], a[16:19], v[252:255]
    v_cvt_pk_bf16_f32 v178, v184, v185
    v_mfma_f32_16x16x32_bf16 v[204:207], a[84:87], a[20:23], v[204:207]
    v_exp_f32 v187, v187
    v_mfma_f32_16x16x32_bf16 v[204:207], a[88:91], a[24:27], v[204:207]
    v_exp_f32 v188, v188
    v_mfma_f32_16x16x32_bf16 v[204:207], a[92:95], a[28:31], v[204:207]
    v_exp_f32 v189, v189
    v_mfma_f32_16x16x32_bf16 v[216:219], a[80:83], a[32:35], v[232:235]
    v_cvt_pk_bf16_f32 v179, v186, v187
    v_cvt_pk_bf16_f32 v182, v188, v189
    v_mfma_f32_16x16x32_bf16 v[216:219], a[84:87], a[36:39], v[216:219]
    v_exp_f32 v190, v190
    v_mfma_f32_16x16x32_bf16 v[216:219], a[88:91], a[40:43], v[216:219]
    v_exp_f32 v191, v191
    v_mfma_f32_16x16x32_bf16 v[216:219], a[92:95], a[44:47], v[216:219]
    v_cvt_pk_bf16_f32 v183, v190, v191
    v_mfma_f32_16x16x32_bf16 v[220:223], a[80:83], a[48:51], v[236:239]
    ds_read_b128 a[80:83], v10 offset:12288
    v_mfma_f32_16x16x32_bf16 v[220:223], a[84:87], a[52:55], v[220:223]
    ds_read_b128 a[84:87], v10 offset:13312
    v_mfma_f32_16x16x32_bf16 v[220:223], a[88:91], a[56:59], v[220:223]
    ds_read_b128 a[88:91], v10 offset:14336
    v_mfma_f32_16x16x32_bf16 v[220:223], a[92:95], a[60:63], v[220:223]
    ds_read_b128 a[92:95], v10 offset:15360
    s_waitcnt vmcnt(8) lgkmcnt(8)
    s_branch L_T
    .p2align 6
L_wuT:
    s_branch L_wbT
L_T:
    s_xor_b32 s6, s5, 6
    s_cmp_lg_u32 s6, 0
    s_cbranch_scc1 L_sg6
    buffer_load_dword v9, v14, s[16:19], 0 offen offset:128 sc1
L_sg6:
    s_mov_b32 s91, m0
    v_mfma_f32_16x16x32_bf16 v[32:35], a[128:131], v[160:163], v[32:35]
    s_barrier
    v_xor_b32 v10, m0, v15
    v_mfma_f32_16x16x32_bf16 v[36:39], a[128:131], v[164:167], v[36:39]
    buffer_load_dwordx4 v2, s[20:23], s44 offen offset:0 sc1 lds
    v_mfma_f32_16x16x32_bf16 v[96:99], a[128:131], v[176:179], v[96:99]
    v_exp_f32 v192, v192
    v_mfma_f32_16x16x32_bf16 v[100:103], a[128:131], v[180:183], v[100:103]
    ds_read_b128 a[128:131], v10 offset:16384
    v_exp_f32 v193, v193
    v_mfma_f32_16x16x32_bf16 v[40:43], a[132:135], v[160:163], v[40:43]
    v_exp_f32 v194, v194
    v_cvt_pk_bf16_f32 v192, v192, v193
    v_mfma_f32_16x16x32_bf16 v[44:47], a[132:135], v[164:167], v[44:47]
    v_exp_f32 v195, v195
    v_mfma_f32_16x16x32_bf16 v[104:107], a[132:135], v[176:179], v[104:107]
    v_exp_f32 v196, v196
    v_cvt_pk_bf16_f32 v193, v194, v195
    v_mfma_f32_16x16x32_bf16 v[108:111], a[132:135], v[180:183], v[108:111]
    ds_read_b128 a[132:135], v10 offset:17408
    v_exp_f32 v197, v197
    v_mfma_f32_16x16x32_bf16 v[48:51], a[136:139], v[160:163], v[48:51]
    v_exp_f32 v198, v198
    v_cvt_pk_bf16_f32 v196, v196, v197
    v_mfma_f32_16x16x32_bf16 v[52:55], a[136:139], v[164:167], v[52:55]
    v_exp_f32 v199, v199
    v_mfma_f32_16x16x32_bf16 v[112:115], a[136:139], v[176:179], v[112:115]
    v_exp_f32 v208, v208
    v_cvt_pk_bf16_f32 v197, v198, v199
    v_mfma_f32_16x16x32_bf16 v[116:119], a[136:139], v[180:183], v[116:119]
    ds_read_b128 a[136:139], v10 offset:18432
    v_exp_f32 v209, v209
    v_mfma_f32_16x16x32_bf16 v[56:59], a[140:143], v[160:163], v[56:59]
    buffer_load_dwordx4 v2, s[20:23], s44 offen offset:1024 sc1 lds
    v_cvt_pk_bf16_f32 v208, v208, v209
    v_mfma_f32_16x16x32_bf16 v[60:63], a[140:143], v[164:167], v[60:63]
    v_exp_f32 v210, v210
    v_mfma_f32_16x16x32_bf16 v[120:123], a[140:143], v[176:179], v[120:123]
    v_exp_f32 v211, v211
    v_mfma_f32_16x16x32_bf16 v[124:127], a[140:143], v[180:183], v[124:127]
    ds_read_b128 a[140:143], v10 offset:19456
    v_exp_f32 v212, v212
    v_mfma_f32_16x16x32_bf16 v[64:67], a[144:147], v[160:163], v[64:67]
    v_exp_f32 v213, v213
    v_mfma_f32_16x16x32_bf16 v[68:71], a[144:147], v[164:167], v[68:71]
    v_exp_f32 v214, v214
    v_mfma_f32_16x16x32_bf16 v[128:131], a[144:147], v[176:179], v[128:131]
    v_exp_f32 v215, v215
    v_mfma_f32_16x16x32_bf16 v[132:135], a[144:147], v[180:183], v[132:135]
    ds_read_b128 a[144:147], v10 offset:20480
    v_exp_f32 v200, v200
    v_mfma_f32_16x16x32_bf16 v[72:75], a[148:151], v[160:163], v[72:75]
    v_exp_f32 v201, v201
    v_mfma_f32_16x16x32_bf16 v[76:79], a[148:151], v[164:167], v[76:79]
    v_exp_f32 v202, v202
    v_mfma_f32_16x16x32_bf16 v[136:139], a[148:151], v[176:179], v[136:139]
    v_exp_f32 v203, v203
    v_mfma_f32_16x16x32_bf16 v[140:143], a[148:151], v[180:183], v[140:143]
    ds_read_b128 a[148:151], v10 offset:21504
    v_cvt_pk_bf16_f32 v209, v210, v211
    v_mfma_f32_16x16x32_bf16 v[80:83], a[152:155], v[160:163], v[80:83]
    buffer_load_dwordx4 v2, s[20:23], s44 offen offset:2048 sc1 lds
    v_mfma_f32_16x16x32_bf16 v[84:87], a[152:155], v[164:167], v[84:87]
    v_exp_f32 v204, v204
    v_mfma_f32_16x16x32_bf16 v[144:147], a[152:155], v[176:179], v[144:147]
    v_exp_f32 v205, v205
    v_mfma_f32_16x16x32_bf16 v[148:151], a[152:155], v[180:183], v[148:151]
    ds_read_b128 a[152:155], v10 offset:22528
    v_cvt_pk_bf16_f32 v212, v212, v213
    v_mfma_f32_16x16x32_bf16 v[88:91], a[156:159], v[160:163], v[88:91]
    v_exp_f32 v206, v206
    v_mfma_f32_16x16x32_bf16 v[92:95], a[156:159], v[164:167], v[92:95]
    v_exp_f32 v207, v207
    v_mfma_f32_16x16x32_bf16 v[152:155], a[156:159], v[176:179], v[152:155]
    v_exp_f32 v216, v216
    v_mfma_f32_16x16x32_bf16 v[156:159], a[156:159], v[180:183], v[156:159]
    ds_read_b128 a[156:159], v10 offset:23552
    v_cvt_pk_bf16_f32 v213, v214, v215
    v_smfmac_f32_16x16x64_bf16 a[96:99], a[116:119], v[160:167], v6
    v_cvt_pk_bf16_f32 v194, v200, v201
    v_smfmac_f32_16x16x64_bf16 a[100:103], a[116:119], v[176:183], v6
    s_waitcnt lgkmcnt(8)
    v_mfma_f32_16x16x32_bf16 v[176:179], a[64:67], a[32:35], v[232:235]
    v_exp_f32 v217, v217
    v_mfma_f32_16x16x32_bf16 v[176:179], a[68:71], a[36:39], v[176:179]
    v_exp_f32 v218, v218
    v_mfma_f32_16x16x32_bf16 v[176:179], a[72:75], a[40:43], v[176:179]
    buffer_load_dwordx4 v2, s[20:23], s44 offen offset:3072 sc1 lds
    s_add_u32 m0, m0, 4096
    v_mfma_f32_16x16x32_bf16 v[176:179], a[76:79], a[44:47], v[176:179]
    v_exp_f32 v219, v219
    v_mfma_f32_16x16x32_bf16 v[180:183], a[64:67], a[48:51], v[236:239]
    ds_read_b128 a[64:67], v10 offset:0
    v_cvt_pk_bf16_f32 v195, v202, v203
    v_mfma_f32_16x16x32_bf16 v[180:183], a[68:71], a[52:55], v[180:183]
    ds_read_b128 a[68:71], v10 offset:1024
    v_cvt_pk_bf16_f32 v198, v204, v205
    v_mfma_f32_16x16x32_bf16 v[180:183], a[72:75], a[56:59], v[180:183]
    ds_read_b128 a[72:75], v10 offset:2048
    v_cvt_pk_bf16_f32 v199, v206, v207
    v_mfma_f32_16x16x32_bf16 v[180:183], a[76:79], a[60:63], v[180:183]
    ds_read_b128 a[76:79], v10 offset:3072
    v_cvt_pk_bf16_f32 v210, v216, v217
    v_mfma_f32_16x16x32_bf16 v[184:187], a[80:83], a[32:35], v[232:235]
    v_exp_f32 v220, v220
    v_mfma_f32_16x16x32_bf16 v[184:187], a[84:87], a[36:39], v[184:187]
    v_exp_f32 v221, v221
    v_mfma_f32_16x16x32_bf16 v[184:187], a[88:91], a[40:43], v[184:187]
    v_exp_f32 v222, v222
    v_mfma_f32_16x16x32_bf16 v[184:187], a[92:95], a[44:47], v[184:187]
    v_exp_f32 v223, v223
    v_mfma_f32_16x16x32_bf16 v[188:191], a[80:83], a[48:51], v[236:239]
    ds_read_b128 a[80:83], v10 offset:4096
    v_cvt_pk_bf16_f32 v211, v218, v219
    v_mfma_f32_16x16x32_bf16 v[188:191], a[84:87], a[52:55], v[188:191]
    ds_read_b128 a[84:87], v10 offset:5120
    v_cvt_pk_bf16_f32 v214, v220, v221
    v_mfma_f32_16x16x32_bf16 v[188:191], a[88:91], a[56:59], v[188:191]
    ds_read_b128 a[88:91], v10 offset:6144
    v_cvt_pk_bf16_f32 v215, v222, v223
    v_mfma_f32_16x16x32_bf16 v[188:191], a[92:95], a[60:63], v[188:191]
    ds_read_b128 a[92:95], v10 offset:7168
    s_waitcnt lgkmcnt(8)
    v_mfma_f32_16x16x32_bf16 v[32:35], a[128:131], v[192:195], v[32:35]
    buffer_load_dwordx4 v3, s[20:23], s44 offen offset:0 sc1 lds
    v_mfma_f32_16x16x32_bf16 v[36:39], a[128:131], v[196:199], v[36:39]
    v_exp_f32 v176, v176
    v_mfma_f32_16x16x32_bf16 v[96:99], a[128:131], v[208:211], v[96:99]
    v_exp_f32 v177, v177
    v_mfma_f32_16x16x32_bf16 v[100:103], a[128:131], v[212:215], v[100:103]
    ds_read_b128 a[128:131], v10 offset:24576
    v_cvt_pk_bf16_f32 v176, v176, v177
    v_mfma_f32_16x16x32_bf16 v[40:43], a[132:135], v[192:195], v[40:43]
    v_mfma_f32_16x16x32_bf16 v[44:47], a[132:135], v[196:199], v[44:47]
    v_exp_f32 v178, v178
    v_mfma_f32_16x16x32_bf16 v[104:107], a[132:135], v[208:211], v[104:107]
    v_mfma_f32_16x16x32_bf16 v[108:111], a[132:135], v[212:215], v[108:111]
    ds_read_b128 a[132:135], v10 offset:25600
    v_mfma_f32_16x16x32_bf16 v[48:51], a[136:139], v[192:195], v[48:51]
    v_exp_f32 v179, v179
    v_mfma_f32_16x16x32_bf16 v[52:55], a[136:139], v[196:199], v[52:55]
    buffer_load_dwordx4 v3, s[20:23], s44 offen offset:1024 sc1 lds
    v_mfma_f32_16x16x32_bf16 v[112:115], a[136:139], v[208:211], v[112:115]
    v_cvt_pk_bf16_f32 v177, v178, v179
    v_mfma_f32_16x16x32_bf16 v[116:119], a[136:139], v[212:215], v[116:119]
    ds_read_b128 a[136:139], v10 offset:26624
    v_mfma_f32_16x16x32_bf16 v[56:59], a[140:143], v[192:195], v[56:59]
    v_exp_f32 v180, v180
    v_mfma_f32_16x16x32_bf16 v[60:63], a[140:143], v[196:199], v[60:63]
    v_exp_f32 v181, v181
    v_mfma_f32_16x16x32_bf16 v[120:123], a[140:143], v[208:211], v[120:123]
    v_cvt_pk_bf16_f32 v180, v180, v181
    v_mfma_f32_16x16x32_bf16 v[124:127], a[140:143], v[212:215], v[124:127]
    ds_read_b128 a[140:143], v10 offset:27648
    v_mfma_f32_16x16x32_bf16 v[64:67], a[144:147], v[192:195], v[64:67]
    v_exp_f32 v182, v182
    v_mfma_f32_16x16x32_bf16 v[68:71], a[144:147], v[196:199], v[68:71]
    v_mfma_f32_16x16x32_bf16 v[128:131], a[144:147], v[208:211], v[128:131]
    v_exp_f32 v183, v183
    v_mfma_f32_16x16x32_bf16 v[132:135], a[144:147], v[212:215], v[132:135]
    ds_read_b128 a[144:147], v10 offset:28672
    v_cvt_pk_bf16_f32 v181, v182, v183
    v_mfma_f32_16x16x32_bf16 v[72:75], a[148:151], v[192:195], v[72:75]
    v_mfma_f32_16x16x32_bf16 v[76:79], a[148:151], v[196:199], v[76:79]
    buffer_load_dwordx4 v3, s[20:23], s44 offen offset:2048 sc1 lds
    v_mfma_f32_16x16x32_bf16 v[136:139], a[148:151], v[208:211], v[136:139]
    v_exp_f32 v184, v184
    v_mfma_f32_16x16x32_bf16 v[140:143], a[148:151], v[212:215], v[140:143]
    ds_read_b128 a[148:151], v10 offset:29696
    v_mfma_f32_16x16x32_bf16 v[80:83], a[152:155], v[192:195], v[80:83]
    v_exp_f32 v185, v185
    v_mfma_f32_16x16x32_bf16 v[84:87], a[152:155], v[196:199], v[84:87]
    v_cvt_pk_bf16_f32 v178, v184, v185
    v_mfma_f32_16x16x32_bf16 v[144:147], a[152:155], v[208:211], v[144:147]
    v_exp_f32 v186, v186
    v_mfma_f32_16x16x32_bf16 v[148:151], a[152:155], v[212:215], v[148:151]
    ds_read_b128 a[152:155], v10 offset:30720
    v_mfma_f32_16x16x32_bf16 v[88:91], a[156:159], v[192:195], v[88:91]
    v_mfma_f32_16x16x32_bf16 v[92:95], a[156:159], v[196:199], v[92:95]
    v_exp_f32 v187, v187
    v_mfma_f32_16x16x32_bf16 v[152:155], a[156:159], v[208:211], v[152:155]
    v_cvt_pk_bf16_f32 v179, v186, v187
    v_mfma_f32_16x16x32_bf16 v[156:159], a[156:159], v[212:215], v[156:159]
    ds_read_b128 a[156:159], v10 offset:31744
    v_smfmac_f32_16x16x64_bf16 a[96:99], a[116:119], v[192:199], v6
    v_smfmac_f32_16x16x64_bf16 a[100:103], a[116:119], v[208:215], v6
    s_waitcnt lgkmcnt(8)
    v_mfma_f32_16x16x32_bf16 v[208:211], a[64:67], a[32:35], v[232:235]
    buffer_load_dwordx4 v3, s[20:23], s44 offen offset:3072 sc1 lds
    v_mfma_f32_16x16x32_bf16 v[208:211], a[68:71], a[36:39], v[208:211]
    v_exp_f32 v188, v188
    v_mfma_f32_16x16x32_bf16 v[208:211], a[72:75], a[40:43], v[208:211]
    v_exp_f32 v189, v189
    v_mfma_f32_16x16x32_bf16 v[208:211], a[76:79], a[44:47], v[208:211]
    v_cvt_pk_bf16_f32 v182, v188, v189
    s_add_u32 s44, s44, 16384
    v_mfma_f32_16x16x32_bf16 v[212:215], a[64:67], a[48:51], v[236:239]
    ds_read_b128 a[64:67], v10 offset:8192
    v_accvgpr_read_b32 v16, a96
    v_mfma_f32_16x16x32_bf16 v[212:215], a[68:71], a[52:55], v[212:215]
    ds_read_b128 a[68:71], v10 offset:9216
    v_accvgpr_read_b32 v18, a97
    v_mfma_f32_16x16x32_bf16 v[212:215], a[72:75], a[56:59], v[212:215]
    ds_read_b128 a[72:75], v10 offset:10240
    v_accvgpr_read_b32 v17, a98
    v_mfma_f32_16x16x32_bf16 v[212:215], a[76:79], a[60:63], v[212:215]
    ds_read_b128 a[76:79], v10 offset:11264
    v_accvgpr_read_b32 v19, a99
    v_mfma_f32_16x16x32_bf16 v[216:219], a[80:83], a[32:35], v[232:235]
    v_exp_f32 v190, v190
    v_mfma_f32_16x16x32_bf16 v[216:219], a[84:87], a[36:39], v[216:219]
    v_add_f32 v16, v16, v18
    v_add_f32 v17, v17, v19
    v_mfma_f32_16x16x32_bf16 v[216:219], a[88:91], a[40:43], v[216:219]
    v_exp_f32 v191, v191
    v_mfma_f32_16x16x32_bf16 v[216:219], a[92:95], a[44:47], v[216:219]
    v_cvt_pk_bf16_f32 v183, v190, v191
    v_add_f32 v5, v16, v17
    v_mfma_f32_16x16x32_bf16 v[220:223], a[80:83], a[48:51], v[236:239]
    ds_read_b128 a[80:83], v10 offset:12288
    v_cmp_nlt_f32 vcc, v5, v13
    v_mfma_f32_16x16x32_bf16 v[220:223], a[84:87], a[52:55], v[220:223]
    ds_read_b128 a[84:87], v10 offset:13312
    v_rcp_f32 v16, v16
    v_mfma_f32_16x16x32_bf16 v[220:223], a[88:91], a[56:59], v[220:223]
    ds_read_b128 a[88:91], v10 offset:14336
    v_rcp_f32 v17, v17
    v_mfma_f32_16x16x32_bf16 v[220:223], a[92:95], a[60:63], v[220:223]
    ds_read_b128 a[92:95], v10 offset:15360
    s_add_u32 m0, m0, 28672
    s_and_b32 m0, m0, 0x1ffff
    s_branch L_TE
    .p2align 6
L_wuTE:
    s_branch L_wbTE
L_TE:
    s_cmp_lg_u64 vcc, 0
    s_cselect_b32 s6, 1, 0
    s_or_b32 s47, s47, s6
    s_add_u32 s9, s48, 0
    v_pk_mul_f32 v[32:33], v[32:33], v[16:17] op_sel_hi:[1,0]
    v_pk_mul_f32 v[34:35], v[34:35], v[16:17] op_sel_hi:[1,0]
    v_pk_mul_f32 v[40:41], v[40:41], v[16:17] op_sel_hi:[1,0]
    v_pk_mul_f32 v[42:43], v[42:43], v[16:17] op_sel_hi:[1,0]
    v_cvt_pk_bf16_f32 v20, v32, v33
    v_cvt_pk_bf16_f32 v21, v34, v35
    v_cvt_pk_bf16_f32 v22, v40, v41
    v_cvt_pk_bf16_f32 v23, v42, v43
    buffer_store_dwordx4 v[20:23], v2, s[52:55], s9 offen offset:0 sc1
    v_and_b32 v4, 60, v1
    v_lshlrev_b32 v4, 25, v4
    v_lshl_or_b32 v11, v1, 7, v4
    s_add_u32 s88, s91, 32768
    s_and_b32 s88, s88, 0x1ffff
    s_add_u32 s89, s88, 32768
    v_pk_mul_f32 v[36:37], v[36:37], v[16:17] op_sel:[0,1]
    v_pk_mul_f32 v[38:39], v[38:39], v[16:17] op_sel:[0,1]
    v_pk_mul_f32 v[44:45], v[44:45], v[16:17] op_sel:[0,1]
    v_pk_mul_f32 v[46:47], v[46:47], v[16:17] op_sel:[0,1]
    v_cvt_pk_bf16_f32 v24, v36, v37
    v_cvt_pk_bf16_f32 v25, v38, v39
    v_cvt_pk_bf16_f32 v26, v44, v45
    v_cvt_pk_bf16_f32 v27, v46, v47
    buffer_store_dwordx4 v[24:27], v2, s[52:55], s9 offen offset:1024 sc1
    s_and_b32 s89, s89, 0x1ffff
    s_add_u32 s90, s89, 32768
    s_and_b32 s90, s90, 0x1ffff
    s_mov_b32 s46, s47
    v_xor_b32 v160, s88, v15
    v_xor_b32 v161, s89, v15
    s_add_u32 s9, s48, 4096
    v_pk_mul_f32 v[48:49], v[48:49], v[16:17] op_sel_hi:[1,0]
    v_pk_mul_f32 v[50:51], v[50:51], v[16:17] op_sel_hi:[1,0]
    v_pk_mul_f32 v[56:57], v[56:57], v[16:17] op_sel_hi:[1,0]
    v_pk_mul_f32 v[58:59], v[58:59], v[16:17] op_sel_hi:[1,0]
    v_cvt_pk_bf16_f32 v28, v48, v49
    v_cvt_pk_bf16_f32 v29, v50, v51
    v_cvt_pk_bf16_f32 v30, v56, v57
    v_cvt_pk_bf16_f32 v31, v58, v59
    buffer_store_dwordx4 v[28:31], v2, s[52:55], s9 offen offset:0 sc1
    v_xor_b32 v162, s90, v15
    v_xor_b32 v163, s91, v15
    v_cndmask_b32 v240, v12, v232, s[60:61]
    v_cndmask_b32 v241, v12, v233, s[62:63]
    v_cndmask_b32 v242, v12, v234, s[30:31]
    v_cndmask_b32 v243, v12, v235, s[32:33]
    v_pk_mul_f32 v[52:53], v[52:53], v[16:17] op_sel:[0,1]
    v_pk_mul_f32 v[54:55], v[54:55], v[16:17] op_sel:[0,1]
    v_pk_mul_f32 v[60:61], v[60:61], v[16:17] op_sel:[0,1]
    v_pk_mul_f32 v[62:63], v[62:63], v[16:17] op_sel:[0,1]
    v_cvt_pk_bf16_f32 v20, v52, v53
    v_cvt_pk_bf16_f32 v21, v54, v55
    v_cvt_pk_bf16_f32 v22, v60, v61
    v_cvt_pk_bf16_f32 v23, v62, v63
    buffer_store_dwordx4 v[20:23], v2, s[52:55], s9 offen offset:1024 sc1
    v_cndmask_b32 v244, v12, v232, s[50:51]
    v_cndmask_b32 v245, v12, v233, s[50:51]
    v_cndmask_b32 v246, v12, v234, s[50:51]
    v_cndmask_b32 v247, v12, v235, s[50:51]
    v_cndmask_b32 v252, v12, v236, s[60:61]
    v_cndmask_b32 v253, v12, v237, s[62:63]
    s_add_u32 s9, s48, 8192
    v_pk_mul_f32 v[64:65], v[64:65], v[16:17] op_sel_hi:[1,0]
    v_pk_mul_f32 v[66:67], v[66:67], v[16:17] op_sel_hi:[1,0]
    v_pk_mul_f32 v[72:73], v[72:73], v[16:17] op_sel_hi:[1,0]
    v_pk_mul_f32 v[74:75], v[74:75], v[16:17] op_sel_hi:[1,0]
    v_cvt_pk_bf16_f32 v24, v64, v65
    v_cvt_pk_bf16_f32 v25, v66, v67
    v_cvt_pk_bf16_f32 v26, v72, v73
    v_cvt_pk_bf16_f32 v27, v74, v75
    buffer_store_dwordx4 v[24:27], v2, s[52:55], s9 offen offset:0 sc1
    v_cndmask_b32 v254, v12, v238, s[30:31]
    v_cndmask_b32 v255, v12, v239, s[32:33]
    v_cndmask_b32 v192, v12, v232, s[34:35]
    v_cndmask_b32 v193, v12, v233, s[36:37]
    v_cndmask_b32 v194, v12, v234, s[84:85]
    v_cndmask_b32 v195, v12, v235, s[86:87]
    v_pk_mul_f32 v[68:69], v[68:69], v[16:17] op_sel:[0,1]
    v_pk_mul_f32 v[70:71], v[70:71], v[16:17] op_sel:[0,1]
    v_pk_mul_f32 v[76:77], v[76:77], v[16:17] op_sel:[0,1]
    v_pk_mul_f32 v[78:79], v[78:79], v[16:17] op_sel:[0,1]
    v_cvt_pk_bf16_f32 v28, v68, v69
    v_cvt_pk_bf16_f32 v29, v70, v71
    v_cvt_pk_bf16_f32 v30, v76, v77
    v_cvt_pk_bf16_f32 v31, v78, v79
    buffer_store_dwordx4 v[28:31], v2, s[52:55], s9 offen offset:1024 sc1
    v_cndmask_b32 v200, v12, v236, s[50:51]
    v_cndmask_b32 v201, v12, v237, s[50:51]
    v_cndmask_b32 v202, v12, v238, s[50:51]
    v_cndmask_b32 v203, v12, v239, s[50:51]
    v_mov_b32 v196, v12
    v_mov_b32 v197, v12
    s_add_u32 s9, s48, 12288
    v_pk_mul_f32 v[80:81], v[80:81], v[16:17] op_sel_hi:[1,0]
    v_pk_mul_f32 v[82:83], v[82:83], v[16:17] op_sel_hi:[1,0]
    v_pk_mul_f32 v[88:89], v[88:89], v[16:17] op_sel_hi:[1,0]
    v_pk_mul_f32 v[90:91], v[90:91], v[16:17] op_sel_hi:[1,0]
    v_cvt_pk_bf16_f32 v20, v80, v81
    v_cvt_pk_bf16_f32 v21, v82, v83
    v_cvt_pk_bf16_f32 v22, v88, v89
    v_cvt_pk_bf16_f32 v23, v90, v91
    buffer_store_dwordx4 v[20:23], v2, s[52:55], s9 offen offset:0 sc1
    v_mov_b32 v198, v12
    v_mov_b32 v199, v12
    v_cndmask_b32 v204, v12, v236, s[34:35]
    v_cndmask_b32 v205, v12, v237, s[36:37]
    v_cndmask_b32 v206, v12, v238, s[84:85]
    v_cndmask_b32 v207, v12, v239, s[86:87]
    v_pk_mul_f32 v[84:85], v[84:85], v[16:17] op_sel:[0,1]
    v_pk_mul_f32 v[86:87], v[86:87], v[16:17] op_sel:[0,1]
    v_pk_mul_f32 v[92:93], v[92:93], v[16:17] op_sel:[0,1]
    v_pk_mul_f32 v[94:95], v[94:95], v[16:17] op_sel:[0,1]
    v_cvt_pk_bf16_f32 v24, v84, v85
    v_cvt_pk_bf16_f32 v25, v86, v87
    v_cvt_pk_bf16_f32 v26, v92, v93
    v_cvt_pk_bf16_f32 v27, v94, v95
    buffer_store_dwordx4 v[24:27], v2, s[52:55], s9 offen offset:1024 sc1
    s_waitcnt vmcnt(16) lgkmcnt(8)
    s_cmp_eq_u32 s5, 7
    s_cbranch_scc1 L_SM
    s_sub_u32 s45, 5, s5
    s_cbranch_scc1 L_SL
    .p2align 6
L_S:
    v_mfma_f32_16x16x32_bf16 v[96:99], a[128:131], v[176:179], v[96:99]
    s_barrier
    s_mov_b32 m0, s88
    v_mfma_f32_16x16x32_bf16 v[100:103], a[128:131], v[180:183], v[100:103]
    v_exp_f32 v208, v208
    v_mfma_f32_16x16x32_bf16 v[104:107], a[132:135], v[176:179], v[104:107]
    buffer_load_dwordx4 v2, s[20:23], s44 offen offset:0 sc1 lds
    v_mfma_f32_16x16x32_bf16 v[108:111], a[132:135], v[180:183], v[108:111]
    ds_read_b128 a[128:131], v160 offset:16384
    ds_read_b128 a[132:135], v160 offset:17408
    v_mfma_f32_16x16x32_bf16 v[112:115], a[136:139], v[176:179], v[112:115]
    v_exp_f32 v209, v209
    v_mfma_f32_16x16x32_bf16 v[116:119], a[136:139], v[180:183], v[116:119]
    v_exp_f32 v210, v210
    v_mfma_f32_16x16x32_bf16 v[120:123], a[140:143], v[176:179], v[120:123]
    v_exp_f32 v211, v211
    v_mfma_f32_16x16x32_bf16 v[124:127], a[140:143], v[180:183], v[124:127]
    ds_read_b128 a[136:139], v160 offset:18432
    ds_read_b128 a[140:143], v160 offset:19456
    v_mfma_f32_16x16x32_bf16 v[128:131], a[144:147], v[176:179], v[128:131]
    buffer_load_dwordx4 v2, s[20:23], s44 offen offset:1024 sc1 lds
    v_mfma_f32_16x16x32_bf16 v[132:135], a[144:147], v[180:183], v[132:135]
    v_exp_f32 v212, v212
    v_mfma_f32_16x16x32_bf16 v[136:139], a[148:151], v[176:179], v[136:139]
    v_exp_f32 v213, v213
    v_mfma_f32_16x16x32_bf16 v[140:143], a[148:151], v[180:183], v[140:143]
    ds_read_b128 a[144:147], v160 offset:20480
    ds_read_b128 a[148:151], v160 offset:21504
    v_mfma_f32_16x16x32_bf16 v[144:147], a[152:155], v[176:179], v[144:147]
    v_exp_f32 v214, v214
    v_mfma_f32_16x16x32_bf16 v[148:151], a[152:155], v[180:183], v[148:151]
    v_exp_f32 v215, v215
    v_mfma_f32_16x16x32_bf16 v[152:155], a[156:159], v[176:179], v[152:155]
    v_cvt_pk_bf16_f32 v208, v208, v209
    v_cvt_pk_bf16_f32 v209, v210, v211
    v_cvt_pk_bf16_f32 v212, v212, v213
    v_mfma_f32_16x16x32_bf16 v[156:159], a[156:159], v[180:183], v[156:159]
    ds_read_b128 a[152:155], v160 offset:22528
    ds_read_b128 a[156:159], v160 offset:23552
    v_cvt_pk_bf16_f32 v213, v214, v215
    v_smfmac_f32_16x16x64_bf16 a[100:103], a[116:119], v[176:183], v6
    s_waitcnt lgkmcnt(8)
    v_mfma_f32_16x16x32_bf16 v[176:179], a[64:67], a[32:35], v[232:235]
    buffer_load_dwordx4 v2, s[20:23], s44 offen offset:2048 sc1 lds
    v_mfma_f32_16x16x32_bf16 v[176:179], a[68:71], a[36:39], v[176:179]
    v_exp_f32 v216, v216
    v_mfma_f32_16x16x32_bf16 v[176:179], a[72:75], a[40:43], v[176:179]
    v_exp_f32 v217, v217
    v_mfma_f32_16x16x32_bf16 v[176:179], a[76:79], a[44:47], v[176:179]
    v_exp_f32 v218, v218
    v_mfma_f32_16x16x32_bf16 v[180:183], a[64:67], a[48:51], v[236:239]
    v_exp_f32 v219, v219
    v_mfma_f32_16x16x32_bf16 v[180:183], a[68:71], a[52:55], v[180:183]
    ds_read_b128 a[64:67], v160 offset:0
    ds_read_b128 a[68:71], v160 offset:1024
    v_mfma_f32_16x16x32_bf16 v[180:183], a[72:75], a[56:59], v[180:183]
    buffer_load_dwordx4 v2, s[20:23], s44 offen offset:3072 sc1 lds
    s_add_u32 m0, s88, 4096
    v_mfma_f32_16x16x32_bf16 v[180:183], a[76:79], a[60:63], v[180:183]
    ds_read_b128 a[72:75], v160 offset:2048
    ds_read_b128 a[76:79], v160 offset:3072
    v_mfma_f32_16x16x32_bf16 v[184:187], a[80:83], a[32:35], v[232:235]
    v_exp_f32 v220, v220
    v_mfma_f32_16x16x32_bf16 v[184:187], a[84:87], a[36:39], v[184:187]
    v_exp_f32 v221, v221
    v_mfma_f32_16x16x32_bf16 v[184:187], a[88:91], a[40:43], v[184:187]
    v_exp_f32 v222, v222
    v_mfma_f32_16x16x32_bf16 v[184:187], a[92:95], a[44:47], v[184:187]
    v_exp_f32 v223, v223
    v_mfma_f32_16x16x32_bf16 v[188:191], a[80:83], a[48:51], v[236:239]
    v_cvt_pk_bf16_f32 v210, v216, v217
    v_cvt_pk_bf16_f32 v211, v218, v219
    v_mfma_f32_16x16x32_bf16 v[188:191], a[84:87], a[52:55], v[188:191]
    ds_read_b128 a[80:83], v160 offset:4096
    ds_read_b128 a[84:87], v160 offset:5120
    v_mfma_f32_16x16x32_bf16 v[188:191], a[88:91], a[56:59], v[188:191]
    v_cvt_pk_bf16_f32 v214, v220, v221
    v_cvt_pk_bf16_f32 v215, v222, v223
    s_waitcnt lgkmcnt(6)
    v_mfma_f32_16x16x32_bf16 v[188:191], a[92:95], a[60:63], v[188:191]
    ds_read_b128 a[88:91], v160 offset:6144
    ds_read_b128 a[92:95], v160 offset:7168
    v_mfma_f32_16x16x32_bf16 v[96:99], a[128:131], v[208:211], v[96:99]
    buffer_load_dwordx4 v3, s[20:23], s44 offen offset:0 sc1 lds
    v_mfma_f32_16x16x32_bf16 v[100:103], a[128:131], v[212:215], v[100:103]
    v_exp_f32 v176, v176
    v_mfma_f32_16x16x32_bf16 v[104:107], a[132:135], v[208:211], v[104:107]
    v_exp_f32 v177, v177
    v_mfma_f32_16x16x32_bf16 v[108:111], a[132:135], v[212:215], v[108:111]
    ds_read_b128 a[128:131], v160 offset:24576
    ds_read_b128 a[132:135], v160 offset:25600
    v_mfma_f32_16x16x32_bf16 v[112:115], a[136:139], v[208:211], v[112:115]
    v_exp_f32 v178, v178
    v_mfma_f32_16x16x32_bf16 v[116:119], a[136:139], v[212:215], v[116:119]
    buffer_load_dwordx4 v3, s[20:23], s44 offen offset:1024 sc1 lds
    v_mfma_f32_16x16x32_bf16 v[120:123], a[140:143], v[208:211], v[120:123]
    v_exp_f32 v179, v179
    v_mfma_f32_16x16x32_bf16 v[124:127], a[140:143], v[212:215], v[124:127]
    ds_read_b128 a[136:139], v160 offset:26624
    ds_read_b128 a[140:143], v160 offset:27648
    v_mfma_f32_16x16x32_bf16 v[128:131], a[144:147], v[208:211], v[128:131]
    v_exp_f32 v180, v180
    v_mfma_f32_16x16x32_bf16 v[132:135], a[144:147], v[212:215], v[132:135]
    v_exp_f32 v181, v181
    v_mfma_f32_16x16x32_bf16 v[136:139], a[148:151], v[208:211], v[136:139]
    v_cvt_pk_bf16_f32 v176, v176, v177
    v_cvt_pk_bf16_f32 v177, v178, v179
    v_cvt_pk_bf16_f32 v180, v180, v181
    v_mfma_f32_16x16x32_bf16 v[140:143], a[148:151], v[212:215], v[140:143]
    ds_read_b128 a[144:147], v160 offset:28672
    ds_read_b128 a[148:151], v160 offset:29696
    v_mfma_f32_16x16x32_bf16 v[144:147], a[152:155], v[208:211], v[144:147]
    v_exp_f32 v182, v182
    v_mfma_f32_16x16x32_bf16 v[148:151], a[152:155], v[212:215], v[148:151]
    buffer_load_dwordx4 v3, s[20:23], s44 offen offset:2048 sc1 lds
    v_mfma_f32_16x16x32_bf16 v[152:155], a[156:159], v[208:211], v[152:155]
    v_exp_f32 v183, v183
    v_mfma_f32_16x16x32_bf16 v[156:159], a[156:159], v[212:215], v[156:159]
    ds_read_b128 a[152:155], v160 offset:30720
    ds_read_b128 a[156:159], v160 offset:31744
    v_smfmac_f32_16x16x64_bf16 a[100:103], a[116:119], v[208:215], v6
    s_waitcnt lgkmcnt(8)
    v_mfma_f32_16x16x32_bf16 v[208:211], a[64:67], a[32:35], v[232:235]
    v_exp_f32 v184, v184
    v_mfma_f32_16x16x32_bf16 v[208:211], a[68:71], a[36:39], v[208:211]
    v_exp_f32 v185, v185
    v_mfma_f32_16x16x32_bf16 v[208:211], a[72:75], a[40:43], v[208:211]
    v_exp_f32 v186, v186
    v_mfma_f32_16x16x32_bf16 v[208:211], a[76:79], a[44:47], v[208:211]
    buffer_load_dwordx4 v3, s[20:23], s44 offen offset:3072 sc1 lds
    s_add_u32 s44, s44, 16384
    v_mfma_f32_16x16x32_bf16 v[212:215], a[64:67], a[48:51], v[236:239]
    v_cvt_pk_bf16_f32 v181, v182, v183
    v_cvt_pk_bf16_f32 v178, v184, v185
    v_mfma_f32_16x16x32_bf16 v[212:215], a[68:71], a[52:55], v[212:215]
    ds_read_b128 a[64:67], v160 offset:8192
    ds_read_b128 a[68:71], v160 offset:9216
    v_mfma_f32_16x16x32_bf16 v[212:215], a[72:75], a[56:59], v[212:215]
    v_exp_f32 v187, v187
    v_mfma_f32_16x16x32_bf16 v[212:215], a[76:79], a[60:63], v[212:215]
    ds_read_b128 a[72:75], v160 offset:10240
    ds_read_b128 a[76:79], v160 offset:11264
    v_mfma_f32_16x16x32_bf16 v[216:219], a[80:83], a[32:35], v[232:235]
    v_exp_f32 v188, v188
    v_mfma_f32_16x16x32_bf16 v[216:219], a[84:87], a[36:39], v[216:219]
    v_exp_f32 v189, v189
    v_mfma_f32_16x16x32_bf16 v[216:219], a[88:91], a[40:43], v[216:219]
    v_exp_f32 v190, v190
    v_mfma_f32_16x16x32_bf16 v[216:219], a[92:95], a[44:47], v[216:219]
    v_exp_f32 v191, v191
    v_mfma_f32_16x16x32_bf16 v[220:223], a[80:83], a[48:51], v[236:239]
    v_cvt_pk_bf16_f32 v179, v186, v187
    v_cvt_pk_bf16_f32 v182, v188, v189
    v_mfma_f32_16x16x32_bf16 v[220:223], a[84:87], a[52:55], v[220:223]
    ds_read_b128 a[80:83], v160 offset:12288
    ds_read_b128 a[84:87], v160 offset:13312
    v_mfma_f32_16x16x32_bf16 v[220:223], a[88:91], a[56:59], v[220:223]
    v_cvt_pk_bf16_f32 v183, v190, v191
    s_waitcnt vmcnt(8) lgkmcnt(6)
    v_mfma_f32_16x16x32_bf16 v[220:223], a[92:95], a[60:63], v[220:223]
    ds_read_b128 a[88:91], v160 offset:14336
    ds_read_b128 a[92:95], v160 offset:15360
    v_mfma_f32_16x16x32_bf16 v[96:99], a[128:131], v[176:179], v[96:99]
    s_barrier
    s_mov_b32 m0, s89
    v_mfma_f32_16x16x32_bf16 v[100:103], a[128:131], v[180:183], v[100:103]
    v_exp_f32 v208, v208
    v_mfma_f32_16x16x32_bf16 v[104:107], a[132:135], v[176:179], v[104:107]
    s_cmp_lg_u32 s46, 0
    s_cbranch_scc1 L_sg7
    buffer_atomic_add v8, v11, s[16:19], s83 offen
    s_mov_b32 s46, 1
L_sg7:
    v_mfma_f32_16x16x32_bf16 v[108:111], a[132:135], v[180:183], v[108:111]
    ds_read_b128 a[128:131], v161 offset:16384
    ds_read_b128 a[132:135], v161 offset:17408
    v_mfma_f32_16x16x32_bf16 v[112:115], a[136:139], v[176:179], v[112:115]
    buffer_load_dwordx4 v2, s[20:23], s44 offen offset:0 sc1 lds
    v_mfma_f32_16x16x32_bf16 v[116:119], a[136:139], v[180:183], v[116:119]
    v_exp_f32 v209, v209
    v_mfma_f32_16x16x32_bf16 v[120:123], a[140:143], v[176:179], v[120:123]
    v_exp_f32 v210, v210
    v_cvt_pk_bf16_f32 v208, v208, v209
    v_mfma_f32_16x16x32_bf16 v[124:127], a[140:143], v[180:183], v[124:127]
    ds_read_b128 a[136:139], v161 offset:18432
    ds_read_b128 a[140:143], v161 offset:19456
    v_mfma_f32_16x16x32_bf16 v[128:131], a[144:147], v[176:179], v[128:131]
    buffer_load_dwordx4 v2, s[20:23], s44 offen offset:1024 sc1 lds
    v_mfma_f32_16x16x32_bf16 v[132:135], a[144:147], v[180:183], v[132:135]
    v_exp_f32 v211, v211
    v_mfma_f32_16x16x32_bf16 v[136:139], a[148:151], v[176:179], v[136:139]
    v_exp_f32 v212, v212
    v_cvt_pk_bf16_f32 v209, v210, v211
    v_mfma_f32_16x16x32_bf16 v[140:143], a[148:151], v[180:183], v[140:143]
    ds_read_b128 a[144:147], v161 offset:20480
    ds_read_b128 a[148:151], v161 offset:21504
    v_mfma_f32_16x16x32_bf16 v[144:147], a[152:155], v[176:179], v[144:147]
    v_exp_f32 v213, v213
    v_mfma_f32_16x16x32_bf16 v[148:151], a[152:155], v[180:183], v[148:151]
    v_exp_f32 v214, v214
    v_cvt_pk_bf16_f32 v212, v212, v213
    v_mfma_f32_16x16x32_bf16 v[152:155], a[156:159], v[176:179], v[152:155]
    v_exp_f32 v215, v215
    v_mfma_f32_16x16x32_bf16 v[156:159], a[156:159], v[180:183], v[156:159]
    ds_read_b128 a[152:155], v161 offset:22528
    ds_read_b128 a[156:159], v161 offset:23552
    v_cvt_pk_bf16_f32 v213, v214, v215
    v_smfmac_f32_16x16x64_bf16 a[100:103], a[116:119], v[176:183], v6
    s_waitcnt lgkmcnt(8)
    v_mfma_f32_16x16x32_bf16 v[176:179], a[64:67], a[32:35], v[232:235]
    buffer_load_dwordx4 v2, s[20:23], s44 offen offset:2048 sc1 lds
    v_mfma_f32_16x16x32_bf16 v[176:179], a[68:71], a[36:39], v[176:179]
    v_exp_f32 v216, v216
    v_mfma_f32_16x16x32_bf16 v[176:179], a[72:75], a[40:43], v[176:179]
    v_exp_f32 v217, v217
    v_mfma_f32_16x16x32_bf16 v[176:179], a[76:79], a[44:47], v[176:179]
    v_exp_f32 v218, v218
    v_mfma_f32_16x16x32_bf16 v[180:183], a[64:67], a[48:51], v[236:239]
    v_exp_f32 v219, v219
    v_mfma_f32_16x16x32_bf16 v[180:183], a[68:71], a[52:55], v[180:183]
    ds_read_b128 a[64:67], v161 offset:0
    ds_read_b128 a[68:71], v161 offset:1024
    v_mfma_f32_16x16x32_bf16 v[180:183], a[72:75], a[56:59], v[180:183]
    buffer_load_dwordx4 v2, s[20:23], s44 offen offset:3072 sc1 lds
    s_add_u32 m0, s89, 4096
    v_mfma_f32_16x16x32_bf16 v[180:183], a[76:79], a[60:63], v[180:183]
    ds_read_b128 a[72:75], v161 offset:2048
    ds_read_b128 a[76:79], v161 offset:3072
    v_mfma_f32_16x16x32_bf16 v[184:187], a[80:83], a[32:35], v[232:235]
    v_exp_f32 v220, v220
    v_mfma_f32_16x16x32_bf16 v[184:187], a[84:87], a[36:39], v[184:187]
    v_exp_f32 v221, v221
    v_mfma_f32_16x16x32_bf16 v[184:187], a[88:91], a[40:43], v[184:187]
    v_exp_f32 v222, v222
    v_mfma_f32_16x16x32_bf16 v[184:187], a[92:95], a[44:47], v[184:187]
    v_exp_f32 v223, v223
    v_mfma_f32_16x16x32_bf16 v[188:191], a[80:83], a[48:51], v[236:239]
    v_cvt_pk_bf16_f32 v210, v216, v217
    v_cvt_pk_bf16_f32 v211, v218, v219
    v_mfma_f32_16x16x32_bf16 v[188:191], a[84:87], a[52:55], v[188:191]
    ds_read_b128 a[80:83], v161 offset:4096
    ds_read_b128 a[84:87], v161 offset:5120
    v_mfma_f32_16x16x32_bf16 v[188:191], a[88:91], a[56:59], v[188:191]
    v_cvt_pk_bf16_f32 v214, v220, v221
    v_cvt_pk_bf16_f32 v215, v222, v223
    s_waitcnt lgkmcnt(6)
    v_mfma_f32_16x16x32_bf16 v[188:191], a[92:95], a[60:63], v[188:191]
    ds_read_b128 a[88:91], v161 offset:6144
    ds_read_b128 a[92:95], v161 offset:7168
    v_mfma_f32_16x16x32_bf16 v[96:99], a[128:131], v[208:211], v[96:99]
    buffer_load_dwordx4 v3, s[20:23], s44 offen offset:0 sc1 lds
    v_mfma_f32_16x16x32_bf16 v[100:103], a[128:131], v[212:215], v[100:103]
    v_exp_f32 v176, v176
    v_mfma_f32_16x16x32_bf16 v[104:107], a[132:135], v[208:211], v[104:107]
    v_exp_f32 v177, v177
    v_mfma_f32_16x16x32_bf16 v[108:111], a[132:135], v[212:215], v[108:111]
    ds_read_b128 a[128:131], v161 offset:24576
    ds_read_b128 a[132:135], v161 offset:25600
    v_mfma_f32_16x16x32_bf16 v[112:115], a[136:139], v[208:211], v[112:115]
    v_exp_f32 v178, v178
    v_mfma_f32_16x16x32_bf16 v[116:119], a[136:139], v[212:215], v[116:119]
    buffer_load_dwordx4 v3, s[20:23], s44 offen offset:1024 sc1 lds
    v_mfma_f32_16x16x32_bf16 v[120:123], a[140:143], v[208:211], v[120:123]
    v_exp_f32 v179, v179
    v_mfma_f32_16x16x32_bf16 v[124:127], a[140:143], v[212:215], v[124:127]
    ds_read_b128 a[136:139], v161 offset:26624
    ds_read_b128 a[140:143], v161 offset:27648
    v_mfma_f32_16x16x32_bf16 v[128:131], a[144:147], v[208:211], v[128:131]
    v_exp_f32 v180, v180
    v_mfma_f32_16x16x32_bf16 v[132:135], a[144:147], v[212:215], v[132:135]
    v_exp_f32 v181, v181
    v_mfma_f32_16x16x32_bf16 v[136:139], a[148:151], v[208:211], v[136:139]
    v_cvt_pk_bf16_f32 v176, v176, v177
    v_cvt_pk_bf16_f32 v177, v178, v179
    v_cvt_pk_bf16_f32 v180, v180, v181
    v_mfma_f32_16x16x32_bf16 v[140:143], a[148:151], v[212:215], v[140:143]
    ds_read_b128 a[144:147], v161 offset:28672
    ds_read_b128 a[148:151], v161 offset:29696
    v_mfma_f32_16x16x32_bf16 v[144:147], a[152:155], v[208:211], v[144:147]
    v_exp_f32 v182, v182
    v_mfma_f32_16x16x32_bf16 v[148:151], a[152:155], v[212:215], v[148:151]
    buffer_load_dwordx4 v3, s[20:23], s44 offen offset:2048 sc1 lds
    v_mfma_f32_16x16x32_bf16 v[152:155], a[156:159], v[208:211], v[152:155]
    v_exp_f32 v183, v183
    v_mfma_f32_16x16x32_bf16 v[156:159], a[156:159], v[212:215], v[156:159]
    ds_read_b128 a[152:155], v161 offset:30720
    ds_read_b128 a[156:159], v161 offset:31744
    v_smfmac_f32_16x16x64_bf16 a[100:103], a[116:119], v[208:215], v6
    s_waitcnt lgkmcnt(8)
    v_mfma_f32_16x16x32_bf16 v[208:211], a[64:67], a[32:35], v[232:235]
    v_exp_f32 v184, v184
    v_mfma_f32_16x16x32_bf16 v[208:211], a[68:71], a[36:39], v[208:211]
    v_exp_f32 v185, v185
    v_mfma_f32_16x16x32_bf16 v[208:211], a[72:75], a[40:43], v[208:211]
    v_exp_f32 v186, v186
    v_mfma_f32_16x16x32_bf16 v[208:211], a[76:79], a[44:47], v[208:211]
    buffer_load_dwordx4 v3, s[20:23], s44 offen offset:3072 sc1 lds
    s_add_u32 s44, s44, 16384
    v_mfma_f32_16x16x32_bf16 v[212:215], a[64:67], a[48:51], v[236:239]
    v_cvt_pk_bf16_f32 v181, v182, v183
    v_cvt_pk_bf16_f32 v178, v184, v185
    v_mfma_f32_16x16x32_bf16 v[212:215], a[68:71], a[52:55], v[212:215]
    ds_read_b128 a[64:67], v161 offset:8192
    ds_read_b128 a[68:71], v161 offset:9216
    v_mfma_f32_16x16x32_bf16 v[212:215], a[72:75], a[56:59], v[212:215]
    v_exp_f32 v187, v187
    v_mfma_f32_16x16x32_bf16 v[212:215], a[76:79], a[60:63], v[212:215]
    ds_read_b128 a[72:75], v161 offset:10240
    ds_read_b128 a[76:79], v161 offset:11264
    v_mfma_f32_16x16x32_bf16 v[216:219], a[80:83], a[32:35], v[232:235]
    v_exp_f32 v188, v188
    v_mfma_f32_16x16x32_bf16 v[216:219], a[84:87], a[36:39], v[216:219]
    v_exp_f32 v189, v189
    v_mfma_f32_16x16x32_bf16 v[216:219], a[88:91], a[40:43], v[216:219]
    v_exp_f32 v190, v190
    v_mfma_f32_16x16x32_bf16 v[216:219], a[92:95], a[44:47], v[216:219]
    v_exp_f32 v191, v191
    v_mfma_f32_16x16x32_bf16 v[220:223], a[80:83], a[48:51], v[236:239]
    v_cvt_pk_bf16_f32 v179, v186, v187
    v_cvt_pk_bf16_f32 v182, v188, v189
    v_mfma_f32_16x16x32_bf16 v[220:223], a[84:87], a[52:55], v[220:223]
    ds_read_b128 a[80:83], v161 offset:12288
    ds_read_b128 a[84:87], v161 offset:13312
    v_mfma_f32_16x16x32_bf16 v[220:223], a[88:91], a[56:59], v[220:223]
    v_cvt_pk_bf16_f32 v183, v190, v191
    s_waitcnt vmcnt(8) lgkmcnt(6)
    v_mfma_f32_16x16x32_bf16 v[220:223], a[92:95], a[60:63], v[220:223]
    ds_read_b128 a[88:91], v161 offset:14336
    ds_read_b128 a[92:95], v161 offset:15360
    v_mfma_f32_16x16x32_bf16 v[96:99], a[128:131], v[176:179], v[96:99]
    s_barrier
    s_mov_b32 m0, s90
    v_mfma_f32_16x16x32_bf16 v[100:103], a[128:131], v[180:183], v[100:103]
    v_exp_f32 v208, v208
    v_mfma_f32_16x16x32_bf16 v[104:107], a[132:135], v[176:179], v[104:107]
    s_cmp_lg_u32 s45, 0
    s_cbranch_scc1 L_sg8
    buffer_load_dword v9, v14, s[16:19], 0 offen offset:128 sc1
L_sg8:
    v_mfma_f32_16x16x32_bf16 v[108:111], a[132:135], v[180:183], v[108:111]
    ds_read_b128 a[128:131], v162 offset:16384
    ds_read_b128 a[132:135], v162 offset:17408
    v_mfma_f32_16x16x32_bf16 v[112:115], a[136:139], v[176:179], v[112:115]
    buffer_load_dwordx4 v2, s[20:23], s44 offen offset:0 sc1 lds
    v_mfma_f32_16x16x32_bf16 v[116:119], a[136:139], v[180:183], v[116:119]
    v_exp_f32 v209, v209
    v_mfma_f32_16x16x32_bf16 v[120:123], a[140:143], v[176:179], v[120:123]
    v_exp_f32 v210, v210
    v_cvt_pk_bf16_f32 v208, v208, v209
    v_mfma_f32_16x16x32_bf16 v[124:127], a[140:143], v[180:183], v[124:127]
    ds_read_b128 a[136:139], v162 offset:18432
    ds_read_b128 a[140:143], v162 offset:19456
    v_mfma_f32_16x16x32_bf16 v[128:131], a[144:147], v[176:179], v[128:131]
    buffer_load_dwordx4 v2, s[20:23], s44 offen offset:1024 sc1 lds
    v_mfma_f32_16x16x32_bf16 v[132:135], a[144:147], v[180:183], v[132:135]
    v_exp_f32 v211, v211
    v_mfma_f32_16x16x32_bf16 v[136:139], a[148:151], v[176:179], v[136:139]
    v_exp_f32 v212, v212
    v_cvt_pk_bf16_f32 v209, v210, v211
    v_mfma_f32_16x16x32_bf16 v[140:143], a[148:151], v[180:183], v[140:143]
    ds_read_b128 a[144:147], v162 offset:20480
    ds_read_b128 a[148:151], v162 offset:21504
    v_mfma_f32_16x16x32_bf16 v[144:147], a[152:155], v[176:179], v[144:147]
    v_exp_f32 v213, v213
    v_mfma_f32_16x16x32_bf16 v[148:151], a[152:155], v[180:183], v[148:151]
    v_exp_f32 v214, v214
    v_cvt_pk_bf16_f32 v212, v212, v213
    v_mfma_f32_16x16x32_bf16 v[152:155], a[156:159], v[176:179], v[152:155]
    v_exp_f32 v215, v215
    v_mfma_f32_16x16x32_bf16 v[156:159], a[156:159], v[180:183], v[156:159]
    ds_read_b128 a[152:155], v162 offset:22528
    ds_read_b128 a[156:159], v162 offset:23552
    v_cvt_pk_bf16_f32 v213, v214, v215
    v_smfmac_f32_16x16x64_bf16 a[100:103], a[116:119], v[176:183], v6
    s_waitcnt lgkmcnt(8)
    v_mfma_f32_16x16x32_bf16 v[176:179], a[64:67], a[32:35], v[232:235]
    buffer_load_dwordx4 v2, s[20:23], s44 offen offset:2048 sc1 lds
    v_mfma_f32_16x16x32_bf16 v[176:179], a[68:71], a[36:39], v[176:179]
    v_exp_f32 v216, v216
    v_mfma_f32_16x16x32_bf16 v[176:179], a[72:75], a[40:43], v[176:179]
    v_exp_f32 v217, v217
    v_mfma_f32_16x16x32_bf16 v[176:179], a[76:79], a[44:47], v[176:179]
    v_exp_f32 v218, v218
    v_mfma_f32_16x16x32_bf16 v[180:183], a[64:67], a[48:51], v[236:239]
    v_exp_f32 v219, v219
    v_mfma_f32_16x16x32_bf16 v[180:183], a[68:71], a[52:55], v[180:183]
    ds_read_b128 a[64:67], v162 offset:0
    ds_read_b128 a[68:71], v162 offset:1024
    v_mfma_f32_16x16x32_bf16 v[180:183], a[72:75], a[56:59], v[180:183]
    buffer_load_dwordx4 v2, s[20:23], s44 offen offset:3072 sc1 lds
    s_add_u32 m0, s90, 4096
    v_mfma_f32_16x16x32_bf16 v[180:183], a[76:79], a[60:63], v[180:183]
    ds_read_b128 a[72:75], v162 offset:2048
    ds_read_b128 a[76:79], v162 offset:3072
    v_mfma_f32_16x16x32_bf16 v[184:187], a[80:83], a[32:35], v[232:235]
    v_exp_f32 v220, v220
    v_mfma_f32_16x16x32_bf16 v[184:187], a[84:87], a[36:39], v[184:187]
    v_exp_f32 v221, v221
    v_mfma_f32_16x16x32_bf16 v[184:187], a[88:91], a[40:43], v[184:187]
    v_exp_f32 v222, v222
    v_mfma_f32_16x16x32_bf16 v[184:187], a[92:95], a[44:47], v[184:187]
    v_exp_f32 v223, v223
    v_mfma_f32_16x16x32_bf16 v[188:191], a[80:83], a[48:51], v[236:239]
    v_cvt_pk_bf16_f32 v210, v216, v217
    v_cvt_pk_bf16_f32 v211, v218, v219
    v_mfma_f32_16x16x32_bf16 v[188:191], a[84:87], a[52:55], v[188:191]
    ds_read_b128 a[80:83], v162 offset:4096
    ds_read_b128 a[84:87], v162 offset:5120
    v_mfma_f32_16x16x32_bf16 v[188:191], a[88:91], a[56:59], v[188:191]
    v_cvt_pk_bf16_f32 v214, v220, v221
    v_cvt_pk_bf16_f32 v215, v222, v223
    s_waitcnt lgkmcnt(6)
    v_mfma_f32_16x16x32_bf16 v[188:191], a[92:95], a[60:63], v[188:191]
    ds_read_b128 a[88:91], v162 offset:6144
    ds_read_b128 a[92:95], v162 offset:7168
    v_mfma_f32_16x16x32_bf16 v[96:99], a[128:131], v[208:211], v[96:99]
    buffer_load_dwordx4 v3, s[20:23], s44 offen offset:0 sc1 lds
    v_mfma_f32_16x16x32_bf16 v[100:103], a[128:131], v[212:215], v[100:103]
    v_exp_f32 v176, v176
    v_mfma_f32_16x16x32_bf16 v[104:107], a[132:135], v[208:211], v[104:107]
    v_exp_f32 v177, v177
    v_mfma_f32_16x16x32_bf16 v[108:111], a[132:135], v[212:215], v[108:111]
    ds_read_b128 a[128:131], v162 offset:24576
    ds_read_b128 a[132:135], v162 offset:25600
    v_mfma_f32_16x16x32_bf16 v[112:115], a[136:139], v[208:211], v[112:115]
    v_exp_f32 v178, v178
    v_mfma_f32_16x16x32_bf16 v[116:119], a[136:139], v[212:215], v[116:119]
    buffer_load_dwordx4 v3, s[20:23], s44 offen offset:1024 sc1 lds
    v_mfma_f32_16x16x32_bf16 v[120:123], a[140:143], v[208:211], v[120:123]
    v_exp_f32 v179, v179
    v_mfma_f32_16x16x32_bf16 v[124:127], a[140:143], v[212:215], v[124:127]
    ds_read_b128 a[136:139], v162 offset:26624
    ds_read_b128 a[140:143], v162 offset:27648
    v_mfma_f32_16x16x32_bf16 v[128:131], a[144:147], v[208:211], v[128:131]
    v_exp_f32 v180, v180
    v_mfma_f32_16x16x32_bf16 v[132:135], a[144:147], v[212:215], v[132:135]
    v_exp_f32 v181, v181
    v_mfma_f32_16x16x32_bf16 v[136:139], a[148:151], v[208:211], v[136:139]
    v_cvt_pk_bf16_f32 v176, v176, v177
    v_cvt_pk_bf16_f32 v177, v178, v179
    v_cvt_pk_bf16_f32 v180, v180, v181
    v_mfma_f32_16x16x32_bf16 v[140:143], a[148:151], v[212:215], v[140:143]
    ds_read_b128 a[144:147], v162 offset:28672
    ds_read_b128 a[148:151], v162 offset:29696
    v_mfma_f32_16x16x32_bf16 v[144:147], a[152:155], v[208:211], v[144:147]
    v_exp_f32 v182, v182
    v_mfma_f32_16x16x32_bf16 v[148:151], a[152:155], v[212:215], v[148:151]
    buffer_load_dwordx4 v3, s[20:23], s44 offen offset:2048 sc1 lds
    v_mfma_f32_16x16x32_bf16 v[152:155], a[156:159], v[208:211], v[152:155]
    v_exp_f32 v183, v183
    v_mfma_f32_16x16x32_bf16 v[156:159], a[156:159], v[212:215], v[156:159]
    ds_read_b128 a[152:155], v162 offset:30720
    ds_read_b128 a[156:159], v162 offset:31744
    v_smfmac_f32_16x16x64_bf16 a[100:103], a[116:119], v[208:215], v6
    s_waitcnt lgkmcnt(8)
    v_mfma_f32_16x16x32_bf16 v[208:211], a[64:67], a[32:35], v[232:235]
    v_exp_f32 v184, v184
    v_mfma_f32_16x16x32_bf16 v[208:211], a[68:71], a[36:39], v[208:211]
    v_exp_f32 v185, v185
    v_mfma_f32_16x16x32_bf16 v[208:211], a[72:75], a[40:43], v[208:211]
    v_exp_f32 v186, v186
    v_mfma_f32_16x16x32_bf16 v[208:211], a[76:79], a[44:47], v[208:211]
    buffer_load_dwordx4 v3, s[20:23], s44 offen offset:3072 sc1 lds
    s_add_u32 s44, s44, 16384
    v_mfma_f32_16x16x32_bf16 v[212:215], a[64:67], a[48:51], v[236:239]
    v_cvt_pk_bf16_f32 v181, v182, v183
    v_cvt_pk_bf16_f32 v178, v184, v185
    v_mfma_f32_16x16x32_bf16 v[212:215], a[68:71], a[52:55], v[212:215]
    ds_read_b128 a[64:67], v162 offset:8192
    ds_read_b128 a[68:71], v162 offset:9216
    v_mfma_f32_16x16x32_bf16 v[212:215], a[72:75], a[56:59], v[212:215]
    v_exp_f32 v187, v187
    v_mfma_f32_16x16x32_bf16 v[212:215], a[76:79], a[60:63], v[212:215]
    ds_read_b128 a[72:75], v162 offset:10240
    ds_read_b128 a[76:79], v162 offset:11264
    v_mfma_f32_16x16x32_bf16 v[216:219], a[80:83], a[32:35], v[232:235]
    v_exp_f32 v188, v188
    v_mfma_f32_16x16x32_bf16 v[216:219], a[84:87], a[36:39], v[216:219]
    v_exp_f32 v189, v189
    v_mfma_f32_16x16x32_bf16 v[216:219], a[88:91], a[40:43], v[216:219]
    v_exp_f32 v190, v190
    v_mfma_f32_16x16x32_bf16 v[216:219], a[92:95], a[44:47], v[216:219]
    v_exp_f32 v191, v191
    v_mfma_f32_16x16x32_bf16 v[220:223], a[80:83], a[48:51], v[236:239]
    v_cvt_pk_bf16_f32 v179, v186, v187
    v_cvt_pk_bf16_f32 v182, v188, v189
    v_mfma_f32_16x16x32_bf16 v[220:223], a[84:87], a[52:55], v[220:223]
    ds_read_b128 a[80:83], v162 offset:12288
    ds_read_b128 a[84:87], v162 offset:13312
    v_mfma_f32_16x16x32_bf16 v[220:223], a[88:91], a[56:59], v[220:223]
    v_cvt_pk_bf16_f32 v183, v190, v191
    s_waitcnt vmcnt(8) lgkmcnt(6)
    v_mfma_f32_16x16x32_bf16 v[220:223], a[92:95], a[60:63], v[220:223]
    ds_read_b128 a[88:91], v162 offset:14336
    ds_read_b128 a[92:95], v162 offset:15360
    v_mfma_f32_16x16x32_bf16 v[96:99], a[128:131], v[176:179], v[96:99]
    s_barrier
    s_mov_b32 m0, s91
    v_mfma_f32_16x16x32_bf16 v[100:103], a[128:131], v[180:183], v[100:103]
    v_exp_f32 v208, v208
    v_mfma_f32_16x16x32_bf16 v[104:107], a[132:135], v[176:179], v[104:107]
    buffer_load_dwordx4 v2, s[20:23], s44 offen offset:0 sc1 lds
    v_mfma_f32_16x16x32_bf16 v[108:111], a[132:135], v[180:183], v[108:111]
    ds_read_b128 a[128:131], v163 offset:16384
    ds_read_b128 a[132:135], v163 offset:17408
    v_mfma_f32_16x16x32_bf16 v[112:115], a[136:139], v[176:179], v[112:115]
    v_exp_f32 v209, v209
    v_mfma_f32_16x16x32_bf16 v[116:119], a[136:139], v[180:183], v[116:119]
    v_exp_f32 v210, v210
    v_mfma_f32_16x16x32_bf16 v[120:123], a[140:143], v[176:179], v[120:123]
    v_exp_f32 v211, v211
    v_mfma_f32_16x16x32_bf16 v[124:127], a[140:143], v[180:183], v[124:127]
    ds_read_b128 a[136:139], v163 offset:18432
    ds_read_b128 a[140:143], v163 offset:19456
    v_mfma_f32_16x16x32_bf16 v[128:131], a[144:147], v[176:179], v[128:131]
    buffer_load_dwordx4 v2, s[20:23], s44 offen offset:1024 sc1 lds
    v_mfma_f32_16x16x32_bf16 v[132:135], a[144:147], v[180:183], v[132:135]
    v_exp_f32 v212, v212
    v_mfma_f32_16x16x32_bf16 v[136:139], a[148:151], v[176:179], v[136:139]
    v_exp_f32 v213, v213
    v_mfma_f32_16x16x32_bf16 v[140:143], a[148:151], v[180:183], v[140:143]
    ds_read_b128 a[144:147], v163 offset:20480
    ds_read_b128 a[148:151], v163 offset:21504
    v_mfma_f32_16x16x32_bf16 v[144:147], a[152:155], v[176:179], v[144:147]
    v_exp_f32 v214, v214
    v_mfma_f32_16x16x32_bf16 v[148:151], a[152:155], v[180:183], v[148:151]
    v_exp_f32 v215, v215
    v_mfma_f32_16x16x32_bf16 v[152:155], a[156:159], v[176:179], v[152:155]
    v_cvt_pk_bf16_f32 v208, v208, v209
    v_cvt_pk_bf16_f32 v209, v210, v211
    v_cvt_pk_bf16_f32 v212, v212, v213
    v_mfma_f32_16x16x32_bf16 v[156:159], a[156:159], v[180:183], v[156:159]
    ds_read_b128 a[152:155], v163 offset:22528
    ds_read_b128 a[156:159], v163 offset:23552
    v_cvt_pk_bf16_f32 v213, v214, v215
    v_smfmac_f32_16x16x64_bf16 a[100:103], a[116:119], v[176:183], v6
    s_waitcnt lgkmcnt(8)
    v_mfma_f32_16x16x32_bf16 v[176:179], a[64:67], a[32:35], v[232:235]
    buffer_load_dwordx4 v2, s[20:23], s44 offen offset:2048 sc1 lds
    v_mfma_f32_16x16x32_bf16 v[176:179], a[68:71], a[36:39], v[176:179]
    v_exp_f32 v216, v216
    v_mfma_f32_16x16x32_bf16 v[176:179], a[72:75], a[40:43], v[176:179]
    v_exp_f32 v217, v217
    v_mfma_f32_16x16x32_bf16 v[176:179], a[76:79], a[44:47], v[176:179]
    v_exp_f32 v218, v218
    v_mfma_f32_16x16x32_bf16 v[180:183], a[64:67], a[48:51], v[236:239]
    v_exp_f32 v219, v219
    v_mfma_f32_16x16x32_bf16 v[180:183], a[68:71], a[52:55], v[180:183]
    ds_read_b128 a[64:67], v163 offset:0
    ds_read_b128 a[68:71], v163 offset:1024
    v_mfma_f32_16x16x32_bf16 v[180:183], a[72:75], a[56:59], v[180:183]
    buffer_load_dwordx4 v2, s[20:23], s44 offen offset:3072 sc1 lds
    s_add_u32 m0, s91, 4096
    v_mfma_f32_16x16x32_bf16 v[180:183], a[76:79], a[60:63], v[180:183]
    ds_read_b128 a[72:75], v163 offset:2048
    ds_read_b128 a[76:79], v163 offset:3072
    v_mfma_f32_16x16x32_bf16 v[184:187], a[80:83], a[32:35], v[232:235]
    v_exp_f32 v220, v220
    v_mfma_f32_16x16x32_bf16 v[184:187], a[84:87], a[36:39], v[184:187]
    v_exp_f32 v221, v221
    v_mfma_f32_16x16x32_bf16 v[184:187], a[88:91], a[40:43], v[184:187]
    v_exp_f32 v222, v222
    v_mfma_f32_16x16x32_bf16 v[184:187], a[92:95], a[44:47], v[184:187]
    v_exp_f32 v223, v223
    v_mfma_f32_16x16x32_bf16 v[188:191], a[80:83], a[48:51], v[236:239]
    v_cvt_pk_bf16_f32 v210, v216, v217
    v_cvt_pk_bf16_f32 v211, v218, v219
    v_mfma_f32_16x16x32_bf16 v[188:191], a[84:87], a[52:55], v[188:191]
    ds_read_b128 a[80:83], v163 offset:4096
    ds_read_b128 a[84:87], v163 offset:5120
    v_mfma_f32_16x16x32_bf16 v[188:191], a[88:91], a[56:59], v[188:191]
    v_cvt_pk_bf16_f32 v214, v220, v221
    v_cvt_pk_bf16_f32 v215, v222, v223
    s_waitcnt lgkmcnt(6)
    v_mfma_f32_16x16x32_bf16 v[188:191], a[92:95], a[60:63], v[188:191]
    ds_read_b128 a[88:91], v163 offset:6144
    ds_read_b128 a[92:95], v163 offset:7168
    v_mfma_f32_16x16x32_bf16 v[96:99], a[128:131], v[208:211], v[96:99]
    buffer_load_dwordx4 v3, s[20:23], s44 offen offset:0 sc1 lds
    v_mfma_f32_16x16x32_bf16 v[100:103], a[128:131], v[212:215], v[100:103]
    v_exp_f32 v176, v176
    v_mfma_f32_16x16x32_bf16 v[104:107], a[132:135], v[208:211], v[104:107]
    v_exp_f32 v177, v177
    v_mfma_f32_16x16x32_bf16 v[108:111], a[132:135], v[212:215], v[108:111]
    ds_read_b128 a[128:131], v163 offset:24576
    ds_read_b128 a[132:135], v163 offset:25600
    v_mfma_f32_16x16x32_bf16 v[112:115], a[136:139], v[208:211], v[112:115]
    v_exp_f32 v178, v178
    v_mfma_f32_16x16x32_bf16 v[116:119], a[136:139], v[212:215], v[116:119]
    buffer_load_dwordx4 v3, s[20:23], s44 offen offset:1024 sc1 lds
    v_mfma_f32_16x16x32_bf16 v[120:123], a[140:143], v[208:211], v[120:123]
    v_exp_f32 v179, v179
    v_mfma_f32_16x16x32_bf16 v[124:127], a[140:143], v[212:215], v[124:127]
    ds_read_b128 a[136:139], v163 offset:26624
    ds_read_b128 a[140:143], v163 offset:27648
    v_mfma_f32_16x16x32_bf16 v[128:131], a[144:147], v[208:211], v[128:131]
    v_exp_f32 v180, v180
    v_mfma_f32_16x16x32_bf16 v[132:135], a[144:147], v[212:215], v[132:135]
    v_exp_f32 v181, v181
    v_mfma_f32_16x16x32_bf16 v[136:139], a[148:151], v[208:211], v[136:139]
    v_cvt_pk_bf16_f32 v176, v176, v177
    v_cvt_pk_bf16_f32 v177, v178, v179
    v_cvt_pk_bf16_f32 v180, v180, v181
    v_mfma_f32_16x16x32_bf16 v[140:143], a[148:151], v[212:215], v[140:143]
    ds_read_b128 a[144:147], v163 offset:28672
    ds_read_b128 a[148:151], v163 offset:29696
    v_mfma_f32_16x16x32_bf16 v[144:147], a[152:155], v[208:211], v[144:147]
    v_exp_f32 v182, v182
    v_mfma_f32_16x16x32_bf16 v[148:151], a[152:155], v[212:215], v[148:151]
    buffer_load_dwordx4 v3, s[20:23], s44 offen offset:2048 sc1 lds
    v_mfma_f32_16x16x32_bf16 v[152:155], a[156:159], v[208:211], v[152:155]
    v_exp_f32 v183, v183
    v_mfma_f32_16x16x32_bf16 v[156:159], a[156:159], v[212:215], v[156:159]
    ds_read_b128 a[152:155], v163 offset:30720
    ds_read_b128 a[156:159], v163 offset:31744
    v_smfmac_f32_16x16x64_bf16 a[100:103], a[116:119], v[208:215], v6
    s_waitcnt lgkmcnt(8)
    v_mfma_f32_16x16x32_bf16 v[208:211], a[64:67], a[32:35], v[232:235]
    v_exp_f32 v184, v184
    v_mfma_f32_16x16x32_bf16 v[208:211], a[68:71], a[36:39], v[208:211]
    v_exp_f32 v185, v185
    v_mfma_f32_16x16x32_bf16 v[208:211], a[72:75], a[40:43], v[208:211]
    v_exp_f32 v186, v186
    v_mfma_f32_16x16x32_bf16 v[208:211], a[76:79], a[44:47], v[208:211]
    buffer_load_dwordx4 v3, s[20:23], s44 offen offset:3072 sc1 lds
    s_add_u32 s44, s44, 16384
    v_mfma_f32_16x16x32_bf16 v[212:215], a[64:67], a[48:51], v[236:239]
    v_cvt_pk_bf16_f32 v181, v182, v183
    v_cvt_pk_bf16_f32 v178, v184, v185
    s_sub_u32 s45, s45, 1
    v_mfma_f32_16x16x32_bf16 v[212:215], a[68:71], a[52:55], v[212:215]
    ds_read_b128 a[64:67], v163 offset:8192
    ds_read_b128 a[68:71], v163 offset:9216
    v_mfma_f32_16x16x32_bf16 v[212:215], a[72:75], a[56:59], v[212:215]
    v_exp_f32 v187, v187
    v_mfma_f32_16x16x32_bf16 v[212:215], a[76:79], a[60:63], v[212:215]
    ds_read_b128 a[72:75], v163 offset:10240
    ds_read_b128 a[76:79], v163 offset:11264
    v_mfma_f32_16x16x32_bf16 v[216:219], a[80:83], a[32:35], v[232:235]
    v_exp_f32 v188, v188
    v_mfma_f32_16x16x32_bf16 v[216:219], a[84:87], a[36:39], v[216:219]
    v_exp_f32 v189, v189
    v_mfma_f32_16x16x32_bf16 v[216:219], a[88:91], a[40:43], v[216:219]
    v_exp_f32 v190, v190
    v_mfma_f32_16x16x32_bf16 v[216:219], a[92:95], a[44:47], v[216:219]
    v_exp_f32 v191, v191
    v_mfma_f32_16x16x32_bf16 v[220:223], a[80:83], a[48:51], v[236:239]
    v_cvt_pk_bf16_f32 v179, v186, v187
    v_cvt_pk_bf16_f32 v182, v188, v189
    v_mfma_f32_16x16x32_bf16 v[220:223], a[84:87], a[52:55], v[220:223]
    ds_read_b128 a[80:83], v163 offset:12288
    ds_read_b128 a[84:87], v163 offset:13312
    v_mfma_f32_16x16x32_bf16 v[220:223], a[88:91], a[56:59], v[220:223]
    v_cvt_pk_bf16_f32 v183, v190, v191
    s_waitcnt vmcnt(8) lgkmcnt(6)
    v_mfma_f32_16x16x32_bf16 v[220:223], a[92:95], a[60:63], v[220:223]
    ds_read_b128 a[88:91], v163 offset:14336
    ds_read_b128 a[92:95], v163 offset:15360
    s_cbranch_scc0 L_S
L_SL:
    v_cmp_gt_u32 vcc, 28, v9
    s_nop 0
    s_cbranch_vccnz L_spinpa
L_backpa:
    v_mfma_f32_16x16x32_bf16 v[96:99], a[128:131], v[176:179], v[96:99]
    s_barrier
    s_mov_b32 m0, s88
    v_mfma_f32_16x16x32_bf16 v[100:103], a[128:131], v[180:183], v[100:103]
    v_exp_f32 v208, v208
    v_exp_f32 v209, v209
    v_mfma_f32_16x16x32_bf16 v[104:107], a[132:135], v[176:179], v[104:107]
    buffer_load_dwordx4 v2, s[20:23], s44 offen offset:0 sc1 lds
    v_cvt_pk_bf16_f32 v208, v208, v209
    v_mfma_f32_16x16x32_bf16 v[108:111], a[132:135], v[180:183], v[108:111]
    ds_read_b128 a[128:131], v160 offset:16384
    ds_read_b128 a[132:135], v160 offset:17408
    v_mfma_f32_16x16x32_bf16 v[112:115], a[136:139], v[176:179], v[112:115]
    buffer_load_dwordx4 a[160:163], v2, s[24:27], s28 offen offset:0 sc1
    v_mfma_f32_16x16x32_bf16 v[116:119], a[136:139], v[180:183], v[116:119]
    v_exp_f32 v210, v210
    v_mfma_f32_16x16x32_bf16 v[120:123], a[140:143], v[176:179], v[120:123]
    v_exp_f32 v211, v211
    v_mfma_f32_16x16x32_bf16 v[124:127], a[140:143], v[180:183], v[124:127]
    ds_read_b128 a[136:139], v160 offset:18432
    ds_read_b128 a[140:143], v160 offset:19456
    v_cvt_pk_bf16_f32 v209, v210, v211
    v_mfma_f32_16x16x32_bf16 v[128:131], a[144:147], v[176:179], v[128:131]
    buffer_load_dwordx4 v2, s[20:23], s44 offen offset:1024 sc1 lds
    v_mfma_f32_16x16x32_bf16 v[132:135], a[144:147], v[180:183], v[132:135]
    v_exp_f32 v212, v212
    v_mfma_f32_16x16x32_bf16 v[136:139], a[148:151], v[176:179], v[136:139]
    v_exp_f32 v213, v213
    v_mfma_f32_16x16x32_bf16 v[140:143], a[148:151], v[180:183], v[140:143]
    ds_read_b128 a[144:147], v160 offset:20480
    ds_read_b128 a[148:151], v160 offset:21504
    v_cvt_pk_bf16_f32 v212, v212, v213
    v_mfma_f32_16x16x32_bf16 v[144:147], a[152:155], v[176:179], v[144:147]
    v_exp_f32 v214, v214
    v_mfma_f32_16x16x32_bf16 v[148:151], a[152:155], v[180:183], v[148:151]
    buffer_load_dwordx4 a[164:167], v2, s[24:27], s28 offen offset:1024 sc1
    v_mfma_f32_16x16x32_bf16 v[152:155], a[156:159], v[176:179], v[152:155]
    v_exp_f32 v215, v215
    v_mfma_f32_16x16x32_bf16 v[156:159], a[156:159], v[180:183], v[156:159]
    ds_read_b128 a[152:155], v160 offset:22528
    ds_read_b128 a[156:159], v160 offset:23552
    v_cvt_pk_bf16_f32 v213, v214, v215
    v_smfmac_f32_16x16x64_bf16 a[100:103], a[116:119], v[176:183], v6
    s_waitcnt lgkmcnt(8)
    v_mfma_f32_16x16x32_bf16 v[176:179], a[64:67], a[32:35], v[232:235]
    buffer_load_dwordx4 v2, s[20:23], s44 offen offset:2048 sc1 lds
    v_mfma_f32_16x16x32_bf16 v[176:179], a[68:71], a[36:39], v[176:179]
    v_exp_f32 v216, v216
    v_mfma_f32_16x16x32_bf16 v[176:179], a[72:75], a[40:43], v[176:179]
    v_exp_f32 v217, v217
    v_mfma_f32_16x16x32_bf16 v[176:179], a[76:79], a[44:47], v[176:179]
    v_exp_f32 v218, v218
    v_cvt_pk_bf16_f32 v210, v216, v217
    v_mfma_f32_16x16x32_bf16 v[180:183], a[64:67], a[48:51], v[236:239]
    v_exp_f32 v219, v219
    v_mfma_f32_16x16x32_bf16 v[180:183], a[68:71], a[52:55], v[180:183]
    ds_read_b128 a[64:67], v160 offset:0
    ds_read_b128 a[68:71], v160 offset:1024
    v_mfma_f32_16x16x32_bf16 v[180:183], a[72:75], a[56:59], v[180:183]
    buffer_load_dwordx4 v2, s[20:23], s44 offen offset:3072 sc1 lds
    s_add_u32 m0, s88, 4096
    v_mfma_f32_16x16x32_bf16 v[180:183], a[76:79], a[60:63], v[180:183]
    ds_read_b128 a[72:75], v160 offset:2048
    ds_read_b128 a[76:79], v160 offset:3072
    v_mfma_f32_16x16x32_bf16 v[184:187], a[80:83], a[32:35], v[232:235]
    buffer_load_dwordx4 a[168:171], v2, s[24:27], s28 offen offset:2048 sc1
    v_mfma_f32_16x16x32_bf16 v[184:187], a[84:87], a[36:39], v[184:187]
    v_exp_f32 v220, v220
    v_mfma_f32_16x16x32_bf16 v[184:187], a[88:91], a[40:43], v[184:187]
    v_exp_f32 v221, v221
    v_mfma_f32_16x16x32_bf16 v[184:187], a[92:95], a[44:47], v[184:187]
    v_exp_f32 v222, v222
    v_mfma_f32_16x16x32_bf16 v[188:191], a[80:83], a[48:51], v[236:239]
    v_exp_f32 v223, v223
    v_mfma_f32_16x16x32_bf16 v[188:191], a[84:87], a[52:55], v[188:191]
    ds_read_b128 a[80:83], v160 offset:4096
    ds_read_b128 a[84:87], v160 offset:5120
    v_mfma_f32_16x16x32_bf16 v[188:191], a[88:91], a[56:59], v[188:191]
    v_cvt_pk_bf16_f32 v211, v218, v219
    v_cvt_pk_bf16_f32 v214, v220, v221
    v_cvt_pk_bf16_f32 v215, v222, v223
    s_waitcnt lgkmcnt(6)
    v_mfma_f32_16x16x32_bf16 v[188:191], a[92:95], a[60:63], v[188:191]
    ds_read_b128 a[88:91], v160 offset:6144
    ds_read_b128 a[92:95], v160 offset:7168
    v_mfma_f32_16x16x32_bf16 v[96:99], a[128:131], v[208:211], v[96:99]
    buffer_load_dwordx4 v3, s[20:23], s44 offen offset:0 sc1 lds
    v_mfma_f32_16x16x32_bf16 v[100:103], a[128:131], v[212:215], v[100:103]
    buffer_load_dwordx4 a[172:175], v2, s[24:27], s28 offen offset:3072 sc1
    v_mfma_f32_16x16x32_bf16 v[104:107], a[132:135], v[208:211], v[104:107]
    s_xor_b32 s28, s28, 4096
    v_exp_f32 v176, v176
    v_mfma_f32_16x16x32_bf16 v[108:111], a[132:135], v[212:215], v[108:111]
    ds_read_b128 a[128:131], v160 offset:24576
    ds_read_b128 a[132:135], v160 offset:25600
    v_mfma_f32_16x16x32_bf16 v[112:115], a[136:139], v[208:211], v[112:115]
    v_exp_f32 v177, v177
    v_mfma_f32_16x16x32_bf16 v[116:119], a[136:139], v[212:215], v[116:119]
    buffer_load_dwordx4 v3, s[20:23], s44 offen offset:1024 sc1 lds
    v_cvt_pk_bf16_f32 v176, v176, v177
    v_mfma_f32_16x16x32_bf16 v[120:123], a[140:143], v[208:211], v[120:123]
    v_exp_f32 v178, v178
    v_mfma_f32_16x16x32_bf16 v[124:127], a[140:143], v[212:215], v[124:127]
    ds_read_b128 a[136:139], v160 offset:26624
    ds_read_b128 a[140:143], v160 offset:27648
    v_mfma_f32_16x16x32_bf16 v[128:131], a[144:147], v[208:211], v[128:131]
    buffer_load_dwordx4 a[176:179], v2, s[24:27], s28 offen offset:0 sc1
    v_mfma_f32_16x16x32_bf16 v[132:135], a[144:147], v[212:215], v[132:135]
    v_exp_f32 v179, v179
    v_mfma_f32_16x16x32_bf16 v[136:139], a[148:151], v[208:211], v[136:139]
    v_exp_f32 v180, v180
    v_cvt_pk_bf16_f32 v177, v178, v179
    v_mfma_f32_16x16x32_bf16 v[140:143], a[148:151], v[212:215], v[140:143]
    ds_read_b128 a[144:147], v160 offset:28672
    ds_read_b128 a[148:151], v160 offset:29696
    v_mfma_f32_16x16x32_bf16 v[144:147], a[152:155], v[208:211], v[144:147]
    v_exp_f32 v181, v181
    v_mfma_f32_16x16x32_bf16 v[148:151], a[152:155], v[212:215], v[148:151]
    buffer_load_dwordx4 v3, s[20:23], s44 offen offset:2048 sc1 lds
    v_cvt_pk_bf16_f32 v180, v180, v181
    v_mfma_f32_16x16x32_bf16 v[152:155], a[156:159], v[208:211], v[152:155]
    v_exp_f32 v182, v182
    v_mfma_f32_16x16x32_bf16 v[156:159], a[156:159], v[212:215], v[156:159]
    ds_read_b128 a[152:155], v160 offset:30720
    ds_read_b128 a[156:159], v160 offset:31744
    v_smfmac_f32_16x16x64_bf16 a[100:103], a[116:119], v[208:215], v6
    s_waitcnt lgkmcnt(8)
    v_mfma_f32_16x16x32_bf16 v[208:211], a[64:67], a[32:35], v[232:235]
    buffer_load_dwordx4 a[180:183], v2, s[24:27], s28 offen offset:1024 sc1
    v_mfma_f32_16x16x32_bf16 v[208:211], a[68:71], a[36:39], v[208:211]
    v_exp_f32 v183, v183
    v_mfma_f32_16x16x32_bf16 v[208:211], a[72:75], a[40:43], v[208:211]
    v_exp_f32 v184, v184
    v_cvt_pk_bf16_f32 v181, v182, v183
    v_mfma_f32_16x16x32_bf16 v[208:211], a[76:79], a[44:47], v[208:211]
    buffer_load_dwordx4 v3, s[20:23], s44 offen offset:3072 sc1 lds
    s_add_u32 s44, s44, 16384
    v_mfma_f32_16x16x32_bf16 v[212:215], a[64:67], a[48:51], v[236:239]
    v_exp_f32 v185, v185
    v_mfma_f32_16x16x32_bf16 v[212:215], a[68:71], a[52:55], v[212:215]
    ds_read_b128 a[64:67], v160 offset:8192
    ds_read_b128 a[68:71], v160 offset:9216
    v_mfma_f32_16x16x32_bf16 v[212:215], a[72:75], a[56:59], v[212:215]
    v_exp_f32 v186, v186
    v_mfma_f32_16x16x32_bf16 v[212:215], a[76:79], a[60:63], v[212:215]
    ds_read_b128 a[72:75], v160 offset:10240
    ds_read_b128 a[76:79], v160 offset:11264
    v_mfma_f32_16x16x32_bf16 v[216:219], a[80:83], a[32:35], v[232:235]
    v_exp_f32 v187, v187
    v_mfma_f32_16x16x32_bf16 v[216:219], a[84:87], a[36:39], v[216:219]
    v_exp_f32 v188, v188
    v_mfma_f32_16x16x32_bf16 v[216:219], a[88:91], a[40:43], v[216:219]
    v_exp_f32 v189, v189
    v_mfma_f32_16x16x32_bf16 v[216:219], a[92:95], a[44:47], v[216:219]
    v_exp_f32 v190, v190
    v_mfma_f32_16x16x32_bf16 v[220:223], a[80:83], a[48:51], v[236:239]
    v_exp_f32 v191, v191
    v_mfma_f32_16x16x32_bf16 v[220:223], a[84:87], a[52:55], v[220:223]
    ds_read_b128 a[80:83], v160 offset:12288
    ds_read_b128 a[84:87], v160 offset:13312
    v_mfma_f32_16x16x32_bf16 v[220:223], a[88:91], a[56:59], v[220:223]
    v_cvt_pk_bf16_f32 v178, v184, v185
    v_cvt_pk_bf16_f32 v179, v186, v187
    v_cvt_pk_bf16_f32 v182, v188, v189
    v_cvt_pk_bf16_f32 v183, v190, v191
    s_waitcnt vmcnt(14) lgkmcnt(6)
    v_mfma_f32_16x16x32_bf16 v[220:223], a[92:95], a[60:63], v[220:223]
    ds_read_b128 a[88:91], v160 offset:14336
    ds_read_b128 a[92:95], v160 offset:15360
    v_mfma_f32_16x16x32_bf16 v[96:99], a[128:131], v[176:179], v[96:99]
    s_barrier
    s_mov_b32 m0, s89
    v_mfma_f32_16x16x32_bf16 v[100:103], a[128:131], v[180:183], v[100:103]
    v_exp_f32 v208, v208
    v_exp_f32 v209, v209
    v_mfma_f32_16x16x32_bf16 v[104:107], a[132:135], v[176:179], v[104:107]
    s_cmp_lg_u32 s46, 0
    s_cbranch_scc1 L_sg9
    buffer_atomic_add v8, v11, s[16:19], s83 offen
    s_mov_b32 s46, 1
L_sg9:
    v_exp_f32 v210, v210
    v_mfma_f32_16x16x32_bf16 v[108:111], a[132:135], v[180:183], v[108:111]
    ds_read_b128 a[128:131], v161 offset:16384
    ds_read_b128 a[132:135], v161 offset:17408
    v_cvt_pk_bf16_f32 v208, v208, v209
    v_mfma_f32_16x16x32_bf16 v[112:115], a[136:139], v[176:179], v[112:115]
    buffer_load_dwordx4 v2, s[20:23], s44 offen offset:0 sc1 lds
    v_mfma_f32_16x16x32_bf16 v[116:119], a[136:139], v[180:183], v[116:119]
    buffer_load_dwordx4 a[184:187], v2, s[24:27], s28 offen offset:2048 sc1
    v_mfma_f32_16x16x32_bf16 v[120:123], a[140:143], v[176:179], v[120:123]
    v_exp_f32 v211, v211
    v_mfma_f32_16x16x32_bf16 v[124:127], a[140:143], v[180:183], v[124:127]
    ds_read_b128 a[136:139], v161 offset:18432
    ds_read_b128 a[140:143], v161 offset:19456
    v_cvt_pk_bf16_f32 v209, v210, v211
    v_mfma_f32_16x16x32_bf16 v[128:131], a[144:147], v[176:179], v[128:131]
    buffer_load_dwordx4 v2, s[20:23], s44 offen offset:1024 sc1 lds
    v_mfma_f32_16x16x32_bf16 v[132:135], a[144:147], v[180:183], v[132:135]
    v_exp_f32 v212, v212
    v_mfma_f32_16x16x32_bf16 v[136:139], a[148:151], v[176:179], v[136:139]
    v_exp_f32 v213, v213
    v_mfma_f32_16x16x32_bf16 v[140:143], a[148:151], v[180:183], v[140:143]
    ds_read_b128 a[144:147], v161 offset:20480
    ds_read_b128 a[148:151], v161 offset:21504
    v_cvt_pk_bf16_f32 v212, v212, v213
    v_mfma_f32_16x16x32_bf16 v[144:147], a[152:155], v[176:179], v[144:147]
    v_exp_f32 v214, v214
    v_mfma_f32_16x16x32_bf16 v[148:151], a[152:155], v[180:183], v[148:151]
    buffer_load_dwordx4 a[188:191], v2, s[24:27], s28 offen offset:3072 sc1
    v_mfma_f32_16x16x32_bf16 v[152:155], a[156:159], v[176:179], v[152:155]
    s_xor_b32 s28, s28, 12288
    v_exp_f32 v215, v215
    v_mfma_f32_16x16x32_bf16 v[156:159], a[156:159], v[180:183], v[156:159]
    ds_read_b128 a[152:155], v161 offset:22528
    ds_read_b128 a[156:159], v161 offset:23552
    v_cvt_pk_bf16_f32 v213, v214, v215
    v_smfmac_f32_16x16x64_bf16 a[100:103], a[116:119], v[176:183], v6
    s_waitcnt lgkmcnt(8)
    v_mfma_f32_16x16x32_bf16 v[176:179], a[64:67], a[32:35], v[232:235]
    buffer_load_dwordx4 v2, s[20:23], s44 offen offset:2048 sc1 lds
    v_mfma_f32_16x16x32_bf16 v[176:179], a[68:71], a[36:39], v[176:179]
    v_exp_f32 v216, v216
    v_mfma_f32_16x16x32_bf16 v[176:179], a[72:75], a[40:43], v[176:179]
    v_exp_f32 v217, v217
    v_mfma_f32_16x16x32_bf16 v[176:179], a[76:79], a[44:47], v[176:179]
    v_exp_f32 v218, v218
    v_cvt_pk_bf16_f32 v210, v216, v217
    v_mfma_f32_16x16x32_bf16 v[180:183], a[64:67], a[48:51], v[236:239]
    v_exp_f32 v219, v219
    v_mfma_f32_16x16x32_bf16 v[180:183], a[68:71], a[52:55], v[180:183]
    ds_read_b128 a[64:67], v161 offset:0
    ds_read_b128 a[68:71], v161 offset:1024
    v_mfma_f32_16x16x32_bf16 v[180:183], a[72:75], a[56:59], v[180:183]
    buffer_load_dwordx4 v2, s[20:23], s44 offen offset:3072 sc1 lds
    s_add_u32 m0, s89, 4096
    v_mfma_f32_16x16x32_bf16 v[180:183], a[76:79], a[60:63], v[180:183]
    ds_read_b128 a[72:75], v161 offset:2048
    ds_read_b128 a[76:79], v161 offset:3072
    v_mfma_f32_16x16x32_bf16 v[184:187], a[80:83], a[32:35], v[232:235]
    buffer_load_dwordx4 a[192:195], v2, s[24:27], s28 offen offset:0 sc1
    v_mfma_f32_16x16x32_bf16 v[184:187], a[84:87], a[36:39], v[184:187]
    v_exp_f32 v220, v220
    v_mfma_f32_16x16x32_bf16 v[184:187], a[88:91], a[40:43], v[184:187]
    v_exp_f32 v221, v221
    v_mfma_f32_16x16x32_bf16 v[184:187], a[92:95], a[44:47], v[184:187]
    v_exp_f32 v222, v222
    v_mfma_f32_16x16x32_bf16 v[188:191], a[80:83], a[48:51], v[236:239]
    v_exp_f32 v223, v223
    v_mfma_f32_16x16x32_bf16 v[188:191], a[84:87], a[52:55], v[188:191]
    ds_read_b128 a[80:83], v161 offset:4096
    ds_read_b128 a[84:87], v161 offset:5120
    v_mfma_f32_16x16x32_bf16 v[188:191], a[88:91], a[56:59], v[188:191]
    v_cvt_pk_bf16_f32 v211, v218, v219
    v_cvt_pk_bf16_f32 v214, v220, v221
    v_cvt_pk_bf16_f32 v215, v222, v223
    s_waitcnt lgkmcnt(6)
    v_mfma_f32_16x16x32_bf16 v[188:191], a[92:95], a[60:63], v[188:191]
    ds_read_b128 a[88:91], v161 offset:6144
    ds_read_b128 a[92:95], v161 offset:7168
    v_mfma_f32_16x16x32_bf16 v[96:99], a[128:131], v[208:211], v[96:99]
    buffer_load_dwordx4 v3, s[20:23], s44 offen offset:0 sc1 lds
    v_mfma_f32_16x16x32_bf16 v[100:103], a[128:131], v[212:215], v[100:103]
    buffer_load_dwordx4 a[196:199], v2, s[24:27], s28 offen offset:1024 sc1
    v_mfma_f32_16x16x32_bf16 v[104:107], a[132:135], v[208:211], v[104:107]
    v_exp_f32 v176, v176
    v_mfma_f32_16x16x32_bf16 v[108:111], a[132:135], v[212:215], v[108:111]
    ds_read_b128 a[128:131], v161 offset:24576
    ds_read_b128 a[132:135], v161 offset:25600
    v_mfma_f32_16x16x32_bf16 v[112:115], a[136:139], v[208:211], v[112:115]
    v_exp_f32 v177, v177
    v_mfma_f32_16x16x32_bf16 v[116:119], a[136:139], v[212:215], v[116:119]
    buffer_load_dwordx4 v3, s[20:23], s44 offen offset:1024 sc1 lds
    v_cvt_pk_bf16_f32 v176, v176, v177
    v_mfma_f32_16x16x32_bf16 v[120:123], a[140:143], v[208:211], v[120:123]
    v_exp_f32 v178, v178
    v_mfma_f32_16x16x32_bf16 v[124:127], a[140:143], v[212:215], v[124:127]
    ds_read_b128 a[136:139], v161 offset:26624
    ds_read_b128 a[140:143], v161 offset:27648
    v_mfma_f32_16x16x32_bf16 v[128:131], a[144:147], v[208:211], v[128:131]
    buffer_load_dwordx4 a[200:203], v2, s[24:27], s28 offen offset:2048 sc1
    v_mfma_f32_16x16x32_bf16 v[132:135], a[144:147], v[212:215], v[132:135]
    v_exp_f32 v179, v179
    v_mfma_f32_16x16x32_bf16 v[136:139], a[148:151], v[208:211], v[136:139]
    v_exp_f32 v180, v180
    v_cvt_pk_bf16_f32 v177, v178, v179
    v_mfma_f32_16x16x32_bf16 v[140:143], a[148:151], v[212:215], v[140:143]
    ds_read_b128 a[144:147], v161 offset:28672
    ds_read_b128 a[148:151], v161 offset:29696
    v_mfma_f32_16x16x32_bf16 v[144:147], a[152:155], v[208:211], v[144:147]
    v_exp_f32 v181, v181
    v_mfma_f32_16x16x32_bf16 v[148:151], a[152:155], v[212:215], v[148:151]
    buffer_load_dwordx4 v3, s[20:23], s44 offen offset:2048 sc1 lds
    v_cvt_pk_bf16_f32 v180, v180, v181
    v_mfma_f32_16x16x32_bf16 v[152:155], a[156:159], v[208:211], v[152:155]
    v_exp_f32 v182, v182
    v_mfma_f32_16x16x32_bf16 v[156:159], a[156:159], v[212:215], v[156:159]
    ds_read_b128 a[152:155], v161 offset:30720
    ds_read_b128 a[156:159], v161 offset:31744
    v_smfmac_f32_16x16x64_bf16 a[100:103], a[116:119], v[208:215], v6
    s_waitcnt lgkmcnt(8)
    v_mfma_f32_16x16x32_bf16 v[208:211], a[64:67], a[32:35], v[232:235]
    buffer_load_dwordx4 a[204:207], v2, s[24:27], s28 offen offset:3072 sc1
    v_mfma_f32_16x16x32_bf16 v[208:211], a[68:71], a[36:39], v[208:211]
    s_xor_b32 s28, s28, 4096
    v_exp_f32 v183, v183
    v_mfma_f32_16x16x32_bf16 v[208:211], a[72:75], a[40:43], v[208:211]
    v_exp_f32 v184, v184
    v_cvt_pk_bf16_f32 v181, v182, v183
    v_mfma_f32_16x16x32_bf16 v[208:211], a[76:79], a[44:47], v[208:211]
    buffer_load_dwordx4 v3, s[20:23], s44 offen offset:3072 sc1 lds
    s_add_u32 s44, s44, 16384
    v_mfma_f32_16x16x32_bf16 v[212:215], a[64:67], a[48:51], v[236:239]
    v_exp_f32 v185, v185
    v_mfma_f32_16x16x32_bf16 v[212:215], a[68:71], a[52:55], v[212:215]
    ds_read_b128 a[64:67], v161 offset:8192
    ds_read_b128 a[68:71], v161 offset:9216
    v_mfma_f32_16x16x32_bf16 v[212:215], a[72:75], a[56:59], v[212:215]
    v_exp_f32 v186, v186
    v_mfma_f32_16x16x32_bf16 v[212:215], a[76:79], a[60:63], v[212:215]
    ds_read_b128 a[72:75], v161 offset:10240
    ds_read_b128 a[76:79], v161 offset:11264
    v_mfma_f32_16x16x32_bf16 v[216:219], a[80:83], a[32:35], v[232:235]
    v_exp_f32 v187, v187
    v_mfma_f32_16x16x32_bf16 v[216:219], a[84:87], a[36:39], v[216:219]
    v_exp_f32 v188, v188
    v_mfma_f32_16x16x32_bf16 v[216:219], a[88:91], a[40:43], v[216:219]
    v_exp_f32 v189, v189
    v_mfma_f32_16x16x32_bf16 v[216:219], a[92:95], a[44:47], v[216:219]
    v_exp_f32 v190, v190
    v_mfma_f32_16x16x32_bf16 v[220:223], a[80:83], a[48:51], v[236:239]
    v_exp_f32 v191, v191
    v_mfma_f32_16x16x32_bf16 v[220:223], a[84:87], a[52:55], v[220:223]
    ds_read_b128 a[80:83], v161 offset:12288
    ds_read_b128 a[84:87], v161 offset:13312
    v_mfma_f32_16x16x32_bf16 v[220:223], a[88:91], a[56:59], v[220:223]
    v_cvt_pk_bf16_f32 v178, v184, v185
    v_cvt_pk_bf16_f32 v179, v186, v187
    v_cvt_pk_bf16_f32 v182, v188, v189
    v_cvt_pk_bf16_f32 v183, v190, v191
    s_waitcnt vmcnt(14) lgkmcnt(6)
    v_mfma_f32_16x16x32_bf16 v[220:223], a[92:95], a[60:63], v[220:223]
    ds_read_b128 a[88:91], v161 offset:14336
    ds_read_b128 a[92:95], v161 offset:15360
    v_mfma_f32_16x16x32_bf16 v[96:99], a[128:131], v[176:179], v[96:99]
    s_barrier
    s_mov_b32 m0, s90
    v_mfma_f32_16x16x32_bf16 v[100:103], a[128:131], v[180:183], v[100:103]
    v_exp_f32 v208, v208
    v_exp_f32 v209, v209
    v_mfma_f32_16x16x32_bf16 v[104:107], a[132:135], v[176:179], v[104:107]
    buffer_load_dwordx4 v2, s[20:23], s44 offen offset:0 sc1 lds
    v_cvt_pk_bf16_f32 v208, v208, v209
    v_mfma_f32_16x16x32_bf16 v[108:111], a[132:135], v[180:183], v[108:111]
    ds_read_b128 a[128:131], v162 offset:16384
    ds_read_b128 a[132:135], v162 offset:17408
    v_mfma_f32_16x16x32_bf16 v[112:115], a[136:139], v[176:179], v[112:115]
    buffer_load_dwordx4 a[208:211], v2, s[24:27], s28 offen offset:0 sc1
    v_mfma_f32_16x16x32_bf16 v[116:119], a[136:139], v[180:183], v[116:119]
    v_exp_f32 v210, v210
    v_mfma_f32_16x16x32_bf16 v[120:123], a[140:143], v[176:179], v[120:123]
    v_exp_f32 v211, v211
    v_mfma_f32_16x16x32_bf16 v[124:127], a[140:143], v[180:183], v[124:127]
    ds_read_b128 a[136:139], v162 offset:18432
    ds_read_b128 a[140:143], v162 offset:19456
    v_cvt_pk_bf16_f32 v209, v210, v211
    v_mfma_f32_16x16x32_bf16 v[128:131], a[144:147], v[176:179], v[128:131]
    buffer_load_dwordx4 v2, s[20:23], s44 offen offset:1024 sc1 lds
    v_mfma_f32_16x16x32_bf16 v[132:135], a[144:147], v[180:183], v[132:135]
    v_exp_f32 v212, v212
    v_mfma_f32_16x16x32_bf16 v[136:139], a[148:151], v[176:179], v[136:139]
    v_exp_f32 v213, v213
    v_mfma_f32_16x16x32_bf16 v[140:143], a[148:151], v[180:183], v[140:143]
    ds_read_b128 a[144:147], v162 offset:20480
    ds_read_b128 a[148:151], v162 offset:21504
    v_cvt_pk_bf16_f32 v212, v212, v213
    v_mfma_f32_16x16x32_bf16 v[144:147], a[152:155], v[176:179], v[144:147]
    v_exp_f32 v214, v214
    v_mfma_f32_16x16x32_bf16 v[148:151], a[152:155], v[180:183], v[148:151]
    buffer_load_dwordx4 a[212:215], v2, s[24:27], s28 offen offset:1024 sc1
    v_mfma_f32_16x16x32_bf16 v[152:155], a[156:159], v[176:179], v[152:155]
    v_exp_f32 v215, v215
    v_mfma_f32_16x16x32_bf16 v[156:159], a[156:159], v[180:183], v[156:159]
    ds_read_b128 a[152:155], v162 offset:22528
    ds_read_b128 a[156:159], v162 offset:23552
    v_cvt_pk_bf16_f32 v213, v214, v215
    v_smfmac_f32_16x16x64_bf16 a[100:103], a[116:119], v[176:183], v6
    s_waitcnt lgkmcnt(8)
    v_mfma_f32_16x16x32_bf16 v[176:179], a[64:67], a[32:35], v[232:235]
    buffer_load_dwordx4 v2, s[20:23], s44 offen offset:2048 sc1 lds
    v_mfma_f32_16x16x32_bf16 v[176:179], a[68:71], a[36:39], v[176:179]
    v_exp_f32 v216, v216
    v_mfma_f32_16x16x32_bf16 v[176:179], a[72:75], a[40:43], v[176:179]
    v_exp_f32 v217, v217
    v_mfma_f32_16x16x32_bf16 v[176:179], a[76:79], a[44:47], v[176:179]
    v_exp_f32 v218, v218
    v_cvt_pk_bf16_f32 v210, v216, v217
    v_mfma_f32_16x16x32_bf16 v[180:183], a[64:67], a[48:51], v[236:239]
    v_exp_f32 v219, v219
    v_mfma_f32_16x16x32_bf16 v[180:183], a[68:71], a[52:55], v[180:183]
    ds_read_b128 a[64:67], v162 offset:0
    ds_read_b128 a[68:71], v162 offset:1024
    v_mfma_f32_16x16x32_bf16 v[180:183], a[72:75], a[56:59], v[180:183]
    buffer_load_dwordx4 v2, s[20:23], s44 offen offset:3072 sc1 lds
    s_add_u32 m0, s90, 4096
    v_mfma_f32_16x16x32_bf16 v[180:183], a[76:79], a[60:63], v[180:183]
    ds_read_b128 a[72:75], v162 offset:2048
    ds_read_b128 a[76:79], v162 offset:3072
    v_mfma_f32_16x16x32_bf16 v[184:187], a[80:83], a[32:35], v[232:235]
    buffer_load_dwordx4 a[216:219], v2, s[24:27], s28 offen offset:2048 sc1
    v_mfma_f32_16x16x32_bf16 v[184:187], a[84:87], a[36:39], v[184:187]
    v_exp_f32 v220, v220
    v_mfma_f32_16x16x32_bf16 v[184:187], a[88:91], a[40:43], v[184:187]
    v_exp_f32 v221, v221
    v_mfma_f32_16x16x32_bf16 v[184:187], a[92:95], a[44:47], v[184:187]
    v_exp_f32 v222, v222
    v_mfma_f32_16x16x32_bf16 v[188:191], a[80:83], a[48:51], v[236:239]
    v_exp_f32 v223, v223
    v_mfma_f32_16x16x32_bf16 v[188:191], a[84:87], a[52:55], v[188:191]
    ds_read_b128 a[80:83], v162 offset:4096
    ds_read_b128 a[84:87], v162 offset:5120
    v_mfma_f32_16x16x32_bf16 v[188:191], a[88:91], a[56:59], v[188:191]
    v_cvt_pk_bf16_f32 v211, v218, v219
    v_cvt_pk_bf16_f32 v214, v220, v221
    v_cvt_pk_bf16_f32 v215, v222, v223
    s_waitcnt lgkmcnt(6)
    v_mfma_f32_16x16x32_bf16 v[188:191], a[92:95], a[60:63], v[188:191]
    ds_read_b128 a[88:91], v162 offset:6144
    ds_read_b128 a[92:95], v162 offset:7168
    v_mfma_f32_16x16x32_bf16 v[96:99], a[128:131], v[208:211], v[96:99]
    buffer_load_dwordx4 v3, s[20:23], s44 offen offset:0 sc1 lds
    v_mfma_f32_16x16x32_bf16 v[100:103], a[128:131], v[212:215], v[100:103]
    buffer_load_dwordx4 a[220:223], v2, s[24:27], s28 offen offset:3072 sc1
    v_mfma_f32_16x16x32_bf16 v[104:107], a[132:135], v[208:211], v[104:107]
    s_xor_b32 s28, s28, 28672
    v_exp_f32 v176, v176
    v_mfma_f32_16x16x32_bf16 v[108:111], a[132:135], v[212:215], v[108:111]
    ds_read_b128 a[128:131], v162 offset:24576
    ds_read_b128 a[132:135], v162 offset:25600
    v_mfma_f32_16x16x32_bf16 v[112:115], a[136:139], v[208:211], v[112:115]
    v_exp_f32 v177, v177
    v_mfma_f32_16x16x32_bf16 v[116:119], a[136:139], v[212:215], v[116:119]
    buffer_load_dwordx4 v3, s[20:23], s44 offen offset:1024 sc1 lds
    v_cvt_pk_bf16_f32 v176, v176, v177
    v_mfma_f32_16x16x32_bf16 v[120:123], a[140:143], v[208:211], v[120:123]
    v_exp_f32 v178, v178
    v_mfma_f32_16x16x32_bf16 v[124:127], a[140:143], v[212:215], v[124:127]
    ds_read_b128 a[136:139], v162 offset:26624
    ds_read_b128 a[140:143], v162 offset:27648
    v_mfma_f32_16x16x32_bf16 v[128:131], a[144:147], v[208:211], v[128:131]
    buffer_load_dwordx4 a[224:227], v2, s[24:27], s28 offen offset:0 sc1
    v_mfma_f32_16x16x32_bf16 v[132:135], a[144:147], v[212:215], v[132:135]
    v_exp_f32 v179, v179
    v_mfma_f32_16x16x32_bf16 v[136:139], a[148:151], v[208:211], v[136:139]
    v_exp_f32 v180, v180
    v_cvt_pk_bf16_f32 v177, v178, v179
    v_mfma_f32_16x16x32_bf16 v[140:143], a[148:151], v[212:215], v[140:143]
    ds_read_b128 a[144:147], v162 offset:28672
    ds_read_b128 a[148:151], v162 offset:29696
    v_mfma_f32_16x16x32_bf16 v[144:147], a[152:155], v[208:211], v[144:147]
    v_exp_f32 v181, v181
    v_mfma_f32_16x16x32_bf16 v[148:151], a[152:155], v[212:215], v[148:151]
    buffer_load_dwordx4 v3, s[20:23], s44 offen offset:2048 sc1 lds
    v_cvt_pk_bf16_f32 v180, v180, v181
    v_mfma_f32_16x16x32_bf16 v[152:155], a[156:159], v[208:211], v[152:155]
    v_exp_f32 v182, v182
    v_mfma_f32_16x16x32_bf16 v[156:159], a[156:159], v[212:215], v[156:159]
    ds_read_b128 a[152:155], v162 offset:30720
    ds_read_b128 a[156:159], v162 offset:31744
    v_smfmac_f32_16x16x64_bf16 a[100:103], a[116:119], v[208:215], v6
    s_waitcnt lgkmcnt(8)
    v_mfma_f32_16x16x32_bf16 v[208:211], a[64:67], a[32:35], v[232:235]
    buffer_load_dwordx4 a[228:231], v2, s[24:27], s28 offen offset:1024 sc1
    v_mfma_f32_16x16x32_bf16 v[208:211], a[68:71], a[36:39], v[208:211]
    v_exp_f32 v183, v183
    v_mfma_f32_16x16x32_bf16 v[208:211], a[72:75], a[40:43], v[208:211]
    v_exp_f32 v184, v184
    v_cvt_pk_bf16_f32 v181, v182, v183
    v_mfma_f32_16x16x32_bf16 v[208:211], a[76:79], a[44:47], v[208:211]
    buffer_load_dwordx4 v3, s[20:23], s44 offen offset:3072 sc1 lds
    s_add_u32 s44, s44, 16384
    v_mfma_f32_16x16x32_bf16 v[212:215], a[64:67], a[48:51], v[236:239]
    v_exp_f32 v185, v185
    v_mfma_f32_16x16x32_bf16 v[212:215], a[68:71], a[52:55], v[212:215]
    ds_read_b128 a[64:67], v162 offset:8192
    ds_read_b128 a[68:71], v162 offset:9216
    v_mfma_f32_16x16x32_bf16 v[212:215], a[72:75], a[56:59], v[212:215]
    v_exp_f32 v186, v186
    v_mfma_f32_16x16x32_bf16 v[212:215], a[76:79], a[60:63], v[212:215]
    ds_read_b128 a[72:75], v162 offset:10240
    ds_read_b128 a[76:79], v162 offset:11264
    v_mfma_f32_16x16x32_bf16 v[216:219], a[80:83], a[32:35], v[232:235]
    v_exp_f32 v187, v187
    v_mfma_f32_16x16x32_bf16 v[216:219], a[84:87], a[36:39], v[216:219]
    v_exp_f32 v188, v188
    v_mfma_f32_16x16x32_bf16 v[216:219], a[88:91], a[40:43], v[216:219]
    v_exp_f32 v189, v189
    v_mfma_f32_16x16x32_bf16 v[216:219], a[92:95], a[44:47], v[216:219]
    v_exp_f32 v190, v190
    v_mfma_f32_16x16x32_bf16 v[220:223], a[80:83], a[48:51], v[236:239]
    v_exp_f32 v191, v191
    v_mfma_f32_16x16x32_bf16 v[220:223], a[84:87], a[52:55], v[220:223]
    ds_read_b128 a[80:83], v162 offset:12288
    ds_read_b128 a[84:87], v162 offset:13312
    v_mfma_f32_16x16x32_bf16 v[220:223], a[88:91], a[56:59], v[220:223]
    v_cvt_pk_bf16_f32 v178, v184, v185
    v_cvt_pk_bf16_f32 v179, v186, v187
    v_cvt_pk_bf16_f32 v182, v188, v189
    v_cvt_pk_bf16_f32 v183, v190, v191
    s_waitcnt vmcnt(14) lgkmcnt(6)
    v_mfma_f32_16x16x32_bf16 v[220:223], a[92:95], a[60:63], v[220:223]
    ds_read_b128 a[88:91], v162 offset:14336
    ds_read_b128 a[92:95], v162 offset:15360
    v_mfma_f32_16x16x32_bf16 v[96:99], a[128:131], v[176:179], v[96:99]
    s_barrier
    s_mov_b32 m0, s91
    v_mfma_f32_16x16x32_bf16 v[100:103], a[128:131], v[180:183], v[100:103]
    v_exp_f32 v208, v208
    v_exp_f32 v209, v209
    v_mfma_f32_16x16x32_bf16 v[104:107], a[132:135], v[176:179], v[104:107]
    buffer_load_dwordx4 v2, s[20:23], s44 offen offset:0 sc1 lds
    v_cvt_pk_bf16_f32 v208, v208, v209
    v_mfma_f32_16x16x32_bf16 v[108:111], a[132:135], v[180:183], v[108:111]
    ds_read_b128 a[128:131], v163 offset:16384
    ds_read_b128 a[132:135], v163 offset:17408
    v_mfma_f32_16x16x32_bf16 v[112:115], a[136:139], v[176:179], v[112:115]
    buffer_load_dwordx4 a[232:235], v2, s[24:27], s28 offen offset:2048 sc1
    v_mfma_f32_16x16x32_bf16 v[116:119], a[136:139], v[180:183], v[116:119]
    v_exp_f32 v210, v210
    v_mfma_f32_16x16x32_bf16 v[120:123], a[140:143], v[176:179], v[120:123]
    v_exp_f32 v211, v211
    v_mfma_f32_16x16x32_bf16 v[124:127], a[140:143], v[180:183], v[124:127]
    ds_read_b128 a[136:139], v163 offset:18432
    ds_read_b128 a[140:143], v163 offset:19456
    v_cvt_pk_bf16_f32 v209, v210, v211
    v_mfma_f32_16x16x32_bf16 v[128:131], a[144:147], v[176:179], v[128:131]
    buffer_load_dwordx4 v2, s[20:23], s44 offen offset:1024 sc1 lds
    v_mfma_f32_16x16x32_bf16 v[132:135], a[144:147], v[180:183], v[132:135]
    v_exp_f32 v212, v212
    v_mfma_f32_16x16x32_bf16 v[136:139], a[148:151], v[176:179], v[136:139]
    v_exp_f32 v213, v213
    v_mfma_f32_16x16x32_bf16 v[140:143], a[148:151], v[180:183], v[140:143]
    ds_read_b128 a[144:147], v163 offset:20480
    ds_read_b128 a[148:151], v163 offset:21504
    v_cvt_pk_bf16_f32 v212, v212, v213
    v_mfma_f32_16x16x32_bf16 v[144:147], a[152:155], v[176:179], v[144:147]
    v_exp_f32 v214, v214
    v_mfma_f32_16x16x32_bf16 v[148:151], a[152:155], v[180:183], v[148:151]
    buffer_load_dwordx4 a[236:239], v2, s[24:27], s28 offen offset:3072 sc1
    v_mfma_f32_16x16x32_bf16 v[152:155], a[156:159], v[176:179], v[152:155]
    s_xor_b32 s28, s28, 4096
    v_exp_f32 v215, v215
    v_mfma_f32_16x16x32_bf16 v[156:159], a[156:159], v[180:183], v[156:159]
    ds_read_b128 a[152:155], v163 offset:22528
    ds_read_b128 a[156:159], v163 offset:23552
    v_cvt_pk_bf16_f32 v213, v214, v215
    v_smfmac_f32_16x16x64_bf16 a[100:103], a[116:119], v[176:183], v6
    s_waitcnt lgkmcnt(8)
    v_mfma_f32_16x16x32_bf16 v[176:179], a[64:67], a[32:35], v[232:235]
    buffer_load_dwordx4 v2, s[20:23], s44 offen offset:2048 sc1 lds
    v_mfma_f32_16x16x32_bf16 v[176:179], a[68:71], a[36:39], v[176:179]
    v_exp_f32 v216, v216
    v_mfma_f32_16x16x32_bf16 v[176:179], a[72:75], a[40:43], v[176:179]
    v_exp_f32 v217, v217
    v_mfma_f32_16x16x32_bf16 v[176:179], a[76:79], a[44:47], v[176:179]
    v_exp_f32 v218, v218
    v_cvt_pk_bf16_f32 v210, v216, v217
    v_mfma_f32_16x16x32_bf16 v[180:183], a[64:67], a[48:51], v[236:239]
    v_exp_f32 v219, v219
    v_mfma_f32_16x16x32_bf16 v[180:183], a[68:71], a[52:55], v[180:183]
    ds_read_b128 a[64:67], v163 offset:0
    ds_read_b128 a[68:71], v163 offset:1024
    v_mfma_f32_16x16x32_bf16 v[180:183], a[72:75], a[56:59], v[180:183]
    buffer_load_dwordx4 v2, s[20:23], s44 offen offset:3072 sc1 lds
    s_add_u32 m0, s91, 4096
    v_mfma_f32_16x16x32_bf16 v[180:183], a[76:79], a[60:63], v[180:183]
    ds_read_b128 a[72:75], v163 offset:2048
    ds_read_b128 a[76:79], v163 offset:3072
    v_mfma_f32_16x16x32_bf16 v[184:187], a[80:83], a[32:35], v[232:235]
    buffer_load_dwordx4 a[240:243], v2, s[24:27], s28 offen offset:0 sc1
    v_mfma_f32_16x16x32_bf16 v[184:187], a[84:87], a[36:39], v[184:187]
    v_exp_f32 v220, v220
    v_mfma_f32_16x16x32_bf16 v[184:187], a[88:91], a[40:43], v[184:187]
    v_exp_f32 v221, v221
    v_mfma_f32_16x16x32_bf16 v[184:187], a[92:95], a[44:47], v[184:187]
    v_exp_f32 v222, v222
    v_mfma_f32_16x16x32_bf16 v[188:191], a[80:83], a[48:51], v[236:239]
    v_exp_f32 v223, v223
    v_mfma_f32_16x16x32_bf16 v[188:191], a[84:87], a[52:55], v[188:191]
    ds_read_b128 a[80:83], v163 offset:4096
    ds_read_b128 a[84:87], v163 offset:5120
    v_mfma_f32_16x16x32_bf16 v[188:191], a[88:91], a[56:59], v[188:191]
    v_cvt_pk_bf16_f32 v211, v218, v219
    v_cvt_pk_bf16_f32 v214, v220, v221
    v_cvt_pk_bf16_f32 v215, v222, v223
    s_waitcnt lgkmcnt(6)
    v_mfma_f32_16x16x32_bf16 v[188:191], a[92:95], a[60:63], v[188:191]
    ds_read_b128 a[88:91], v163 offset:6144
    ds_read_b128 a[92:95], v163 offset:7168
    v_mfma_f32_16x16x32_bf16 v[96:99], a[128:131], v[208:211], v[96:99]
    buffer_load_dwordx4 v3, s[20:23], s44 offen offset:0 sc1 lds
    v_mfma_f32_16x16x32_bf16 v[100:103], a[128:131], v[212:215], v[100:103]
    buffer_load_dwordx4 a[244:247], v2, s[24:27], s28 offen offset:1024 sc1
    v_mfma_f32_16x16x32_bf16 v[104:107], a[132:135], v[208:211], v[104:107]
    v_exp_f32 v176, v176
    v_mfma_f32_16x16x32_bf16 v[108:111], a[132:135], v[212:215], v[108:111]
    ds_read_b128 a[128:131], v163 offset:24576
    ds_read_b128 a[132:135], v163 offset:25600
    v_mfma_f32_16x16x32_bf16 v[112:115], a[136:139], v[208:211], v[112:115]
    v_exp_f32 v177, v177
    v_mfma_f32_16x16x32_bf16 v[116:119], a[136:139], v[212:215], v[116:119]
    buffer_load_dwordx4 v3, s[20:23], s44 offen offset:1024 sc1 lds
    v_cvt_pk_bf16_f32 v176, v176, v177
    v_mfma_f32_16x16x32_bf16 v[120:123], a[140:143], v[208:211], v[120:123]
    v_exp_f32 v178, v178
    v_mfma_f32_16x16x32_bf16 v[124:127], a[140:143], v[212:215], v[124:127]
    ds_read_b128 a[136:139], v163 offset:26624
    ds_read_b128 a[140:143], v163 offset:27648
    v_mfma_f32_16x16x32_bf16 v[128:131], a[144:147], v[208:211], v[128:131]
    buffer_load_dwordx4 a[248:251], v2, s[24:27], s28 offen offset:2048 sc1
    v_mfma_f32_16x16x32_bf16 v[132:135], a[144:147], v[212:215], v[132:135]
    v_exp_f32 v179, v179
    v_mfma_f32_16x16x32_bf16 v[136:139], a[148:151], v[208:211], v[136:139]
    v_exp_f32 v180, v180
    v_cvt_pk_bf16_f32 v177, v178, v179
    v_mfma_f32_16x16x32_bf16 v[140:143], a[148:151], v[212:215], v[140:143]
    ds_read_b128 a[144:147], v163 offset:28672
    ds_read_b128 a[148:151], v163 offset:29696
    v_mfma_f32_16x16x32_bf16 v[144:147], a[152:155], v[208:211], v[144:147]
    v_exp_f32 v181, v181
    v_mfma_f32_16x16x32_bf16 v[148:151], a[152:155], v[212:215], v[148:151]
    buffer_load_dwordx4 v3, s[20:23], s44 offen offset:2048 sc1 lds
    v_cvt_pk_bf16_f32 v180, v180, v181
    v_mfma_f32_16x16x32_bf16 v[152:155], a[156:159], v[208:211], v[152:155]
    v_exp_f32 v182, v182
    v_mfma_f32_16x16x32_bf16 v[156:159], a[156:159], v[212:215], v[156:159]
    ds_read_b128 a[152:155], v163 offset:30720
    ds_read_b128 a[156:159], v163 offset:31744
    v_smfmac_f32_16x16x64_bf16 a[100:103], a[116:119], v[208:215], v6
    s_waitcnt lgkmcnt(8)
    v_mfma_f32_16x16x32_bf16 v[208:211], a[64:67], a[32:35], v[232:235]
    buffer_load_dwordx4 a[252:255], v2, s[24:27], s28 offen offset:3072 sc1
    v_mfma_f32_16x16x32_bf16 v[208:211], a[68:71], a[36:39], v[208:211]
    s_xor_b32 s28, s28, 12288
    v_exp_f32 v183, v183
    v_mfma_f32_16x16x32_bf16 v[208:211], a[72:75], a[40:43], v[208:211]
    v_exp_f32 v184, v184
    v_cvt_pk_bf16_f32 v181, v182, v183
    v_mfma_f32_16x16x32_bf16 v[208:211], a[76:79], a[44:47], v[208:211]
    buffer_load_dwordx4 v3, s[20:23], s44 offen offset:3072 sc1 lds
    s_add_u32 s44, s44, 16384
    v_mfma_f32_16x16x32_bf16 v[212:215], a[64:67], a[48:51], v[236:239]
    v_exp_f32 v185, v185
    v_mfma_f32_16x16x32_bf16 v[212:215], a[68:71], a[52:55], v[212:215]
    ds_read_b128 a[64:67], v163 offset:8192
    ds_read_b128 a[68:71], v163 offset:9216
    v_mfma_f32_16x16x32_bf16 v[212:215], a[72:75], a[56:59], v[212:215]
    v_exp_f32 v186, v186
    v_mfma_f32_16x16x32_bf16 v[212:215], a[76:79], a[60:63], v[212:215]
    ds_read_b128 a[72:75], v163 offset:10240
    ds_read_b128 a[76:79], v163 offset:11264
    v_mfma_f32_16x16x32_bf16 v[216:219], a[80:83], a[32:35], v[232:235]
    v_exp_f32 v187, v187
    v_mfma_f32_16x16x32_bf16 v[216:219], a[84:87], a[36:39], v[216:219]
    v_exp_f32 v188, v188
    v_mfma_f32_16x16x32_bf16 v[216:219], a[88:91], a[40:43], v[216:219]
    v_exp_f32 v189, v189
    v_mfma_f32_16x16x32_bf16 v[216:219], a[92:95], a[44:47], v[216:219]
    v_exp_f32 v190, v190
    v_mfma_f32_16x16x32_bf16 v[220:223], a[80:83], a[48:51], v[236:239]
    v_exp_f32 v191, v191
    v_mfma_f32_16x16x32_bf16 v[220:223], a[84:87], a[52:55], v[220:223]
    ds_read_b128 a[80:83], v163 offset:12288
    ds_read_b128 a[84:87], v163 offset:13312
    v_mfma_f32_16x16x32_bf16 v[220:223], a[88:91], a[56:59], v[220:223]
    v_cvt_pk_bf16_f32 v178, v184, v185
    v_cvt_pk_bf16_f32 v179, v186, v187
    v_cvt_pk_bf16_f32 v182, v188, v189
    v_cvt_pk_bf16_f32 v183, v190, v191
    s_waitcnt vmcnt(14) lgkmcnt(6)
    v_mfma_f32_16x16x32_bf16 v[220:223], a[92:95], a[60:63], v[220:223]
    ds_read_b128 a[88:91], v163 offset:14336
    ds_read_b128 a[92:95], v163 offset:15360
    s_mov_b32 m0, s88
L_SM:
    v_mfma_f32_16x16x32_bf16 v[96:99], a[128:131], v[176:179], v[96:99]
    s_barrier
    v_xor_b32 v10, m0, v15
    v_mfma_f32_16x16x32_bf16 v[100:103], a[128:131], v[180:183], v[100:103]
    ds_read_b128 a[128:131], v10 offset:16384
    buffer_load_dwordx4 v[32:35], v2, s[24:27], s28 offen offset:0 sc1
    v_mfma_f32_16x16x32_bf16 v[104:107], a[132:135], v[176:179], v[104:107]
    v_exp_f32 v208, v208
    v_mfma_f32_16x16x32_bf16 v[108:111], a[132:135], v[180:183], v[108:111]
    ds_read_b128 a[132:135], v10 offset:17408
    v_exp_f32 v209, v209
    v_mfma_f32_16x16x32_bf16 v[112:115], a[136:139], v[176:179], v[112:115]
    v_exp_f32 v210, v210
    v_cvt_pk_bf16_f32 v208, v208, v209
    v_mfma_f32_16x16x32_bf16 v[116:119], a[136:139], v[180:183], v[116:119]
    ds_read_b128 a[136:139], v10 offset:18432
    buffer_load_dwordx4 v[36:39], v2, s[24:27], s28 offen offset:1024 sc1
    v_mfma_f32_16x16x32_bf16 v[120:123], a[140:143], v[176:179], v[120:123]
    v_exp_f32 v211, v211
    v_mfma_f32_16x16x32_bf16 v[124:127], a[140:143], v[180:183], v[124:127]
    ds_read_b128 a[140:143], v10 offset:19456
    v_exp_f32 v212, v212
    v_mfma_f32_16x16x32_bf16 v[128:131], a[144:147], v[176:179], v[128:131]
    v_exp_f32 v213, v213
    v_cvt_pk_bf16_f32 v209, v210, v211
    v_mfma_f32_16x16x32_bf16 v[132:135], a[144:147], v[180:183], v[132:135]
    ds_read_b128 a[144:147], v10 offset:20480
    buffer_load_dwordx4 v[40:43], v2, s[24:27], s28 offen offset:2048 sc1
    v_mfma_f32_16x16x32_bf16 v[136:139], a[148:151], v[176:179], v[136:139]
    v_exp_f32 v214, v214
    v_cvt_pk_bf16_f32 v212, v212, v213
    v_mfma_f32_16x16x32_bf16 v[140:143], a[148:151], v[180:183], v[140:143]
    ds_read_b128 a[148:151], v10 offset:21504
    v_exp_f32 v215, v215
    v_mfma_f32_16x16x32_bf16 v[144:147], a[152:155], v[176:179], v[144:147]
    v_exp_f32 v216, v216
    v_mfma_f32_16x16x32_bf16 v[148:151], a[152:155], v[180:183], v[148:151]
    ds_read_b128 a[152:155], v10 offset:22528
    buffer_load_dwordx4 v[44:47], v2, s[24:27], s28 offen offset:3072 sc1
    v_mfma_f32_16x16x32_bf16 v[152:155], a[156:159], v[176:179], v[152:155]
    v_exp_f32 v217, v217
    v_mfma_f32_16x16x32_bf16 v[156:159], a[156:159], v[180:183], v[156:159]
    ds_read_b128 a[156:159], v10 offset:23552
    s_xor_b32 s28, s28, 4096
    v_smfmac_f32_16x16x64_bf16 a[100:103], a[116:119], v[176:183], v6
    s_waitcnt lgkmcnt(8)
    v_mfma_f32_16x16x32_bf16 v[176:179], a[64:67], a[32:35], v[240:243]
    buffer_load_dwordx4 v[48:51], v2, s[24:27], s28 offen offset:0 sc1
    v_mfma_f32_16x16x32_bf16 v[176:179], a[68:71], a[36:39], v[176:179]
    v_exp_f32 v218, v218
    v_mfma_f32_16x16x32_bf16 v[176:179], a[72:75], a[40:43], v[176:179]
    v_exp_f32 v219, v219
    v_mfma_f32_16x16x32_bf16 v[176:179], a[76:79], a[44:47], v[176:179]
    v_exp_f32 v220, v220
    v_mfma_f32_16x16x32_bf16 v[180:183], a[64:67], a[48:51], v[236:239]
    ds_read_b128 a[64:67], v10 offset:0
    buffer_load_dwordx4 v[52:55], v2, s[24:27], s28 offen offset:1024 sc1
    v_mfma_f32_16x16x32_bf16 v[180:183], a[68:71], a[52:55], v[180:183]
    ds_read_b128 a[68:71], v10 offset:1024
    v_cvt_pk_bf16_f32 v213, v214, v215
    v_mfma_f32_16x16x32_bf16 v[180:183], a[72:75], a[56:59], v[180:183]
    ds_read_b128 a[72:75], v10 offset:2048
    v_cvt_pk_bf16_f32 v210, v216, v217
    v_mfma_f32_16x16x32_bf16 v[180:183], a[76:79], a[60:63], v[180:183]
    ds_read_b128 a[76:79], v10 offset:3072
    v_cvt_pk_bf16_f32 v211, v218, v219
    v_mfma_f32_16x16x32_bf16 v[184:187], a[80:83], a[32:35], v[244:247]
    buffer_load_dwordx4 v[56:59], v2, s[24:27], s28 offen offset:2048 sc1
    v_mfma_f32_16x16x32_bf16 v[184:187], a[84:87], a[36:39], v[184:187]
    v_exp_f32 v221, v221
    v_mfma_f32_16x16x32_bf16 v[184:187], a[88:91], a[40:43], v[184:187]
    v_exp_f32 v222, v222
    v_mfma_f32_16x16x32_bf16 v[184:187], a[92:95], a[44:47], v[184:187]
    v_exp_f32 v223, v223
    v_mfma_f32_16x16x32_bf16 v[188:191], a[80:83], a[48:51], v[252:255]
    ds_read_b128 a[80:83], v10 offset:4096
    buffer_load_dwordx4 v[60:63], v2, s[24:27], s28 offen offset:3072 sc1
    v_mfma_f32_16x16x32_bf16 v[188:191], a[84:87], a[52:55], v[188:191]
    ds_read_b128 a[84:87], v10 offset:5120
    v_cvt_pk_bf16_f32 v214, v220, v221
    v_cvt_pk_bf16_f32 v215, v222, v223
    v_mfma_f32_16x16x32_bf16 v[188:191], a[88:91], a[56:59], v[188:191]
    ds_read_b128 a[88:91], v10 offset:6144
    s_xor_b32 s28, s28, 61440
    v_mfma_f32_16x16x32_bf16 v[188:191], a[92:95], a[60:63], v[188:191]
    ds_read_b128 a[92:95], v10 offset:7168
    s_waitcnt lgkmcnt(8)
    v_mfma_f32_16x16x32_bf16 v[96:99], a[128:131], v[208:211], v[96:99]
    buffer_load_dwordx4 v[64:67], v2, s[24:27], s28 offen offset:0 sc1
    v_mfma_f32_16x16x32_bf16 v[100:103], a[128:131], v[212:215], v[100:103]
    ds_read_b128 a[128:131], v10 offset:24576
    v_exp_f32 v176, v176
    v_mfma_f32_16x16x32_bf16 v[104:107], a[132:135], v[208:211], v[104:107]
    v_exp_f32 v177, v177
    v_mfma_f32_16x16x32_bf16 v[108:111], a[132:135], v[212:215], v[108:111]
    ds_read_b128 a[132:135], v10 offset:25600
    v_exp_f32 v178, v178
    v_mfma_f32_16x16x32_bf16 v[112:115], a[136:139], v[208:211], v[112:115]
    buffer_load_dwordx4 v[68:71], v2, s[24:27], s28 offen offset:1024 sc1
    v_mfma_f32_16x16x32_bf16 v[116:119], a[136:139], v[212:215], v[116:119]
    ds_read_b128 a[136:139], v10 offset:26624
    v_exp_f32 v179, v179
    v_mfma_f32_16x16x32_bf16 v[120:123], a[140:143], v[208:211], v[120:123]
    v_exp_f32 v180, v180
    v_mfma_f32_16x16x32_bf16 v[124:127], a[140:143], v[212:215], v[124:127]
    ds_read_b128 a[140:143], v10 offset:27648
    v_cvt_pk_bf16_f32 v176, v176, v177
    v_mfma_f32_16x16x32_bf16 v[128:131], a[144:147], v[208:211], v[128:131]
    buffer_load_dwordx4 v[72:75], v2, s[24:27], s28 offen offset:2048 sc1
    v_mfma_f32_16x16x32_bf16 v[132:135], a[144:147], v[212:215], v[132:135]
    ds_read_b128 a[144:147], v10 offset:28672
    v_cvt_pk_bf16_f32 v177, v178, v179
    v_mfma_f32_16x16x32_bf16 v[136:139], a[148:151], v[208:211], v[136:139]
    v_exp_f32 v181, v181
    v_mfma_f32_16x16x32_bf16 v[140:143], a[148:151], v[212:215], v[140:143]
    ds_read_b128 a[148:151], v10 offset:29696
    v_cvt_pk_bf16_f32 v180, v180, v181
    v_mfma_f32_16x16x32_bf16 v[144:147], a[152:155], v[208:211], v[144:147]
    buffer_load_dwordx4 v[76:79], v2, s[24:27], s28 offen offset:3072 sc1
    v_mfma_f32_16x16x32_bf16 v[148:151], a[152:155], v[212:215], v[148:151]
    ds_read_b128 a[152:155], v10 offset:30720
    s_add_u32 m0, m0, 32768
    v_mfma_f32_16x16x32_bf16 v[152:155], a[156:159], v[208:211], v[152:155]
    s_xor_b32 s28, s28, 4096
    s_and_b32 m0, m0, 0x1ffff
    v_mfma_f32_16x16x32_bf16 v[156:159], a[156:159], v[212:215], v[156:159]
    ds_read_b128 a[156:159], v10 offset:31744
    v_smfmac_f32_16x16x64_bf16 a[100:103], a[116:119], v[208:215], v6
    buffer_load_dwordx4 v[80:83], v2, s[24:27], s28 offen offset:0 sc1
    s_waitcnt lgkmcnt(8)
    v_mfma_f32_16x16x32_bf16 v[208:211], a[64:67], a[32:35], v[192:195]
    v_exp_f32 v182, v182
    v_mfma_f32_16x16x32_bf16 v[208:211], a[68:71], a[36:39], v[208:211]
    v_exp_f32 v183, v183
    v_mfma_f32_16x16x32_bf16 v[208:211], a[72:75], a[40:43], v[208:211]
    v_exp_f32 v184, v184
    v_cvt_pk_bf16_f32 v181, v182, v183
    v_mfma_f32_16x16x32_bf16 v[208:211], a[76:79], a[44:47], v[208:211]
    buffer_load_dwordx4 v[84:87], v2, s[24:27], s28 offen offset:1024 sc1
    v_mfma_f32_16x16x32_bf16 v[212:215], a[64:67], a[48:51], v[200:203]
    v_exp_f32 v185, v185
    v_mfma_f32_16x16x32_bf16 v[212:215], a[68:71], a[52:55], v[212:215]
    v_exp_f32 v186, v186
    v_mfma_f32_16x16x32_bf16 v[212:215], a[72:75], a[56:59], v[212:215]
    v_exp_f32 v187, v187
    v_mfma_f32_16x16x32_bf16 v[212:215], a[76:79], a[60:63], v[212:215]
    buffer_load_dwordx4 v[88:91], v2, s[24:27], s28 offen offset:2048 sc1
    v_mfma_f32_16x16x32_bf16 v[216:219], a[80:83], a[32:35], v[196:199]
    v_exp_f32 v188, v188
    v_mfma_f32_16x16x32_bf16 v[216:219], a[84:87], a[36:39], v[216:219]
    v_exp_f32 v189, v189
    v_mfma_f32_16x16x32_bf16 v[216:219], a[88:91], a[40:43], v[216:219]
    v_exp_f32 v190, v190
    v_mfma_f32_16x16x32_bf16 v[216:219], a[92:95], a[44:47], v[216:219]
    buffer_load_dwordx4 v[92:95], v2, s[24:27], s28 offen offset:3072 sc1
    v_mfma_f32_16x16x32_bf16 v[220:223], a[80:83], a[48:51], v[204:207]
    v_exp_f32 v191, v191
    v_mfma_f32_16x16x32_bf16 v[220:223], a[84:87], a[52:55], v[220:223]
    s_xor_b32 s28, s28, 12288
    v_cvt_pk_bf16_f32 v178, v184, v185
    v_mfma_f32_16x16x32_bf16 v[220:223], a[88:91], a[56:59], v[220:223]
    v_cvt_pk_bf16_f32 v179, v186, v187
    v_cvt_pk_bf16_f32 v182, v188, v189
    v_cvt_pk_bf16_f32 v183, v190, v191
    v_mfma_f32_16x16x32_bf16 v[220:223], a[92:95], a[60:63], v[220:223]
    s_waitcnt vmcnt(16) lgkmcnt(0)
    s_cmp_lg_u32 s46, 0
    s_cbranch_scc1 L_sg10
    buffer_atomic_add v8, v11, s[16:19], s83 offen
    s_mov_b32 s46, 1
L_sg10:
    buffer_load_dword v9, v7, s[16:19], s96 offen offset:0 sc1
    v_mfma_f32_16x16x32_bf16 v[96:99], a[128:131], v[176:179], v[96:99]
    s_barrier
    v_xor_b32 v10, m0, v15
    v_mfma_f32_16x16x32_bf16 v[100:103], a[128:131], v[180:183], v[100:103]
    ds_read_b128 a[128:131], v10 offset:16384
    v_exp_f32 v208, v208
    v_mfma_f32_16x16x32_bf16 v[104:107], a[132:135], v[176:179], v[104:107]
    v_exp_f32 v209, v209
    v_exp_f32 v210, v210
    v_mfma_f32_16x16x32_bf16 v[108:111], a[132:135], v[180:183], v[108:111]
    ds_read_b128 a[132:135], v10 offset:17408
    v_exp_f32 v211, v211
    v_mfma_f32_16x16x32_bf16 v[112:115], a[136:139], v[176:179], v[112:115]
    v_exp_f32 v212, v212
    v_exp_f32 v213, v213
    v_mfma_f32_16x16x32_bf16 v[116:119], a[136:139], v[180:183], v[116:119]
    ds_read_b128 a[136:139], v10 offset:18432
    v_exp_f32 v214, v214
    v_mfma_f32_16x16x32_bf16 v[120:123], a[140:143], v[176:179], v[120:123]
    v_exp_f32 v215, v215
    v_cvt_pk_bf16_f32 v208, v208, v209
    v_mfma_f32_16x16x32_bf16 v[124:127], a[140:143], v[180:183], v[124:127]
    ds_read_b128 a[140:143], v10 offset:19456
    v_exp_f32 v216, v216
    v_mfma_f32_16x16x32_bf16 v[128:131], a[144:147], v[176:179], v[128:131]
    v_exp_f32 v217, v217
    v_mfma_f32_16x16x32_bf16 v[132:135], a[144:147], v[180:183], v[132:135]
    ds_read_b128 a[144:147], v10 offset:20480
    v_exp_f32 v218, v218
    v_mfma_f32_16x16x32_bf16 v[136:139], a[148:151], v[176:179], v[136:139]
    v_exp_f32 v219, v219
    v_mfma_f32_16x16x32_bf16 v[140:143], a[148:151], v[180:183], v[140:143]
    ds_read_b128 a[148:151], v10 offset:21504
    v_exp_f32 v220, v220
    v_mfma_f32_16x16x32_bf16 v[144:147], a[152:155], v[176:179], v[144:147]
    v_exp_f32 v221, v221
    v_mfma_f32_16x16x32_bf16 v[148:151], a[152:155], v[180:183], v[148:151]
    ds_read_b128 a[152:155], v10 offset:22528
    v_exp_f32 v222, v222
    v_mfma_f32_16x16x32_bf16 v[152:155], a[156:159], v[176:179], v[152:155]
    v_exp_f32 v223, v223
    v_mfma_f32_16x16x32_bf16 v[156:159], a[156:159], v[180:183], v[156:159]
    ds_read_b128 a[156:159], v10 offset:23552
    v_cvt_pk_bf16_f32 v209, v210, v211
    v_cvt_pk_bf16_f32 v212, v212, v213
    v_cvt_pk_bf16_f32 v213, v214, v215
    v_cvt_pk_bf16_f32 v210, v216, v217
    v_cvt_pk_bf16_f32 v211, v218, v219
    v_cvt_pk_bf16_f32 v214, v220, v221
    v_cvt_pk_bf16_f32 v215, v222, v223
    v_smfmac_f32_16x16x64_bf16 a[100:103], a[116:119], v[176:183], v6
    s_nop 0
    v_smfmac_f32_16x16x64_bf16 a[100:103], a[116:119], v[208:215], v6
    s_waitcnt lgkmcnt(4)
    v_mfma_f32_16x16x32_bf16 v[96:99], a[128:131], v[208:211], v[96:99]
    v_mfma_f32_16x16x32_bf16 v[100:103], a[128:131], v[212:215], v[100:103]
    v_mfma_f32_16x16x32_bf16 v[104:107], a[132:135], v[208:211], v[104:107]
    v_mfma_f32_16x16x32_bf16 v[108:111], a[132:135], v[212:215], v[108:111]
    v_mfma_f32_16x16x32_bf16 v[112:115], a[136:139], v[208:211], v[112:115]
    v_mfma_f32_16x16x32_bf16 v[116:119], a[136:139], v[212:215], v[116:119]
    s_nop 4
    v_accvgpr_read_b32 v16, a100
    v_accvgpr_read_b32 v18, a101
    v_mfma_f32_16x16x32_bf16 v[120:123], a[140:143], v[208:211], v[120:123]
    v_accvgpr_read_b32 v17, a102
    v_accvgpr_read_b32 v19, a103
    v_mfma_f32_16x16x32_bf16 v[124:127], a[140:143], v[212:215], v[124:127]
    v_add_f32 v16, v16, v18
    s_waitcnt lgkmcnt(0)
    v_mfma_f32_16x16x32_bf16 v[128:131], a[144:147], v[208:211], v[128:131]
    v_add_f32 v17, v17, v19
    v_add_f32 v5, v16, v17
    v_mfma_f32_16x16x32_bf16 v[132:135], a[144:147], v[212:215], v[132:135]
    v_cmp_nlt_f32 vcc, v5, v13
    v_mfma_f32_16x16x32_bf16 v[136:139], a[148:151], v[208:211], v[136:139]
    v_rcp_f32 v16, v16
    v_mfma_f32_16x16x32_bf16 v[140:143], a[148:151], v[212:215], v[140:143]
    v_rcp_f32 v17, v17
    v_mfma_f32_16x16x32_bf16 v[144:147], a[152:155], v[208:211], v[144:147]
    v_mfma_f32_16x16x32_bf16 v[148:151], a[152:155], v[212:215], v[148:151]
    v_mfma_f32_16x16x32_bf16 v[152:155], a[156:159], v[208:211], v[152:155]
    v_mfma_f32_16x16x32_bf16 v[156:159], a[156:159], v[212:215], v[156:159]
    s_waitcnt vmcnt(0)
    s_load_dwordx2 s[56:57], s[0:1], 0
    s_load_dwordx4 s[60:63], s[0:1], 80
    s_load_dwordx2 s[64:65], s[0:1], 64
    s_lshr_b32 s42, s3, 1
    s_cmp_lg_u64 vcc, 0
    s_cselect_b32 s6, 2, 0
    s_or_b32 s47, s47, s6
    s_add_u32 s9, s49, 0
    v_pk_mul_f32 v[96:97], v[96:97], v[16:17] op_sel_hi:[1,0]
    v_pk_mul_f32 v[98:99], v[98:99], v[16:17] op_sel_hi:[1,0]
    v_pk_mul_f32 v[104:105], v[104:105], v[16:17] op_sel_hi:[1,0]
    v_pk_mul_f32 v[106:107], v[106:107], v[16:17] op_sel_hi:[1,0]
    v_cvt_pk_bf16_f32 v20, v96, v97
    v_cvt_pk_bf16_f32 v21, v98, v99
    v_cvt_pk_bf16_f32 v22, v104, v105
    v_cvt_pk_bf16_f32 v23, v106, v107
    buffer_store_dwordx4 v[20:23], v2, s[52:55], s9 offen offset:0 sc1
    s_bfe_u32 s33, s2, 0x20001
    s_lshr_b32 s31, s2, 5
    s_lshl_b32 s31, s31, 1
    s_and_b32 s6, s2, 1
    s_add_u32 s31, s31, s6
    s_lshl_b32 s38, s31, 11
    v_pk_mul_f32 v[100:101], v[100:101], v[16:17] op_sel:[0,1]
    v_pk_mul_f32 v[102:103], v[102:103], v[16:17] op_sel:[0,1]
    v_pk_mul_f32 v[108:109], v[108:109], v[16:17] op_sel:[0,1]
    v_pk_mul_f32 v[110:111], v[110:111], v[16:17] op_sel:[0,1]
    v_cvt_pk_bf16_f32 v24, v100, v101
    v_cvt_pk_bf16_f32 v25, v102, v103
    v_cvt_pk_bf16_f32 v26, v108, v109
    v_cvt_pk_bf16_f32 v27, v110, v111
    buffer_store_dwordx4 v[24:27], v2, s[52:55], s9 offen offset:1024 sc1
    s_and_b32 s34, s5, 3
    s_lshl_b32 s40, s34, 7
    s_add_u32 s40, s40, s38
    s_lshl_b32 s36, s33, 9
    s_add_u32 s36, s36, s40
    s_add_u32 s68, s14, 35651584
    s_addc_u32 s69, s15, 0
    s_add_u32 s9, s49, 4096
    v_pk_mul_f32 v[112:113], v[112:113], v[16:17] op_sel_hi:[1,0]
    v_pk_mul_f32 v[114:115], v[114:115], v[16:17] op_sel_hi:[1,0]
    v_pk_mul_f32 v[120:121], v[120:121], v[16:17] op_sel_hi:[1,0]
    v_pk_mul_f32 v[122:123], v[122:123], v[16:17] op_sel_hi:[1,0]
    v_cvt_pk_bf16_f32 v28, v112, v113
    v_cvt_pk_bf16_f32 v29, v114, v115
    v_cvt_pk_bf16_f32 v30, v120, v121
    v_cvt_pk_bf16_f32 v31, v122, v123
    buffer_store_dwordx4 v[28:31], v2, s[52:55], s9 offen offset:0 sc1
    s_mov_b32 s70, 16777216
    s_mov_b32 s71, 0x20000
    s_lshl_b32 s35, s31, 19
    s_lshl_b32 s6, s33, 17
    s_add_u32 s35, s35, s6
    s_add_u32 s35, s35, s10
    v_pk_mul_f32 v[116:117], v[116:117], v[16:17] op_sel:[0,1]
    v_pk_mul_f32 v[118:119], v[118:119], v[16:17] op_sel:[0,1]
    v_pk_mul_f32 v[124:125], v[124:125], v[16:17] op_sel:[0,1]
    v_pk_mul_f32 v[126:127], v[126:127], v[16:17] op_sel:[0,1]
    v_cvt_pk_bf16_f32 v20, v116, v117
    v_cvt_pk_bf16_f32 v21, v118, v119
    v_cvt_pk_bf16_f32 v22, v124, v125
    v_cvt_pk_bf16_f32 v23, v126, v127
    buffer_store_dwordx4 v[20:23], v2, s[52:55], s9 offen offset:1024 sc1
    s_and_b32 s6, s5, 0
    s_lshl_b32 s6, s6, 15
    s_add_u32 s35, s35, s6
    s_xor_b32 s6, s33, 0
    s_lshl_b32 s6, s6, 10
    v_add_u32 v172, s6, v2
    s_add_u32 s9, s49, 8192
    v_pk_mul_f32 v[128:129], v[128:129], v[16:17] op_sel_hi:[1,0]
    v_pk_mul_f32 v[130:131], v[130:131], v[16:17] op_sel_hi:[1,0]
    v_pk_mul_f32 v[136:137], v[136:137], v[16:17] op_sel_hi:[1,0]
    v_pk_mul_f32 v[138:139], v[138:139], v[16:17] op_sel_hi:[1,0]
    v_cvt_pk_bf16_f32 v24, v128, v129
    v_cvt_pk_bf16_f32 v25, v130, v131
    v_cvt_pk_bf16_f32 v26, v136, v137
    v_cvt_pk_bf16_f32 v27, v138, v139
    buffer_store_dwordx4 v[24:27], v2, s[52:55], s9 offen offset:0 sc1
    v_add_u32 v173, 65536, v172
    v_add_u32 v174, 131072, v172
    s_xor_b32 s6, s33, 1
    s_lshl_b32 s6, s6, 10
    v_add_u32 v175, s6, v2
    v_add_u32 v176, 65536, v175
    v_pk_mul_f32 v[132:133], v[132:133], v[16:17] op_sel:[0,1]
    v_pk_mul_f32 v[134:135], v[134:135], v[16:17] op_sel:[0,1]
    v_pk_mul_f32 v[140:141], v[140:141], v[16:17] op_sel:[0,1]
    v_pk_mul_f32 v[142:143], v[142:143], v[16:17] op_sel:[0,1]
    v_cvt_pk_bf16_f32 v28, v132, v133
    v_cvt_pk_bf16_f32 v29, v134, v135
    v_cvt_pk_bf16_f32 v30, v140, v141
    v_cvt_pk_bf16_f32 v31, v142, v143
    buffer_store_dwordx4 v[28:31], v2, s[52:55], s9 offen offset:1024 sc1
    v_add_u32 v177, 131072, v175
    s_xor_b32 s6, s33, 2
    s_lshl_b32 s6, s6, 10
    v_add_u32 v178, s6, v2
    v_add_u32 v179, 65536, v178
    v_add_u32 v180, 131072, v178
    s_add_u32 s9, s49, 12288
    v_pk_mul_f32 v[144:145], v[144:145], v[16:17] op_sel_hi:[1,0]
    v_pk_mul_f32 v[146:147], v[146:147], v[16:17] op_sel_hi:[1,0]
    v_pk_mul_f32 v[152:153], v[152:153], v[16:17] op_sel_hi:[1,0]
    v_pk_mul_f32 v[154:155], v[154:155], v[16:17] op_sel_hi:[1,0]
    v_cvt_pk_bf16_f32 v20, v144, v145
    v_cvt_pk_bf16_f32 v21, v146, v147
    v_cvt_pk_bf16_f32 v22, v152, v153
    v_cvt_pk_bf16_f32 v23, v154, v155
    buffer_store_dwordx4 v[20:23], v2, s[52:55], s9 offen offset:0 sc1
    s_xor_b32 s6, s33, 3
    s_lshl_b32 s6, s6, 10
    v_add_u32 v181, s6, v2
    v_add_u32 v182, 65536, v181
    v_add_u32 v183, 131072, v181
    v_pk_mul_f32 v[148:149], v[148:149], v[16:17] op_sel:[0,1]
    v_pk_mul_f32 v[150:151], v[150:151], v[16:17] op_sel:[0,1]
    v_pk_mul_f32 v[156:157], v[156:157], v[16:17] op_sel:[0,1]
    v_pk_mul_f32 v[158:159], v[158:159], v[16:17] op_sel:[0,1]
    v_cvt_pk_bf16_f32 v24, v148, v149
    v_cvt_pk_bf16_f32 v25, v150, v151
    v_cvt_pk_bf16_f32 v26, v156, v157
    v_cvt_pk_bf16_f32 v27, v158, v159
    buffer_store_dwordx4 v[24:27], v2, s[52:55], s9 offen offset:1024 sc1
    s_cmp_ge_u32 s3, 2
    s_cbranch_scc1 L_nb
    s_barrier
L_nb:
    s_cmp_lg_u32 s47, 0
    s_cbranch_scc1 L_fallback
L_fbret:
    s_cmp_lg_u32 s42, 0
    s_cbranch_scc1 L_na0
    s_mov_b32 s41, 16
    s_mov_b32 s11, 200000
L_splp2a:
    v_readfirstlane_b32 s9, v9
    s_nop 0
    s_cmp_ge_u32 s9, s41
    s_cbranch_scc1 L_backp2a
    buffer_load_dword v9, v7, s[16:19], s36 offen offset:0 sc1
    s_sub_u32 s11, s11, 1
    s_waitcnt vmcnt(0)
    s_cbranch_scc0 L_splp2a
L_backp2a:
    s_add_u32 s7, s35, s10
    s_lshl_b32 s8, s10, 1
    s_add_u32 m0, s8, 131072
    s_nop 0
    buffer_load_dwordx4 v2, s[68:71], s7 offen offset:0 sc1 lds
    buffer_load_dwordx4 v2, s[68:71], s7 offen offset:1024 sc1 lds
    buffer_load_dwordx4 v2, s[68:71], s7 offen offset:2048 sc1 lds
    buffer_load_dwordx4 v2, s[68:71], s7 offen offset:3072 sc1 lds
    s_add_u32 m0, s8, 135168
    s_nop 0
    buffer_load_dwordx4 v3, s[68:71], s7 offen offset:0 sc1 lds
    buffer_load_dwordx4 v3, s[68:71], s7 offen offset:1024 sc1 lds
    buffer_load_dwordx4 v3, s[68:71], s7 offen offset:2048 sc1 lds
    buffer_load_dwordx4 v3, s[68:71], s7 offen offset:3072 sc1 lds
    s_add_u32 m0, s8, 139264
    s_add_u32 s7, s7, 8192
    buffer_load_dwordx4 v2, s[68:71], s7 offen offset:0 sc1 lds
    buffer_load_dwordx4 v2, s[68:71], s7 offen offset:1024 sc1 lds
    buffer_load_dwordx4 v2, s[68:71], s7 offen offset:2048 sc1 lds
    buffer_load_dwordx4 v2, s[68:71], s7 offen offset:3072 sc1 lds
    s_add_u32 m0, s8, 143360
    s_nop 0
    buffer_load_dwordx4 v3, s[68:71], s7 offen offset:0 sc1 lds
    buffer_load_dwordx4 v3, s[68:71], s7 offen offset:1024 sc1 lds
    buffer_load_dwordx4 v3, s[68:71], s7 offen offset:2048 sc1 lds
    buffer_load_dwordx4 v3, s[68:71], s7 offen offset:3072 sc1 lds
L_na0:
    s_xor_b32 s35, s35, 32768
    s_cmp_ge_u32 s3, 2
    s_cbranch_scc1 L_na1
    s_waitcnt vmcnt(0)
L_na1:
    s_waitcnt lgkmcnt(0)
    s_barrier
    ds_read_b128 a[96:99], v174 offset:0
    ds_read_b128 a[100:103], v174 offset:4096
    ds_read_b128 a[104:107], v174 offset:8192
    ds_read_b128 a[108:111], v174 offset:12288
    ds_read_b128 a[112:115], v174 offset:16384
    ds_read_b128 a[116:119], v174 offset:20480
    ds_read_b128 a[120:123], v174 offset:24576
    ds_read_b128 a[124:127], v174 offset:28672
    s_waitcnt lgkmcnt(4)
    v_mfma_f32_16x16x32_bf16 v[96:99], a[160:163], a[96:99], 0
    ds_read_b128 a[128:131], v177 offset:0
    s_add_u32 m0, s10, 0
    v_mfma_f32_16x16x32_bf16 v[96:99], a[168:171], a[100:103], v[96:99]
    buffer_load_dwordx4 v2, s[68:71], s35 offen offset:0 sc1 lds
    v_mfma_f32_16x16x32_bf16 v[96:99], a[176:179], a[104:107], v[96:99]
    ds_read_b128 a[132:135], v177 offset:4096
    s_cmp_eq_u32 s3, 0
    s_cselect_b32 s42, -1, 0
    s_cselect_b32 s6, 0, 0x80000000
    v_mfma_f32_16x16x32_bf16 v[96:99], a[184:187], a[108:111], v[96:99]
    buffer_load_dwordx4 v2, s[68:71], s35 offen offset:1024 sc1 lds
    v_mfma_f32_16x16x32_bf16 v[100:103], a[164:167], a[96:99], 0
    ds_read_b128 a[136:139], v177 offset:8192
    v_or_b32 v14, s6, v7
    v_mfma_f32_16x16x32_bf16 v[100:103], a[172:175], a[100:103], v[100:103]
    v_and_b32 v4, 15, v1
    v_lshl_or_b32 v4, v4, 7, s6
    v_mfma_f32_16x16x32_bf16 v[100:103], a[180:183], a[104:107], v[100:103]
    ds_read_b128 a[140:143], v177 offset:12288
    v_and_b32 v5, 48, v1
    v_mfma_f32_16x16x32_bf16 v[100:103], a[188:191], a[108:111], v[100:103]
    v_lshl_or_b32 v7, v5, 25, v4
    v_and_b32 v5, 60, v1
    s_waitcnt lgkmcnt(4)
    v_mfma_f32_16x16x32_bf16 v[96:99], a[192:195], a[112:115], v[96:99]
    ds_read_b128 a[96:99], v177 offset:16384
    v_lshl_or_b32 v13, v5, 25, v4
    v_mfma_f32_16x16x32_bf16 v[96:99], a[200:203], a[116:119], v[96:99]
    buffer_load_dwordx4 v2, s[68:71], s35 offen offset:2048 sc1 lds
    v_mfma_f32_16x16x32_bf16 v[96:99], a[208:211], a[120:123], v[96:99]
    ds_read_b128 a[100:103], v177 offset:20480
    v_and_b32 v4, 3, v1
    v_mfma_f32_16x16x32_bf16 v[96:99], a[216:219], a[124:127], v[96:99]
    buffer_load_dwordx4 v2, s[68:71], s35 offen offset:3072 sc1 lds
    v_mfma_f32_16x16x32_bf16 v[100:103], a[196:199], a[112:115], v[100:103]
    ds_read_b128 a[104:107], v177 offset:24576
    v_lshl_or_b32 v4, v4, 9, s6
    v_mfma_f32_16x16x32_bf16 v[100:103], a[204:207], a[116:119], v[100:103]
    v_lshl_or_b32 v15, v5, 25, v4
    s_lshr_b32 s6, s4, 3
    v_mfma_f32_16x16x32_bf16 v[100:103], a[212:215], a[120:123], v[100:103]
    ds_read_b128 a[108:111], v177 offset:28672
    s_lshl_b32 s6, s6, 9
    v_mfma_f32_16x16x32_bf16 v[100:103], a[220:223], a[124:127], v[100:103]
    s_lshl_b32 s29, s5, 12
    s_sub_u32 s29, 28672, s29
    s_waitcnt lgkmcnt(4)
    v_mfma_f32_16x16x32_bf16 v[104:107], a[160:163], a[128:131], 0
    ds_read_b128 a[112:115], v180 offset:0
    s_add_u32 m0, s10, 4096
    v_mfma_f32_16x16x32_bf16 v[104:107], a[168:171], a[132:135], v[104:107]
    buffer_load_dwordx4 v3, s[68:71], s35 offen offset:0 sc1 lds
    v_mfma_f32_16x16x32_bf16 v[104:107], a[176:179], a[136:139], v[104:107]
    ds_read_b128 a[116:119], v180 offset:4096
    s_add_u32 s29, s29, s6
    v_mfma_f32_16x16x32_bf16 v[104:107], a[184:187], a[140:143], v[104:107]
    buffer_load_dwordx4 v3, s[68:71], s35 offen offset:1024 sc1 lds
    v_mfma_f32_16x16x32_bf16 v[108:111], a[164:167], a[128:131], 0
    ds_read_b128 a[120:123], v180 offset:8192
    s_bfe_u32 s30, s2, 0x40003
    v_mfma_f32_16x16x32_bf16 v[108:111], a[172:175], a[132:135], v[108:111]
    s_lshr_b32 s6, s2, 7
    s_lshl_b32 s6, s6, 3
    v_mfma_f32_16x16x32_bf16 v[108:111], a[180:183], a[136:139], v[108:111]
    ds_read_b128 a[124:127], v180 offset:12288
    s_and_b32 s32, s2, 7
    v_mfma_f32_16x16x32_bf16 v[108:111], a[188:191], a[140:143], v[108:111]
    s_add_u32 s32, s32, s6
    s_lshl_b32 s39, s32, 11
    s_waitcnt lgkmcnt(4)
    v_mfma_f32_16x16x32_bf16 v[104:107], a[192:195], a[96:99], v[104:107]
    ds_read_b128 a[128:131], v180 offset:16384
    s_lshl_b32 s37, s30, 7
    v_mfma_f32_16x16x32_bf16 v[104:107], a[200:203], a[100:103], v[104:107]
    buffer_load_dwordx4 v3, s[68:71], s35 offen offset:2048 sc1 lds
    v_mfma_f32_16x16x32_bf16 v[104:107], a[208:211], a[104:107], v[104:107]
    ds_read_b128 a[132:135], v180 offset:20480
    s_add_u32 s37, s37, s39
    v_mfma_f32_16x16x32_bf16 v[104:107], a[216:219], a[108:111], v[104:107]
    buffer_load_dwordx4 v3, s[68:71], s35 offen offset:3072 sc1 lds
    v_mfma_f32_16x16x32_bf16 v[108:111], a[196:199], a[96:99], v[108:111]
    ds_read_b128 a[136:139], v180 offset:24576
    s_lshl_b32 s6, s31, 2
    v_mfma_f32_16x16x32_bf16 v[108:111], a[204:207], a[100:103], v[108:111]
    s_add_u32 s6, s6, s34
    s_mul_i32 s6, s6, 98304
    v_mfma_f32_16x16x32_bf16 v[108:111], a[212:215], a[104:107], v[108:111]
    ds_read_b128 a[140:143], v180 offset:28672
    s_add_u32 s6, s6, 75497472
    v_mfma_f32_16x16x32_bf16 v[108:111], a[220:223], a[108:111], v[108:111]
    s_add_u32 s96, s14, s6
    s_addc_u32 s97, s15, 0
    s_mov_b32 s98, 98304
    s_waitcnt lgkmcnt(4)
    v_mfma_f32_16x16x32_bf16 v[112:115], a[160:163], a[112:115], 0
    ds_read_b128 a[96:99], v183 offset:0
    s_xor_b32 s35, s35, 98304
    s_add_u32 m0, s10, 32768
    v_mfma_f32_16x16x32_bf16 v[112:115], a[168:171], a[116:119], v[112:115]
    buffer_load_dwordx4 v2, s[68:71], s35 offen offset:0 sc1 lds
    v_mfma_f32_16x16x32_bf16 v[112:115], a[176:179], a[120:123], v[112:115]
    ds_read_b128 a[100:103], v183 offset:4096
    s_mov_b32 s99, 0x20000
    v_mfma_f32_16x16x32_bf16 v[112:115], a[184:187], a[124:127], v[112:115]
    buffer_load_dwordx4 v2, s[68:71], s35 offen offset:1024 sc1 lds
    v_mfma_f32_16x16x32_bf16 v[116:119], a[164:167], a[112:115], 0
    ds_read_b128 a[104:107], v183 offset:8192
    s_lshl_b32 s8, s3, 10
    v_mfma_f32_16x16x32_bf16 v[116:119], a[172:175], a[116:119], v[116:119]
    s_xor_b32 s6, s33, 1
    s_mul_i32 s6, s6, 12288
    v_mfma_f32_16x16x32_bf16 v[116:119], a[180:183], a[120:123], v[116:119]
    ds_read_b128 a[108:111], v183 offset:12288
    s_add_u32 s6, s6, s8
    v_mfma_f32_16x16x32_bf16 v[116:119], a[188:191], a[124:127], v[116:119]
    s_add_u32 s53, s6, 0
    s_xor_b32 s6, s33, 2
    s_waitcnt lgkmcnt(4)
    v_mfma_f32_16x16x32_bf16 v[112:115], a[192:195], a[128:131], v[112:115]
    ds_read_b128 a[112:115], v183 offset:16384
    s_mul_i32 s6, s6, 12288
    v_mfma_f32_16x16x32_bf16 v[112:115], a[200:203], a[132:135], v[112:115]
    buffer_load_dwordx4 v2, s[68:71], s35 offen offset:2048 sc1 lds
    v_mfma_f32_16x16x32_bf16 v[112:115], a[208:211], a[136:139], v[112:115]
    ds_read_b128 a[116:119], v183 offset:20480
    s_add_u32 s6, s6, s8
    v_mfma_f32_16x16x32_bf16 v[112:115], a[216:219], a[140:143], v[112:115]
    buffer_load_dwordx4 v2, s[68:71], s35 offen offset:3072 sc1 lds
    v_mfma_f32_16x16x32_bf16 v[116:119], a[196:199], a[128:131], v[116:119]
    ds_read_b128 a[120:123], v183 offset:24576
    s_add_u32 s54, s6, 4096
    v_mfma_f32_16x16x32_bf16 v[116:119], a[204:207], a[132:135], v[116:119]
    s_xor_b32 s6, s33, 3
    s_mul_i32 s6, s6, 12288
    v_mfma_f32_16x16x32_bf16 v[116:119], a[212:215], a[136:139], v[116:119]
    ds_read_b128 a[124:127], v183 offset:28672
    s_add_u32 s6, s6, s8
    v_mfma_f32_16x16x32_bf16 v[116:119], a[220:223], a[140:143], v[116:119]
    s_add_u32 s55, s6, 8192
    s_mul_i32 s47, s33, 12288
    s_waitcnt vmcnt(4) lgkmcnt(4)
    s_barrier
    s_cmp_lg_u32 s3, 0
    s_cbranch_scc1 L_sg12
    buffer_atomic_add v8, v13, s[16:19], s29 offen offset:28
    buffer_atomic_add v8, v13, s[16:19], s29 offen offset:2076
L_sg12:
    v_mfma_f32_16x16x32_bf16 v[120:123], a[160:163], a[96:99], 0
    ds_read_b128 a[128:131], v172 offset:0
    s_add_u32 m0, s10, 36864
    v_mfma_f32_16x16x32_bf16 v[120:123], a[168:171], a[100:103], v[120:123]
    buffer_load_dwordx4 v3, s[68:71], s35 offen offset:0 sc1 lds
    v_mfma_f32_16x16x32_bf16 v[120:123], a[176:179], a[104:107], v[120:123]
    ds_read_b128 a[132:135], v172 offset:4096
    s_add_u32 s47, s47, s8
    v_mfma_f32_16x16x32_bf16 v[120:123], a[184:187], a[108:111], v[120:123]
    buffer_load_dwordx4 v3, s[68:71], s35 offen offset:1024 sc1 lds
    v_mfma_f32_16x16x32_bf16 v[124:127], a[164:167], a[96:99], 0
    ds_read_b128 a[136:139], v172 offset:8192
    s_lshl_b32 s34, s34, 2
    v_mfma_f32_16x16x32_bf16 v[124:127], a[172:175], a[100:103], v[124:127]
    s_add_u32 s34, s34, s3
    s_lshl_b32 s8, s31, 2
    v_mfma_f32_16x16x32_bf16 v[124:127], a[180:183], a[104:107], v[124:127]
    ds_read_b128 a[140:143], v172 offset:12288
    s_add_u32 s8, s8, s33
    v_mfma_f32_16x16x32_bf16 v[124:127], a[188:191], a[108:111], v[124:127]
    s_lshl_b32 s44, s8, 14
    s_lshl_b32 s6, s34, 6
    s_waitcnt lgkmcnt(4)
    v_mfma_f32_16x16x32_bf16 v[120:123], a[192:195], a[112:115], v[120:123]
    ds_read_b128 a[96:99], v172 offset:16384
    s_add_u32 s45, s44, s6
    v_mfma_f32_16x16x32_bf16 v[120:123], a[200:203], a[116:119], v[120:123]
    buffer_load_dwordx4 v3, s[68:71], s35 offen offset:2048 sc1 lds
    v_mfma_f32_16x16x32_bf16 v[120:123], a[208:211], a[120:123], v[120:123]
    ds_read_b128 a[100:103], v172 offset:20480
    s_lshl_b32 s6, s34, 10
    v_mfma_f32_16x16x32_bf16 v[120:123], a[216:219], a[124:127], v[120:123]
    buffer_load_dwordx4 v3, s[68:71], s35 offen offset:3072 sc1 lds
    v_mfma_f32_16x16x32_bf16 v[124:127], a[196:199], a[112:115], v[124:127]
    ds_read_b128 a[104:107], v172 offset:24576
    s_add_u32 s44, s44, s6
    v_mfma_f32_16x16x32_bf16 v[124:127], a[204:207], a[116:119], v[124:127]
    s_lshl_b32 s46, s8, 11
    s_lshl_b32 s6, s34, 7
    v_mfma_f32_16x16x32_bf16 v[124:127], a[212:215], a[120:123], v[124:127]
    ds_read_b128 a[108:111], v172 offset:28672
    s_add_u32 s46, s46, s6
    v_mfma_f32_16x16x32_bf16 v[124:127], a[220:223], a[124:127], v[124:127]
    v_and_b32 v4, 15, v1
    v_lshrrev_b32 v5, 4, v1
    s_waitcnt lgkmcnt(4)
    v_mfma_f32_16x16x32_bf16 v[96:99], a[224:227], a[128:131], v[96:99]
    ds_read_b128 a[112:115], v175 offset:0
    s_xor_b32 s35, s35, 32768
    v_mfma_f32_16x16x32_bf16 v[96:99], a[232:235], a[132:135], v[96:99]
    buffer_load_dwordx4 a[0:3], v2, s[24:27], s28 offen offset:0 sc1
    v_mfma_f32_16x16x32_bf16 v[96:99], a[240:243], a[136:139], v[96:99]
    ds_read_b128 a[116:119], v175 offset:4096
    v_lshlrev_b32 v25, 4, v5
    v_mfma_f32_16x16x32_bf16 v[96:99], a[248:251], a[140:143], v[96:99]
    buffer_load_dwordx4 a[4:7], v2, s[24:27], s28 offen offset:1024 sc1
    v_mfma_f32_16x16x32_bf16 v[100:103], a[228:231], a[128:131], v[100:103]
    ds_read_b128 a[120:123], v175 offset:8192
    v_lshl_add_u32 v24, v4, 10, v25
    v_mfma_f32_16x16x32_bf16 v[100:103], a[236:239], a[132:135], v[100:103]
    s_mov_b32 s72, s56
    s_mov_b32 s73, s57
    v_mfma_f32_16x16x32_bf16 v[100:103], a[244:247], a[136:139], v[100:103]
    ds_read_b128 a[124:127], v175 offset:12288
    s_mov_b32 s74, 2097152
    v_mfma_f32_16x16x32_bf16 v[100:103], a[252:255], a[140:143], v[100:103]
    s_mov_b32 s75, 0x20000
    s_mov_b32 s88, s64
    s_waitcnt lgkmcnt(4)
    v_mfma_f32_16x16x32_bf16 v[96:99], v[32:35], a[96:99], v[96:99]
    ds_read_b128 a[128:131], v175 offset:16384
    s_mov_b32 s89, s65
    v_mfma_f32_16x16x32_bf16 v[96:99], v[40:43], a[100:103], v[96:99]
    buffer_load_dwordx4 a[8:11], v2, s[24:27], s28 offen offset:2048 sc1
    v_mfma_f32_16x16x32_bf16 v[96:99], v[48:51], a[104:107], v[96:99]
    ds_read_b128 a[132:135], v175 offset:20480
    s_mov_b32 s90, 2752
    v_mfma_f32_16x16x32_bf16 v[96:99], v[56:59], a[108:111], v[96:99]
    buffer_load_dwordx4 a[12:15], v2, s[24:27], s28 offen offset:3072 sc1
    v_mfma_f32_16x16x32_bf16 v[100:103], v[36:39], a[96:99], v[100:103]
    ds_read_b128 a[136:139], v175 offset:24576
    s_mov_b32 s91, 0x20000
    v_mfma_f32_16x16x32_bf16 v[100:103], v[44:47], a[100:103], v[100:103]
    s_add_u32 s76, s14, 61865984
    s_addc_u32 s77, s15, 0
    s_mov_b32 s78, 2097152
    v_mfma_f32_16x16x32_bf16 v[100:103], v[52:55], a[104:107], v[100:103]
    ds_read_b128 a[140:143], v175 offset:28672
    s_mov_b32 s79, 0x20000
    v_mfma_f32_16x16x32_bf16 v[100:103], v[60:63], a[108:111], v[100:103]
    s_add_u32 s80, s14, 63963136
    s_addc_u32 s81, s15, 0
    s_mov_b32 s82, 262144
    s_waitcnt lgkmcnt(4)
    v_mfma_f32_16x16x32_bf16 v[104:107], a[224:227], a[112:115], v[104:107]
    ds_read_b128 a[96:99], v178 offset:0
    s_xor_b32 s28, s28, 4096
    v_mfma_f32_16x16x32_bf16 v[104:107], a[232:235], a[116:119], v[104:107]
    buffer_load_dwordx4 a[16:19], v2, s[24:27], s28 offen offset:0 sc1
    v_mfma_f32_16x16x32_bf16 v[104:107], a[240:243], a[120:123], v[104:107]
    ds_read_b128 a[100:103], v178 offset:4096
    s_mov_b32 s83, 0x20000
    v_mfma_f32_16x16x32_bf16 v[104:107], a[248:251], a[124:127], v[104:107]
    buffer_load_dwordx4 a[20:23], v2, s[24:27], s28 offen offset:1024 sc1
    v_mfma_f32_16x16x32_bf16 v[108:111], a[228:231], a[112:115], v[108:111]
    ds_read_b128 a[104:107], v178 offset:8192
    s_add_u32 s84, s14, 58720256
    s_addc_u32 s85, s15, 0
    v_mfma_f32_16x16x32_bf16 v[108:111], a[236:239], a[116:119], v[108:111]
    s_mov_b32 s86, 1441792
    s_mov_b32 s87, 0x20000
    v_mfma_f32_16x16x32_bf16 v[108:111], a[244:247], a[120:123], v[108:111]
    ds_read_b128 a[108:111], v178 offset:12288
    s_mul_i32 s43, s30, 98304
    v_mfma_f32_16x16x32_bf16 v[108:111], a[252:255], a[124:127], v[108:111]
    s_add_u32 s43, s43, s10
    v_bfe_u32 v4, v1, 2, 2
    s_waitcnt lgkmcnt(4)
    v_mfma_f32_16x16x32_bf16 v[104:107], v[32:35], a[128:131], v[104:107]
    ds_read_b128 a[112:115], v178 offset:16384
    v_lshrrev_b32 v5, 4, v1
    v_mfma_f32_16x16x32_bf16 v[104:107], v[40:43], a[132:135], v[104:107]
    buffer_load_dwordx4 a[24:27], v2, s[24:27], s28 offen offset:2048 sc1
    v_mfma_f32_16x16x32_bf16 v[104:107], v[48:51], a[136:139], v[104:107]
    ds_read_b128 a[116:119], v178 offset:20480
    v_sub_u32 v5, v5, v4
    v_mfma_f32_16x16x32_bf16 v[104:107], v[56:59], a[140:143], v[104:107]
    buffer_load_dwordx4 a[28:31], v2, s[24:27], s28 offen offset:3072 sc1
    v_mfma_f32_16x16x32_bf16 v[108:111], v[36:39], a[128:131], v[108:111]
    ds_read_b128 a[120:123], v178 offset:24576
    v_and_b32 v5, 3, v5
    v_mfma_f32_16x16x32_bf16 v[108:111], v[44:47], a[132:135], v[108:111]
    v_and_b32 v4, 1, v1
    v_lshlrev_b32 v4, 4, v4
    v_mfma_f32_16x16x32_bf16 v[108:111], v[52:55], a[136:139], v[108:111]
    ds_read_b128 a[124:127], v178 offset:28672
    v_mov_b32 v220, 0x3f80
    v_mfma_f32_16x16x32_bf16 v[108:111], v[60:63], a[140:143], v[108:111]
    v_lshlrev_b32 v4, v4, v220
    v_bfe_u32 v221, v1, 1, 1
    s_waitcnt lgkmcnt(4)
    v_mfma_f32_16x16x32_bf16 v[112:115], a[224:227], a[96:99], v[112:115]
    ds_read_b128 a[128:131], v181 offset:0
    s_xor_b32 s28, s28, 28672
    s_add_u32 m0, s10, 65536
    v_mfma_f32_16x16x32_bf16 v[112:115], a[232:235], a[100:103], v[112:115]
    buffer_load_dwordx4 v2, s[68:71], s35 offen offset:0 sc1 lds
    v_mfma_f32_16x16x32_bf16 v[112:115], a[240:243], a[104:107], v[112:115]
    ds_read_b128 a[132:135], v181 offset:4096
    v_lshl_or_b32 v221, v5, 1, v221
    v_mfma_f32_16x16x32_bf16 v[112:115], a[248:251], a[108:111], v[112:115]
    buffer_load_dwordx4 v2, s[68:71], s35 offen offset:1024 sc1 lds
    v_mfma_f32_16x16x32_bf16 v[116:119], a[228:231], a[96:99], v[116:119]
    ds_read_b128 a[136:139], v181 offset:8192
    v_cmp_eq_u32 vcc, 0, v221
    v_mfma_f32_16x16x32_bf16 v[116:119], a[236:239], a[100:103], v[116:119]
    s_nop 0
    v_cndmask_b32 v222, 0, v4, vcc
    v_cmp_eq_u32 vcc, 1, v221
    v_mfma_f32_16x16x32_bf16 v[116:119], a[244:247], a[104:107], v[116:119]
    ds_read_b128 a[140:143], v181 offset:12288
    v_cndmask_b32 v223, 0, v4, vcc
    v_mfma_f32_16x16x32_bf16 v[116:119], a[252:255], a[108:111], v[116:119]
    v_mov_b32 v220, 0
    v_mov_b32 v221, 0
    s_waitcnt lgkmcnt(4)
    v_mfma_f32_16x16x32_bf16 v[112:115], v[32:35], a[112:115], v[112:115]
    ds_read_b128 a[96:99], v181 offset:16384
    v_mov_b32 v224, 0
    v_mfma_f32_16x16x32_bf16 v[112:115], v[40:43], a[116:119], v[112:115]
    buffer_load_dwordx4 v2, s[68:71], s35 offen offset:2048 sc1 lds
    v_mfma_f32_16x16x32_bf16 v[112:115], v[48:51], a[120:123], v[112:115]
    ds_read_b128 a[100:103], v181 offset:20480
    v_mov_b32 v225, 0
    v_mfma_f32_16x16x32_bf16 v[112:115], v[56:59], a[124:127], v[112:115]
    buffer_load_dwordx4 v2, s[68:71], s35 offen offset:3072 sc1 lds
    v_mfma_f32_16x16x32_bf16 v[116:119], v[36:39], a[112:115], v[116:119]
    ds_read_b128 a[104:107], v181 offset:24576
    v_and_b32 v4, 15, v1
    v_mfma_f32_16x16x32_bf16 v[116:119], v[44:47], a[116:119], v[116:119]
    v_lshlrev_b32 v4, 2, v4
    v_xor_b32 v10, 1, v5
    v_mfma_f32_16x16x32_bf16 v[116:119], v[52:55], a[120:123], v[116:119]
    ds_read_b128 a[108:111], v181 offset:28672
    v_and_b32 v10, 1, v10
    v_mfma_f32_16x16x32_bf16 v[116:119], v[60:63], a[124:127], v[116:119]
    v_lshl_or_b32 v4, v10, 6, v4
    v_lshrrev_b32 v5, 1, v5
    s_waitcnt vmcnt(12) lgkmcnt(4)
    s_barrier
    v_mfma_f32_16x16x32_bf16 v[120:123], a[224:227], a[128:131], v[120:123]
    ds_read_b128 a[112:115], v172 offset:32768
    s_add_u32 m0, s10, 69632
    v_mfma_f32_16x16x32_bf16 v[120:123], a[232:235], a[132:135], v[120:123]
    buffer_load_dwordx4 v3, s[68:71], s35 offen offset:0 sc1 lds
    v_mfma_f32_16x16x32_bf16 v[120:123], a[240:243], a[136:139], v[120:123]
    ds_read_b128 a[116:119], v172 offset:36864
    v_lshl_or_b32 v10, v5, 31, v4
    v_mfma_f32_16x16x32_bf16 v[120:123], a[248:251], a[140:143], v[120:123]
    buffer_load_dwordx4 v3, s[68:71], s35 offen offset:1024 sc1 lds
    v_mfma_f32_16x16x32_bf16 v[124:127], a[228:231], a[128:131], v[124:127]
    ds_read_b128 a[120:123], v172 offset:40960
    s_mov_b32 s56, 572662306
    v_mfma_f32_16x16x32_bf16 v[124:127], a[236:239], a[132:135], v[124:127]
    s_mov_b32 s57, 572662306
    s_mov_b32 s64, 1145324612
    v_mfma_f32_16x16x32_bf16 v[124:127], a[244:247], a[136:139], v[124:127]
    ds_read_b128 a[124:127], v172 offset:45056
    s_mov_b32 s65, 1145324612
    v_mfma_f32_16x16x32_bf16 v[124:127], a[252:255], a[140:143], v[124:127]
    s_mov_b32 s20, 2290649224
    s_mov_b32 s21, 2290649224
    s_waitcnt lgkmcnt(4)
    v_mfma_f32_16x16x32_bf16 v[120:123], v[32:35], a[96:99], v[120:123]
    ds_read_b128 a[128:131], v172 offset:49152
    s_mov_b32 s22, 0x00f0000f
    v_mfma_f32_16x16x32_bf16 v[120:123], v[40:43], a[100:103], v[120:123]
    buffer_load_dwordx4 v3, s[68:71], s35 offen offset:2048 sc1 lds
    v_mfma_f32_16x16x32_bf16 v[120:123], v[48:51], a[104:107], v[120:123]
    ds_read_b128 a[132:135], v172 offset:53248
    s_mov_b32 s23, 0xf0000f00
    v_mfma_f32_16x16x32_bf16 v[120:123], v[56:59], a[108:111], v[120:123]
    buffer_load_dwordx4 v3, s[68:71], s35 offen offset:3072 sc1 lds
    v_mfma_f32_16x16x32_bf16 v[124:127], v[36:39], a[96:99], v[124:127]
    ds_read_b128 a[136:139], v172 offset:57344
    v_mov_b32 v28, 0x3f803f80
    v_mfma_f32_16x16x32_bf16 v[124:127], v[44:47], a[100:103], v[124:127]
    v_mov_b32 v29, 0x3f803f80
    v_mov_b32 v30, 0x3f803f80
    v_mfma_f32_16x16x32_bf16 v[124:127], v[52:55], a[104:107], v[124:127]
    ds_read_b128 a[140:143], v172 offset:61440
    v_mov_b32 v31, 0x3f803f80
    v_mfma_f32_16x16x32_bf16 v[124:127], v[60:63], a[108:111], v[124:127]
    v_lshlrev_b32 v11, 2, v1
    v_mov_b32 v228, 0xbdd2d3e8
    s_waitcnt lgkmcnt(4)
    v_mfma_f32_16x16x32_bf16 v[96:99], v[64:67], a[112:115], v[96:99]
    ds_read_b128 a[96:99], v175 offset:32768
    s_xor_b32 s35, s35, 8486912
    v_mfma_f32_16x16x32_bf16 v[96:99], v[72:75], a[116:119], v[96:99]
    buffer_load_dwordx4 a[32:35], v2, s[24:27], s28 offen offset:0 sc1
    v_mfma_f32_16x16x32_bf16 v[96:99], v[80:83], a[120:123], v[96:99]
    ds_read_b128 a[100:103], v175 offset:36864
    v_mov_b32 v229, 0xc0135761
    v_mfma_f32_16x16x32_bf16 v[96:99], v[88:91], a[124:127], v[96:99]
    buffer_load_dwordx4 a[36:39], v2, s[24:27], s28 offen offset:1024 sc1
    v_mfma_f32_16x16x32_bf16 v[100:103], v[68:71], a[112:115], v[100:103]
    ds_read_b128 a[104:107], v175 offset:40960
    v_mov_b32 v230, 1.0
    v_mfma_f32_16x16x32_bf16 v[100:103], v[76:79], a[116:119], v[100:103]
    s_mul_i32 s6, s32, 176128
    s_add_u32 s6, s6, 65011712
    v_mfma_f32_16x16x32_bf16 v[100:103], v[84:87], a[120:123], v[100:103]
    ds_read_b128 a[108:111], v175 offset:45056
    s_add_u32 s92, s14, s6
    s_addc_u32 s93, s15, 0
    v_mfma_f32_16x16x32_bf16 v[100:103], v[92:95], a[124:127], v[100:103]
    s_mov_b32 s94, 176128
    s_mov_b32 s95, 0x20000
    s_waitcnt vmcnt(10) lgkmcnt(4)
    v_mfma_f32_16x16x32_bf16 v[96:99], a[0:3], a[128:131], v[96:99]
    ds_read_b128 a[112:115], v175 offset:49152
    s_mul_i32 s50, s30, 12288
    v_mfma_f32_16x16x32_bf16 v[96:99], a[8:11], a[132:135], v[96:99]
    buffer_load_dwordx4 a[40:43], v2, s[24:27], s28 offen offset:2048 sc1
    v_mfma_f32_16x16x32_bf16 v[96:99], a[16:19], a[136:139], v[96:99]
    ds_read_b128 a[116:119], v175 offset:53248
    s_lshl_b32 s6, s3, 10
    v_mfma_f32_16x16x32_bf16 v[96:99], a[24:27], a[140:143], v[96:99]
    buffer_load_dwordx4 a[44:47], v2, s[24:27], s28 offen offset:3072 sc1
    v_mfma_f32_16x16x32_bf16 v[100:103], a[4:7], a[128:131], v[100:103]
    ds_read_b128 a[120:123], v175 offset:57344
    s_add_u32 s50, s50, s6
    v_mfma_f32_16x16x32_bf16 v[100:103], a[12:15], a[132:135], v[100:103]
    s_lshl_b32 s49, s32, 2
    s_add_u32 s49, s49, s3
    v_mfma_f32_16x16x32_bf16 v[100:103], a[20:23], a[136:139], v[100:103]
    ds_read_b128 a[124:127], v175 offset:61440
    s_lshl_b32 s48, s49, 14
    v_mfma_f32_16x16x32_bf16 v[100:103], a[28:31], a[140:143], v[100:103]
    s_lshl_b32 s49, s49, 11
    s_and_b32 s8, s30, 3
    s_waitcnt lgkmcnt(4)
    v_mfma_f32_16x16x32_bf16 v[104:107], v[64:67], a[96:99], v[104:107]
    ds_read_b128 a[128:131], v178 offset:32768
    s_xor_b32 s28, s28, 4096
    v_mfma_f32_16x16x32_bf16 v[104:107], v[72:75], a[100:103], v[104:107]
    buffer_load_dwordx4 a[48:51], v2, s[24:27], s28 offen offset:0 sc1
    v_mfma_f32_16x16x32_bf16 v[104:107], v[80:83], a[104:107], v[104:107]
    ds_read_b128 a[132:135], v178 offset:36864
    s_lshl_b32 s8, s8, 12
    v_mfma_f32_16x16x32_bf16 v[104:107], v[88:91], a[108:111], v[104:107]
    buffer_load_dwordx4 a[52:55], v2, s[24:27], s28 offen offset:1024 sc1
    v_mfma_f32_16x16x32_bf16 v[108:111], v[68:71], a[96:99], v[108:111]
    ds_read_b128 a[136:139], v178 offset:40960
    s_add_u32 s48, s48, s8
    v_mfma_f32_16x16x32_bf16 v[108:111], v[76:79], a[100:103], v[108:111]
    s_xor_b32 s6, s8, 65536
    v_add_u32 v184, s6, v2
    v_mfma_f32_16x16x32_bf16 v[108:111], v[84:87], a[104:107], v[108:111]
    ds_read_b128 a[140:143], v178 offset:45056
    v_add_u32 v185, 65536, v184
    v_mfma_f32_16x16x32_bf16 v[108:111], v[92:95], a[108:111], v[108:111]
    s_xor_b32 s6, s8, 69632
    v_add_u32 v186, s6, v2
    s_waitcnt lgkmcnt(4)
    v_mfma_f32_16x16x32_bf16 v[104:107], a[0:3], a[112:115], v[104:107]
    ds_read_b128 a[96:99], v178 offset:49152
    v_add_u32 v187, 65536, v186
    v_mfma_f32_16x16x32_bf16 v[104:107], a[8:11], a[116:119], v[104:107]
    buffer_load_dword v9, v14, s[16:19], s36 offen offset:28 sc1
    v_mfma_f32_16x16x32_bf16 v[104:107], a[16:19], a[120:123], v[104:107]
    ds_read_b128 a[100:103], v178 offset:53248
    s_xor_b32 s6, s8, 73728
    v_mfma_f32_16x16x32_bf16 v[104:107], a[24:27], a[124:127], v[104:107]
    buffer_load_dwordx4 a[56:59], v2, s[24:27], s28 offen offset:2048 sc1
    v_mfma_f32_16x16x32_bf16 v[108:111], a[4:7], a[112:115], v[108:111]
    ds_read_b128 a[104:107], v178 offset:57344
    v_add_u32 v188, s6, v2
    v_mfma_f32_16x16x32_bf16 v[108:111], a[12:15], a[116:119], v[108:111]
    buffer_load_dwordx4 a[60:63], v2, s[24:27], s28 offen offset:3072 sc1
    v_mfma_f32_16x16x32_bf16 v[108:111], a[20:23], a[120:123], v[108:111]
    ds_read_b128 a[108:111], v178 offset:61440
    v_add_u32 v189, 65536, v188
    v_mfma_f32_16x16x32_bf16 v[108:111], a[28:31], a[124:127], v[108:111]
    s_xor_b32 s6, s8, 77824
    v_add_u32 v190, s6, v2
    s_waitcnt lgkmcnt(4)
    v_mfma_f32_16x16x32_bf16 v[112:115], v[64:67], a[128:131], v[112:115]
    ds_read_b128 a[112:115], v181 offset:32768
    s_xor_b32 s28, s28, 12288
    v_mfma_f32_16x16x32_bf16 v[112:115], v[72:75], a[132:135], v[112:115]
    buffer_load_dwordx4 a[64:67], v2, s[24:27], s28 offen offset:0 sc1
    v_mfma_f32_16x16x32_bf16 v[112:115], v[80:83], a[136:139], v[112:115]
    ds_read_b128 a[116:119], v181 offset:36864
    v_add_u32 v191, 65536, v190
    v_mfma_f32_16x16x32_bf16 v[112:115], v[88:91], a[140:143], v[112:115]
    buffer_load_dwordx4 a[68:71], v2, s[24:27], s28 offen offset:1024 sc1
    v_mfma_f32_16x16x32_bf16 v[116:119], v[68:71], a[128:131], v[116:119]
    ds_read_b128 a[120:123], v181 offset:40960
    s_lshr_b32 s6, s30, 3
    v_mfma_f32_16x16x32_bf16 v[116:119], v[76:79], a[132:135], v[116:119]
    s_lshl_b32 s6, s6, 1
    s_and_b32 s8, s3, 1
    v_mfma_f32_16x16x32_bf16 v[116:119], v[84:87], a[136:139], v[116:119]
    ds_read_b128 a[124:127], v181 offset:45056
    s_add_u32 s6, s6, s8
    v_mfma_f32_16x16x32_bf16 v[116:119], v[92:95], a[140:143], v[116:119]
    s_lshl_b32 s6, s6, 10
    v_add_u32 v16, s6, v2
    s_waitcnt lgkmcnt(4)
    v_mfma_f32_16x16x32_bf16 v[112:115], a[0:3], a[96:99], v[112:115]
    ds_read_b128 a[128:131], v181 offset:49152
    v_xor_b32 v17, 1024, v16
    v_mfma_f32_16x16x32_bf16 v[112:115], a[8:11], a[100:103], v[112:115]
    buffer_load_dwordx4 a[72:75], v2, s[24:27], s28 offen offset:2048 sc1
    v_mfma_f32_16x16x32_bf16 v[112:115], a[16:19], a[104:107], v[112:115]
    ds_read_b128 a[132:135], v181 offset:53248
    s_lshr_b32 s6, s3, 1
    v_mfma_f32_16x16x32_bf16 v[112:115], a[24:27], a[108:111], v[112:115]
    buffer_load_dwordx4 a[76:79], v2, s[24:27], s28 offen offset:3072 sc1
    v_mfma_f32_16x16x32_bf16 v[116:119], a[4:7], a[96:99], v[116:119]
    ds_read_b128 a[136:139], v181 offset:57344
    s_lshl_b32 s6, s6, 11
    v_mfma_f32_16x16x32_bf16 v[116:119], a[12:15], a[100:103], v[116:119]
    v_add_u32 v18, s6, v2
    v_xor_b32 v19, 2048, v18
    v_mfma_f32_16x16x32_bf16 v[116:119], a[20:23], a[104:107], v[116:119]
    ds_read_b128 a[140:143], v181 offset:61440
    s_xor_b32 s6, s3, 0
    v_mfma_f32_16x16x32_bf16 v[116:119], a[28:31], a[108:111], v[116:119]
    s_mul_i32 s6, s6, 6144
    v_add_u32 v23, s6, v2
    s_xor_b32 s6, s3, 1
    s_mul_i32 s6, s6, 6144
    v_add_u32 v20, s6, v2
    s_xor_b32 s6, s3, 2
    s_mul_i32 s6, s6, 6144
    s_add_u32 s6, s6, 2048
    v_add_u32 v21, s6, v2
    s_xor_b32 s6, s3, 3
    s_mul_i32 s6, s6, 6144
    s_add_u32 s6, s6, 4096
    v_add_u32 v22, s6, v2
    s_mul_i32 s51, s3, 45056
    s_lshr_b32 s52, s2, 6
    s_lshl_b32 s52, s52, 1
    s_xor_b32 s52, s52, s5
    s_and_b32 s52, s52, 0
    s_lshl_b32 s52, s52, 12
    s_and_b32 s41, s42, 8
    s_mov_b32 s11, 200000
    s_waitcnt vmcnt(6)
L_splp2b:
    v_readfirstlane_b32 s9, v9
    s_nop 0
    s_cmp_ge_u32 s9, s41
    s_cbranch_scc1 L_backp2b
    buffer_load_dword v9, v14, s[16:19], s36 offen offset:28 sc1
    s_sub_u32 s11, s11, 1
    s_waitcnt vmcnt(0)
    s_cbranch_scc0 L_splp2b
L_backp2b:
    s_waitcnt lgkmcnt(4)
    s_barrier
    v_mfma_f32_16x16x32_bf16 v[120:123], v[64:67], a[112:115], v[120:123]
    ds_read_b128 a[96:99], v176 offset:0
    s_xor_b32 s28, s28, 4096
    v_mfma_f32_16x16x32_bf16 v[120:123], v[72:75], a[116:119], v[120:123]
    buffer_load_dwordx4 a[80:83], v2, s[24:27], s28 offen offset:0 sc1
    v_mfma_f32_16x16x32_bf16 v[120:123], v[80:83], a[120:123], v[120:123]
    ds_read_b128 a[100:103], v176 offset:4096
    v_mfma_f32_16x16x32_bf16 v[120:123], v[88:91], a[124:127], v[120:123]
    buffer_load_dwordx4 a[84:87], v2, s[24:27], s28 offen offset:1024 sc1
    v_mfma_f32_16x16x32_bf16 v[124:127], v[68:71], a[112:115], v[124:127]
    ds_read_b128 a[104:107], v176 offset:8192
    v_mfma_f32_16x16x32_bf16 v[124:127], v[76:79], a[116:119], v[124:127]
    v_mfma_f32_16x16x32_bf16 v[124:127], v[84:87], a[120:123], v[124:127]
    ds_read_b128 a[108:111], v176 offset:12288
    v_mfma_f32_16x16x32_bf16 v[124:127], v[92:95], a[124:127], v[124:127]
    s_waitcnt lgkmcnt(4)
    v_mfma_f32_16x16x32_bf16 v[120:123], a[0:3], a[128:131], v[120:123]
    ds_read_b128 a[112:115], v176 offset:16384
    v_mfma_f32_16x16x32_bf16 v[120:123], a[8:11], a[132:135], v[120:123]
    buffer_load_dwordx4 a[88:91], v2, s[24:27], s28 offen offset:2048 sc1
    v_mfma_f32_16x16x32_bf16 v[120:123], a[16:19], a[136:139], v[120:123]
    ds_read_b128 a[116:119], v176 offset:20480
    v_mfma_f32_16x16x32_bf16 v[120:123], a[24:27], a[140:143], v[120:123]
    buffer_load_dwordx4 a[92:95], v2, s[24:27], s28 offen offset:3072 sc1
    v_mfma_f32_16x16x32_bf16 v[124:127], a[4:7], a[128:131], v[124:127]
    ds_read_b128 a[120:123], v176 offset:24576
    v_mfma_f32_16x16x32_bf16 v[124:127], a[12:15], a[132:135], v[124:127]
    v_mfma_f32_16x16x32_bf16 v[124:127], a[20:23], a[136:139], v[124:127]
    ds_read_b128 a[124:127], v176 offset:28672
    v_mfma_f32_16x16x32_bf16 v[124:127], a[28:31], a[140:143], v[124:127]
    s_waitcnt vmcnt(8) lgkmcnt(4)
    v_mfma_f32_16x16x32_bf16 v[104:107], a[32:35], a[96:99], v[104:107]
    ds_read_b128 a[128:131], v179 offset:0
    s_xor_b32 s28, s28, 126976
    s_add_u32 m0, s10, 98304
    v_mfma_f32_16x16x32_bf16 v[104:107], a[40:43], a[100:103], v[104:107]
    buffer_load_dwordx4 v2, s[68:71], s35 offen offset:0 sc1 lds
    v_mfma_f32_16x16x32_bf16 v[104:107], a[48:51], a[104:107], v[104:107]
    ds_read_b128 a[132:135], v179 offset:4096
    v_mfma_f32_16x16x32_bf16 v[104:107], a[56:59], a[108:111], v[104:107]
    buffer_load_dwordx4 v2, s[68:71], s35 offen offset:1024 sc1 lds
    v_mfma_f32_16x16x32_bf16 v[108:111], a[36:39], a[96:99], v[108:111]
    ds_read_b128 a[136:139], v179 offset:8192
    v_mfma_f32_16x16x32_bf16 v[108:111], a[44:47], a[100:103], v[108:111]
    v_mfma_f32_16x16x32_bf16 v[108:111], a[52:55], a[104:107], v[108:111]
    ds_read_b128 a[140:143], v179 offset:12288
    v_mfma_f32_16x16x32_bf16 v[108:111], a[60:63], a[108:111], v[108:111]
    s_waitcnt vmcnt(2) lgkmcnt(4)
    v_mfma_f32_16x16x32_bf16 v[104:107], a[64:67], a[112:115], v[104:107]
    ds_read_b128 a[96:99], v179 offset:16384
    v_mfma_f32_16x16x32_bf16 v[104:107], a[72:75], a[116:119], v[104:107]
    buffer_load_dwordx4 v2, s[68:71], s35 offen offset:2048 sc1 lds
    v_mfma_f32_16x16x32_bf16 v[104:107], a[80:83], a[120:123], v[104:107]
    ds_read_b128 a[100:103], v179 offset:20480
    v_mfma_f32_16x16x32_bf16 v[104:107], a[88:91], a[124:127], v[104:107]
    buffer_load_dwordx4 v2, s[68:71], s35 offen offset:3072 sc1 lds
    v_mfma_f32_16x16x32_bf16 v[108:111], a[68:71], a[112:115], v[108:111]
    ds_read_b128 a[104:107], v179 offset:24576
    v_mfma_f32_16x16x32_bf16 v[108:111], a[76:79], a[116:119], v[108:111]
    v_mfma_f32_16x16x32_bf16 v[108:111], a[84:87], a[120:123], v[108:111]
    ds_read_b128 a[108:111], v179 offset:28672
    v_mfma_f32_16x16x32_bf16 v[108:111], a[92:95], a[124:127], v[108:111]
    s_waitcnt lgkmcnt(4)
    v_mfma_f32_16x16x32_bf16 v[112:115], a[32:35], a[128:131], v[112:115]
    ds_read_b128 a[112:115], v182 offset:0
    s_add_u32 m0, s10, 102400
    v_mfma_f32_16x16x32_bf16 v[112:115], a[40:43], a[132:135], v[112:115]
    buffer_load_dwordx4 v3, s[68:71], s35 offen offset:0 sc1 lds
    v_mfma_f32_16x16x32_bf16 v[112:115], a[48:51], a[136:139], v[112:115]
    ds_read_b128 a[116:119], v182 offset:4096
    v_mfma_f32_16x16x32_bf16 v[112:115], a[56:59], a[140:143], v[112:115]
    buffer_load_dwordx4 v3, s[68:71], s35 offen offset:1024 sc1 lds
    v_mfma_f32_16x16x32_bf16 v[116:119], a[36:39], a[128:131], v[116:119]
    ds_read_b128 a[120:123], v182 offset:8192
    v_cvt_pk_bf16_f32 v160, v104, v105
    v_mfma_f32_16x16x32_bf16 v[116:119], a[44:47], a[132:135], v[116:119]
    v_cvt_pk_bf16_f32 v161, v106, v107
    v_cvt_pk_bf16_f32 v162, v108, v109
    v_mfma_f32_16x16x32_bf16 v[116:119], a[52:55], a[136:139], v[116:119]
    ds_read_b128 a[124:127], v182 offset:12288
    v_cvt_pk_bf16_f32 v163, v110, v111
    v_mfma_f32_16x16x32_bf16 v[116:119], a[60:63], a[140:143], v[116:119]
    s_waitcnt lgkmcnt(4)
    v_mfma_f32_16x16x32_bf16 v[112:115], a[64:67], a[96:99], v[112:115]
    ds_read_b128 a[128:131], v182 offset:16384
    v_mfma_f32_16x16x32_bf16 v[112:115], a[72:75], a[100:103], v[112:115]
    buffer_store_dwordx4 v[160:163], v2, s[96:99], s53 offen sc1
    v_mfma_f32_16x16x32_bf16 v[112:115], a[80:83], a[104:107], v[112:115]
    ds_read_b128 a[132:135], v182 offset:20480
    v_mfma_f32_16x16x32_bf16 v[112:115], a[88:91], a[108:111], v[112:115]
    v_mfma_f32_16x16x32_bf16 v[116:119], a[68:71], a[96:99], v[116:119]
    ds_read_b128 a[136:139], v182 offset:24576
    v_mfma_f32_16x16x32_bf16 v[116:119], a[76:79], a[100:103], v[116:119]
    v_mfma_f32_16x16x32_bf16 v[116:119], a[84:87], a[104:107], v[116:119]
    ds_read_b128 a[140:143], v182 offset:28672
    v_mfma_f32_16x16x32_bf16 v[116:119], a[92:95], a[108:111], v[116:119]
    s_waitcnt lgkmcnt(4)
    v_mfma_f32_16x16x32_bf16 v[120:123], a[32:35], a[112:115], v[120:123]
    ds_read_b128 a[96:99], v173 offset:0
    v_mfma_f32_16x16x32_bf16 v[120:123], a[40:43], a[116:119], v[120:123]
    buffer_load_dwordx4 v3, s[68:71], s35 offen offset:2048 sc1 lds
    v_mfma_f32_16x16x32_bf16 v[120:123], a[48:51], a[120:123], v[120:123]
    ds_read_b128 a[100:103], v173 offset:4096
    v_mfma_f32_16x16x32_bf16 v[120:123], a[56:59], a[124:127], v[120:123]
    buffer_load_dwordx4 v3, s[68:71], s35 offen offset:3072 sc1 lds
    v_mfma_f32_16x16x32_bf16 v[124:127], a[36:39], a[112:115], v[124:127]
    ds_read_b128 a[104:107], v173 offset:8192
    v_cvt_pk_bf16_f32 v164, v112, v113
    v_mfma_f32_16x16x32_bf16 v[124:127], a[44:47], a[116:119], v[124:127]
    v_cvt_pk_bf16_f32 v165, v114, v115
    v_cvt_pk_bf16_f32 v166, v116, v117
    v_mfma_f32_16x16x32_bf16 v[124:127], a[52:55], a[120:123], v[124:127]
    ds_read_b128 a[108:111], v173 offset:12288
    v_cvt_pk_bf16_f32 v167, v118, v119
    v_mfma_f32_16x16x32_bf16 v[124:127], a[60:63], a[124:127], v[124:127]
    s_waitcnt lgkmcnt(4)
    v_mfma_f32_16x16x32_bf16 v[120:123], a[64:67], a[128:131], v[120:123]
    ds_read_b128 a[112:115], v173 offset:16384
    v_mfma_f32_16x16x32_bf16 v[120:123], a[72:75], a[132:135], v[120:123]
    buffer_store_dwordx4 v[164:167], v2, s[96:99], s54 offen sc1
    v_mfma_f32_16x16x32_bf16 v[120:123], a[80:83], a[136:139], v[120:123]
    ds_read_b128 a[116:119], v173 offset:20480
    v_mfma_f32_16x16x32_bf16 v[120:123], a[88:91], a[140:143], v[120:123]
    v_mfma_f32_16x16x32_bf16 v[124:127], a[68:71], a[128:131], v[124:127]
    ds_read_b128 a[120:123], v173 offset:24576
    v_mfma_f32_16x16x32_bf16 v[124:127], a[76:79], a[132:135], v[124:127]
    v_mfma_f32_16x16x32_bf16 v[124:127], a[84:87], a[136:139], v[124:127]
    ds_read_b128 a[124:127], v173 offset:28672
    v_mfma_f32_16x16x32_bf16 v[124:127], a[92:95], a[140:143], v[124:127]
    s_waitcnt vmcnt(1) lgkmcnt(4)
    s_barrier
    v_mfma_f32_16x16x32_bf16 v[96:99], a[32:35], a[96:99], v[96:99]
    ds_read_b128 a[128:131], v173 offset:32768
    s_xor_b32 s35, s35, 32768
    s_add_u32 m0, s10, 131072
    v_mfma_f32_16x16x32_bf16 v[96:99], a[40:43], a[100:103], v[96:99]
    buffer_load_dwordx4 v2, s[68:71], s35 offen offset:0 sc1 lds
    v_mfma_f32_16x16x32_bf16 v[96:99], a[48:51], a[104:107], v[96:99]
    ds_read_b128 a[132:135], v173 offset:36864
    v_mfma_f32_16x16x32_bf16 v[96:99], a[56:59], a[108:111], v[96:99]
    v_mfma_f32_16x16x32_bf16 v[100:103], a[36:39], a[96:99], v[100:103]
    ds_read_b128 a[136:139], v173 offset:40960
    v_cvt_pk_bf16_f32 v168, v120, v121
    v_mfma_f32_16x16x32_bf16 v[100:103], a[44:47], a[100:103], v[100:103]
    buffer_load_dwordx4 v2, s[68:71], s35 offen offset:1024 sc1 lds
    v_mfma_f32_16x16x32_bf16 v[100:103], a[52:55], a[104:107], v[100:103]
    ds_read_b128 a[140:143], v173 offset:45056
    v_cvt_pk_bf16_f32 v169, v122, v123
    v_mfma_f32_16x16x32_bf16 v[100:103], a[60:63], a[108:111], v[100:103]
    v_cvt_pk_bf16_f32 v170, v124, v125
    v_cvt_pk_bf16_f32 v171, v126, v127
    s_waitcnt lgkmcnt(4)
    v_mfma_f32_16x16x32_bf16 v[96:99], a[64:67], a[112:115], v[96:99]
    ds_read_b128 a[96:99], v173 offset:49152
    v_mfma_f32_16x16x32_bf16 v[96:99], a[72:75], a[116:119], v[96:99]
    buffer_store_dwordx4 v[168:171], v2, s[96:99], s55 offen sc1
    v_mfma_f32_16x16x32_bf16 v[96:99], a[80:83], a[120:123], v[96:99]
    ds_read_b128 a[100:103], v173 offset:53248
    v_mfma_f32_16x16x32_bf16 v[96:99], a[88:91], a[124:127], v[96:99]
    v_mfma_f32_16x16x32_bf16 v[100:103], a[68:71], a[112:115], v[100:103]
    ds_read_b128 a[104:107], v173 offset:57344
    v_mfma_f32_16x16x32_bf16 v[100:103], a[76:79], a[116:119], v[100:103]
    v_mfma_f32_16x16x32_bf16 v[100:103], a[84:87], a[120:123], v[100:103]
    ds_read_b128 a[108:111], v173 offset:61440
    v_mfma_f32_16x16x32_bf16 v[100:103], a[92:95], a[124:127], v[100:103]
    s_waitcnt lgkmcnt(4)
    v_mfma_f32_16x16x32_bf16 v[128:131], a[160:163], a[128:131], 0
    ds_read_b128 a[112:115], v176 offset:32768
    v_mfma_f32_16x16x32_bf16 v[128:131], a[168:171], a[132:135], v[128:131]
    buffer_load_dwordx4 v2, s[68:71], s35 offen offset:2048 sc1 lds
    v_mfma_f32_16x16x32_bf16 v[128:131], a[176:179], a[136:139], v[128:131]
    ds_read_b128 a[116:119], v176 offset:36864
    v_mfma_f32_16x16x32_bf16 v[128:131], a[184:187], a[140:143], v[128:131]
    v_mfma_f32_16x16x32_bf16 v[132:135], a[164:167], a[128:131], 0
    ds_read_b128 a[120:123], v176 offset:40960
    v_mfma_f32_16x16x32_bf16 v[132:135], a[172:175], a[132:135], v[132:135]
    buffer_load_dwordx4 v2, s[68:71], s35 offen offset:3072 sc1 lds
    v_mfma_f32_16x16x32_bf16 v[132:135], a[180:183], a[136:139], v[132:135]
    ds_read_b128 a[124:127], v176 offset:45056
    v_mfma_f32_16x16x32_bf16 v[132:135], a[188:191], a[140:143], v[132:135]
    s_waitcnt lgkmcnt(4)
    v_mfma_f32_16x16x32_bf16 v[128:131], a[192:195], a[96:99], v[128:131]
    ds_read_b128 a[128:131], v176 offset:49152
    s_add_u32 m0, s10, 135168
    v_mfma_f32_16x16x32_bf16 v[128:131], a[200:203], a[100:103], v[128:131]
    buffer_load_dwordx4 v3, s[68:71], s35 offen offset:0 sc1 lds
    v_mfma_f32_16x16x32_bf16 v[128:131], a[208:211], a[104:107], v[128:131]
    ds_read_b128 a[132:135], v176 offset:53248
    v_mfma_f32_16x16x32_bf16 v[128:131], a[216:219], a[108:111], v[128:131]
    v_mfma_f32_16x16x32_bf16 v[132:135], a[196:199], a[96:99], v[132:135]
    ds_read_b128 a[136:139], v176 offset:57344
    v_mfma_f32_16x16x32_bf16 v[132:135], a[204:207], a[100:103], v[132:135]
    buffer_load_dwordx4 v3, s[68:71], s35 offen offset:1024 sc1 lds
    v_mfma_f32_16x16x32_bf16 v[132:135], a[212:215], a[104:107], v[132:135]
    ds_read_b128 a[140:143], v176 offset:61440
    v_mfma_f32_16x16x32_bf16 v[132:135], a[220:223], a[108:111], v[132:135]
    s_waitcnt lgkmcnt(4)
    v_mfma_f32_16x16x32_bf16 v[136:139], a[160:163], a[112:115], 0
    ds_read_b128 a[96:99], v179 offset:32768
    v_mfma_f32_16x16x32_bf16 v[136:139], a[168:171], a[116:119], v[136:139]
    buffer_load_dwordx4 v3, s[68:71], s35 offen offset:2048 sc1 lds
    v_mfma_f32_16x16x32_bf16 v[136:139], a[176:179], a[120:123], v[136:139]
    ds_read_b128 a[100:103], v179 offset:36864
    v_mfma_f32_16x16x32_bf16 v[136:139], a[184:187], a[124:127], v[136:139]
    v_mfma_f32_16x16x32_bf16 v[140:143], a[164:167], a[112:115], 0
    ds_read_b128 a[104:107], v179 offset:40960
    v_mfma_f32_16x16x32_bf16 v[140:143], a[172:175], a[116:119], v[140:143]
    buffer_load_dwordx4 v3, s[68:71], s35 offen offset:3072 sc1 lds
    v_mfma_f32_16x16x32_bf16 v[140:143], a[180:183], a[120:123], v[140:143]
    ds_read_b128 a[108:111], v179 offset:45056
    v_mfma_f32_16x16x32_bf16 v[140:143], a[188:191], a[124:127], v[140:143]
    s_waitcnt lgkmcnt(4)
    v_mfma_f32_16x16x32_bf16 v[136:139], a[192:195], a[128:131], v[136:139]
    ds_read_b128 a[112:115], v179 offset:49152
    s_xor_b32 s35, s35, 98304
    v_mfma_f32_16x16x32_bf16 v[136:139], a[200:203], a[132:135], v[136:139]
    buffer_load_dwordx4 a[156:159], v24, s[72:75], s45 offen
    v_mfma_f32_16x16x32_bf16 v[136:139], a[208:211], a[136:139], v[136:139]
    ds_read_b128 a[116:119], v179 offset:53248
    v_mfma_f32_16x16x32_bf16 v[136:139], a[216:219], a[140:143], v[136:139]
    v_mfma_f32_16x16x32_bf16 v[140:143], a[196:199], a[128:131], v[140:143]
    ds_read_b128 a[120:123], v179 offset:57344
    s_add_u32 s7, s45, 1048576
    v_mfma_f32_16x16x32_bf16 v[140:143], a[204:207], a[132:135], v[140:143]
    buffer_load_dwordx4 v[204:207], v24, s[72:75], s7 offen
    v_mfma_f32_16x16x32_bf16 v[140:143], a[212:215], a[136:139], v[140:143]
    ds_read_b128 a[124:127], v179 offset:61440
    v_mfma_f32_16x16x32_bf16 v[140:143], a[220:223], a[140:143], v[140:143]
    s_waitcnt lgkmcnt(4)
    v_mfma_f32_16x16x32_bf16 v[144:147], a[160:163], a[96:99], 0
    ds_read_b128 a[128:131], v182 offset:32768
    v_lshrrev_b32 v12, 1, v25
    s_mul_i32 s29, s30, 192
    v_mfma_f32_16x16x32_bf16 v[144:147], a[168:171], a[100:103], v[144:147]
    buffer_load_dwordx2 v[192:193], v12, s[88:91], s29 offen offset:0
    v_mfma_f32_16x16x32_bf16 v[144:147], a[176:179], a[104:107], v[144:147]
    ds_read_b128 a[132:135], v182 offset:36864
    v_mfma_f32_16x16x32_bf16 v[144:147], a[184:187], a[108:111], v[144:147]
    buffer_load_dwordx2 v[194:195], v12, s[88:91], s29 offen offset:32
    v_mfma_f32_16x16x32_bf16 v[148:151], a[164:167], a[96:99], 0
    ds_read_b128 a[136:139], v182 offset:40960
    v_mfma_f32_16x16x32_bf16 v[148:151], a[172:175], a[100:103], v[148:151]
    buffer_load_dwordx2 v[196:197], v12, s[88:91], s29 offen offset:64
    v_mfma_f32_16x16x32_bf16 v[148:151], a[180:183], a[104:107], v[148:151]
    ds_read_b128 a[140:143], v182 offset:45056
    v_mfma_f32_16x16x32_bf16 v[148:151], a[188:191], a[108:111], v[148:151]
    s_waitcnt lgkmcnt(4)
    v_mfma_f32_16x16x32_bf16 v[144:147], a[192:195], a[112:115], v[144:147]
    ds_read_b128 a[96:99], v182 offset:49152
    v_mfma_f32_16x16x32_bf16 v[144:147], a[200:203], a[116:119], v[144:147]
    buffer_load_dwordx2 v[198:199], v12, s[88:91], s29 offen offset:96
    v_mfma_f32_16x16x32_bf16 v[144:147], a[208:211], a[120:123], v[144:147]
    ds_read_b128 a[100:103], v182 offset:53248
    v_mfma_f32_16x16x32_bf16 v[144:147], a[216:219], a[124:127], v[144:147]
    buffer_load_dwordx2 v[200:201], v12, s[88:91], s29 offen offset:128
    v_mfma_f32_16x16x32_bf16 v[148:151], a[196:199], a[112:115], v[148:151]
    ds_read_b128 a[104:107], v182 offset:57344
    v_mfma_f32_16x16x32_bf16 v[148:151], a[204:207], a[116:119], v[148:151]
    buffer_load_dwordx2 v[202:203], v12, s[88:91], s29 offen offset:160
    v_mfma_f32_16x16x32_bf16 v[148:151], a[212:215], a[120:123], v[148:151]
    ds_read_b128 a[108:111], v182 offset:61440
    v_mfma_f32_16x16x32_bf16 v[148:151], a[220:223], a[124:127], v[148:151]
    s_waitcnt vmcnt(8) lgkmcnt(4)
    s_barrier
    s_cmp_lg_u32 s3, 0
    s_cbranch_scc1 L_sg13
    buffer_atomic_add v8, v15, s[16:19], s40 offen offset:20
L_sg13:
    v_mfma_f32_16x16x32_bf16 v[152:155], a[160:163], a[128:131], 0
    ds_read_b128 a[112:115], v174 offset:0
    s_add_u32 m0, s10, 0
    v_mfma_f32_16x16x32_bf16 v[152:155], a[168:171], a[132:135], v[152:155]
    buffer_load_dwordx4 v2, s[68:71], s35 offen offset:0 sc1 lds
    v_mfma_f32_16x16x32_bf16 v[152:155], a[176:179], a[136:139], v[152:155]
    ds_read_b128 a[116:119], v174 offset:4096
    v_mfma_f32_16x16x32_bf16 v[152:155], a[184:187], a[140:143], v[152:155]
    v_mfma_f32_16x16x32_bf16 v[156:159], a[164:167], a[128:131], 0
    ds_read_b128 a[120:123], v174 offset:8192
    v_mfma_f32_16x16x32_bf16 v[156:159], a[172:175], a[132:135], v[156:159]
    buffer_load_dwordx4 v2, s[68:71], s35 offen offset:1024 sc1 lds
    v_mfma_f32_16x16x32_bf16 v[156:159], a[180:183], a[136:139], v[156:159]
    ds_read_b128 a[124:127], v174 offset:12288
    v_mfma_f32_16x16x32_bf16 v[156:159], a[188:191], a[140:143], v[156:159]
    s_waitcnt lgkmcnt(4)
    v_mfma_f32_16x16x32_bf16 v[152:155], a[192:195], a[96:99], v[152:155]
    ds_read_b128 a[128:131], v174 offset:16384
    s_and_b32 s8, s30, 7
    v_mfma_f32_16x16x32_bf16 v[152:155], a[200:203], a[100:103], v[152:155]
    buffer_load_dwordx4 v2, s[68:71], s35 offen offset:2048 sc1 lds
    v_mfma_f32_16x16x32_bf16 v[152:155], a[208:211], a[104:107], v[152:155]
    ds_read_b128 a[132:135], v174 offset:20480
    s_mul_i32 s8, s8, 176128
    v_mfma_f32_16x16x32_bf16 v[152:155], a[216:219], a[108:111], v[152:155]
    s_add_u32 s8, s8, 56623104
    s_add_u32 s24, s14, s8
    s_addc_u32 s25, s15, 0
    v_mfma_f32_16x16x32_bf16 v[156:159], a[196:199], a[96:99], v[156:159]
    ds_read_b128 a[136:139], v174 offset:24576
    s_mov_b32 s26, 176128
    v_mfma_f32_16x16x32_bf16 v[156:159], a[204:207], a[100:103], v[156:159]
    buffer_load_dwordx4 v2, s[68:71], s35 offen offset:3072 sc1 lds
    v_mfma_f32_16x16x32_bf16 v[156:159], a[212:215], a[104:107], v[156:159]
    ds_read_b128 a[140:143], v174 offset:28672
    s_mov_b32 s27, 0x20000
    v_mfma_f32_16x16x32_bf16 v[156:159], a[220:223], a[108:111], v[156:159]
    s_add_u32 s53, s53, 49152
    s_add_u32 s54, s54, 49152
    s_waitcnt lgkmcnt(4)
    v_mfma_f32_16x16x32_bf16 v[128:131], a[224:227], a[112:115], v[128:131]
    ds_read_b128 a[96:99], v177 offset:0
    s_add_u32 m0, s10, 4096
    v_mfma_f32_16x16x32_bf16 v[128:131], a[232:235], a[116:119], v[128:131]
    buffer_load_dwordx4 v3, s[68:71], s35 offen offset:0 sc1 lds
    v_mfma_f32_16x16x32_bf16 v[128:131], a[240:243], a[120:123], v[128:131]
    ds_read_b128 a[100:103], v177 offset:4096
    s_add_u32 s55, s55, 49152
    v_mfma_f32_16x16x32_bf16 v[128:131], a[248:251], a[124:127], v[128:131]
    v_mfma_f32_16x16x32_bf16 v[132:135], a[228:231], a[112:115], v[132:135]
    ds_read_b128 a[104:107], v177 offset:8192
    v_mfma_f32_16x16x32_bf16 v[132:135], a[236:239], a[116:119], v[132:135]
    buffer_load_dwordx4 v3, s[68:71], s35 offen offset:1024 sc1 lds
    v_mfma_f32_16x16x32_bf16 v[132:135], a[244:247], a[120:123], v[132:135]
    ds_read_b128 a[108:111], v177 offset:12288
    v_mfma_f32_16x16x32_bf16 v[132:135], a[252:255], a[124:127], v[132:135]
    s_waitcnt lgkmcnt(4)
    v_mfma_f32_16x16x32_bf16 v[128:131], v[32:35], a[128:131], v[128:131]
    ds_read_b128 a[112:115], v177 offset:16384
    v_mfma_f32_16x16x32_bf16 v[128:131], v[40:43], a[132:135], v[128:131]
    buffer_load_dwordx4 v3, s[68:71], s35 offen offset:2048 sc1 lds
    v_mfma_f32_16x16x32_bf16 v[128:131], v[48:51], a[136:139], v[128:131]
    ds_read_b128 a[116:119], v177 offset:20480
    v_mfma_f32_16x16x32_bf16 v[128:131], v[56:59], a[140:143], v[128:131]
    v_mfma_f32_16x16x32_bf16 v[132:135], v[36:39], a[128:131], v[132:135]
    ds_read_b128 a[120:123], v177 offset:24576
    v_mfma_f32_16x16x32_bf16 v[132:135], v[44:47], a[132:135], v[132:135]
    buffer_load_dwordx4 v3, s[68:71], s35 offen offset:3072 sc1 lds
    v_mfma_f32_16x16x32_bf16 v[132:135], v[52:55], a[136:139], v[132:135]
    ds_read_b128 a[124:127], v177 offset:28672
    v_mfma_f32_16x16x32_bf16 v[132:135], v[60:63], a[140:143], v[132:135]
    s_waitcnt lgkmcnt(4)
    v_mfma_f32_16x16x32_bf16 v[136:139], a[224:227], a[96:99], v[136:139]
    ds_read_b128 a[128:131], v180 offset:0
    s_xor_b32 s35, s35, 32768
    s_add_u32 m0, s10, 32768
    v_mfma_f32_16x16x32_bf16 v[136:139], a[232:235], a[100:103], v[136:139]
    buffer_load_dwordx4 v2, s[68:71], s35 offen offset:0 sc1 lds
    v_mfma_f32_16x16x32_bf16 v[136:139], a[240:243], a[104:107], v[136:139]
    ds_read_b128 a[132:135], v180 offset:4096
    v_mfma_f32_16x16x32_bf16 v[136:139], a[248:251], a[108:111], v[136:139]
    v_mfma_f32_16x16x32_bf16 v[140:143], a[228:231], a[96:99], v[140:143]
    ds_read_b128 a[136:139], v180 offset:8192
    v_mfma_f32_16x16x32_bf16 v[140:143], a[236:239], a[100:103], v[140:143]
    buffer_load_dwordx4 v2, s[68:71], s35 offen offset:1024 sc1 lds
    v_mfma_f32_16x16x32_bf16 v[140:143], a[244:247], a[104:107], v[140:143]
    ds_read_b128 a[140:143], v180 offset:12288
    v_mfma_f32_16x16x32_bf16 v[140:143], a[252:255], a[108:111], v[140:143]
    s_waitcnt lgkmcnt(4)
    v_mfma_f32_16x16x32_bf16 v[136:139], v[32:35], a[112:115], v[136:139]
    ds_read_b128 a[96:99], v180 offset:16384
    v_mfma_f32_16x16x32_bf16 v[136:139], v[40:43], a[116:119], v[136:139]
    buffer_load_dword v9, v14, s[16:19], s36 offen offset:20 sc1
    v_mfma_f32_16x16x32_bf16 v[136:139], v[48:51], a[120:123], v[136:139]
    ds_read_b128 a[100:103], v180 offset:20480
    v_mfma_f32_16x16x32_bf16 v[136:139], v[56:59], a[124:127], v[136:139]
    buffer_load_dwordx4 v2, s[68:71], s35 offen offset:2048 sc1 lds
    v_mfma_f32_16x16x32_bf16 v[140:143], v[36:39], a[112:115], v[140:143]
    ds_read_b128 a[104:107], v180 offset:24576
    v_mfma_f32_16x16x32_bf16 v[140:143], v[44:47], a[116:119], v[140:143]
    v_mfma_f32_16x16x32_bf16 v[140:143], v[52:55], a[120:123], v[140:143]
    ds_read_b128 a[108:111], v180 offset:28672
    v_mfma_f32_16x16x32_bf16 v[140:143], v[60:63], a[124:127], v[140:143]
    s_waitcnt lgkmcnt(4)
    v_mfma_f32_16x16x32_bf16 v[144:147], a[224:227], a[128:131], v[144:147]
    ds_read_b128 a[112:115], v183 offset:0
    v_mfma_f32_16x16x32_bf16 v[144:147], a[232:235], a[132:135], v[144:147]
    buffer_load_dwordx4 v2, s[68:71], s35 offen offset:3072 sc1 lds
    v_mfma_f32_16x16x32_bf16 v[144:147], a[240:243], a[136:139], v[144:147]
    ds_read_b128 a[116:119], v183 offset:4096
    v_mfma_f32_16x16x32_bf16 v[144:147], a[248:251], a[140:143], v[144:147]
    v_mfma_f32_16x16x32_bf16 v[148:151], a[228:231], a[128:131], v[148:151]
    ds_read_b128 a[120:123], v183 offset:8192
    s_add_u32 m0, s10, 36864
    v_mfma_f32_16x16x32_bf16 v[148:151], a[236:239], a[132:135], v[148:151]
    buffer_load_dwordx4 v3, s[68:71], s35 offen offset:0 sc1 lds
    v_mfma_f32_16x16x32_bf16 v[148:151], a[244:247], a[136:139], v[148:151]
    ds_read_b128 a[124:127], v183 offset:12288
    v_mfma_f32_16x16x32_bf16 v[148:151], a[252:255], a[140:143], v[148:151]
    s_waitcnt lgkmcnt(4)
    v_mfma_f32_16x16x32_bf16 v[144:147], v[32:35], a[96:99], v[144:147]
    ds_read_b128 a[128:131], v183 offset:16384
    v_mfma_f32_16x16x32_bf16 v[144:147], v[40:43], a[100:103], v[144:147]
    buffer_load_dwordx4 v3, s[68:71], s35 offen offset:1024 sc1 lds
    v_mfma_f32_16x16x32_bf16 v[144:147], v[48:51], a[104:107], v[144:147]
    ds_read_b128 a[132:135], v183 offset:20480
    v_mfma_f32_16x16x32_bf16 v[144:147], v[56:59], a[108:111], v[144:147]
    v_mfma_f32_16x16x32_bf16 v[148:151], v[36:39], a[96:99], v[148:151]
    ds_read_b128 a[136:139], v183 offset:24576
    v_mfma_f32_16x16x32_bf16 v[148:151], v[44:47], a[100:103], v[148:151]
    buffer_load_dwordx4 v3, s[68:71], s35 offen offset:2048 sc1 lds
    v_mfma_f32_16x16x32_bf16 v[148:151], v[52:55], a[104:107], v[148:151]
    ds_read_b128 a[140:143], v183 offset:28672
    v_mfma_f32_16x16x32_bf16 v[148:151], v[60:63], a[108:111], v[148:151]
    s_and_b32 s41, s42, 4
    s_mov_b32 s11, 200000
    s_waitcnt vmcnt(5)
L_splppa:
    v_readfirstlane_b32 s9, v9
    s_nop 0
    s_cmp_ge_u32 s9, s41
    s_cbranch_scc1 L_backppa
    buffer_load_dword v9, v14, s[16:19], s36 offen offset:20 sc1
    s_sub_u32 s11, s11, 1
    s_waitcnt vmcnt(0)
    s_cbranch_scc0 L_splppa
L_backppa:
    s_waitcnt lgkmcnt(4)
    s_barrier
    v_mfma_f32_16x16x32_bf16 v[152:155], a[224:227], a[112:115], v[152:155]
    ds_read_b128 a[96:99], v172 offset:0
    s_add_u32 s7, s47, 0
    v_mfma_f32_16x16x32_bf16 v[152:155], a[232:235], a[116:119], v[152:155]
    buffer_load_dwordx4 a[144:147], v2, s[96:99], s7 offen sc1
    v_mfma_f32_16x16x32_bf16 v[152:155], a[240:243], a[120:123], v[152:155]
    ds_read_b128 a[100:103], v172 offset:4096
    v_mfma_f32_16x16x32_bf16 v[152:155], a[248:251], a[124:127], v[152:155]
    v_mfma_f32_16x16x32_bf16 v[156:159], a[228:231], a[112:115], v[156:159]
    ds_read_b128 a[104:107], v172 offset:8192
    s_add_u32 s7, s47, 4096
    v_mfma_f32_16x16x32_bf16 v[156:159], a[236:239], a[116:119], v[156:159]
    buffer_load_dwordx4 a[148:151], v2, s[96:99], s7 offen sc1
    v_mfma_f32_16x16x32_bf16 v[156:159], a[244:247], a[120:123], v[156:159]
    ds_read_b128 a[108:111], v172 offset:12288
    v_mfma_f32_16x16x32_bf16 v[156:159], a[252:255], a[124:127], v[156:159]
    s_waitcnt lgkmcnt(4)
    v_mfma_f32_16x16x32_bf16 v[152:155], v[32:35], a[128:131], v[152:155]
    ds_read_b128 a[112:115], v172 offset:16384
    s_add_u32 s7, s47, 8192
    v_mfma_f32_16x16x32_bf16 v[152:155], v[40:43], a[132:135], v[152:155]
    buffer_load_dwordx4 a[152:155], v2, s[96:99], s7 offen sc1
    v_mfma_f32_16x16x32_bf16 v[152:155], v[48:51], a[136:139], v[152:155]
    ds_read_b128 a[116:119], v172 offset:20480
    v_mfma_f32_16x16x32_bf16 v[152:155], v[56:59], a[140:143], v[152:155]
    v_mfma_f32_16x16x32_bf16 v[156:159], v[36:39], a[128:131], v[156:159]
    ds_read_b128 a[120:123], v172 offset:24576
    v_mfma_f32_16x16x32_bf16 v[156:159], v[44:47], a[132:135], v[156:159]
    buffer_load_dwordx4 v3, s[68:71], s35 offen offset:3072 sc1 lds
    v_mfma_f32_16x16x32_bf16 v[156:159], v[52:55], a[136:139], v[156:159]
    ds_read_b128 a[124:127], v172 offset:28672
    v_mfma_f32_16x16x32_bf16 v[156:159], v[60:63], a[140:143], v[156:159]
    s_waitcnt lgkmcnt(4)
    v_mfma_f32_16x16x32_bf16 v[128:131], v[64:67], a[96:99], v[128:131]
    ds_read_b128 a[128:131], v175 offset:0
    s_xor_b32 s35, s35, 98304
    s_add_u32 m0, s10, 65536
    v_mfma_f32_16x16x32_bf16 v[128:131], v[72:75], a[100:103], v[128:131]
    buffer_load_dwordx4 v2, s[84:87], s43 offen offset:0 sc1 lds
    v_mfma_f32_16x16x32_bf16 v[128:131], v[80:83], a[104:107], v[128:131]
    ds_read_b128 a[132:135], v175 offset:4096
    s_nop 0
    v_mfma_f32_16x16x32_bf16 v[128:131], v[88:91], a[108:111], v[128:131]
    v_lshlrev_b32 v104, 16, v192
    v_and_b32 v105, 0xffff0000, v192
    v_mfma_f32_16x16x32_bf16 v[132:135], v[68:71], a[96:99], v[132:135]
    ds_read_b128 a[136:139], v175 offset:8192
    v_lshlrev_b32 v106, 16, v193
    v_mfma_f32_16x16x32_bf16 v[132:135], v[76:79], a[100:103], v[132:135]
    buffer_load_dwordx4 v2, s[84:87], s43 offen offset:1024 sc1 lds
    v_mfma_f32_16x16x32_bf16 v[132:135], v[84:87], a[104:107], v[132:135]
    ds_read_b128 a[140:143], v175 offset:12288
    v_and_b32 v107, 0xffff0000, v193
    v_mfma_f32_16x16x32_bf16 v[132:135], v[92:95], a[108:111], v[132:135]
    v_lshlrev_b32 v108, 16, v194
    v_and_b32 v109, 0xffff0000, v194
    s_waitcnt lgkmcnt(4)
    v_mfma_f32_16x16x32_bf16 v[128:131], a[0:3], a[112:115], v[128:131]
    ds_read_b128 a[96:99], v175 offset:16384
    v_lshlrev_b32 v110, 16, v195
    v_mfma_f32_16x16x32_bf16 v[128:131], a[8:11], a[116:119], v[128:131]
    buffer_load_dwordx4 v2, s[84:87], s43 offen offset:2048 sc1 lds
    v_mfma_f32_16x16x32_bf16 v[128:131], a[16:19], a[120:123], v[128:131]
    ds_read_b128 a[100:103], v175 offset:20480
    v_and_b32 v111, 0xffff0000, v195
    v_mfma_f32_16x16x32_bf16 v[128:131], a[24:27], a[124:127], v[128:131]
    v_lshlrev_b32 v112, 16, v196
    v_and_b32 v113, 0xffff0000, v196
    v_mfma_f32_16x16x32_bf16 v[132:135], a[4:7], a[112:115], v[132:135]
    ds_read_b128 a[104:107], v175 offset:24576
    v_lshlrev_b32 v114, 16, v197
    v_mfma_f32_16x16x32_bf16 v[132:135], a[12:15], a[116:119], v[132:135]
    buffer_load_dwordx4 v2, s[84:87], s43 offen offset:3072 sc1 lds
    v_mfma_f32_16x16x32_bf16 v[132:135], a[20:23], a[120:123], v[132:135]
    ds_read_b128 a[108:111], v175 offset:28672
    v_and_b32 v115, 0xffff0000, v197
    v_mfma_f32_16x16x32_bf16 v[132:135], a[28:31], a[124:127], v[132:135]
    v_lshlrev_b32 v116, 16, v198
    v_and_b32 v117, 0xffff0000, v198
    s_waitcnt lgkmcnt(4)
    v_mfma_f32_16x16x32_bf16 v[136:139], v[64:67], a[128:131], v[136:139]
    ds_read_b128 a[112:115], v178 offset:0
    s_add_u32 m0, s10, 69632
    v_mfma_f32_16x16x32_bf16 v[136:139], v[72:75], a[132:135], v[136:139]
    buffer_load_dwordx4 v3, s[84:87], s43 offen offset:0 sc1 lds
    v_mfma_f32_16x16x32_bf16 v[136:139], v[80:83], a[136:139], v[136:139]
    ds_read_b128 a[116:119], v178 offset:4096
    v_lshlrev_b32 v118, 16, v199
    v_mfma_f32_16x16x32_bf16 v[136:139], v[88:91], a[140:143], v[136:139]
    v_and_b32 v119, 0xffff0000, v199
    v_lshlrev_b32 v120, 16, v200
    v_mfma_f32_16x16x32_bf16 v[140:143], v[68:71], a[128:131], v[140:143]
    ds_read_b128 a[120:123], v178 offset:8192
    v_and_b32 v121, 0xffff0000, v200
    v_mfma_f32_16x16x32_bf16 v[140:143], v[76:79], a[132:135], v[140:143]
    buffer_load_dwordx4 v3, s[84:87], s43 offen offset:1024 sc1 lds
    v_mfma_f32_16x16x32_bf16 v[140:143], v[84:87], a[136:139], v[140:143]
    ds_read_b128 a[124:127], v178 offset:12288
    v_lshlrev_b32 v122, 16, v201
    v_mfma_f32_16x16x32_bf16 v[140:143], v[92:95], a[140:143], v[140:143]
    v_and_b32 v123, 0xffff0000, v201
    v_lshlrev_b32 v124, 16, v202
    s_waitcnt lgkmcnt(4)
    v_mfma_f32_16x16x32_bf16 v[136:139], a[0:3], a[96:99], v[136:139]
    ds_read_b128 a[128:131], v178 offset:16384
    v_and_b32 v125, 0xffff0000, v202
    v_mfma_f32_16x16x32_bf16 v[136:139], a[8:11], a[100:103], v[136:139]
    buffer_load_dwordx4 v3, s[84:87], s43 offen offset:2048 sc1 lds
    v_mfma_f32_16x16x32_bf16 v[136:139], a[16:19], a[104:107], v[136:139]
    ds_read_b128 a[132:135], v178 offset:20480
    v_lshlrev_b32 v126, 16, v203
    v_mfma_f32_16x16x32_bf16 v[136:139], a[24:27], a[108:111], v[136:139]
    v_and_b32 v127, 0xffff0000, v203
    v_mfma_f32_16x16x32_bf16 v[140:143], a[4:7], a[96:99], v[140:143]
    ds_read_b128 a[136:139], v178 offset:24576
    v_mfma_f32_16x16x32_bf16 v[140:143], a[12:15], a[100:103], v[140:143]
    buffer_load_dwordx4 v3, s[84:87], s43 offen offset:3072 sc1 lds
    v_mfma_f32_16x16x32_bf16 v[140:143], a[20:23], a[104:107], v[140:143]
    ds_read_b128 a[140:143], v178 offset:28672
    v_mfma_f32_16x16x32_bf16 v[140:143], a[28:31], a[108:111], v[140:143]
    s_waitcnt lgkmcnt(4)
    s_waitcnt vmcnt(9)
    v_mfma_f32_16x16x32_bf16 v[96:99], v[222:225], a[156:159], v[96:99]
    v_mfma_f32_16x16x32_bf16 v[100:103], v[220:223], a[156:159], v[100:103]
    v_mfma_f32_16x16x32_bf16 v[96:99], v[222:225], a[144:147], v[96:99]
    v_mfma_f32_16x16x32_bf16 v[100:103], v[220:223], a[144:147], v[100:103]
    v_mfma_f32_16x16x32_bf16 v[96:99], v[222:225], a[148:151], v[96:99]
    v_mfma_f32_16x16x32_bf16 v[100:103], v[220:223], a[148:151], v[100:103]
    v_mfma_f32_16x16x32_bf16 v[96:99], v[222:225], a[152:155], v[96:99]
    v_mfma_f32_16x16x32_bf16 v[100:103], v[220:223], a[152:155], v[100:103]
    v_mfma_f32_16x16x32_bf16 v[144:147], v[64:67], a[112:115], v[144:147]
    ds_read_b128 a[96:99], v181 offset:0
    s_add_u32 s43, s43, 32768
    s_add_u32 m0, s10, 98304
    v_mfma_f32_16x16x32_bf16 v[144:147], v[72:75], a[116:119], v[144:147]
    buffer_load_dwordx4 v2, s[84:87], s43 offen offset:0 sc1 lds
    v_mfma_f32_16x16x32_bf16 v[144:147], v[80:83], a[120:123], v[144:147]
    ds_read_b128 a[100:103], v181 offset:4096
    v_mfma_f32_16x16x32_bf16 v[144:147], v[88:91], a[124:127], v[144:147]
    v_mfma_f32_16x16x32_bf16 v[148:151], v[68:71], a[112:115], v[148:151]
    ds_read_b128 a[104:107], v181 offset:8192
    v_mfma_f32_16x16x32_bf16 v[148:151], v[76:79], a[116:119], v[148:151]
    buffer_load_dwordx4 v2, s[84:87], s43 offen offset:1024 sc1 lds
    v_mfma_f32_16x16x32_bf16 v[148:151], v[84:87], a[120:123], v[148:151]
    ds_read_b128 a[108:111], v181 offset:12288
    v_mfma_f32_16x16x32_bf16 v[148:151], v[92:95], a[124:127], v[148:151]
    s_waitcnt lgkmcnt(4)
    v_cvt_pk_bf16_f32 v216, v96, v97
    v_cvt_pk_bf16_f32 v217, v98, v99
    v_cvt_pk_bf16_f32 v218, v100, v101
    v_cvt_pk_bf16_f32 v219, v102, v103
    buffer_store_dwordx4 v[216:219], v2, s[76:79], s44 offen sc1
    s_add_u32 s44, s44, 1048576
    v_mfma_f32_16x16x32_bf16 v[208:211], v[216:219], v[216:219], 0
    v_mfma_f32_16x16x32_bf16 v[212:215], v[28:31], v[216:219], 0
    v_mfma_f32_16x16x32_bf16 v[144:147], a[0:3], a[128:131], v[144:147]
    ds_read_b128 a[112:115], v181 offset:16384
    v_mfma_f32_16x16x32_bf16 v[144:147], a[8:11], a[132:135], v[144:147]
    buffer_load_dwordx4 v2, s[84:87], s43 offen offset:2048 sc1 lds
    v_mfma_f32_16x16x32_bf16 v[144:147], a[16:19], a[136:139], v[144:147]
    ds_read_b128 a[116:119], v181 offset:20480
    v_mfma_f32_16x16x32_bf16 v[144:147], a[24:27], a[140:143], v[144:147]
    v_mfma_f32_16x16x32_bf16 v[148:151], a[4:7], a[128:131], v[148:151]
    ds_read_b128 a[120:123], v181 offset:24576
    v_mfma_f32_16x16x32_bf16 v[148:151], a[12:15], a[132:135], v[148:151]
    buffer_load_dwordx4 v2, s[84:87], s43 offen offset:3072 sc1 lds
    v_mfma_f32_16x16x32_bf16 v[148:151], a[20:23], a[136:139], v[148:151]
    ds_read_b128 a[124:127], v181 offset:28672
    v_mfma_f32_16x16x32_bf16 v[148:151], a[28:31], a[140:143], v[148:151]
    s_waitcnt vmcnt(13) lgkmcnt(4)
    s_barrier
    v_cndmask_b32 v208, v208, v209, s[56:57]
    v_cndmask_b32 v208, v208, v210, s[64:65]
    v_cndmask_b32 v208, v208, v211, s[20:21]
    v_cndmask_b32 v208, v212, v208, s[22:23]
    buffer_store_dword v208, v10, s[80:83], s46 offen sc1
    s_add_u32 s46, s46, 131072
    v_mfma_f32_16x16x32_bf16 v[152:155], v[64:67], a[96:99], v[152:155]
    ds_read_b128 a[128:131], v175 offset:32768
    s_add_u32 m0, s10, 102400
    v_mfma_f32_16x16x32_bf16 v[152:155], v[72:75], a[100:103], v[152:155]
    buffer_load_dwordx4 v3, s[84:87], s43 offen offset:0 sc1 lds
    v_mfma_f32_16x16x32_bf16 v[152:155], v[80:83], a[104:107], v[152:155]
    ds_read_b128 a[132:135], v175 offset:36864
    v_mfma_f32_16x16x32_bf16 v[152:155], v[88:91], a[108:111], v[152:155]
    v_mfma_f32_16x16x32_bf16 v[156:159], v[68:71], a[96:99], v[156:159]
    ds_read_b128 a[136:139], v175 offset:40960
    v_mfma_f32_16x16x32_bf16 v[156:159], v[76:79], a[100:103], v[156:159]
    buffer_load_dwordx4 v3, s[84:87], s43 offen offset:1024 sc1 lds
    v_mfma_f32_16x16x32_bf16 v[156:159], v[84:87], a[104:107], v[156:159]
    ds_read_b128 a[140:143], v175 offset:45056
    v_mfma_f32_16x16x32_bf16 v[156:159], v[92:95], a[108:111], v[156:159]
    s_waitcnt lgkmcnt(4)
    v_mfma_f32_16x16x32_bf16 v[152:155], a[0:3], a[112:115], v[152:155]
    ds_read_b128 a[96:99], v175 offset:49152
    v_mfma_f32_16x16x32_bf16 v[152:155], a[8:11], a[116:119], v[152:155]
    buffer_load_dwordx4 v3, s[84:87], s43 offen offset:2048 sc1 lds
    v_mfma_f32_16x16x32_bf16 v[152:155], a[16:19], a[120:123], v[152:155]
    ds_read_b128 a[100:103], v175 offset:53248
    v_mfma_f32_16x16x32_bf16 v[152:155], a[24:27], a[124:127], v[152:155]
    v_mfma_f32_16x16x32_bf16 v[156:159], a[4:7], a[112:115], v[156:159]
    ds_read_b128 a[104:107], v175 offset:57344
    v_mfma_f32_16x16x32_bf16 v[156:159], a[12:15], a[116:119], v[156:159]
    buffer_load_dwordx4 v3, s[84:87], s43 offen offset:3072 sc1 lds
    v_mfma_f32_16x16x32_bf16 v[156:159], a[20:23], a[120:123], v[156:159]
    ds_read_b128 a[108:111], v175 offset:61440
    v_mfma_f32_16x16x32_bf16 v[156:159], a[28:31], a[124:127], v[156:159]
    s_waitcnt lgkmcnt(4)
    v_mfma_f32_16x16x32_bf16 v[136:139], a[32:35], a[128:131], v[136:139]
    ds_read_b128 a[112:115], v178 offset:32768
    s_add_u32 s43, s43, 32768
    s_add_u32 m0, s10, 131072
    v_mfma_f32_16x16x32_bf16 v[136:139], a[40:43], a[132:135], v[136:139]
    buffer_load_dwordx4 v2, s[84:87], s43 offen offset:0 sc1 lds
    v_mfma_f32_16x16x32_bf16 v[136:139], a[48:51], a[136:139], v[136:139]
    ds_read_b128 a[116:119], v178 offset:36864
    v_mfma_f32_16x16x32_bf16 v[136:139], a[56:59], a[140:143], v[136:139]
    v_mfma_f32_16x16x32_bf16 v[140:143], a[36:39], a[128:131], v[140:143]
    ds_read_b128 a[120:123], v178 offset:40960
    v_mfma_f32_16x16x32_bf16 v[140:143], a[44:47], a[132:135], v[140:143]
    buffer_load_dwordx4 v2, s[84:87], s43 offen offset:1024 sc1 lds
    v_mfma_f32_16x16x32_bf16 v[140:143], a[52:55], a[136:139], v[140:143]
    ds_read_b128 a[124:127], v178 offset:45056
    v_mfma_f32_16x16x32_bf16 v[140:143], a[60:63], a[140:143], v[140:143]
    s_waitcnt lgkmcnt(4)
    v_mfma_f32_16x16x32_bf16 v[136:139], a[64:67], a[96:99], v[136:139]
    ds_read_b128 a[128:131], v178 offset:49152
    v_mfma_f32_16x16x32_bf16 v[136:139], a[72:75], a[100:103], v[136:139]
    buffer_load_dwordx4 v2, s[84:87], s43 offen offset:2048 sc1 lds
    v_mfma_f32_16x16x32_bf16 v[136:139], a[80:83], a[104:107], v[136:139]
    ds_read_b128 a[132:135], v178 offset:53248
    v_mfma_f32_16x16x32_bf16 v[136:139], a[88:91], a[108:111], v[136:139]
    v_mfma_f32_16x16x32_bf16 v[140:143], a[68:71], a[96:99], v[140:143]
    ds_read_b128 a[136:139], v178 offset:57344
    v_mfma_f32_16x16x32_bf16 v[140:143], a[76:79], a[100:103], v[140:143]
    buffer_load_dwordx4 v2, s[84:87], s43 offen offset:3072 sc1 lds
    v_mfma_f32_16x16x32_bf16 v[140:143], a[84:87], a[104:107], v[140:143]
    ds_read_b128 a[140:143], v178 offset:61440
    v_mfma_f32_16x16x32_bf16 v[140:143], a[92:95], a[108:111], v[140:143]
    s_waitcnt lgkmcnt(4)
    v_mfma_f32_16x16x32_bf16 v[144:147], a[32:35], a[112:115], v[144:147]
    ds_read_b128 a[96:99], v181 offset:32768
    s_add_u32 m0, s10, 135168
    v_mfma_f32_16x16x32_bf16 v[144:147], a[40:43], a[116:119], v[144:147]
    buffer_load_dwordx4 v3, s[84:87], s43 offen offset:0 sc1 lds
    v_mfma_f32_16x16x32_bf16 v[144:147], a[48:51], a[120:123], v[144:147]
    ds_read_b128 a[100:103], v181 offset:36864
    v_mfma_f32_16x16x32_bf16 v[144:147], a[56:59], a[124:127], v[144:147]
    v_mfma_f32_16x16x32_bf16 v[148:151], a[36:39], a[112:115], v[148:151]
    ds_read_b128 a[104:107], v181 offset:40960
    v_cvt_pk_bf16_f32 v160, v136, v137
    v_mfma_f32_16x16x32_bf16 v[148:151], a[44:47], a[116:119], v[148:151]
    buffer_load_dwordx4 v3, s[84:87], s43 offen offset:1024 sc1 lds
    v_mfma_f32_16x16x32_bf16 v[148:151], a[52:55], a[120:123], v[148:151]
    ds_read_b128 a[108:111], v181 offset:45056
    v_cvt_pk_bf16_f32 v161, v138, v139
    v_mfma_f32_16x16x32_bf16 v[148:151], a[60:63], a[124:127], v[148:151]
    v_cvt_pk_bf16_f32 v162, v140, v141
    v_cvt_pk_bf16_f32 v163, v142, v143
    s_waitcnt lgkmcnt(4)
    v_mfma_f32_16x16x32_bf16 v[144:147], a[64:67], a[128:131], v[144:147]
    ds_read_b128 a[112:115], v181 offset:49152
    v_mfma_f32_16x16x32_bf16 v[144:147], a[72:75], a[132:135], v[144:147]
    buffer_store_dwordx4 v[160:163], v2, s[96:99], s53 offen sc1
    v_mfma_f32_16x16x32_bf16 v[144:147], a[80:83], a[136:139], v[144:147]
    ds_read_b128 a[116:119], v181 offset:53248
    v_mfma_f32_16x16x32_bf16 v[144:147], a[88:91], a[140:143], v[144:147]
    v_mfma_f32_16x16x32_bf16 v[148:151], a[68:71], a[128:131], v[148:151]
    ds_read_b128 a[120:123], v181 offset:57344
    v_mfma_f32_16x16x32_bf16 v[148:151], a[76:79], a[132:135], v[148:151]
    v_mfma_f32_16x16x32_bf16 v[148:151], a[84:87], a[136:139], v[148:151]
    ds_read_b128 a[124:127], v181 offset:61440
    v_mfma_f32_16x16x32_bf16 v[148:151], a[92:95], a[140:143], v[148:151]
    s_waitcnt vmcnt(7) lgkmcnt(4)
    s_barrier
    s_cmp_lg_u32 s3, 0
    s_cbranch_scc1 L_sg14
    buffer_atomic_add v8, v7, s[16:19], s38 offen offset:4
L_sg14:
    v_mfma_f32_16x16x32_bf16 v[152:155], a[32:35], a[96:99], v[152:155]
    ds_read_b128 a[128:131], v172 offset:32768
    v_mfma_f32_16x16x32_bf16 v[152:155], a[40:43], a[100:103], v[152:155]
    buffer_load_dwordx4 v3, s[84:87], s43 offen offset:2048 sc1 lds
    v_mfma_f32_16x16x32_bf16 v[152:155], a[48:51], a[104:107], v[152:155]
    ds_read_b128 a[132:135], v172 offset:36864
    v_mfma_f32_16x16x32_bf16 v[152:155], a[56:59], a[108:111], v[152:155]
    v_mfma_f32_16x16x32_bf16 v[156:159], a[36:39], a[96:99], v[156:159]
    ds_read_b128 a[136:139], v172 offset:40960
    v_cvt_pk_bf16_f32 v164, v144, v145
    v_mfma_f32_16x16x32_bf16 v[156:159], a[44:47], a[100:103], v[156:159]
    buffer_load_dwordx4 v3, s[84:87], s43 offen offset:3072 sc1 lds
    v_mfma_f32_16x16x32_bf16 v[156:159], a[52:55], a[104:107], v[156:159]
    ds_read_b128 a[140:143], v172 offset:45056
    v_cvt_pk_bf16_f32 v165, v146, v147
    v_mfma_f32_16x16x32_bf16 v[156:159], a[60:63], a[108:111], v[156:159]
    v_cvt_pk_bf16_f32 v166, v148, v149
    v_cvt_pk_bf16_f32 v167, v150, v151
    s_waitcnt lgkmcnt(4)
    v_mfma_f32_16x16x32_bf16 v[152:155], a[64:67], a[112:115], v[152:155]
    ds_read_b128 a[96:99], v172 offset:49152
    v_mfma_f32_16x16x32_bf16 v[152:155], a[72:75], a[116:119], v[152:155]
    buffer_store_dwordx4 v[164:167], v2, s[96:99], s54 offen sc1
    v_mfma_f32_16x16x32_bf16 v[152:155], a[80:83], a[120:123], v[152:155]
    ds_read_b128 a[100:103], v172 offset:53248
    v_mfma_f32_16x16x32_bf16 v[152:155], a[88:91], a[124:127], v[152:155]
    v_mfma_f32_16x16x32_bf16 v[156:159], a[68:71], a[112:115], v[156:159]
    ds_read_b128 a[104:107], v172 offset:57344
    v_mfma_f32_16x16x32_bf16 v[156:159], a[76:79], a[116:119], v[156:159]
    v_mfma_f32_16x16x32_bf16 v[156:159], a[84:87], a[120:123], v[156:159]
    ds_read_b128 a[108:111], v172 offset:61440
    v_mfma_f32_16x16x32_bf16 v[156:159], a[92:95], a[124:127], v[156:159]
    s_waitcnt lgkmcnt(4)
    v_mfma_f32_16x16x32_bf16 v[128:131], a[32:35], a[128:131], v[128:131]
    s_add_u32 s43, s43, 32768
    v_mfma_f32_16x16x32_bf16 v[128:131], a[40:43], a[132:135], v[128:131]
    v_mfma_f32_16x16x32_bf16 v[128:131], a[48:51], a[136:139], v[128:131]
    v_mfma_f32_16x16x32_bf16 v[128:131], a[56:59], a[140:143], v[128:131]
    v_mfma_f32_16x16x32_bf16 v[132:135], a[36:39], a[128:131], v[132:135]
    v_cvt_pk_bf16_f32 v168, v152, v153
    v_cvt_pk_bf16_f32 v169, v154, v155
    v_mfma_f32_16x16x32_bf16 v[132:135], a[44:47], a[132:135], v[132:135]
    v_cvt_pk_bf16_f32 v170, v156, v157
    v_cvt_pk_bf16_f32 v171, v158, v159
    v_mfma_f32_16x16x32_bf16 v[132:135], a[52:55], a[136:139], v[132:135]
    v_mfma_f32_16x16x32_bf16 v[132:135], a[60:63], a[140:143], v[132:135]
    s_waitcnt lgkmcnt(0)
    v_mfma_f32_16x16x32_bf16 v[128:131], a[64:67], a[96:99], v[128:131]
    v_mfma_f32_16x16x32_bf16 v[128:131], a[72:75], a[100:103], v[128:131]
    buffer_store_dwordx4 v[168:171], v2, s[96:99], s55 offen sc1
    v_mfma_f32_16x16x32_bf16 v[128:131], a[80:83], a[104:107], v[128:131]
    v_mfma_f32_16x16x32_bf16 v[128:131], a[88:91], a[108:111], v[128:131]
    v_mfma_f32_16x16x32_bf16 v[132:135], a[68:71], a[96:99], v[132:135]
    v_mfma_f32_16x16x32_bf16 v[132:135], a[76:79], a[100:103], v[132:135]
    v_mfma_f32_16x16x32_bf16 v[132:135], a[84:87], a[104:107], v[132:135]
    v_mfma_f32_16x16x32_bf16 v[132:135], a[92:95], a[108:111], v[132:135]
    ds_read_b128 a[96:99], v184 offset:0
    ds_read_b128 a[100:103], v184 offset:1024
    ds_read_b128 a[104:107], v184 offset:2048
    ds_read_b128 a[108:111], v184 offset:3072
    ds_read_b128 a[112:115], v186 offset:0
    ds_read_b128 a[116:119], v186 offset:1024
    ds_read_b128 a[120:123], v186 offset:2048
    ds_read_b128 a[124:127], v186 offset:3072
    ds_read_b128 a[128:131], v188 offset:0
    ds_read_b128 a[132:135], v188 offset:1024
    ds_read_b128 a[136:139], v188 offset:2048
    ds_read_b128 a[140:143], v188 offset:3072
    s_waitcnt lgkmcnt(8)
    v_mfma_f32_16x16x32_bf16 v[232:235], a[96:99], v[28:31], 0
    ds_read_b128 a[96:99], v190 offset:0
    v_mfma_f32_16x16x32_bf16 v[232:235], a[100:103], v[28:31], v[232:235]
    ds_read_b128 a[100:103], v190 offset:1024
    v_mfma_f32_16x16x32_bf16 v[232:235], a[104:107], v[28:31], v[232:235]
    ds_read_b128 a[104:107], v190 offset:2048
    v_mfma_f32_16x16x32_bf16 v[232:235], a[108:111], v[28:31], v[232:235]
    ds_read_b128 a[108:111], v190 offset:3072
    s_waitcnt lgkmcnt(8)
    v_mfma_f32_16x16x32_bf16 v[232:235], a[112:115], v[28:31], v[232:235]
    ds_read_b128 a[112:115], v184 offset:16384
    v_mfma_f32_16x16x32_bf16 v[232:235], a[116:119], v[28:31], v[232:235]
    ds_read_b128 a[116:119], v184 offset:17408
    v_mfma_f32_16x16x32_bf16 v[232:235], a[120:123], v[28:31], v[232:235]
    ds_read_b128 a[120:123], v184 offset:18432
    v_mfma_f32_16x16x32_bf16 v[232:235], a[124:127], v[28:31], v[232:235]
    ds_read_b128 a[124:127], v184 offset:19456
    s_waitcnt lgkmcnt(8)
    v_mfma_f32_16x16x32_bf16 v[232:235], a[128:131], v[28:31], v[232:235]
    ds_read_b128 a[128:131], v186 offset:16384
    v_mfma_f32_16x16x32_bf16 v[232:235], a[132:135], v[28:31], v[232:235]
    ds_read_b128 a[132:135], v186 offset:17408
    v_mfma_f32_16x16x32_bf16 v[232:235], a[136:139], v[28:31], v[232:235]
    ds_read_b128 a[136:139], v186 offset:18432
    buffer_load_dword v9, v14, s[16:19], s37 offen offset:4 sc1
    v_mfma_f32_16x16x32_bf16 v[232:235], a[140:143], v[28:31], v[232:235]
    ds_read_b128 a[140:143], v186 offset:19456
    s_waitcnt lgkmcnt(8)
    v_mfma_f32_16x16x32_bf16 v[232:235], a[96:99], v[28:31], v[232:235]
    ds_read_b128 a[96:99], v188 offset:16384
    v_mfma_f32_16x16x32_bf16 v[232:235], a[100:103], v[28:31], v[232:235]
    ds_read_b128 a[100:103], v188 offset:17408
    v_mfma_f32_16x16x32_bf16 v[232:235], a[104:107], v[28:31], v[232:235]
    ds_read_b128 a[104:107], v188 offset:18432
    v_mfma_f32_16x16x32_bf16 v[232:235], a[108:111], v[28:31], v[232:235]
    ds_read_b128 a[108:111], v188 offset:19456
    s_waitcnt lgkmcnt(8)
    v_mfma_f32_16x16x32_bf16 v[236:239], a[112:115], v[28:31], 0
    ds_read_b128 a[112:115], v190 offset:16384
    v_mfma_f32_16x16x32_bf16 v[236:239], a[116:119], v[28:31], v[236:239]
    ds_read_b128 a[116:119], v190 offset:17408
    v_mfma_f32_16x16x32_bf16 v[236:239], a[120:123], v[28:31], v[236:239]
    ds_read_b128 a[120:123], v190 offset:18432
    v_mfma_f32_16x16x32_bf16 v[236:239], a[124:127], v[28:31], v[236:239]
    ds_read_b128 a[124:127], v190 offset:19456
    s_waitcnt lgkmcnt(8)
    v_mfma_f32_16x16x32_bf16 v[236:239], a[128:131], v[28:31], v[236:239]
    ds_read_b128 a[128:131], v184 offset:32768
    v_mfma_f32_16x16x32_bf16 v[236:239], a[132:135], v[28:31], v[236:239]
    ds_read_b128 a[132:135], v184 offset:33792
    v_mfma_f32_16x16x32_bf16 v[236:239], a[136:139], v[28:31], v[236:239]
    ds_read_b128 a[136:139], v184 offset:34816
    v_mfma_f32_16x16x32_bf16 v[236:239], a[140:143], v[28:31], v[236:239]
    ds_read_b128 a[140:143], v184 offset:35840
    s_waitcnt lgkmcnt(8)
    v_mfma_f32_16x16x32_bf16 v[236:239], a[96:99], v[28:31], v[236:239]
    ds_read_b128 a[96:99], v186 offset:32768
    v_mfma_f32_16x16x32_bf16 v[236:239], a[100:103], v[28:31], v[236:239]
    ds_read_b128 a[100:103], v186 offset:33792
    v_mfma_f32_16x16x32_bf16 v[236:239], a[104:107], v[28:31], v[236:239]
    ds_read_b128 a[104:107], v186 offset:34816
    v_mfma_f32_16x16x32_bf16 v[236:239], a[108:111], v[28:31], v[236:239]
    ds_read_b128 a[108:111], v186 offset:35840
    s_waitcnt lgkmcnt(8)
    v_mfma_f32_16x16x32_bf16 v[236:239], a[112:115], v[28:31], v[236:239]
    ds_read_b128 a[112:115], v188 offset:32768
    v_mfma_f32_16x16x32_bf16 v[236:239], a[116:119], v[28:31], v[236:239]
    ds_read_b128 a[116:119], v188 offset:33792
    v_mfma_f32_16x16x32_bf16 v[236:239], a[120:123], v[28:31], v[236:239]
    ds_read_b128 a[120:123], v188 offset:34816
    v_mfma_f32_16x16x32_bf16 v[236:239], a[124:127], v[28:31], v[236:239]
    ds_read_b128 a[124:127], v188 offset:35840
    s_waitcnt lgkmcnt(8)
    v_mfma_f32_16x16x32_bf16 v[240:243], a[128:131], v[28:31], 0
    ds_read_b128 a[128:131], v190 offset:32768
    v_mfma_f32_16x16x32_bf16 v[240:243], a[132:135], v[28:31], v[240:243]
    ds_read_b128 a[132:135], v190 offset:33792
    v_mfma_f32_16x16x32_bf16 v[240:243], a[136:139], v[28:31], v[240:243]
    ds_read_b128 a[136:139], v190 offset:34816
    v_mfma_f32_16x16x32_bf16 v[240:243], a[140:143], v[28:31], v[240:243]
    ds_read_b128 a[140:143], v190 offset:35840
    s_waitcnt lgkmcnt(8)
    v_mfma_f32_16x16x32_bf16 v[240:243], a[96:99], v[28:31], v[240:243]
    ds_read_b128 a[96:99], v184 offset:49152
    v_mfma_f32_16x16x32_bf16 v[240:243], a[100:103], v[28:31], v[240:243]
    ds_read_b128 a[100:103], v184 offset:50176
    v_mfma_f32_16x16x32_bf16 v[240:243], a[104:107], v[28:31], v[240:243]
    ds_read_b128 a[104:107], v184 offset:51200
    v_mfma_f32_16x16x32_bf16 v[240:243], a[108:111], v[28:31], v[240:243]
    ds_read_b128 a[108:111], v184 offset:52224
    s_and_b32 s41, s42, 16
    s_mov_b32 s11, 200000
    s_waitcnt vmcnt(0)
L_splp3a:
    v_readfirstlane_b32 s9, v9
    s_nop 0
    s_cmp_ge_u32 s9, s41
    s_cbranch_scc1 L_backp3a
    buffer_load_dword v9, v14, s[16:19], s37 offen offset:4 sc1
    s_sub_u32 s11, s11, 1
    s_waitcnt vmcnt(0)
    s_cbranch_scc0 L_splp3a
L_backp3a:
    s_nop 0
    s_barrier
    s_cmp_lg_u32 s3, 0
    s_cbranch_scc1 L_sg15
    buffer_atomic_add v8, v15, s[16:19], s40 offen offset:40
L_sg15:
    s_waitcnt lgkmcnt(8)
    v_mfma_f32_16x16x32_bf16 v[240:243], a[112:115], v[28:31], v[240:243]
    ds_read_b128 a[112:115], v186 offset:49152
    s_xor_b32 s7, s48, 0
    buffer_load_dwordx4 a[32:35], v2, s[76:79], s7 offen offset:0 sc1
    v_mfma_f32_16x16x32_bf16 v[240:243], a[116:119], v[28:31], v[240:243]
    ds_read_b128 a[116:119], v186 offset:50176
    v_mfma_f32_16x16x32_bf16 v[240:243], a[120:123], v[28:31], v[240:243]
    ds_read_b128 a[120:123], v186 offset:51200
    v_mfma_f32_16x16x32_bf16 v[240:243], a[124:127], v[28:31], v[240:243]
    ds_read_b128 a[124:127], v186 offset:52224
    s_waitcnt lgkmcnt(8)
    v_mfma_f32_16x16x32_bf16 v[240:243], a[128:131], v[28:31], v[240:243]
    ds_read_b128 a[128:131], v188 offset:49152
    buffer_load_dwordx4 a[36:39], v2, s[76:79], s7 offen offset:1024 sc1
    v_mfma_f32_16x16x32_bf16 v[240:243], a[132:135], v[28:31], v[240:243]
    ds_read_b128 a[132:135], v188 offset:50176
    v_mfma_f32_16x16x32_bf16 v[240:243], a[136:139], v[28:31], v[240:243]
    ds_read_b128 a[136:139], v188 offset:51200
    v_mfma_f32_16x16x32_bf16 v[240:243], a[140:143], v[28:31], v[240:243]
    ds_read_b128 a[140:143], v188 offset:52224
    s_waitcnt lgkmcnt(8)
    v_mfma_f32_16x16x32_bf16 v[244:247], a[96:99], v[28:31], 0
    ds_read_b128 a[96:99], v190 offset:49152
    buffer_load_dwordx4 a[40:43], v2, s[76:79], s7 offen offset:2048 sc1
    v_mfma_f32_16x16x32_bf16 v[244:247], a[100:103], v[28:31], v[244:247]
    ds_read_b128 a[100:103], v190 offset:50176
    v_mfma_f32_16x16x32_bf16 v[244:247], a[104:107], v[28:31], v[244:247]
    ds_read_b128 a[104:107], v190 offset:51200
    v_mfma_f32_16x16x32_bf16 v[244:247], a[108:111], v[28:31], v[244:247]
    ds_read_b128 a[108:111], v190 offset:52224
    s_waitcnt lgkmcnt(8)
    v_mfma_f32_16x16x32_bf16 v[244:247], a[112:115], v[28:31], v[244:247]
    ds_read_b128 a[112:115], v185 offset:0
    buffer_load_dwordx4 a[44:47], v2, s[76:79], s7 offen offset:3072 sc1
    v_mfma_f32_16x16x32_bf16 v[244:247], a[116:119], v[28:31], v[244:247]
    ds_read_b128 a[116:119], v185 offset:1024
    v_mfma_f32_16x16x32_bf16 v[244:247], a[120:123], v[28:31], v[244:247]
    ds_read_b128 a[120:123], v185 offset:2048
    v_mfma_f32_16x16x32_bf16 v[244:247], a[124:127], v[28:31], v[244:247]
    ds_read_b128 a[124:127], v185 offset:3072
    s_waitcnt lgkmcnt(8)
    v_mfma_f32_16x16x32_bf16 v[244:247], a[128:131], v[28:31], v[244:247]
    ds_read_b128 a[128:131], v187 offset:0
    s_xor_b32 s7, s48, 4096
    buffer_load_dwordx4 a[48:51], v2, s[76:79], s7 offen offset:0 sc1
    v_mfma_f32_16x16x32_bf16 v[244:247], a[132:135], v[28:31], v[244:247]
    ds_read_b128 a[132:135], v187 offset:1024
    v_mfma_f32_16x16x32_bf16 v[244:247], a[136:139], v[28:31], v[244:247]
    ds_read_b128 a[136:139], v187 offset:2048
    v_mfma_f32_16x16x32_bf16 v[244:247], a[140:143], v[28:31], v[244:247]
    ds_read_b128 a[140:143], v187 offset:3072
    s_waitcnt lgkmcnt(8)
    v_mfma_f32_16x16x32_bf16 v[244:247], a[96:99], v[28:31], v[244:247]
    ds_read_b128 a[96:99], v189 offset:0
    buffer_load_dwordx4 a[52:55], v2, s[76:79], s7 offen offset:1024 sc1
    v_mfma_f32_16x16x32_bf16 v[244:247], a[100:103], v[28:31], v[244:247]
    ds_read_b128 a[100:103], v189 offset:1024
    v_mfma_f32_16x16x32_bf16 v[244:247], a[104:107], v[28:31], v[244:247]
    ds_read_b128 a[104:107], v189 offset:2048
    v_mfma_f32_16x16x32_bf16 v[244:247], a[108:111], v[28:31], v[244:247]
    ds_read_b128 a[108:111], v189 offset:3072
    s_waitcnt lgkmcnt(8)
    v_mfma_f32_16x16x32_bf16 v[248:251], a[112:115], v[28:31], 0
    ds_read_b128 a[112:115], v191 offset:0
    buffer_load_dwordx4 a[56:59], v2, s[76:79], s7 offen offset:2048 sc1
    v_mfma_f32_16x16x32_bf16 v[248:251], a[116:119], v[28:31], v[248:251]
    ds_read_b128 a[116:119], v191 offset:1024
    v_mfma_f32_16x16x32_bf16 v[248:251], a[120:123], v[28:31], v[248:251]
    ds_read_b128 a[120:123], v191 offset:2048
    v_mfma_f32_16x16x32_bf16 v[248:251], a[124:127], v[28:31], v[248:251]
    ds_read_b128 a[124:127], v191 offset:3072
    s_waitcnt lgkmcnt(8)
    v_mfma_f32_16x16x32_bf16 v[248:251], a[128:131], v[28:31], v[248:251]
    ds_read_b128 a[128:131], v185 offset:16384
    buffer_load_dwordx4 a[60:63], v2, s[76:79], s7 offen offset:3072 sc1
    v_mfma_f32_16x16x32_bf16 v[248:251], a[132:135], v[28:31], v[248:251]
    ds_read_b128 a[132:135], v185 offset:17408
    v_mfma_f32_16x16x32_bf16 v[248:251], a[136:139], v[28:31], v[248:251]
    ds_read_b128 a[136:139], v185 offset:18432
    v_mfma_f32_16x16x32_bf16 v[248:251], a[140:143], v[28:31], v[248:251]
    ds_read_b128 a[140:143], v185 offset:19456
    s_waitcnt lgkmcnt(8)
    v_mfma_f32_16x16x32_bf16 v[248:251], a[96:99], v[28:31], v[248:251]
    ds_read_b128 a[96:99], v187 offset:16384
    buffer_load_dword v6, v14, s[16:19], s36 offen offset:40 sc1
    v_mfma_f32_16x16x32_bf16 v[248:251], a[100:103], v[28:31], v[248:251]
    ds_read_b128 a[100:103], v187 offset:17408
    s_xor_b32 s7, s48, 8192
    buffer_load_dwordx4 a[64:67], v2, s[76:79], s7 offen offset:0 sc1
    v_mfma_f32_16x16x32_bf16 v[248:251], a[104:107], v[28:31], v[248:251]
    ds_read_b128 a[104:107], v187 offset:18432
    v_mfma_f32_16x16x32_bf16 v[248:251], a[108:111], v[28:31], v[248:251]
    ds_read_b128 a[108:111], v187 offset:19456
    s_waitcnt lgkmcnt(8)
    v_mfma_f32_16x16x32_bf16 v[248:251], a[112:115], v[28:31], v[248:251]
    ds_read_b128 a[112:115], v189 offset:16384
    v_mfma_f32_16x16x32_bf16 v[248:251], a[116:119], v[28:31], v[248:251]
    ds_read_b128 a[116:119], v189 offset:17408
    buffer_load_dwordx4 a[68:71], v2, s[76:79], s7 offen offset:1024 sc1
    v_mfma_f32_16x16x32_bf16 v[248:251], a[120:123], v[28:31], v[248:251]
    ds_read_b128 a[120:123], v189 offset:18432
    v_mfma_f32_16x16x32_bf16 v[248:251], a[124:127], v[28:31], v[248:251]
    ds_read_b128 a[124:127], v189 offset:19456
    s_waitcnt lgkmcnt(8)
    v_mfma_f32_16x16x32_bf16 v[252:255], a[128:131], v[28:31], 0
    ds_read_b128 a[128:131], v191 offset:16384
    v_mfma_f32_16x16x32_bf16 v[252:255], a[132:135], v[28:31], v[252:255]
    ds_read_b128 a[132:135], v191 offset:17408
    buffer_load_dwordx4 a[72:75], v2, s[76:79], s7 offen offset:2048 sc1
    v_mfma_f32_16x16x32_bf16 v[252:255], a[136:139], v[28:31], v[252:255]
    ds_read_b128 a[136:139], v191 offset:18432
    v_mfma_f32_16x16x32_bf16 v[252:255], a[140:143], v[28:31], v[252:255]
    ds_read_b128 a[140:143], v191 offset:19456
    s_waitcnt lgkmcnt(8)
    v_mfma_f32_16x16x32_bf16 v[252:255], a[96:99], v[28:31], v[252:255]
    ds_read_b128 a[96:99], v184 offset:0
    v_mfma_f32_16x16x32_bf16 v[252:255], a[100:103], v[28:31], v[252:255]
    ds_read_b128 a[100:103], v184 offset:1024
    buffer_load_dwordx4 a[76:79], v2, s[76:79], s7 offen offset:3072 sc1
    v_mfma_f32_16x16x32_bf16 v[252:255], a[104:107], v[28:31], v[252:255]
    ds_read_b128 a[104:107], v184 offset:2048
    v_mfma_f32_16x16x32_bf16 v[252:255], a[108:111], v[28:31], v[252:255]
    ds_read_b128 a[108:111], v184 offset:3072
    s_waitcnt lgkmcnt(8)
    v_mfma_f32_16x16x32_bf16 v[252:255], a[112:115], v[28:31], v[252:255]
    ds_read_b128 a[112:115], v184 offset:16384
    v_mfma_f32_16x16x32_bf16 v[252:255], a[116:119], v[28:31], v[252:255]
    ds_read_b128 a[116:119], v184 offset:17408
    s_xor_b32 s7, s48, 12288
    buffer_load_dwordx4 a[80:83], v2, s[76:79], s7 offen offset:0 sc1
    v_mfma_f32_16x16x32_bf16 v[252:255], a[120:123], v[28:31], v[252:255]
    ds_read_b128 a[120:123], v184 offset:18432
    v_mfma_f32_16x16x32_bf16 v[252:255], a[124:127], v[28:31], v[252:255]
    ds_read_b128 a[124:127], v184 offset:19456
    s_waitcnt lgkmcnt(8)
    v_mfma_f32_16x16x32_bf16 v[252:255], a[128:131], v[28:31], v[252:255]
    ds_read_b128 a[128:131], v184 offset:32768
    v_mfma_f32_16x16x32_bf16 v[252:255], a[132:135], v[28:31], v[252:255]
    ds_read_b128 a[132:135], v184 offset:33792
    buffer_load_dwordx4 a[84:87], v2, s[76:79], s7 offen offset:1024 sc1
    v_mfma_f32_16x16x32_bf16 v[252:255], a[136:139], v[28:31], v[252:255]
    ds_read_b128 a[136:139], v184 offset:34816
    s_and_b32 s41, s42, 4
    s_mov_b32 s11, 200000
    s_waitcnt vmcnt(6)
L_splppb:
    v_readfirstlane_b32 s9, v6
    s_nop 0
    s_cmp_ge_u32 s9, s41
    s_cbranch_scc1 L_backppb
    buffer_load_dword v6, v14, s[16:19], s36 offen offset:40 sc1
    s_sub_u32 s11, s11, 1
    s_waitcnt vmcnt(0)
    s_cbranch_scc0 L_splppb
L_backppb:
    s_barrier
    s_add_u32 s8, s47, 49152
    buffer_load_dwordx4 a[144:147], v2, s[96:99], s8 offen sc1
    s_add_u32 s8, s47, 53248
    buffer_load_dwordx4 a[148:151], v2, s[96:99], s8 offen sc1
    s_add_u32 s8, s47, 57344
    buffer_load_dwordx4 a[152:155], v2, s[96:99], s8 offen sc1
    v_mfma_f32_16x16x32_bf16 v[252:255], a[140:143], v[28:31], v[252:255]
    ds_read_b128 a[140:143], v184 offset:35840
    s_waitcnt lgkmcnt(8)
    v_mfma_f32_16x16x32_bf16 v[136:139], a[96:99], a[32:35], 0
    ds_read_b128 a[96:99], v184 offset:49152
    v_mfma_f32_16x16x32_bf16 v[136:139], a[100:103], a[36:39], v[136:139]
    ds_read_b128 a[100:103], v184 offset:50176
    buffer_load_dwordx4 a[88:91], v2, s[76:79], s7 offen offset:2048 sc1
    v_mfma_f32_16x16x32_bf16 v[136:139], a[104:107], a[40:43], v[136:139]
    ds_read_b128 a[104:107], v184 offset:51200
    v_mfma_f32_16x16x32_bf16 v[136:139], a[108:111], a[44:47], v[136:139]
    ds_read_b128 a[108:111], v184 offset:52224
    s_waitcnt lgkmcnt(8)
    v_mfma_f32_16x16x32_bf16 v[140:143], a[112:115], a[32:35], 0
    ds_read_b128 a[112:115], v185 offset:0
    v_mfma_f32_16x16x32_bf16 v[140:143], a[116:119], a[36:39], v[140:143]
    ds_read_b128 a[116:119], v185 offset:1024
    buffer_load_dwordx4 a[92:95], v2, s[76:79], s7 offen offset:3072 sc1
    v_mfma_f32_16x16x32_bf16 v[140:143], a[120:123], a[40:43], v[140:143]
    ds_read_b128 a[120:123], v185 offset:2048
    v_mfma_f32_16x16x32_bf16 v[140:143], a[124:127], a[44:47], v[140:143]
    ds_read_b128 a[124:127], v185 offset:3072
    s_waitcnt lgkmcnt(8)
    v_mfma_f32_16x16x32_bf16 v[144:147], a[128:131], a[32:35], 0
    ds_read_b128 a[128:131], v185 offset:16384
    v_mfma_f32_16x16x32_bf16 v[144:147], a[132:135], a[36:39], v[144:147]
    ds_read_b128 a[132:135], v185 offset:17408
    s_add_u32 s7, s49, 0
    buffer_load_dword v160, v11, s[80:83], s7 offen offset:0 sc1
    v_mfma_f32_16x16x32_bf16 v[144:147], a[136:139], a[40:43], v[144:147]
    ds_read_b128 a[136:139], v185 offset:18432
    buffer_load_dword v161, v11, s[80:83], s7 offen offset:256 sc1
    v_mfma_f32_16x16x32_bf16 v[144:147], a[140:143], a[44:47], v[144:147]
    ds_read_b128 a[140:143], v185 offset:19456
    buffer_load_dword v162, v11, s[80:83], s7 offen offset:512 sc1
    s_waitcnt lgkmcnt(8)
    v_mfma_f32_16x16x32_bf16 v[148:151], a[96:99], a[32:35], 0
    ds_read_b128 a[96:99], v186 offset:0
    buffer_load_dword v163, v11, s[80:83], s7 offen offset:768 sc1
    v_mfma_f32_16x16x32_bf16 v[148:151], a[100:103], a[36:39], v[148:151]
    ds_read_b128 a[100:103], v186 offset:1024
    buffer_load_dword v164, v11, s[80:83], s7 offen offset:1024 sc1
    v_mfma_f32_16x16x32_bf16 v[148:151], a[104:107], a[40:43], v[148:151]
    ds_read_b128 a[104:107], v186 offset:2048
    buffer_load_dword v165, v11, s[80:83], s7 offen offset:1280 sc1
    v_mfma_f32_16x16x32_bf16 v[148:151], a[108:111], a[44:47], v[148:151]
    ds_read_b128 a[108:111], v186 offset:3072
    buffer_load_dword v166, v11, s[80:83], s7 offen offset:1536 sc1
    s_waitcnt lgkmcnt(8)
    v_mfma_f32_16x16x32_bf16 v[152:155], a[112:115], a[32:35], 0
    ds_read_b128 a[112:115], v186 offset:16384
    buffer_load_dword v167, v11, s[80:83], s7 offen offset:1792 sc1
    v_mfma_f32_16x16x32_bf16 v[152:155], a[116:119], a[36:39], v[152:155]
    ds_read_b128 a[116:119], v186 offset:17408
    s_xor_b32 s28, s52, 0
    s_add_u32 s28, s28, s51
    buffer_load_dwordx4 a[160:163], v18, s[24:27], s28 offen offset:0 sc1
    v_mfma_f32_16x16x32_bf16 v[152:155], a[120:123], a[40:43], v[152:155]
    ds_read_b128 a[120:123], v186 offset:18432
    v_mfma_f32_16x16x32_bf16 v[152:155], a[124:127], a[44:47], v[152:155]
    ds_read_b128 a[124:127], v186 offset:19456
    s_waitcnt lgkmcnt(8)
    v_mfma_f32_16x16x32_bf16 v[156:159], a[128:131], a[32:35], 0
    ds_read_b128 a[128:131], v186 offset:32768
    v_mfma_f32_16x16x32_bf16 v[156:159], a[132:135], a[36:39], v[156:159]
    ds_read_b128 a[132:135], v186 offset:33792
    buffer_load_dwordx4 a[164:167], v18, s[24:27], s28 offen offset:1024 sc1
    v_mfma_f32_16x16x32_bf16 v[156:159], a[136:139], a[40:43], v[156:159]
    ds_read_b128 a[136:139], v186 offset:34816
    v_mfma_f32_16x16x32_bf16 v[156:159], a[140:143], a[44:47], v[156:159]
    ds_read_b128 a[140:143], v186 offset:35840
    s_waitcnt lgkmcnt(8)
    v_mfma_f32_16x16x32_bf16 v[136:139], a[96:99], a[48:51], v[136:139]
    ds_read_b128 a[96:99], v186 offset:49152
    v_mfma_f32_16x16x32_bf16 v[136:139], a[100:103], a[52:55], v[136:139]
    ds_read_b128 a[100:103], v186 offset:50176
    buffer_load_dwordx4 a[168:171], v19, s[24:27], s28 offen offset:0 sc1
    v_mfma_f32_16x16x32_bf16 v[136:139], a[104:107], a[56:59], v[136:139]
    ds_read_b128 a[104:107], v186 offset:51200
    v_mfma_f32_16x16x32_bf16 v[136:139], a[108:111], a[60:63], v[136:139]
    ds_read_b128 a[108:111], v186 offset:52224
    s_waitcnt lgkmcnt(8)
    v_mfma_f32_16x16x32_bf16 v[140:143], a[112:115], a[48:51], v[140:143]
    ds_read_b128 a[112:115], v187 offset:0
    v_mfma_f32_16x16x32_bf16 v[140:143], a[116:119], a[52:55], v[140:143]
    ds_read_b128 a[116:119], v187 offset:1024
    buffer_load_dwordx4 a[172:175], v19, s[24:27], s28 offen offset:1024 sc1
    v_mfma_f32_16x16x32_bf16 v[140:143], a[120:123], a[56:59], v[140:143]
    ds_read_b128 a[120:123], v187 offset:2048
    v_mfma_f32_16x16x32_bf16 v[140:143], a[124:127], a[60:63], v[140:143]
    ds_read_b128 a[124:127], v187 offset:3072
    s_waitcnt lgkmcnt(8)
    v_mfma_f32_16x16x32_bf16 v[144:147], a[128:131], a[48:51], v[144:147]
    ds_read_b128 a[128:131], v187 offset:16384
    v_mfma_f32_16x16x32_bf16 v[144:147], a[132:135], a[52:55], v[144:147]
    ds_read_b128 a[132:135], v187 offset:17408
    s_xor_b32 s28, s52, 4096
    s_add_u32 s28, s28, s51
    buffer_load_dwordx4 a[176:179], v18, s[24:27], s28 offen offset:0 sc1
    v_mfma_f32_16x16x32_bf16 v[144:147], a[136:139], a[56:59], v[144:147]
    ds_read_b128 a[136:139], v187 offset:18432
    v_mfma_f32_16x16x32_bf16 v[144:147], a[140:143], a[60:63], v[144:147]
    ds_read_b128 a[140:143], v187 offset:19456
    s_waitcnt lgkmcnt(8)
    v_mfma_f32_16x16x32_bf16 v[148:151], a[96:99], a[48:51], v[148:151]
    ds_read_b128 a[96:99], v188 offset:0
    v_mfma_f32_16x16x32_bf16 v[148:151], a[100:103], a[52:55], v[148:151]
    ds_read_b128 a[100:103], v188 offset:1024
    buffer_load_dwordx4 a[180:183], v18, s[24:27], s28 offen offset:1024 sc1
    v_mfma_f32_16x16x32_bf16 v[148:151], a[104:107], a[56:59], v[148:151]
    ds_read_b128 a[104:107], v188 offset:2048
    s_waitcnt vmcnt(16)
    v_mfma_f32_16x16x32_bf16 v[128:131], v[222:225], v[204:207], v[128:131]
    v_mfma_f32_16x16x32_bf16 v[132:135], v[220:223], v[204:207], v[132:135]
    v_mfma_f32_16x16x32_bf16 v[128:131], v[222:225], a[144:147], v[128:131]
    v_mfma_f32_16x16x32_bf16 v[132:135], v[220:223], a[144:147], v[132:135]
    v_mfma_f32_16x16x32_bf16 v[128:131], v[222:225], a[148:151], v[128:131]
    v_mfma_f32_16x16x32_bf16 v[132:135], v[220:223], a[148:151], v[132:135]
    v_mfma_f32_16x16x32_bf16 v[128:131], v[222:225], a[152:155], v[128:131]
    v_mfma_f32_16x16x32_bf16 v[132:135], v[220:223], a[152:155], v[132:135]
    v_mfma_f32_16x16x32_bf16 v[148:151], a[108:111], a[60:63], v[148:151]
    ds_read_b128 a[108:111], v188 offset:3072
    s_waitcnt lgkmcnt(8)
    v_mfma_f32_16x16x32_bf16 v[152:155], a[112:115], a[48:51], v[152:155]
    ds_read_b128 a[112:115], v188 offset:16384
    v_mfma_f32_16x16x32_bf16 v[152:155], a[116:119], a[52:55], v[152:155]
    ds_read_b128 a[116:119], v188 offset:17408
    buffer_load_dwordx4 a[184:187], v19, s[24:27], s28 offen offset:0 sc1
    v_mfma_f32_16x16x32_bf16 v[152:155], a[120:123], a[56:59], v[152:155]
    ds_read_b128 a[120:123], v188 offset:18432
    v_mfma_f32_16x16x32_bf16 v[152:155], a[124:127], a[60:63], v[152:155]
    ds_read_b128 a[124:127], v188 offset:19456
    s_waitcnt lgkmcnt(8)
    v_mfma_f32_16x16x32_bf16 v[156:159], a[128:131], a[48:51], v[156:159]
    ds_read_b128 a[128:131], v188 offset:32768
    v_cvt_pk_bf16_f32 v216, v128, v129
    v_cvt_pk_bf16_f32 v217, v130, v131
    v_cvt_pk_bf16_f32 v218, v132, v133
    v_cvt_pk_bf16_f32 v219, v134, v135
    buffer_store_dwordx4 v[216:219], v2, s[76:79], s44 offen sc1
    s_add_u32 s44, s44, 1048576
    v_mfma_f32_16x16x32_bf16 v[208:211], v[216:219], v[216:219], 0
    v_mfma_f32_16x16x32_bf16 v[212:215], v[28:31], v[216:219], 0
    v_mfma_f32_16x16x32_bf16 v[156:159], a[132:135], a[52:55], v[156:159]
    ds_read_b128 a[132:135], v188 offset:33792
    buffer_load_dwordx4 a[188:191], v19, s[24:27], s28 offen offset:1024 sc1
    v_mfma_f32_16x16x32_bf16 v[156:159], a[136:139], a[56:59], v[156:159]
    ds_read_b128 a[136:139], v188 offset:34816
    v_mfma_f32_16x16x32_bf16 v[156:159], a[140:143], a[60:63], v[156:159]
    ds_read_b128 a[140:143], v188 offset:35840
    s_waitcnt lgkmcnt(8)
    v_mfma_f32_16x16x32_bf16 v[136:139], a[96:99], a[64:67], v[136:139]
    ds_read_b128 a[96:99], v188 offset:49152
    v_mfma_f32_16x16x32_bf16 v[136:139], a[100:103], a[68:71], v[136:139]
    ds_read_b128 a[100:103], v188 offset:50176
    v_mfma_f32_16x16x32_bf16 v[136:139], a[104:107], a[72:75], v[136:139]
    ds_read_b128 a[104:107], v188 offset:51200
    v_cndmask_b32 v208, v208, v209, s[56:57]
    v_cndmask_b32 v208, v208, v210, s[64:65]
    v_cndmask_b32 v208, v208, v211, s[20:21]
    v_cndmask_b32 v208, v212, v208, s[22:23]
    buffer_store_dword v208, v10, s[80:83], s46 offen sc1
    s_add_u32 s46, s46, 131072
    v_mfma_f32_16x16x32_bf16 v[136:139], a[108:111], a[76:79], v[136:139]
    ds_read_b128 a[108:111], v188 offset:52224
    s_xor_b32 s28, s52, 8192
    s_add_u32 s28, s28, s51
    buffer_load_dwordx4 a[192:195], v18, s[24:27], s28 offen offset:0 sc1
    s_waitcnt lgkmcnt(8)
    v_mfma_f32_16x16x32_bf16 v[140:143], a[112:115], a[64:67], v[140:143]
    ds_read_b128 a[112:115], v189 offset:0
    v_mfma_f32_16x16x32_bf16 v[140:143], a[116:119], a[68:71], v[140:143]
    ds_read_b128 a[116:119], v189 offset:1024
    v_mfma_f32_16x16x32_bf16 v[140:143], a[120:123], a[72:75], v[140:143]
    ds_read_b128 a[120:123], v189 offset:2048
    v_mfma_f32_16x16x32_bf16 v[140:143], a[124:127], a[76:79], v[140:143]
    ds_read_b128 a[124:127], v189 offset:3072
    buffer_load_dwordx4 a[196:199], v18, s[24:27], s28 offen offset:1024 sc1
    s_waitcnt lgkmcnt(8)
    v_mfma_f32_16x16x32_bf16 v[144:147], a[128:131], a[64:67], v[144:147]
    ds_read_b128 a[128:131], v189 offset:16384
    v_mfma_f32_16x16x32_bf16 v[144:147], a[132:135], a[68:71], v[144:147]
    ds_read_b128 a[132:135], v189 offset:17408
    v_mfma_f32_16x16x32_bf16 v[144:147], a[136:139], a[72:75], v[144:147]
    ds_read_b128 a[136:139], v189 offset:18432
    v_mfma_f32_16x16x32_bf16 v[144:147], a[140:143], a[76:79], v[144:147]
    ds_read_b128 a[140:143], v189 offset:19456
    buffer_load_dwordx4 a[200:203], v19, s[24:27], s28 offen offset:0 sc1
    s_waitcnt lgkmcnt(8)
    v_mfma_f32_16x16x32_bf16 v[148:151], a[96:99], a[64:67], v[148:151]
    ds_read_b128 a[96:99], v190 offset:0
    s_waitcnt vmcnt(13)
    v_mfma_f32_16x16x32_bf16 v[148:151], a[100:103], a[68:71], v[148:151]
    ds_read_b128 a[100:103], v190 offset:1024
    v_add_f32 v160, v160, v164
    v_mfma_f32_16x16x32_bf16 v[148:151], a[104:107], a[72:75], v[148:151]
    ds_read_b128 a[104:107], v190 offset:2048
    v_add_f32 v161, v161, v165
    v_mfma_f32_16x16x32_bf16 v[148:151], a[108:111], a[76:79], v[148:151]
    ds_read_b128 a[108:111], v190 offset:3072
    buffer_load_dwordx4 a[204:207], v19, s[24:27], s28 offen offset:1024 sc1
    s_waitcnt lgkmcnt(8)
    v_mfma_f32_16x16x32_bf16 v[152:155], a[112:115], a[64:67], v[152:155]
    ds_read_b128 a[112:115], v190 offset:16384
    v_add_f32 v162, v162, v166
    v_mfma_f32_16x16x32_bf16 v[152:155], a[116:119], a[68:71], v[152:155]
    ds_read_b128 a[116:119], v190 offset:17408
    v_add_f32 v163, v163, v167
    v_mfma_f32_16x16x32_bf16 v[152:155], a[120:123], a[72:75], v[152:155]
    ds_read_b128 a[120:123], v190 offset:18432
    v_add_f32 v160, v160, v162
    v_mfma_f32_16x16x32_bf16 v[152:155], a[124:127], a[76:79], v[152:155]
    ds_read_b128 a[124:127], v190 offset:19456
    s_xor_b32 s28, s52, 12288
    s_add_u32 s28, s28, s51
    buffer_load_dwordx4 a[208:211], v18, s[24:27], s28 offen offset:0 sc1
    s_waitcnt lgkmcnt(8)
    v_mfma_f32_16x16x32_bf16 v[156:159], a[128:131], a[64:67], v[156:159]
    ds_read_b128 a[128:131], v190 offset:32768
    v_add_f32 v161, v161, v163
    v_mfma_f32_16x16x32_bf16 v[156:159], a[132:135], a[68:71], v[156:159]
    ds_read_b128 a[132:135], v190 offset:33792
    v_add_f32 v160, v160, v161
    v_mfma_f32_16x16x32_bf16 v[156:159], a[136:139], a[72:75], v[156:159]
    ds_read_b128 a[136:139], v190 offset:34816
    v_mov_b32 v161, v160
    v_mfma_f32_16x16x32_bf16 v[156:159], a[140:143], a[76:79], v[156:159]
    ds_read_b128 a[140:143], v190 offset:35840
    buffer_load_dwordx4 a[212:215], v18, s[24:27], s28 offen offset:1024 sc1
    s_waitcnt lgkmcnt(8)
    v_mfma_f32_16x16x32_bf16 v[136:139], a[96:99], a[80:83], v[136:139]
    ds_read_b128 a[96:99], v190 offset:49152
    v_permlane32_swap_b32 v160, v161
    v_mfma_f32_16x16x32_bf16 v[136:139], a[100:103], a[84:87], v[136:139]
    ds_read_b128 a[100:103], v190 offset:50176
    v_add_f32 v160, v160, v161
    v_mfma_f32_16x16x32_bf16 v[136:139], a[104:107], a[88:91], v[136:139]
    ds_read_b128 a[104:107], v190 offset:51200
    v_mul_f32 v160, 0x3b000000, v160
    v_mfma_f32_16x16x32_bf16 v[136:139], a[108:111], a[92:95], v[136:139]
    ds_read_b128 a[108:111], v190 offset:52224
    buffer_load_dwordx4 a[216:219], v19, s[24:27], s28 offen offset:0 sc1
    s_waitcnt lgkmcnt(8)
    v_mfma_f32_16x16x32_bf16 v[140:143], a[112:115], a[80:83], v[140:143]
    ds_read_b128 a[112:115], v191 offset:0
    v_mov_b32 v161, v160
    v_mfma_f32_16x16x32_bf16 v[140:143], a[116:119], a[84:87], v[140:143]
    ds_read_b128 a[116:119], v191 offset:1024
    v_permlane16_swap_b32 v160, v161
    v_mfma_f32_16x16x32_bf16 v[140:143], a[120:123], a[88:91], v[140:143]
    ds_read_b128 a[120:123], v191 offset:2048
    v_fma_f32 v161, -v160, v160, v161
    v_mfma_f32_16x16x32_bf16 v[140:143], a[124:127], a[92:95], v[140:143]
    ds_read_b128 a[124:127], v191 offset:3072
    buffer_load_dwordx4 a[220:223], v19, s[24:27], s28 offen offset:1024 sc1
    s_waitcnt lgkmcnt(8)
    v_mfma_f32_16x16x32_bf16 v[144:147], a[128:131], a[80:83], v[144:147]
    ds_read_b128 a[128:131], v191 offset:16384
    v_max_f32 v161, 0, v161
    v_mfma_f32_16x16x32_bf16 v[144:147], a[132:135], a[84:87], v[144:147]
    ds_read_b128 a[132:135], v191 offset:17408
    v_add_f32 v162, 0x3727c5ac, v161
    v_mfma_f32_16x16x32_bf16 v[144:147], a[136:139], a[88:91], v[144:147]
    ds_read_b128 a[136:139], v191 offset:18432
    v_rsq_f32 v162, v162
    v_mfma_f32_16x16x32_bf16 v[144:147], a[140:143], a[92:95], v[144:147]
    ds_read_b128 a[140:143], v191 offset:19456
    s_waitcnt lgkmcnt(8)
    v_mfma_f32_16x16x32_bf16 v[148:151], a[96:99], a[80:83], v[148:151]
    ds_read_b128 a[96:99], v184 offset:0
    v_mul_f32 v163, v162, v162
    v_mfma_f32_16x16x32_bf16 v[148:151], a[100:103], a[84:87], v[148:151]
    ds_read_b128 a[100:103], v184 offset:1024
    v_mul_f32 v163, v163, v161
    v_mfma_f32_16x16x32_bf16 v[148:151], a[104:107], a[88:91], v[148:151]
    ds_read_b128 a[104:107], v184 offset:2048
    v_add_f32 v163, 0x3727c5ac, v163
    v_mfma_f32_16x16x32_bf16 v[148:151], a[108:111], a[92:95], v[148:151]
    ds_read_b128 a[108:111], v184 offset:3072
    s_waitcnt lgkmcnt(8)
    v_mfma_f32_16x16x32_bf16 v[152:155], a[112:115], a[80:83], v[152:155]
    ds_read_b128 a[112:115], v184 offset:16384
    v_rsq_f32 v163, v163
    v_mfma_f32_16x16x32_bf16 v[152:155], a[116:119], a[84:87], v[152:155]
    ds_read_b128 a[116:119], v184 offset:17408
    v_mul_f32 v26, v162, v163
    v_mfma_f32_16x16x32_bf16 v[152:155], a[120:123], a[88:91], v[152:155]
    ds_read_b128 a[120:123], v184 offset:18432
    v_mul_f32 v27, -v160, v26
    v_mfma_f32_16x16x32_bf16 v[152:155], a[124:127], a[92:95], v[152:155]
    ds_read_b128 a[124:127], v184 offset:19456
    s_waitcnt lgkmcnt(8)
    v_mfma_f32_16x16x32_bf16 v[156:159], a[128:131], a[80:83], v[156:159]
    ds_read_b128 a[128:131], v184 offset:32768
    v_mfma_f32_16x16x32_bf16 v[156:159], a[132:135], a[84:87], v[156:159]
    ds_read_b128 a[132:135], v184 offset:33792
    s_waitcnt vmcnt(8)
    s_barrier
    s_cmp_lg_u32 s3, 0
    s_cbranch_scc1 L_sg16
    buffer_atomic_add v8, v7, s[16:19], s38 offen offset:32
L_sg16:
    v_mfma_f32_16x16x32_bf16 v[156:159], a[136:139], a[88:91], v[156:159]
    ds_read_b128 a[136:139], v184 offset:34816
    s_xor_b32 s28, s52, 16384
    s_add_u32 s28, s28, s51
    buffer_load_dwordx4 a[224:227], v18, s[24:27], s28 offen offset:0 sc1
    v_mfma_f32_16x16x32_bf16 v[156:159], a[140:143], a[92:95], v[156:159]
    ds_read_b128 a[140:143], v184 offset:35840
    v_pk_fma_f32 v[172:173], v[26:27], v[232:233], v[104:105] op_sel:[1,0,0]
    v_pk_fma_f32 v[174:175], v[26:27], v[234:235], v[106:107] op_sel:[1,0,0]
    v_pk_fma_f32 v[176:177], v[26:27], v[236:237], v[108:109] op_sel:[1,0,0]
    v_pk_fma_f32 v[178:179], v[26:27], v[238:239], v[110:111] op_sel:[1,0,0]
    v_pk_fma_f32 v[136:137], v[26:27], v[136:137], v[172:173] op_sel_hi:[0,1,1]
    v_pk_fma_f32 v[138:139], v[26:27], v[138:139], v[174:175] op_sel_hi:[0,1,1]
    v_pk_fma_f32 v[140:141], v[26:27], v[140:141], v[176:177] op_sel_hi:[0,1,1]
    v_pk_fma_f32 v[142:143], v[26:27], v[142:143], v[178:179] op_sel_hi:[0,1,1]
    v_pk_mul_f32 v[172:173], v[136:137], v[136:137]
    v_pk_mul_f32 v[174:175], v[138:139], v[138:139]
    v_pk_mul_f32 v[176:177], v[140:141], v[140:141]
    v_pk_mul_f32 v[178:179], v[142:143], v[142:143]
    v_pk_fma_f32 v[172:173], v[172:173], v[228:229], v[228:229] op_sel:[0,0,1] op_sel_hi:[1,0,1]
    buffer_load_dwordx4 a[228:231], v18, s[24:27], s28 offen offset:1024 sc1
    v_pk_fma_f32 v[174:175], v[174:175], v[228:229], v[228:229] op_sel:[0,0,1] op_sel_hi:[1,0,1]
    v_pk_fma_f32 v[176:177], v[176:177], v[228:229], v[228:229] op_sel:[0,0,1] op_sel_hi:[1,0,1]
    v_pk_fma_f32 v[178:179], v[178:179], v[228:229], v[228:229] op_sel:[0,0,1] op_sel_hi:[1,0,1]
    v_pk_mul_f32 v[172:173], v[172:173], v[136:137]
    v_pk_mul_f32 v[174:175], v[174:175], v[138:139]
    v_pk_mul_f32 v[176:177], v[176:177], v[140:141]
    v_pk_mul_f32 v[178:179], v[178:179], v[142:143]
    v_exp_f32 v172, v172
    v_exp_f32 v173, v173
    v_exp_f32 v174, v174
    v_exp_f32 v175, v175
    v_exp_f32 v176, v176
    buffer_load_dwordx4 a[232:235], v19, s[24:27], s28 offen offset:0 sc1
    v_exp_f32 v177, v177
    v_exp_f32 v178, v178
    v_exp_f32 v179, v179
    v_pk_add_f32 v[172:173], v[172:173], v[230:231] op_sel_hi:[1,0]
    v_pk_add_f32 v[174:175], v[174:175], v[230:231] op_sel_hi:[1,0]
    v_pk_add_f32 v[176:177], v[176:177], v[230:231] op_sel_hi:[1,0]
    v_pk_add_f32 v[178:179], v[178:179], v[230:231] op_sel_hi:[1,0]
    v_rcp_f32 v172, v172
    v_rcp_f32 v173, v173
    v_rcp_f32 v174, v174
    v_rcp_f32 v175, v175
    buffer_load_dwordx4 a[236:239], v19, s[24:27], s28 offen offset:1024 sc1
    v_rcp_f32 v176, v176
    v_rcp_f32 v177, v177
    v_rcp_f32 v178, v178
    v_rcp_f32 v179, v179
    v_pk_mul_f32 v[136:137], v[136:137], v[172:173]
    v_pk_mul_f32 v[138:139], v[138:139], v[174:175]
    v_pk_mul_f32 v[140:141], v[140:141], v[176:177]
    v_pk_mul_f32 v[142:143], v[142:143], v[178:179]
    v_cvt_pk_bf16_f32 v192, v136, v137
    v_cvt_pk_bf16_f32 v193, v138, v139
    v_cvt_pk_bf16_f32 v194, v140, v141
    v_cvt_pk_bf16_f32 v195, v142, v143
    s_add_u32 s8, s50, 0
    buffer_store_dwordx4 v[192:195], v2, s[92:95], s8 offen sc1
    s_xor_b32 s28, s52, 20480
    s_add_u32 s28, s28, s51
    buffer_load_dwordx4 a[240:243], v18, s[24:27], s28 offen offset:0 sc1
    v_pk_fma_f32 v[172:173], v[26:27], v[240:241], v[112:113] op_sel:[1,0,0]
    v_pk_fma_f32 v[174:175], v[26:27], v[242:243], v[114:115] op_sel:[1,0,0]
    v_pk_fma_f32 v[176:177], v[26:27], v[244:245], v[116:117] op_sel:[1,0,0]
    v_pk_fma_f32 v[178:179], v[26:27], v[246:247], v[118:119] op_sel:[1,0,0]
    v_pk_fma_f32 v[144:145], v[26:27], v[144:145], v[172:173] op_sel_hi:[0,1,1]
    v_pk_fma_f32 v[146:147], v[26:27], v[146:147], v[174:175] op_sel_hi:[0,1,1]
    v_pk_fma_f32 v[148:149], v[26:27], v[148:149], v[176:177] op_sel_hi:[0,1,1]
    v_pk_fma_f32 v[150:151], v[26:27], v[150:151], v[178:179] op_sel_hi:[0,1,1]
    v_pk_mul_f32 v[172:173], v[144:145], v[144:145]
    v_pk_mul_f32 v[174:175], v[146:147], v[146:147]
    v_pk_mul_f32 v[176:177], v[148:149], v[148:149]
    v_pk_mul_f32 v[178:179], v[150:151], v[150:151]
    v_pk_fma_f32 v[172:173], v[172:173], v[228:229], v[228:229] op_sel:[0,0,1] op_sel_hi:[1,0,1]
    v_pk_fma_f32 v[174:175], v[174:175], v[228:229], v[228:229] op_sel:[0,0,1] op_sel_hi:[1,0,1]
    v_pk_fma_f32 v[176:177], v[176:177], v[228:229], v[228:229] op_sel:[0,0,1] op_sel_hi:[1,0,1]
    v_pk_fma_f32 v[178:179], v[178:179], v[228:229], v[228:229] op_sel:[0,0,1] op_sel_hi:[1,0,1]
    v_pk_mul_f32 v[172:173], v[172:173], v[144:145]
    buffer_load_dwordx4 a[244:247], v18, s[24:27], s28 offen offset:1024 sc1
    v_pk_mul_f32 v[174:175], v[174:175], v[146:147]
    v_pk_mul_f32 v[176:177], v[176:177], v[148:149]
    v_pk_mul_f32 v[178:179], v[178:179], v[150:151]
    v_exp_f32 v172, v172
    v_exp_f32 v173, v173
    v_exp_f32 v174, v174
    v_exp_f32 v175, v175
    v_exp_f32 v176, v176
    v_exp_f32 v177, v177
    v_exp_f32 v178, v178
    buffer_load_dwordx4 a[248:251], v19, s[24:27], s28 offen offset:0 sc1
    v_exp_f32 v179, v179
    v_pk_add_f32 v[172:173], v[172:173], v[230:231] op_sel_hi:[1,0]
    v_pk_add_f32 v[174:175], v[174:175], v[230:231] op_sel_hi:[1,0]
    v_pk_add_f32 v[176:177], v[176:177], v[230:231] op_sel_hi:[1,0]
    v_pk_add_f32 v[178:179], v[178:179], v[230:231] op_sel_hi:[1,0]
    v_rcp_f32 v172, v172
    v_rcp_f32 v173, v173
    v_rcp_f32 v174, v174
    v_rcp_f32 v175, v175
    v_rcp_f32 v176, v176
    v_rcp_f32 v177, v177
    buffer_load_dwordx4 a[252:255], v19, s[24:27], s28 offen offset:1024 sc1
    v_rcp_f32 v178, v178
    v_rcp_f32 v179, v179
    v_pk_mul_f32 v[144:145], v[144:145], v[172:173]
    v_pk_mul_f32 v[146:147], v[146:147], v[174:175]
    v_pk_mul_f32 v[148:149], v[148:149], v[176:177]
    v_pk_mul_f32 v[150:151], v[150:151], v[178:179]
    v_cvt_pk_bf16_f32 v196, v144, v145
    v_cvt_pk_bf16_f32 v197, v146, v147
    v_cvt_pk_bf16_f32 v198, v148, v149
    v_cvt_pk_bf16_f32 v199, v150, v151
    s_add_u32 s8, s50, 4096
    buffer_store_dwordx4 v[196:199], v2, s[92:95], s8 offen sc1
    v_pk_fma_f32 v[172:173], v[26:27], v[248:249], v[120:121] op_sel:[1,0,0]
    v_pk_fma_f32 v[174:175], v[26:27], v[250:251], v[122:123] op_sel:[1,0,0]
    v_pk_fma_f32 v[176:177], v[26:27], v[252:253], v[124:125] op_sel:[1,0,0]
    v_pk_fma_f32 v[178:179], v[26:27], v[254:255], v[126:127] op_sel:[1,0,0]
    s_xor_b32 s28, s52, 24576
    s_add_u32 s28, s28, s51
    buffer_load_dwordx4 v[32:35], v18, s[24:27], s28 offen offset:0 sc1
    v_pk_fma_f32 v[152:153], v[26:27], v[152:153], v[172:173] op_sel_hi:[0,1,1]
    v_pk_fma_f32 v[154:155], v[26:27], v[154:155], v[174:175] op_sel_hi:[0,1,1]
    v_pk_fma_f32 v[156:157], v[26:27], v[156:157], v[176:177] op_sel_hi:[0,1,1]
    v_pk_fma_f32 v[158:159], v[26:27], v[158:159], v[178:179] op_sel_hi:[0,1,1]
    v_pk_mul_f32 v[172:173], v[152:153], v[152:153]
    v_pk_mul_f32 v[174:175], v[154:155], v[154:155]
    v_pk_mul_f32 v[176:177], v[156:157], v[156:157]
    buffer_load_dword v9, v14, s[16:19], s37 offen offset:32 sc1
    v_pk_mul_f32 v[178:179], v[158:159], v[158:159]
    v_pk_fma_f32 v[172:173], v[172:173], v[228:229], v[228:229] op_sel:[0,0,1] op_sel_hi:[1,0,1]
    v_pk_fma_f32 v[174:175], v[174:175], v[228:229], v[228:229] op_sel:[0,0,1] op_sel_hi:[1,0,1]
    v_pk_fma_f32 v[176:177], v[176:177], v[228:229], v[228:229] op_sel:[0,0,1] op_sel_hi:[1,0,1]
    buffer_load_dwordx4 v[36:39], v18, s[24:27], s28 offen offset:1024 sc1
    v_pk_fma_f32 v[178:179], v[178:179], v[228:229], v[228:229] op_sel:[0,0,1] op_sel_hi:[1,0,1]
    v_pk_mul_f32 v[172:173], v[172:173], v[152:153]
    v_pk_mul_f32 v[174:175], v[174:175], v[154:155]
    v_pk_mul_f32 v[176:177], v[176:177], v[156:157]
    v_pk_mul_f32 v[178:179], v[178:179], v[158:159]
    v_exp_f32 v172, v172
    v_exp_f32 v173, v173
    v_exp_f32 v174, v174
    v_exp_f32 v175, v175
    v_exp_f32 v176, v176
    v_exp_f32 v177, v177
    buffer_load_dwordx4 v[40:43], v19, s[24:27], s28 offen offset:0 sc1
    v_exp_f32 v178, v178
    v_exp_f32 v179, v179
    v_pk_add_f32 v[172:173], v[172:173], v[230:231] op_sel_hi:[1,0]
    v_pk_add_f32 v[174:175], v[174:175], v[230:231] op_sel_hi:[1,0]
    v_pk_add_f32 v[176:177], v[176:177], v[230:231] op_sel_hi:[1,0]
    v_pk_add_f32 v[178:179], v[178:179], v[230:231] op_sel_hi:[1,0]
    v_rcp_f32 v172, v172
    v_rcp_f32 v173, v173
    v_rcp_f32 v174, v174
    v_rcp_f32 v175, v175
    v_rcp_f32 v176, v176
    buffer_load_dwordx4 v[44:47], v19, s[24:27], s28 offen offset:1024 sc1
    v_rcp_f32 v177, v177
    v_rcp_f32 v178, v178
    v_rcp_f32 v179, v179
    v_pk_mul_f32 v[152:153], v[152:153], v[172:173]
    v_pk_mul_f32 v[154:155], v[154:155], v[174:175]
    v_pk_mul_f32 v[156:157], v[156:157], v[176:177]
    v_pk_mul_f32 v[158:159], v[158:159], v[178:179]
    v_cvt_pk_bf16_f32 v192, v152, v153
    v_cvt_pk_bf16_f32 v193, v154, v155
    v_cvt_pk_bf16_f32 v194, v156, v157
    v_cvt_pk_bf16_f32 v195, v158, v159
    s_add_u32 s8, s50, 8192
    buffer_store_dwordx4 v[192:195], v2, s[92:95], s8 offen sc1
    s_mov_b32 s68, s92
    s_mov_b32 s69, s93
    s_mov_b32 s70, 176128
    s_add_u32 s92, s92, 2818048
    s_addc_u32 s93, s93, 0
    s_mov_b32 s72, s62
    s_mov_b32 s73, s63
    s_mov_b32 s74, 2097152
    s_mov_b32 s75, 0x20000
    s_mov_b32 s88, s60
    s_mov_b32 s89, s61
    s_mov_b32 s90, 1024
    s_mov_b32 s91, 0x20000
    s_lshl_b32 s44, s32, 2
    s_lshr_b32 s6, s30, 3
    s_lshl_b32 s6, s6, 1
    s_add_u32 s44, s44, s6
    s_and_b32 s6, s3, 1
    s_add_u32 s44, s44, s6
    s_lshl_b32 s44, s44, 14
    s_and_b32 s6, s30, 7
    s_lshl_b32 s6, s6, 1
    s_lshr_b32 s8, s3, 1
    s_add_u32 s6, s6, s8
    s_lshl_b32 s47, s6, 6
    s_add_u32 s45, s44, s47
    s_lshl_b32 s6, s6, 10
    s_add_u32 s44, s44, s6
    s_and_b32 s41, s42, 16
    s_mov_b32 s11, 200000
    s_waitcnt vmcnt(4)
L_splp3b:
    v_readfirstlane_b32 s9, v9
    s_nop 0
    s_cmp_ge_u32 s9, s41
    s_cbranch_scc1 L_backp3b
    buffer_load_dword v9, v14, s[16:19], s37 offen offset:32 sc1
    s_sub_u32 s11, s11, 1
    s_waitcnt vmcnt(0)
    s_cbranch_scc0 L_splp3b
L_backp3b:
    s_barrier
    s_xor_b32 s7, s48, 1048576
    buffer_load_dwordx4 a[32:35], v2, s[76:79], s7 offen offset:0 sc1
    buffer_load_dwordx4 a[36:39], v2, s[76:79], s7 offen offset:1024 sc1
    buffer_load_dwordx4 a[40:43], v2, s[76:79], s7 offen offset:2048 sc1
    buffer_load_dwordx4 a[44:47], v2, s[76:79], s7 offen offset:3072 sc1
    s_xor_b32 s7, s48, 1052672
    buffer_load_dwordx4 a[48:51], v2, s[76:79], s7 offen offset:0 sc1
    buffer_load_dwordx4 a[52:55], v2, s[76:79], s7 offen offset:1024 sc1
    buffer_load_dwordx4 a[56:59], v2, s[76:79], s7 offen offset:2048 sc1
    buffer_load_dwordx4 a[60:63], v2, s[76:79], s7 offen offset:3072 sc1
    s_waitcnt vmcnt(8)
    s_barrier
    s_cmp_lg_u32 s3, 0
    s_cbranch_scc1 L_sg17
    buffer_atomic_add v8, v7, s[16:19], s39 offen offset:8
L_sg17:
    s_xor_b32 s7, s48, 1056768
    buffer_load_dwordx4 a[64:67], v2, s[76:79], s7 offen offset:0 sc1
    buffer_load_dwordx4 a[68:71], v2, s[76:79], s7 offen offset:1024 sc1
    buffer_load_dwordx4 a[72:75], v2, s[76:79], s7 offen offset:2048 sc1
    buffer_load_dwordx4 a[76:79], v2, s[76:79], s7 offen offset:3072 sc1
    s_waitcnt vmcnt(8) lgkmcnt(8)
    v_mfma_f32_16x16x32_bf16 v[136:139], a[96:99], a[32:35], 0
    ds_read_b128 a[96:99], v184 offset:49152
    s_xor_b32 s7, s48, 1060864
    buffer_load_dwordx4 a[80:83], v2, s[76:79], s7 offen offset:0 sc1
    v_mfma_f32_16x16x32_bf16 v[136:139], a[100:103], a[36:39], v[136:139]
    ds_read_b128 a[100:103], v184 offset:50176
    v_mfma_f32_16x16x32_bf16 v[136:139], a[104:107], a[40:43], v[136:139]
    ds_read_b128 a[104:107], v184 offset:51200
    v_mfma_f32_16x16x32_bf16 v[136:139], a[108:111], a[44:47], v[136:139]
    ds_read_b128 a[108:111], v184 offset:52224
    s_waitcnt lgkmcnt(8)
    v_mfma_f32_16x16x32_bf16 v[140:143], a[112:115], a[32:35], 0
    ds_read_b128 a[112:115], v185 offset:0
    buffer_load_dwordx4 a[84:87], v2, s[76:79], s7 offen offset:1024 sc1
    v_mfma_f32_16x16x32_bf16 v[140:143], a[116:119], a[36:39], v[140:143]
    ds_read_b128 a[116:119], v185 offset:1024
    v_mfma_f32_16x16x32_bf16 v[140:143], a[120:123], a[40:43], v[140:143]
    ds_read_b128 a[120:123], v185 offset:2048
    v_mfma_f32_16x16x32_bf16 v[140:143], a[124:127], a[44:47], v[140:143]
    ds_read_b128 a[124:127], v185 offset:3072
    s_waitcnt lgkmcnt(8)
    v_mfma_f32_16x16x32_bf16 v[144:147], a[128:131], a[32:35], 0
    ds_read_b128 a[128:131], v185 offset:16384
    buffer_load_dword v9, v14, s[16:19], s37 offen offset:8 sc1
    v_mfma_f32_16x16x32_bf16 v[144:147], a[132:135], a[36:39], v[144:147]
    ds_read_b128 a[132:135], v185 offset:17408
    buffer_load_dwordx4 a[88:91], v2, s[76:79], s7 offen offset:2048 sc1
    v_mfma_f32_16x16x32_bf16 v[144:147], a[136:139], a[40:43], v[144:147]
    ds_read_b128 a[136:139], v185 offset:18432
    v_mfma_f32_16x16x32_bf16 v[144:147], a[140:143], a[44:47], v[144:147]
    ds_read_b128 a[140:143], v185 offset:19456
    s_waitcnt lgkmcnt(8)
    v_mfma_f32_16x16x32_bf16 v[148:151], a[96:99], a[32:35], 0
    ds_read_b128 a[96:99], v186 offset:0
    v_mfma_f32_16x16x32_bf16 v[148:151], a[100:103], a[36:39], v[148:151]
    ds_read_b128 a[100:103], v186 offset:1024
    buffer_load_dwordx4 a[92:95], v2, s[76:79], s7 offen offset:3072 sc1
    v_mfma_f32_16x16x32_bf16 v[148:151], a[104:107], a[40:43], v[148:151]
    ds_read_b128 a[104:107], v186 offset:2048
    v_mfma_f32_16x16x32_bf16 v[148:151], a[108:111], a[44:47], v[148:151]
    ds_read_b128 a[108:111], v186 offset:3072
    s_waitcnt lgkmcnt(8)
    v_mfma_f32_16x16x32_bf16 v[152:155], a[112:115], a[32:35], 0
    ds_read_b128 a[112:115], v186 offset:16384
    v_mfma_f32_16x16x32_bf16 v[152:155], a[116:119], a[36:39], v[152:155]
    ds_read_b128 a[116:119], v186 offset:17408
    s_add_u32 s7, s49, 131072
    buffer_load_dword v160, v11, s[80:83], s7 offen offset:0 sc1
    v_mfma_f32_16x16x32_bf16 v[152:155], a[120:123], a[40:43], v[152:155]
    ds_read_b128 a[120:123], v186 offset:18432
    buffer_load_dword v161, v11, s[80:83], s7 offen offset:256 sc1
    v_mfma_f32_16x16x32_bf16 v[152:155], a[124:127], a[44:47], v[152:155]
    ds_read_b128 a[124:127], v186 offset:19456
    buffer_load_dword v162, v11, s[80:83], s7 offen offset:512 sc1
    s_waitcnt lgkmcnt(8)
    v_mfma_f32_16x16x32_bf16 v[156:159], a[128:131], a[32:35], 0
    ds_read_b128 a[128:131], v186 offset:32768
    buffer_load_dword v163, v11, s[80:83], s7 offen offset:768 sc1
    v_mfma_f32_16x16x32_bf16 v[156:159], a[132:135], a[36:39], v[156:159]
    ds_read_b128 a[132:135], v186 offset:33792
    buffer_load_dword v164, v11, s[80:83], s7 offen offset:1024 sc1
    v_mfma_f32_16x16x32_bf16 v[156:159], a[136:139], a[40:43], v[156:159]
    ds_read_b128 a[136:139], v186 offset:34816
    buffer_load_dword v165, v11, s[80:83], s7 offen offset:1280 sc1
    v_mfma_f32_16x16x32_bf16 v[156:159], a[140:143], a[44:47], v[156:159]
    ds_read_b128 a[140:143], v186 offset:35840
    buffer_load_dword v166, v11, s[80:83], s7 offen offset:1536 sc1
    s_waitcnt vmcnt(16) lgkmcnt(8)
    v_mfma_f32_16x16x32_bf16 v[136:139], a[96:99], a[48:51], v[136:139]
    ds_read_b128 a[96:99], v186 offset:49152
    buffer_load_dword v167, v11, s[80:83], s7 offen offset:1792 sc1
    v_mfma_f32_16x16x32_bf16 v[136:139], a[100:103], a[52:55], v[136:139]
    ds_read_b128 a[100:103], v186 offset:50176
    s_xor_b32 s28, s52, 28672
    s_add_u32 s28, s28, s51
    buffer_load_dwordx4 v[48:51], v18, s[24:27], s28 offen offset:0 sc1
    v_mfma_f32_16x16x32_bf16 v[136:139], a[104:107], a[56:59], v[136:139]
    ds_read_b128 a[104:107], v186 offset:51200
    v_mfma_f32_16x16x32_bf16 v[136:139], a[108:111], a[60:63], v[136:139]
    ds_read_b128 a[108:111], v186 offset:52224
    s_waitcnt lgkmcnt(8)
    v_mfma_f32_16x16x32_bf16 v[140:143], a[112:115], a[48:51], v[140:143]
    ds_read_b128 a[112:115], v187 offset:0
    v_mfma_f32_16x16x32_bf16 v[140:143], a[116:119], a[52:55], v[140:143]
    ds_read_b128 a[116:119], v187 offset:1024
    buffer_load_dwordx4 v[52:55], v18, s[24:27], s28 offen offset:1024 sc1
    v_mfma_f32_16x16x32_bf16 v[140:143], a[120:123], a[56:59], v[140:143]
    ds_read_b128 a[120:123], v187 offset:2048
    v_mfma_f32_16x16x32_bf16 v[140:143], a[124:127], a[60:63], v[140:143]
    ds_read_b128 a[124:127], v187 offset:3072
    s_waitcnt lgkmcnt(8)
    v_mfma_f32_16x16x32_bf16 v[144:147], a[128:131], a[48:51], v[144:147]
    ds_read_b128 a[128:131], v187 offset:16384
    v_mfma_f32_16x16x32_bf16 v[144:147], a[132:135], a[52:55], v[144:147]
    ds_read_b128 a[132:135], v187 offset:17408
    buffer_load_dwordx4 v[56:59], v19, s[24:27], s28 offen offset:0 sc1
    v_mfma_f32_16x16x32_bf16 v[144:147], a[136:139], a[56:59], v[144:147]
    ds_read_b128 a[136:139], v187 offset:18432
    v_mfma_f32_16x16x32_bf16 v[144:147], a[140:143], a[60:63], v[144:147]
    ds_read_b128 a[140:143], v187 offset:19456
    s_waitcnt lgkmcnt(8)
    v_mfma_f32_16x16x32_bf16 v[148:151], a[96:99], a[48:51], v[148:151]
    ds_read_b128 a[96:99], v188 offset:0
    v_mfma_f32_16x16x32_bf16 v[148:151], a[100:103], a[52:55], v[148:151]
    ds_read_b128 a[100:103], v188 offset:1024
    buffer_load_dwordx4 v[60:63], v19, s[24:27], s28 offen offset:1024 sc1
    v_mfma_f32_16x16x32_bf16 v[148:151], a[104:107], a[56:59], v[148:151]
    ds_read_b128 a[104:107], v188 offset:2048
    v_mfma_f32_16x16x32_bf16 v[148:151], a[108:111], a[60:63], v[148:151]
    ds_read_b128 a[108:111], v188 offset:3072
    s_and_b32 s41, s42, 16
    s_mov_b32 s11, 200000
    s_waitcnt vmcnt(14)
L_splp4a:
    v_readfirstlane_b32 s9, v9
    s_nop 0
    s_cmp_ge_u32 s9, s41
    s_cbranch_scc1 L_backp4a
    buffer_load_dword v9, v14, s[16:19], s37 offen offset:8 sc1
    s_sub_u32 s11, s11, 1
    s_waitcnt vmcnt(0)
    s_cbranch_scc0 L_splp4a
L_backp4a:
    s_barrier
    s_waitcnt lgkmcnt(8)
    v_mfma_f32_16x16x32_bf16 v[152:155], a[112:115], a[48:51], v[152:155]
    ds_read_b128 a[112:115], v188 offset:16384
    v_mfma_f32_16x16x32_bf16 v[152:155], a[116:119], a[52:55], v[152:155]
    ds_read_b128 a[116:119], v188 offset:17408
    s_add_u32 s28, s51, 32768
    buffer_load_dwordx4 v[64:67], v18, s[24:27], s28 offen offset:0 sc1
    v_mfma_f32_16x16x32_bf16 v[152:155], a[120:123], a[56:59], v[152:155]
    ds_read_b128 a[120:123], v188 offset:18432
    v_mfma_f32_16x16x32_bf16 v[152:155], a[124:127], a[60:63], v[152:155]
    ds_read_b128 a[124:127], v188 offset:19456
    s_waitcnt lgkmcnt(8)
    v_mfma_f32_16x16x32_bf16 v[156:159], a[128:131], a[48:51], v[156:159]
    ds_read_b128 a[128:131], v188 offset:32768
    v_mfma_f32_16x16x32_bf16 v[156:159], a[132:135], a[52:55], v[156:159]
    ds_read_b128 a[132:135], v188 offset:33792
    buffer_load_dwordx4 v[68:71], v18, s[24:27], s28 offen offset:1024 sc1
    v_mfma_f32_16x16x32_bf16 v[156:159], a[136:139], a[56:59], v[156:159]
    ds_read_b128 a[136:139], v188 offset:34816
    v_mfma_f32_16x16x32_bf16 v[156:159], a[140:143], a[60:63], v[156:159]
    ds_read_b128 a[140:143], v188 offset:35840
    s_waitcnt lgkmcnt(8)
    v_mfma_f32_16x16x32_bf16 v[136:139], a[96:99], a[64:67], v[136:139]
    ds_read_b128 a[96:99], v188 offset:49152
    v_mfma_f32_16x16x32_bf16 v[136:139], a[100:103], a[68:71], v[136:139]
    ds_read_b128 a[100:103], v188 offset:50176
    buffer_load_dwordx4 v[72:75], v19, s[24:27], s28 offen offset:0 sc1
    v_mfma_f32_16x16x32_bf16 v[136:139], a[104:107], a[72:75], v[136:139]
    ds_read_b128 a[104:107], v188 offset:51200
    v_mfma_f32_16x16x32_bf16 v[136:139], a[108:111], a[76:79], v[136:139]
    ds_read_b128 a[108:111], v188 offset:52224
    s_waitcnt lgkmcnt(8)
    v_mfma_f32_16x16x32_bf16 v[140:143], a[112:115], a[64:67], v[140:143]
    ds_read_b128 a[112:115], v189 offset:0
    v_mfma_f32_16x16x32_bf16 v[140:143], a[116:119], a[68:71], v[140:143]
    ds_read_b128 a[116:119], v189 offset:1024
    buffer_load_dwordx4 v[76:79], v19, s[24:27], s28 offen offset:1024 sc1
    v_mfma_f32_16x16x32_bf16 v[140:143], a[120:123], a[72:75], v[140:143]
    ds_read_b128 a[120:123], v189 offset:2048
    v_mfma_f32_16x16x32_bf16 v[140:143], a[124:127], a[76:79], v[140:143]
    ds_read_b128 a[124:127], v189 offset:3072
    s_waitcnt lgkmcnt(8)
    v_mfma_f32_16x16x32_bf16 v[144:147], a[128:131], a[64:67], v[144:147]
    ds_read_b128 a[128:131], v189 offset:16384
    v_mfma_f32_16x16x32_bf16 v[144:147], a[132:135], a[68:71], v[144:147]
    ds_read_b128 a[132:135], v189 offset:17408
    s_add_u32 s28, s51, 36864
    buffer_load_dwordx4 v[80:83], v18, s[24:27], s28 offen offset:0 sc1
    v_mfma_f32_16x16x32_bf16 v[144:147], a[136:139], a[72:75], v[144:147]
    ds_read_b128 a[136:139], v189 offset:18432
    v_mfma_f32_16x16x32_bf16 v[144:147], a[140:143], a[76:79], v[144:147]
    ds_read_b128 a[140:143], v189 offset:19456
    s_waitcnt lgkmcnt(8)
    v_mfma_f32_16x16x32_bf16 v[148:151], a[96:99], a[64:67], v[148:151]
    ds_read_b128 a[96:99], v190 offset:0
    s_waitcnt vmcnt(9)
    v_mfma_f32_16x16x32_bf16 v[148:151], a[100:103], a[68:71], v[148:151]
    ds_read_b128 a[100:103], v190 offset:1024
    v_add_f32 v160, v160, v164
    buffer_load_dwordx4 v[84:87], v18, s[24:27], s28 offen offset:1024 sc1
    v_mfma_f32_16x16x32_bf16 v[148:151], a[104:107], a[72:75], v[148:151]
    ds_read_b128 a[104:107], v190 offset:2048
    v_add_f32 v161, v161, v165
    v_mfma_f32_16x16x32_bf16 v[148:151], a[108:111], a[76:79], v[148:151]
    ds_read_b128 a[108:111], v190 offset:3072
    s_waitcnt lgkmcnt(8)
    v_mfma_f32_16x16x32_bf16 v[152:155], a[112:115], a[64:67], v[152:155]
    ds_read_b128 a[112:115], v190 offset:16384
    v_add_f32 v162, v162, v166
    v_mfma_f32_16x16x32_bf16 v[152:155], a[116:119], a[68:71], v[152:155]
    ds_read_b128 a[116:119], v190 offset:17408
    v_add_f32 v163, v163, v167
    buffer_load_dwordx4 v[88:91], v19, s[24:27], s28 offen offset:0 sc1
    v_mfma_f32_16x16x32_bf16 v[152:155], a[120:123], a[72:75], v[152:155]
    ds_read_b128 a[120:123], v190 offset:18432
    v_add_f32 v160, v160, v162
    v_mfma_f32_16x16x32_bf16 v[152:155], a[124:127], a[76:79], v[152:155]
    ds_read_b128 a[124:127], v190 offset:19456
    s_waitcnt lgkmcnt(8)
    v_mfma_f32_16x16x32_bf16 v[156:159], a[128:131], a[64:67], v[156:159]
    ds_read_b128 a[128:131], v190 offset:32768
    v_add_f32 v161, v161, v163
    v_mfma_f32_16x16x32_bf16 v[156:159], a[132:135], a[68:71], v[156:159]
    ds_read_b128 a[132:135], v190 offset:33792
    v_add_f32 v160, v160, v161
    buffer_load_dwordx4 v[92:95], v19, s[24:27], s28 offen offset:1024 sc1
    v_mfma_f32_16x16x32_bf16 v[156:159], a[136:139], a[72:75], v[156:159]
    ds_read_b128 a[136:139], v190 offset:34816
    v_mov_b32 v161, v160
    v_mfma_f32_16x16x32_bf16 v[156:159], a[140:143], a[76:79], v[156:159]
    ds_read_b128 a[140:143], v190 offset:35840
    s_waitcnt lgkmcnt(8)
    v_mfma_f32_16x16x32_bf16 v[136:139], a[96:99], a[80:83], v[136:139]
    ds_read_b128 a[96:99], v190 offset:49152
    v_permlane32_swap_b32 v160, v161
    v_mfma_f32_16x16x32_bf16 v[136:139], a[100:103], a[84:87], v[136:139]
    ds_read_b128 a[100:103], v190 offset:50176
    v_add_f32 v160, v160, v161
    s_add_u32 s28, s51, 40960
    buffer_load_dwordx4 a[0:3], v18, s[24:27], s28 offen offset:0 sc1
    v_mfma_f32_16x16x32_bf16 v[136:139], a[104:107], a[88:91], v[136:139]
    ds_read_b128 a[104:107], v190 offset:51200
    v_mul_f32 v160, 0x3b000000, v160
    v_mfma_f32_16x16x32_bf16 v[136:139], a[108:111], a[92:95], v[136:139]
    ds_read_b128 a[108:111], v190 offset:52224
    s_waitcnt lgkmcnt(8)
    v_mfma_f32_16x16x32_bf16 v[140:143], a[112:115], a[80:83], v[140:143]
    ds_read_b128 a[112:115], v191 offset:0
    v_mov_b32 v161, v160
    v_mfma_f32_16x16x32_bf16 v[140:143], a[116:119], a[84:87], v[140:143]
    ds_read_b128 a[116:119], v191 offset:1024
    v_permlane16_swap_b32 v160, v161
    buffer_load_dwordx4 a[4:7], v18, s[24:27], s28 offen offset:1024 sc1
    v_mfma_f32_16x16x32_bf16 v[140:143], a[120:123], a[88:91], v[140:143]
    ds_read_b128 a[120:123], v191 offset:2048
    v_fma_f32 v161, -v160, v160, v161
    v_mfma_f32_16x16x32_bf16 v[140:143], a[124:127], a[92:95], v[140:143]
    ds_read_b128 a[124:127], v191 offset:3072
    s_waitcnt lgkmcnt(8)
    v_mfma_f32_16x16x32_bf16 v[144:147], a[128:131], a[80:83], v[144:147]
    ds_read_b128 a[128:131], v191 offset:16384
    v_max_f32 v161, 0, v161
    v_mfma_f32_16x16x32_bf16 v[144:147], a[132:135], a[84:87], v[144:147]
    ds_read_b128 a[132:135], v191 offset:17408
    v_add_f32 v162, 0x3727c5ac, v161
    buffer_load_dwordx4 a[8:11], v19, s[24:27], s28 offen offset:0 sc1
    v_mfma_f32_16x16x32_bf16 v[144:147], a[136:139], a[88:91], v[144:147]
    ds_read_b128 a[136:139], v191 offset:18432
    v_rsq_f32 v162, v162
    v_mfma_f32_16x16x32_bf16 v[144:147], a[140:143], a[92:95], v[144:147]
    ds_read_b128 a[140:143], v191 offset:19456
    s_waitcnt lgkmcnt(8)
    v_mfma_f32_16x16x32_bf16 v[148:151], a[96:99], a[80:83], v[148:151]
    v_mul_f32 v163, v162, v162
    v_mfma_f32_16x16x32_bf16 v[148:151], a[100:103], a[84:87], v[148:151]
    v_mul_f32 v163, v163, v161
    buffer_load_dwordx4 a[12:15], v19, s[24:27], s28 offen offset:1024 sc1
    v_mfma_f32_16x16x32_bf16 v[148:151], a[104:107], a[88:91], v[148:151]
    v_add_f32 v163, 0x3727c5ac, v163
    v_mfma_f32_16x16x32_bf16 v[148:151], a[108:111], a[92:95], v[148:151]
    s_waitcnt lgkmcnt(4)
    v_mfma_f32_16x16x32_bf16 v[152:155], a[112:115], a[80:83], v[152:155]
    v_rsq_f32 v163, v163
    v_mfma_f32_16x16x32_bf16 v[152:155], a[116:119], a[84:87], v[152:155]
    v_mul_f32 v26, v162, v163
    s_xor_b32 s35, s52, 0
    s_add_u32 s35, s35, s51
    buffer_load_dwordx4 a[16:19], v16, s[68:71], s35 offen sc1
    v_mfma_f32_16x16x32_bf16 v[152:155], a[120:123], a[88:91], v[152:155]
    v_mul_f32 v27, -v160, v26
    v_mfma_f32_16x16x32_bf16 v[152:155], a[124:127], a[92:95], v[152:155]
    s_waitcnt lgkmcnt(0)
    v_mfma_f32_16x16x32_bf16 v[156:159], a[128:131], a[80:83], v[156:159]
    v_mfma_f32_16x16x32_bf16 v[156:159], a[132:135], a[84:87], v[156:159]
    buffer_load_dwordx4 a[20:23], v17, s[68:71], s35 offen sc1
    v_mfma_f32_16x16x32_bf16 v[156:159], a[136:139], a[88:91], v[156:159]
    v_mfma_f32_16x16x32_bf16 v[156:159], a[140:143], a[92:95], v[156:159]
    v_pk_fma_f32 v[172:173], v[26:27], v[232:233], v[104:105] op_sel:[1,0,0]
    v_pk_fma_f32 v[174:175], v[26:27], v[234:235], v[106:107] op_sel:[1,0,0]
    v_pk_fma_f32 v[176:177], v[26:27], v[236:237], v[108:109] op_sel:[1,0,0]
    v_pk_fma_f32 v[178:179], v[26:27], v[238:239], v[110:111] op_sel:[1,0,0]
    v_pk_fma_f32 v[136:137], v[26:27], v[136:137], v[172:173] op_sel_hi:[0,1,1]
    v_pk_fma_f32 v[138:139], v[26:27], v[138:139], v[174:175] op_sel_hi:[0,1,1]
    v_pk_fma_f32 v[140:141], v[26:27], v[140:141], v[176:177] op_sel_hi:[0,1,1]
    v_pk_fma_f32 v[142:143], v[26:27], v[142:143], v[178:179] op_sel_hi:[0,1,1]
    s_xor_b32 s35, s52, 4096
    s_add_u32 s35, s35, s51
    buffer_load_dwordx4 a[24:27], v16, s[68:71], s35 offen sc1
    v_pk_mul_f32 v[172:173], v[136:137], v[136:137]
    v_pk_mul_f32 v[174:175], v[138:139], v[138:139]
    v_pk_mul_f32 v[176:177], v[140:141], v[140:141]
    v_pk_mul_f32 v[178:179], v[142:143], v[142:143]
    v_pk_fma_f32 v[172:173], v[172:173], v[228:229], v[228:229] op_sel:[0,0,1] op_sel_hi:[1,0,1]
    v_pk_fma_f32 v[174:175], v[174:175], v[228:229], v[228:229] op_sel:[0,0,1] op_sel_hi:[1,0,1]
    v_pk_fma_f32 v[176:177], v[176:177], v[228:229], v[228:229] op_sel:[0,0,1] op_sel_hi:[1,0,1]
    v_pk_fma_f32 v[178:179], v[178:179], v[228:229], v[228:229] op_sel:[0,0,1] op_sel_hi:[1,0,1]
    v_pk_mul_f32 v[172:173], v[172:173], v[136:137]
    v_pk_mul_f32 v[174:175], v[174:175], v[138:139]
    v_pk_mul_f32 v[176:177], v[176:177], v[140:141]
    v_pk_mul_f32 v[178:179], v[178:179], v[142:143]
    v_exp_f32 v172, v172
    v_exp_f32 v173, v173
    v_exp_f32 v174, v174
    buffer_load_dwordx4 a[28:31], v17, s[68:71], s35 offen sc1
    v_exp_f32 v175, v175
    v_exp_f32 v176, v176
    v_exp_f32 v177, v177
    v_exp_f32 v178, v178
    v_exp_f32 v179, v179
    v_pk_add_f32 v[172:173], v[172:173], v[230:231] op_sel_hi:[1,0]
    v_pk_add_f32 v[174:175], v[174:175], v[230:231] op_sel_hi:[1,0]
    v_pk_add_f32 v[176:177], v[176:177], v[230:231] op_sel_hi:[1,0]
    v_pk_add_f32 v[178:179], v[178:179], v[230:231] op_sel_hi:[1,0]
    v_rcp_f32 v172, v172
    v_rcp_f32 v173, v173
    s_xor_b32 s35, s52, 8192
    s_add_u32 s35, s35, s51
    buffer_load_dwordx4 a[144:147], v16, s[68:71], s35 offen sc1
    v_rcp_f32 v174, v174
    v_rcp_f32 v175, v175
    v_rcp_f32 v176, v176
    v_rcp_f32 v177, v177
    v_rcp_f32 v178, v178
    v_rcp_f32 v179, v179
    v_pk_mul_f32 v[136:137], v[136:137], v[172:173]
    v_pk_mul_f32 v[138:139], v[138:139], v[174:175]
    v_pk_mul_f32 v[140:141], v[140:141], v[176:177]
    v_pk_mul_f32 v[142:143], v[142:143], v[178:179]
    v_cvt_pk_bf16_f32 v192, v136, v137
    buffer_load_dwordx4 a[148:151], v17, s[68:71], s35 offen sc1
    v_cvt_pk_bf16_f32 v193, v138, v139
    v_cvt_pk_bf16_f32 v194, v140, v141
    v_cvt_pk_bf16_f32 v195, v142, v143
    s_add_u32 s8, s50, 0
    buffer_store_dwordx4 v[192:195], v2, s[92:95], s8 offen sc1
    v_pk_fma_f32 v[172:173], v[26:27], v[240:241], v[112:113] op_sel:[1,0,0]
    v_pk_fma_f32 v[174:175], v[26:27], v[242:243], v[114:115] op_sel:[1,0,0]
    v_pk_fma_f32 v[176:177], v[26:27], v[244:245], v[116:117] op_sel:[1,0,0]
    v_pk_fma_f32 v[178:179], v[26:27], v[246:247], v[118:119] op_sel:[1,0,0]
    v_pk_fma_f32 v[144:145], v[26:27], v[144:145], v[172:173] op_sel_hi:[0,1,1]
    v_pk_fma_f32 v[146:147], v[26:27], v[146:147], v[174:175] op_sel_hi:[0,1,1]
    v_pk_fma_f32 v[148:149], v[26:27], v[148:149], v[176:177] op_sel_hi:[0,1,1]
    v_pk_fma_f32 v[150:151], v[26:27], v[150:151], v[178:179] op_sel_hi:[0,1,1]
    v_pk_mul_f32 v[172:173], v[144:145], v[144:145]
    v_pk_mul_f32 v[174:175], v[146:147], v[146:147]
    v_pk_mul_f32 v[176:177], v[148:149], v[148:149]
    v_pk_mul_f32 v[178:179], v[150:151], v[150:151]
    v_pk_fma_f32 v[172:173], v[172:173], v[228:229], v[228:229] op_sel:[0,0,1] op_sel_hi:[1,0,1]
    s_xor_b32 s35, s52, 12288
    s_add_u32 s35, s35, s51
    buffer_load_dwordx4 a[152:155], v16, s[68:71], s35 offen sc1
    v_pk_fma_f32 v[174:175], v[174:175], v[228:229], v[228:229] op_sel:[0,0,1] op_sel_hi:[1,0,1]
    v_pk_fma_f32 v[176:177], v[176:177], v[228:229], v[228:229] op_sel:[0,0,1] op_sel_hi:[1,0,1]
    v_pk_fma_f32 v[178:179], v[178:179], v[228:229], v[228:229] op_sel:[0,0,1] op_sel_hi:[1,0,1]
    v_pk_mul_f32 v[172:173], v[172:173], v[144:145]
    v_pk_mul_f32 v[174:175], v[174:175], v[146:147]
    v_pk_mul_f32 v[176:177], v[176:177], v[148:149]
    v_pk_mul_f32 v[178:179], v[178:179], v[150:151]
    v_exp_f32 v172, v172
    v_exp_f32 v173, v173
    v_exp_f32 v174, v174
    v_exp_f32 v175, v175
    v_exp_f32 v176, v176
    buffer_load_dwordx4 a[156:159], v17, s[68:71], s35 offen sc1
    v_exp_f32 v177, v177
    v_exp_f32 v178, v178
    v_exp_f32 v179, v179
    v_pk_add_f32 v[172:173], v[172:173], v[230:231] op_sel_hi:[1,0]
    v_pk_add_f32 v[174:175], v[174:175], v[230:231] op_sel_hi:[1,0]
    v_pk_add_f32 v[176:177], v[176:177], v[230:231] op_sel_hi:[1,0]
    v_pk_add_f32 v[178:179], v[178:179], v[230:231] op_sel_hi:[1,0]
    v_rcp_f32 v172, v172
    v_rcp_f32 v173, v173
    v_rcp_f32 v174, v174
    v_rcp_f32 v175, v175
    s_xor_b32 s35, s52, 16384
    s_add_u32 s35, s35, s51
    buffer_load_dwordx4 v[96:99], v16, s[68:71], s35 offen sc1
    v_rcp_f32 v176, v176
    v_rcp_f32 v177, v177
    v_rcp_f32 v178, v178
    v_rcp_f32 v179, v179
    v_pk_mul_f32 v[144:145], v[144:145], v[172:173]
    v_pk_mul_f32 v[146:147], v[146:147], v[174:175]
    v_pk_mul_f32 v[148:149], v[148:149], v[176:177]
    v_pk_mul_f32 v[150:151], v[150:151], v[178:179]
    v_cvt_pk_bf16_f32 v196, v144, v145
    v_cvt_pk_bf16_f32 v197, v146, v147
    v_cvt_pk_bf16_f32 v198, v148, v149
    v_cvt_pk_bf16_f32 v199, v150, v151
    s_add_u32 s8, s50, 4096
    buffer_store_dwordx4 v[196:199], v2, s[92:95], s8 offen sc1
    buffer_load_dwordx4 v[100:103], v17, s[68:71], s35 offen sc1
    v_pk_fma_f32 v[172:173], v[26:27], v[248:249], v[120:121] op_sel:[1,0,0]
    v_pk_fma_f32 v[174:175], v[26:27], v[250:251], v[122:123] op_sel:[1,0,0]
    v_pk_fma_f32 v[176:177], v[26:27], v[252:253], v[124:125] op_sel:[1,0,0]
    v_pk_fma_f32 v[178:179], v[26:27], v[254:255], v[126:127] op_sel:[1,0,0]
    v_pk_fma_f32 v[152:153], v[26:27], v[152:153], v[172:173] op_sel_hi:[0,1,1]
    v_pk_fma_f32 v[154:155], v[26:27], v[154:155], v[174:175] op_sel_hi:[0,1,1]
    v_pk_fma_f32 v[156:157], v[26:27], v[156:157], v[176:177] op_sel_hi:[0,1,1]
    v_pk_fma_f32 v[158:159], v[26:27], v[158:159], v[178:179] op_sel_hi:[0,1,1]
    v_pk_mul_f32 v[172:173], v[152:153], v[152:153]
    v_pk_mul_f32 v[174:175], v[154:155], v[154:155]
    v_pk_mul_f32 v[176:177], v[156:157], v[156:157]
    v_pk_mul_f32 v[178:179], v[158:159], v[158:159]
    v_pk_fma_f32 v[172:173], v[172:173], v[228:229], v[228:229] op_sel:[0,0,1] op_sel_hi:[1,0,1]
    v_pk_fma_f32 v[174:175], v[174:175], v[228:229], v[228:229] op_sel:[0,0,1] op_sel_hi:[1,0,1]
    v_pk_fma_f32 v[176:177], v[176:177], v[228:229], v[228:229] op_sel:[0,0,1] op_sel_hi:[1,0,1]
    v_pk_fma_f32 v[178:179], v[178:179], v[228:229], v[228:229] op_sel:[0,0,1] op_sel_hi:[1,0,1]
    v_pk_mul_f32 v[172:173], v[172:173], v[152:153]
    s_xor_b32 s35, s52, 20480
    s_add_u32 s35, s35, s51
    buffer_load_dwordx4 v[128:131], v16, s[68:71], s35 offen sc1
    v_pk_mul_f32 v[174:175], v[174:175], v[154:155]
    v_pk_mul_f32 v[176:177], v[176:177], v[156:157]
    v_pk_mul_f32 v[178:179], v[178:179], v[158:159]
    v_exp_f32 v172, v172
    v_exp_f32 v173, v173
    v_exp_f32 v174, v174
    v_exp_f32 v175, v175
    v_exp_f32 v176, v176
    v_exp_f32 v177, v177
    v_exp_f32 v178, v178
    buffer_load_dwordx4 v[132:135], v17, s[68:71], s35 offen sc1
    v_exp_f32 v179, v179
    v_pk_add_f32 v[172:173], v[172:173], v[230:231] op_sel_hi:[1,0]
    v_pk_add_f32 v[174:175], v[174:175], v[230:231] op_sel_hi:[1,0]
    v_pk_add_f32 v[176:177], v[176:177], v[230:231] op_sel_hi:[1,0]
    v_pk_add_f32 v[178:179], v[178:179], v[230:231] op_sel_hi:[1,0]
    v_rcp_f32 v172, v172
    v_rcp_f32 v173, v173
    v_rcp_f32 v174, v174
    v_rcp_f32 v175, v175
    v_rcp_f32 v176, v176
    v_rcp_f32 v177, v177
    s_xor_b32 s35, s52, 24576
    s_add_u32 s35, s35, s51
    buffer_load_dwordx4 v[168:171], v16, s[68:71], s35 offen sc1
    v_rcp_f32 v178, v178
    v_rcp_f32 v179, v179
    v_pk_mul_f32 v[152:153], v[152:153], v[172:173]
    v_pk_mul_f32 v[154:155], v[154:155], v[174:175]
    v_pk_mul_f32 v[156:157], v[156:157], v[176:177]
    v_pk_mul_f32 v[158:159], v[158:159], v[178:179]
    v_cvt_pk_bf16_f32 v192, v152, v153
    v_cvt_pk_bf16_f32 v193, v154, v155
    v_cvt_pk_bf16_f32 v194, v156, v157
    v_cvt_pk_bf16_f32 v195, v158, v159
    s_add_u32 s8, s50, 8192
    buffer_store_dwordx4 v[192:195], v2, s[92:95], s8 offen sc1
    s_waitcnt vmcnt(14)
    v_mfma_f32_16x16x32_bf16 v[160:163], a[160:163], a[16:19], 0
    v_mfma_f32_16x16x32_bf16 v[164:167], a[164:167], a[16:19], 0
    buffer_load_dwordx4 v[180:183], v17, s[68:71], s35 offen sc1
    v_mfma_f32_16x16x32_bf16 a[96:99], a[160:163], a[20:23], 0
    v_mfma_f32_16x16x32_bf16 a[100:103], a[164:167], a[20:23], 0
    v_mfma_f32_16x16x32_bf16 a[104:107], a[168:171], a[16:19], 0
    s_xor_b32 s35, s52, 28672
    s_add_u32 s35, s35, s51
    v_mfma_f32_16x16x32_bf16 a[108:111], a[172:175], a[16:19], 0
    buffer_load_dwordx4 v[200:203], v16, s[68:71], s35 offen sc1
    v_mfma_f32_16x16x32_bf16 a[112:115], a[168:171], a[20:23], 0
    v_mfma_f32_16x16x32_bf16 a[116:119], a[172:175], a[20:23], 0
    s_waitcnt vmcnt(14)
    v_mfma_f32_16x16x32_bf16 v[160:163], a[176:179], a[24:27], v[160:163]
    v_mfma_f32_16x16x32_bf16 v[164:167], a[180:183], a[24:27], v[164:167]
    buffer_load_dwordx4 v[204:207], v17, s[68:71], s35 offen sc1
    v_mfma_f32_16x16x32_bf16 a[96:99], a[176:179], a[28:31], a[96:99]
    v_mfma_f32_16x16x32_bf16 a[100:103], a[180:183], a[28:31], a[100:103]
    v_mfma_f32_16x16x32_bf16 a[104:107], a[184:187], a[24:27], a[104:107]
    s_add_u32 s35, s51, 32768
    v_mfma_f32_16x16x32_bf16 a[108:111], a[188:191], a[24:27], a[108:111]
    buffer_load_dwordx4 v[208:211], v16, s[68:71], s35 offen sc1
    v_mfma_f32_16x16x32_bf16 a[112:115], a[184:187], a[28:31], a[112:115]
    v_mfma_f32_16x16x32_bf16 a[116:119], a[188:191], a[28:31], a[116:119]
    s_waitcnt vmcnt(14)
    v_mfma_f32_16x16x32_bf16 v[160:163], a[192:195], a[144:147], v[160:163]
    v_mfma_f32_16x16x32_bf16 v[164:167], a[196:199], a[144:147], v[164:167]
    buffer_load_dwordx4 v[212:215], v17, s[68:71], s35 offen sc1
    v_mfma_f32_16x16x32_bf16 a[96:99], a[192:195], a[148:151], a[96:99]
    v_mfma_f32_16x16x32_bf16 a[100:103], a[196:199], a[148:151], a[100:103]
    v_mfma_f32_16x16x32_bf16 a[104:107], a[200:203], a[144:147], a[104:107]
    s_add_u32 s35, s51, 36864
    v_mfma_f32_16x16x32_bf16 a[108:111], a[204:207], a[144:147], a[108:111]
    buffer_load_dwordx4 v[216:219], v16, s[68:71], s35 offen sc1
    v_mfma_f32_16x16x32_bf16 a[112:115], a[200:203], a[148:151], a[112:115]
    v_mfma_f32_16x16x32_bf16 a[116:119], a[204:207], a[148:151], a[116:119]
    s_waitcnt vmcnt(13)
    v_mfma_f32_16x16x32_bf16 v[160:163], a[208:211], a[152:155], v[160:163]
    v_mfma_f32_16x16x32_bf16 v[164:167], a[212:215], a[152:155], v[164:167]
    buffer_load_dwordx4 a[32:35], v17, s[68:71], s35 offen sc1
    v_mfma_f32_16x16x32_bf16 a[96:99], a[208:211], a[156:159], a[96:99]
    v_mfma_f32_16x16x32_bf16 a[100:103], a[212:215], a[156:159], a[100:103]
    v_mfma_f32_16x16x32_bf16 a[104:107], a[216:219], a[152:155], a[104:107]
    s_add_u32 s35, s51, 40960
    v_mfma_f32_16x16x32_bf16 a[108:111], a[220:223], a[152:155], a[108:111]
    buffer_load_dwordx4 a[36:39], v16, s[68:71], s35 offen sc1
    v_mfma_f32_16x16x32_bf16 a[112:115], a[216:219], a[156:159], a[112:115]
    v_mfma_f32_16x16x32_bf16 a[116:119], a[220:223], a[156:159], a[116:119]
    s_waitcnt vmcnt(12)
    v_mfma_f32_16x16x32_bf16 v[160:163], a[224:227], v[96:99], v[160:163]
    v_mfma_f32_16x16x32_bf16 v[164:167], a[228:231], v[96:99], v[164:167]
    buffer_load_dwordx4 a[40:43], v17, s[68:71], s35 offen sc1
    v_mfma_f32_16x16x32_bf16 a[96:99], a[224:227], v[100:103], a[96:99]
    v_mfma_f32_16x16x32_bf16 a[100:103], a[228:231], v[100:103], a[100:103]
    v_mfma_f32_16x16x32_bf16 a[104:107], a[232:235], v[96:99], a[104:107]
    v_mfma_f32_16x16x32_bf16 a[108:111], a[236:239], v[96:99], a[108:111]
    buffer_load_dwordx4 a[44:47], v2, s[76:79], s44 offen sc1
    v_mfma_f32_16x16x32_bf16 a[112:115], a[232:235], v[100:103], a[112:115]
    v_mfma_f32_16x16x32_bf16 a[116:119], a[236:239], v[100:103], a[116:119]
    s_waitcnt vmcnt(12)
    v_mfma_f32_16x16x32_bf16 v[160:163], a[240:243], v[128:131], v[160:163]
    s_add_u32 s44, s44, 1048576
    v_mfma_f32_16x16x32_bf16 v[164:167], a[244:247], v[128:131], v[164:167]
    buffer_load_dwordx4 a[48:51], v2, s[76:79], s44 offen sc1
    v_mfma_f32_16x16x32_bf16 a[96:99], a[240:243], v[132:135], a[96:99]
    v_mfma_f32_16x16x32_bf16 a[100:103], a[244:247], v[132:135], a[100:103]
    v_mfma_f32_16x16x32_bf16 a[104:107], a[248:251], v[128:131], a[104:107]
    v_mfma_f32_16x16x32_bf16 a[108:111], a[252:255], v[128:131], a[108:111]
    buffer_load_dwordx4 a[52:55], v25, s[88:91], s47 offen
    v_mfma_f32_16x16x32_bf16 a[112:115], a[248:251], v[132:135], a[112:115]
    v_mfma_f32_16x16x32_bf16 a[116:119], a[252:255], v[132:135], a[116:119]
    s_waitcnt vmcnt(12)
    s_barrier
    s_cmp_lg_u32 s3, 0
    s_cbranch_scc1 L_sg18
    buffer_atomic_add v8, v7, s[16:19], s39 offen offset:36
L_sg18:
    s_waitcnt vmcnt(11)
    v_mfma_f32_16x16x32_bf16 v[160:163], v[32:35], v[168:171], v[160:163]
    v_mfma_f32_16x16x32_bf16 v[164:167], v[36:39], v[168:171], v[164:167]
    v_mfma_f32_16x16x32_bf16 a[96:99], v[32:35], v[180:183], a[96:99]
    v_mfma_f32_16x16x32_bf16 a[100:103], v[36:39], v[180:183], a[100:103]
    v_mfma_f32_16x16x32_bf16 a[104:107], v[40:43], v[168:171], a[104:107]
    v_mfma_f32_16x16x32_bf16 a[108:111], v[44:47], v[168:171], a[108:111]
    v_mfma_f32_16x16x32_bf16 a[112:115], v[40:43], v[180:183], a[112:115]
    v_mfma_f32_16x16x32_bf16 a[116:119], v[44:47], v[180:183], a[116:119]
    s_waitcnt vmcnt(9)
    v_mfma_f32_16x16x32_bf16 v[160:163], v[48:51], v[200:203], v[160:163]
    v_mfma_f32_16x16x32_bf16 v[164:167], v[52:55], v[200:203], v[164:167]
    v_mfma_f32_16x16x32_bf16 a[96:99], v[48:51], v[204:207], a[96:99]
    v_mfma_f32_16x16x32_bf16 a[100:103], v[52:55], v[204:207], a[100:103]
    v_mfma_f32_16x16x32_bf16 a[104:107], v[56:59], v[200:203], a[104:107]
    v_mfma_f32_16x16x32_bf16 a[108:111], v[60:63], v[200:203], a[108:111]
    v_mfma_f32_16x16x32_bf16 a[112:115], v[56:59], v[204:207], a[112:115]
    v_mfma_f32_16x16x32_bf16 a[116:119], v[60:63], v[204:207], a[116:119]
    s_waitcnt vmcnt(7)
    v_mfma_f32_16x16x32_bf16 v[160:163], v[64:67], v[208:211], v[160:163]
    v_mfma_f32_16x16x32_bf16 v[164:167], v[68:71], v[208:211], v[164:167]
    v_mfma_f32_16x16x32_bf16 a[96:99], v[64:67], v[212:215], a[96:99]
    v_mfma_f32_16x16x32_bf16 a[100:103], v[68:71], v[212:215], a[100:103]
    v_mfma_f32_16x16x32_bf16 a[104:107], v[72:75], v[208:211], a[104:107]
    v_mfma_f32_16x16x32_bf16 a[108:111], v[76:79], v[208:211], a[108:111]
    v_mfma_f32_16x16x32_bf16 a[112:115], v[72:75], v[212:215], a[112:115]
    v_mfma_f32_16x16x32_bf16 a[116:119], v[76:79], v[212:215], a[116:119]
    s_waitcnt vmcnt(5)
    v_mfma_f32_16x16x32_bf16 v[160:163], v[80:83], v[216:219], v[160:163]
    v_mfma_f32_16x16x32_bf16 v[164:167], v[84:87], v[216:219], v[164:167]
    v_mfma_f32_16x16x32_bf16 a[96:99], v[80:83], a[32:35], a[96:99]
    v_mfma_f32_16x16x32_bf16 a[100:103], v[84:87], a[32:35], a[100:103]
    v_mfma_f32_16x16x32_bf16 a[104:107], v[88:91], v[216:219], a[104:107]
    v_mfma_f32_16x16x32_bf16 a[108:111], v[92:95], v[216:219], a[108:111]
    v_mfma_f32_16x16x32_bf16 a[112:115], v[88:91], a[32:35], a[112:115]
    v_mfma_f32_16x16x32_bf16 a[116:119], v[92:95], a[32:35], a[116:119]
    s_waitcnt vmcnt(0)
    v_mfma_f32_16x16x32_bf16 a[96:99], a[0:3], a[40:43], a[96:99]
    v_mfma_f32_16x16x32_bf16 a[100:103], a[4:7], a[40:43], a[100:103]
    v_mfma_f32_16x16x32_bf16 a[104:107], a[8:11], a[36:39], a[104:107]
    v_mfma_f32_16x16x32_bf16 a[108:111], a[12:15], a[36:39], a[108:111]
    v_mfma_f32_16x16x32_bf16 a[112:115], a[8:11], a[40:43], a[112:115]
    v_mfma_f32_16x16x32_bf16 a[116:119], a[12:15], a[40:43], a[116:119]
    v_mfma_f32_16x16x32_bf16 v[160:163], a[0:3], a[36:39], v[160:163]
    s_nop 1
    ds_write_b128 v20, a[96:99] offset:0
    v_mfma_f32_16x16x32_bf16 v[164:167], a[4:7], a[36:39], v[164:167]
    ds_write_b128 v20, a[100:103] offset:1024
    v_mfma_f32_16x16x32_bf16 v[160:163], v[222:225], a[44:47], v[160:163]
    ds_write_b128 v21, a[104:107] offset:0
    v_mfma_f32_16x16x32_bf16 v[164:167], v[220:223], a[44:47], v[164:167]
    ds_write_b128 v21, a[108:111] offset:1024
    v_mfma_f32_16x16x32_bf16 v[160:163], v[222:225], a[52:55], v[160:163]
    ds_write_b128 v22, a[112:115] offset:0
    v_mfma_f32_16x16x32_bf16 v[164:167], v[220:223], a[52:55], v[164:167]
    ds_write_b128 v22, a[116:119] offset:1024
    s_waitcnt lgkmcnt(0)
    s_barrier
    ds_read_b128 v[104:107], v23 offset:0
    ds_read_b128 v[108:111], v23 offset:1024
    ds_read_b128 v[112:115], v23 offset:2048
    ds_read_b128 v[116:119], v23 offset:3072
    ds_read_b128 v[120:123], v23 offset:4096
    ds_read_b128 v[124:127], v23 offset:5120
    buffer_load_dword v9, v14, s[16:19], s37 offen offset:36 sc1
    s_mov_b32 s68, s92
    s_mov_b32 s69, s93
    s_waitcnt lgkmcnt(4)
    v_pk_add_f32 v[160:161], v[160:161], v[104:105]
    v_pk_add_f32 v[162:163], v[162:163], v[106:107]
    v_pk_add_f32 v[164:165], v[164:165], v[108:109]
    v_pk_add_f32 v[166:167], v[166:167], v[110:111]
    s_waitcnt lgkmcnt(2)
    v_pk_add_f32 v[160:161], v[160:161], v[112:113]
    v_pk_add_f32 v[162:163], v[162:163], v[114:115]
    v_pk_add_f32 v[164:165], v[164:165], v[116:117]
    v_pk_add_f32 v[166:167], v[166:167], v[118:119]
    s_waitcnt lgkmcnt(0)
    v_pk_add_f32 v[160:161], v[160:161], v[120:121]
    v_pk_add_f32 v[162:163], v[162:163], v[122:123]
    v_pk_add_f32 v[164:165], v[164:165], v[124:125]
    v_pk_add_f32 v[166:167], v[166:167], v[126:127]
    v_cvt_pk_bf16_f32 v192, v160, v161
    v_cvt_pk_bf16_f32 v193, v162, v163
    v_cvt_pk_bf16_f32 v194, v164, v165
    v_cvt_pk_bf16_f32 v195, v166, v167
    buffer_store_dwordx4 v[192:195], v24, s[72:75], s45 offen
    s_add_u32 s45, s45, 1048576
    s_and_b32 s41, s42, 16
    s_mov_b32 s11, 200000
    s_waitcnt vmcnt(1)
L_splp4b:
    v_readfirstlane_b32 s9, v9
    s_nop 0
    s_cmp_ge_u32 s9, s41
    s_cbranch_scc1 L_backp4b
    buffer_load_dword v9, v14, s[16:19], s37 offen offset:36 sc1
    s_sub_u32 s11, s11, 1
    s_waitcnt vmcnt(0)
    s_cbranch_scc0 L_splp4b
L_backp4b:
    s_barrier
    s_xor_b32 s35, s52, 0
    s_add_u32 s35, s35, s51
    buffer_load_dwordx4 a[16:19], v16, s[68:71], s35 offen sc1
    buffer_load_dwordx4 a[20:23], v17, s[68:71], s35 offen sc1
    s_xor_b32 s35, s52, 4096
    s_add_u32 s35, s35, s51
    buffer_load_dwordx4 a[24:27], v16, s[68:71], s35 offen sc1
    buffer_load_dwordx4 a[28:31], v17, s[68:71], s35 offen sc1
    s_xor_b32 s35, s52, 8192
    s_add_u32 s35, s35, s51
    buffer_load_dwordx4 a[144:147], v16, s[68:71], s35 offen sc1
    buffer_load_dwordx4 a[148:151], v17, s[68:71], s35 offen sc1
    s_xor_b32 s35, s52, 12288
    s_add_u32 s35, s35, s51
    buffer_load_dwordx4 a[152:155], v16, s[68:71], s35 offen sc1
    buffer_load_dwordx4 a[156:159], v17, s[68:71], s35 offen sc1
    s_xor_b32 s35, s52, 16384
    s_add_u32 s35, s35, s51
    buffer_load_dwordx4 v[96:99], v16, s[68:71], s35 offen sc1
    buffer_load_dwordx4 v[100:103], v17, s[68:71], s35 offen sc1
    s_xor_b32 s35, s52, 20480
    s_add_u32 s35, s35, s51
    buffer_load_dwordx4 v[128:131], v16, s[68:71], s35 offen sc1
    buffer_load_dwordx4 v[132:135], v17, s[68:71], s35 offen sc1
    s_waitcnt vmcnt(10)
    v_mfma_f32_16x16x32_bf16 v[160:163], a[160:163], a[16:19], 0
    s_xor_b32 s35, s52, 24576
    s_add_u32 s35, s35, s51
    v_mfma_f32_16x16x32_bf16 v[164:167], a[164:167], a[16:19], 0
    buffer_load_dwordx4 v[168:171], v16, s[68:71], s35 offen sc1
    v_mfma_f32_16x16x32_bf16 a[96:99], a[160:163], a[20:23], 0
    v_mfma_f32_16x16x32_bf16 a[100:103], a[164:167], a[20:23], 0
    v_mfma_f32_16x16x32_bf16 a[104:107], a[168:171], a[16:19], 0
    v_mfma_f32_16x16x32_bf16 a[108:111], a[172:175], a[16:19], 0
    buffer_load_dwordx4 v[180:183], v17, s[68:71], s35 offen sc1
    v_mfma_f32_16x16x32_bf16 a[112:115], a[168:171], a[20:23], 0
    v_mfma_f32_16x16x32_bf16 a[116:119], a[172:175], a[20:23], 0
    s_waitcnt vmcnt(10)
    v_mfma_f32_16x16x32_bf16 v[160:163], a[176:179], a[24:27], v[160:163]
    s_xor_b32 s35, s52, 28672
    s_add_u32 s35, s35, s51
    v_mfma_f32_16x16x32_bf16 v[164:167], a[180:183], a[24:27], v[164:167]
    buffer_load_dwordx4 v[200:203], v16, s[68:71], s35 offen sc1
    v_mfma_f32_16x16x32_bf16 a[96:99], a[176:179], a[28:31], a[96:99]
    v_mfma_f32_16x16x32_bf16 a[100:103], a[180:183], a[28:31], a[100:103]
    v_mfma_f32_16x16x32_bf16 a[104:107], a[184:187], a[24:27], a[104:107]
    v_mfma_f32_16x16x32_bf16 a[108:111], a[188:191], a[24:27], a[108:111]
    buffer_load_dwordx4 v[204:207], v17, s[68:71], s35 offen sc1
    v_mfma_f32_16x16x32_bf16 a[112:115], a[184:187], a[28:31], a[112:115]
    v_mfma_f32_16x16x32_bf16 a[116:119], a[188:191], a[28:31], a[116:119]
    s_waitcnt vmcnt(10)
    v_mfma_f32_16x16x32_bf16 v[160:163], a[192:195], a[144:147], v[160:163]
    s_add_u32 s35, s51, 32768
    v_mfma_f32_16x16x32_bf16 v[164:167], a[196:199], a[144:147], v[164:167]
    buffer_load_dwordx4 v[208:211], v16, s[68:71], s35 offen sc1
    v_mfma_f32_16x16x32_bf16 a[96:99], a[192:195], a[148:151], a[96:99]
    v_mfma_f32_16x16x32_bf16 a[100:103], a[196:199], a[148:151], a[100:103]
    v_mfma_f32_16x16x32_bf16 a[104:107], a[200:203], a[144:147], a[104:107]
    v_mfma_f32_16x16x32_bf16 a[108:111], a[204:207], a[144:147], a[108:111]
    buffer_load_dwordx4 v[212:215], v17, s[68:71], s35 offen sc1
    v_mfma_f32_16x16x32_bf16 a[112:115], a[200:203], a[148:151], a[112:115]
    v_mfma_f32_16x16x32_bf16 a[116:119], a[204:207], a[148:151], a[116:119]
    s_waitcnt vmcnt(10)
    v_mfma_f32_16x16x32_bf16 v[160:163], a[208:211], a[152:155], v[160:163]
    s_add_u32 s35, s51, 36864
    v_mfma_f32_16x16x32_bf16 v[164:167], a[212:215], a[152:155], v[164:167]
    buffer_load_dwordx4 v[216:219], v16, s[68:71], s35 offen sc1
    v_mfma_f32_16x16x32_bf16 a[96:99], a[208:211], a[156:159], a[96:99]
    v_mfma_f32_16x16x32_bf16 a[100:103], a[212:215], a[156:159], a[100:103]
    v_mfma_f32_16x16x32_bf16 a[104:107], a[216:219], a[152:155], a[104:107]
    v_mfma_f32_16x16x32_bf16 a[108:111], a[220:223], a[152:155], a[108:111]
    buffer_load_dwordx4 a[32:35], v17, s[68:71], s35 offen sc1
    v_mfma_f32_16x16x32_bf16 a[112:115], a[216:219], a[156:159], a[112:115]
    v_mfma_f32_16x16x32_bf16 a[116:119], a[220:223], a[156:159], a[116:119]
    s_waitcnt vmcnt(10)
    v_mfma_f32_16x16x32_bf16 v[160:163], a[224:227], v[96:99], v[160:163]
    s_add_u32 s35, s51, 40960
    v_mfma_f32_16x16x32_bf16 v[164:167], a[228:231], v[96:99], v[164:167]
    buffer_load_dwordx4 a[36:39], v16, s[68:71], s35 offen sc1
    v_mfma_f32_16x16x32_bf16 a[96:99], a[224:227], v[100:103], a[96:99]
    v_mfma_f32_16x16x32_bf16 a[100:103], a[228:231], v[100:103], a[100:103]
    v_mfma_f32_16x16x32_bf16 a[104:107], a[232:235], v[96:99], a[104:107]
    v_mfma_f32_16x16x32_bf16 a[108:111], a[236:239], v[96:99], a[108:111]
    buffer_load_dwordx4 a[40:43], v17, s[68:71], s35 offen sc1
    v_mfma_f32_16x16x32_bf16 a[112:115], a[232:235], v[100:103], a[112:115]
    v_mfma_f32_16x16x32_bf16 a[116:119], a[236:239], v[100:103], a[116:119]
    s_waitcnt vmcnt(10)
    v_mfma_f32_16x16x32_bf16 v[160:163], a[240:243], v[128:131], v[160:163]
    v_mfma_f32_16x16x32_bf16 v[164:167], a[244:247], v[128:131], v[164:167]
    v_mfma_f32_16x16x32_bf16 a[96:99], a[240:243], v[132:135], a[96:99]
    v_mfma_f32_16x16x32_bf16 a[100:103], a[244:247], v[132:135], a[100:103]
    v_mfma_f32_16x16x32_bf16 a[104:107], a[248:251], v[128:131], a[104:107]
    v_mfma_f32_16x16x32_bf16 a[108:111], a[252:255], v[128:131], a[108:111]
    v_mfma_f32_16x16x32_bf16 a[112:115], a[248:251], v[132:135], a[112:115]
    v_mfma_f32_16x16x32_bf16 a[116:119], a[252:255], v[132:135], a[116:119]
    s_waitcnt vmcnt(8)
    v_mfma_f32_16x16x32_bf16 v[160:163], v[32:35], v[168:171], v[160:163]
    v_mfma_f32_16x16x32_bf16 v[164:167], v[36:39], v[168:171], v[164:167]
    v_mfma_f32_16x16x32_bf16 a[96:99], v[32:35], v[180:183], a[96:99]
    v_mfma_f32_16x16x32_bf16 a[100:103], v[36:39], v[180:183], a[100:103]
    v_mfma_f32_16x16x32_bf16 a[104:107], v[40:43], v[168:171], a[104:107]
    v_mfma_f32_16x16x32_bf16 a[108:111], v[44:47], v[168:171], a[108:111]
    v_mfma_f32_16x16x32_bf16 a[112:115], v[40:43], v[180:183], a[112:115]
    v_mfma_f32_16x16x32_bf16 a[116:119], v[44:47], v[180:183], a[116:119]
    s_waitcnt vmcnt(6)
    v_mfma_f32_16x16x32_bf16 v[160:163], v[48:51], v[200:203], v[160:163]
    v_mfma_f32_16x16x32_bf16 v[164:167], v[52:55], v[200:203], v[164:167]
    v_mfma_f32_16x16x32_bf16 a[96:99], v[48:51], v[204:207], a[96:99]
    v_mfma_f32_16x16x32_bf16 a[100:103], v[52:55], v[204:207], a[100:103]
    v_mfma_f32_16x16x32_bf16 a[104:107], v[56:59], v[200:203], a[104:107]
    v_mfma_f32_16x16x32_bf16 a[108:111], v[60:63], v[200:203], a[108:111]
    v_mfma_f32_16x16x32_bf16 a[112:115], v[56:59], v[204:207], a[112:115]
    v_mfma_f32_16x16x32_bf16 a[116:119], v[60:63], v[204:207], a[116:119]
    s_waitcnt vmcnt(4)
    v_mfma_f32_16x16x32_bf16 v[160:163], v[64:67], v[208:211], v[160:163]
    v_mfma_f32_16x16x32_bf16 v[164:167], v[68:71], v[208:211], v[164:167]
    v_mfma_f32_16x16x32_bf16 a[96:99], v[64:67], v[212:215], a[96:99]
    v_mfma_f32_16x16x32_bf16 a[100:103], v[68:71], v[212:215], a[100:103]
    v_mfma_f32_16x16x32_bf16 a[104:107], v[72:75], v[208:211], a[104:107]
    v_mfma_f32_16x16x32_bf16 a[108:111], v[76:79], v[208:211], a[108:111]
    v_mfma_f32_16x16x32_bf16 a[112:115], v[72:75], v[212:215], a[112:115]
    v_mfma_f32_16x16x32_bf16 a[116:119], v[76:79], v[212:215], a[116:119]
    s_waitcnt vmcnt(2)
    v_mfma_f32_16x16x32_bf16 v[160:163], v[80:83], v[216:219], v[160:163]
    v_mfma_f32_16x16x32_bf16 v[164:167], v[84:87], v[216:219], v[164:167]
    v_mfma_f32_16x16x32_bf16 a[96:99], v[80:83], a[32:35], a[96:99]
    v_mfma_f32_16x16x32_bf16 a[100:103], v[84:87], a[32:35], a[100:103]
    v_mfma_f32_16x16x32_bf16 a[104:107], v[88:91], v[216:219], a[104:107]
    v_mfma_f32_16x16x32_bf16 a[108:111], v[92:95], v[216:219], a[108:111]
    v_mfma_f32_16x16x32_bf16 a[112:115], v[88:91], a[32:35], a[112:115]
    v_mfma_f32_16x16x32_bf16 a[116:119], v[92:95], a[32:35], a[116:119]
    s_waitcnt vmcnt(0)
    v_mfma_f32_16x16x32_bf16 a[96:99], a[0:3], a[40:43], a[96:99]
    v_mfma_f32_16x16x32_bf16 a[100:103], a[4:7], a[40:43], a[100:103]
    v_mfma_f32_16x16x32_bf16 a[104:107], a[8:11], a[36:39], a[104:107]
    v_mfma_f32_16x16x32_bf16 a[108:111], a[12:15], a[36:39], a[108:111]
    v_mfma_f32_16x16x32_bf16 a[112:115], a[8:11], a[40:43], a[112:115]
    v_mfma_f32_16x16x32_bf16 a[116:119], a[12:15], a[40:43], a[116:119]
    v_mfma_f32_16x16x32_bf16 v[160:163], a[0:3], a[36:39], v[160:163]
    s_nop 1
    ds_write_b128 v20, a[96:99] offset:24576
    v_mfma_f32_16x16x32_bf16 v[164:167], a[4:7], a[36:39], v[164:167]
    ds_write_b128 v20, a[100:103] offset:25600
    v_mfma_f32_16x16x32_bf16 v[160:163], v[222:225], a[48:51], v[160:163]
    ds_write_b128 v21, a[104:107] offset:24576
    v_mfma_f32_16x16x32_bf16 v[164:167], v[220:223], a[48:51], v[164:167]
    ds_write_b128 v21, a[108:111] offset:25600
    v_mfma_f32_16x16x32_bf16 v[160:163], v[222:225], a[52:55], v[160:163]
    ds_write_b128 v22, a[112:115] offset:24576
    v_mfma_f32_16x16x32_bf16 v[164:167], v[220:223], a[52:55], v[164:167]
    ds_write_b128 v22, a[116:119] offset:25600
    s_waitcnt lgkmcnt(0)
    s_barrier
    ds_read_b128 v[104:107], v23 offset:24576
    ds_read_b128 v[108:111], v23 offset:25600
    ds_read_b128 v[112:115], v23 offset:26624
    ds_read_b128 v[116:119], v23 offset:27648
    ds_read_b128 v[120:123], v23 offset:28672
    ds_read_b128 v[124:127], v23 offset:29696
    s_waitcnt lgkmcnt(4)
    v_pk_add_f32 v[160:161], v[160:161], v[104:105]
    v_pk_add_f32 v[162:163], v[162:163], v[106:107]
    v_pk_add_f32 v[164:165], v[164:165], v[108:109]
    v_pk_add_f32 v[166:167], v[166:167], v[110:111]
    s_waitcnt lgkmcnt(2)
    v_pk_add_f32 v[160:161], v[160:161], v[112:113]
    v_pk_add_f32 v[162:163], v[162:163], v[114:115]
    v_pk_add_f32 v[164:165], v[164:165], v[116:117]
    v_pk_add_f32 v[166:167], v[166:167], v[118:119]
    s_waitcnt lgkmcnt(0)
    v_pk_add_f32 v[160:161], v[160:161], v[120:121]
    v_pk_add_f32 v[162:163], v[162:163], v[122:123]
    v_pk_add_f32 v[164:165], v[164:165], v[124:125]
    v_pk_add_f32 v[166:167], v[166:167], v[126:127]
    v_cvt_pk_bf16_f32 v192, v160, v161
    v_cvt_pk_bf16_f32 v193, v162, v163
    v_cvt_pk_bf16_f32 v194, v164, v165
    v_cvt_pk_bf16_f32 v195, v166, v167
    buffer_store_dwordx4 v[192:195], v24, s[72:75], s45 offen
L_end:
    s_endpgm
L_spinp1:
    s_mov_b32 s11, 200000
L_splp1:
    buffer_load_dword v9, v14, s[16:19], s42 offen offset:12 sc1
    s_waitcnt vmcnt(0)
    v_cmp_gt_u32 vcc, s81, v9
    s_nop 0
    s_cbranch_vccz L_backp1
    s_sub_u32 s11, s11, 1
    s_cbranch_scc0 L_splp1
    s_branch L_backp1
L_spinpz:
    s_mov_b32 s11, 200000
L_splpz:
    buffer_load_dword v9, v12, s[60:63], 0 offen offset:0 sc1
    s_waitcnt vmcnt(0)
    v_cmp_gt_u32 vcc, 44, v9
    s_nop 0
    s_cbranch_vccz L_backpz
    s_sub_u32 s11, s11, 1
    s_cbranch_scc0 L_splpz
    s_branch L_backpz
L_spinp0:
    s_mov_b32 s11, 200000
L_splp0:
    buffer_load_dword v9, v14, s[16:19], 0 offen offset:0 sc1
    s_waitcnt vmcnt(0)
    v_cmp_gt_u32 vcc, 16, v9
    s_nop 0
    s_cbranch_vccz L_backp0
    s_sub_u32 s11, s11, 1
    s_cbranch_scc0 L_splp0
    s_branch L_backp0
L_spinpa7:
    s_mov_b32 s11, 200000
L_splpa7:
    buffer_load_dword v9, v14, s[16:19], 0 offen offset:128 sc1
    s_waitcnt vmcnt(0)
    v_cmp_gt_u32 vcc, 28, v9
    s_nop 0
    s_cbranch_vccz L_backpa7
    s_sub_u32 s11, s11, 1
    s_cbranch_scc0 L_splpa7
    s_branch L_backpa7
    .p2align 6
L_wuP1:
    s_branch L_wbP1
L_P1:
    s_waitcnt lgkmcnt(4)
    v_mfma_f32_16x16x32_bf16 v[160:163], a[64:67], a[0:3], v[240:243]
    ds_read_b128 a[128:131], v2 offset:24576
    s_add_u32 m0, s10, 65536
    v_mfma_f32_16x16x32_bf16 v[160:163], a[68:71], a[4:7], v[160:163]
    ds_read_b128 a[132:135], v2 offset:25600
    buffer_load_dwordx4 v2, s[20:23], s44 offen offset:0 sc1 lds
    v_mfma_f32_16x16x32_bf16 v[160:163], a[72:75], a[8:11], v[160:163]
    ds_read_b128 a[136:139], v2 offset:26624
    v_mfma_f32_16x16x32_bf16 v[160:163], a[76:79], a[12:15], v[160:163]
    ds_read_b128 a[140:143], v2 offset:27648
    v_mfma_f32_16x16x32_bf16 v[164:167], a[64:67], a[16:19], 0
    ds_read_b128 a[144:147], v2 offset:28672
    v_mfma_f32_16x16x32_bf16 v[164:167], a[68:71], a[20:23], v[164:167]
    ds_read_b128 a[148:151], v2 offset:29696
    buffer_load_dwordx4 v2, s[20:23], s44 offen offset:1024 sc1 lds
    v_mfma_f32_16x16x32_bf16 v[164:167], a[72:75], a[24:27], v[164:167]
    ds_read_b128 a[152:155], v2 offset:30720
    v_max3_f32 v16, v160, v161, v162
    v_max_f32 v16, v16, v163
    v_mfma_f32_16x16x32_bf16 v[164:167], a[76:79], a[28:31], v[164:167]
    ds_read_b128 a[156:159], v2 offset:31744
    v_mov_b32 v20, v16
    v_mfma_f32_16x16x32_bf16 v[176:179], a[64:67], a[32:35], 0
    v_mfma_f32_16x16x32_bf16 v[176:179], a[68:71], a[36:39], v[176:179]
    buffer_load_dwordx4 v2, s[20:23], s44 offen offset:2048 sc1 lds
    v_permlane16_swap_b32 v16, v20
    v_max_f32 v16, v16, v20
    v_mfma_f32_16x16x32_bf16 v[176:179], a[72:75], a[40:43], v[176:179]
    v_mov_b32 v20, v16
    v_max3_f32 v17, v164, v165, v166
    v_max_f32 v17, v17, v167
    v_mfma_f32_16x16x32_bf16 v[176:179], a[76:79], a[44:47], v[176:179]
    v_mov_b32 v21, v17
    v_mfma_f32_16x16x32_bf16 v[180:183], a[64:67], a[48:51], 0
    ds_read_b128 a[64:67], v2 offset:0
    v_permlane32_swap_b32 v16, v20
    v_max_f32 v16, v16, v20
    v_mfma_f32_16x16x32_bf16 v[180:183], a[68:71], a[52:55], v[180:183]
    ds_read_b128 a[68:71], v2 offset:1024
    buffer_load_dwordx4 v2, s[20:23], s44 offen offset:3072 sc1 lds
    v_sub_f32 v224, 0, v16
    v_sub_f32 v225, 0, v16
    v_permlane16_swap_b32 v17, v21
    v_max_f32 v17, v17, v21
    v_mfma_f32_16x16x32_bf16 v[180:183], a[72:75], a[56:59], v[180:183]
    ds_read_b128 a[72:75], v2 offset:2048
    v_sub_f32 v226, 0, v16
    v_sub_f32 v227, 0, v16
    v_cndmask_b32 v244, v12, v224, s[50:51]
    v_cndmask_b32 v245, v12, v225, s[50:51]
    v_cndmask_b32 v246, v12, v226, s[50:51]
    v_cndmask_b32 v247, v12, v227, s[50:51]
    v_mov_b32 v21, v17
    v_max3_f32 v18, v176, v177, v178
    v_max_f32 v18, v18, v179
    v_mfma_f32_16x16x32_bf16 v[180:183], a[76:79], a[60:63], v[180:183]
    ds_read_b128 a[76:79], v2 offset:3072
    v_mov_b32 v22, v18
    s_waitcnt lgkmcnt(12)
    v_mfma_f32_16x16x32_bf16 v[168:171], a[80:83], a[0:3], v[244:247]
    s_add_u32 m0, s10, 69632
    v_permlane32_swap_b32 v17, v21
    v_max_f32 v17, v17, v21
    v_mfma_f32_16x16x32_bf16 v[168:171], a[84:87], a[4:7], v[168:171]
    buffer_load_dwordx4 v3, s[20:23], s44 offen offset:0 sc1 lds
    v_sub_f32 v228, 0, v17
    v_sub_f32 v229, 0, v17
    v_permlane16_swap_b32 v18, v22
    v_max_f32 v18, v18, v22
    v_mfma_f32_16x16x32_bf16 v[168:171], a[88:91], a[8:11], v[168:171]
    v_sub_f32 v230, 0, v17
    v_sub_f32 v231, 0, v17
    v_cndmask_b32 v252, v12, v228, s[60:61]
    v_cndmask_b32 v253, v12, v229, s[62:63]
    v_cndmask_b32 v254, v12, v230, s[30:31]
    v_cndmask_b32 v255, v12, v231, s[32:33]
    v_mov_b32 v22, v18
    v_max3_f32 v19, v180, v181, v182
    v_max_f32 v19, v19, v183
    v_mfma_f32_16x16x32_bf16 v[168:171], a[92:95], a[12:15], v[168:171]
    v_mov_b32 v23, v19
    v_mfma_f32_16x16x32_bf16 v[172:175], a[80:83], a[16:19], v[252:255]
    v_permlane32_swap_b32 v18, v22
    v_max_f32 v18, v18, v22
    v_mfma_f32_16x16x32_bf16 v[172:175], a[84:87], a[20:23], v[172:175]
    buffer_load_dwordx4 v3, s[20:23], s44 offen offset:1024 sc1 lds
    v_sub_f32 v232, 0, v18
    v_sub_f32 v233, 0, v18
    v_permlane16_swap_b32 v19, v23
    v_max_f32 v19, v19, v23
    v_mfma_f32_16x16x32_bf16 v[172:175], a[88:91], a[24:27], v[172:175]
    v_sub_f32 v234, 0, v18
    v_sub_f32 v235, 0, v18
    v_mov_b32 v23, v19
    v_mfma_f32_16x16x32_bf16 v[172:175], a[92:95], a[28:31], v[172:175]
    v_mfma_f32_16x16x32_bf16 v[184:187], a[80:83], a[32:35], v[232:235]
    v_permlane32_swap_b32 v19, v23
    v_max_f32 v19, v19, v23
    v_mfma_f32_16x16x32_bf16 v[184:187], a[84:87], a[36:39], v[184:187]
    buffer_load_dwordx4 v3, s[20:23], s44 offen offset:2048 sc1 lds
    v_sub_f32 v236, 0, v19
    v_sub_f32 v237, 0, v19
    v_mfma_f32_16x16x32_bf16 v[184:187], a[88:91], a[40:43], v[184:187]
    v_sub_f32 v238, 0, v19
    v_sub_f32 v239, 0, v19
    v_cndmask_b32 v240, v12, v224, s[34:35]
    v_mfma_f32_16x16x32_bf16 v[184:187], a[92:95], a[44:47], v[184:187]
    v_sub_f32 v160, v160, v16
    v_sub_f32 v161, v161, v16
    v_cndmask_b32 v241, v12, v225, s[36:37]
    v_mfma_f32_16x16x32_bf16 v[188:191], a[80:83], a[48:51], v[236:239]
    ds_read_b128 a[80:83], v2 offset:4096
    v_sub_f32 v162, v162, v16
    v_cndmask_b32 v242, v12, v226, s[84:85]
    v_cndmask_b32 v243, v12, v227, s[86:87]
    v_mfma_f32_16x16x32_bf16 v[188:191], a[84:87], a[52:55], v[188:191]
    ds_read_b128 a[84:87], v2 offset:5120
    buffer_load_dwordx4 v3, s[20:23], s44 offen offset:3072 sc1 lds
    v_cndmask_b32 v248, v12, v228, s[50:51]
    v_mfma_f32_16x16x32_bf16 v[188:191], a[88:91], a[56:59], v[188:191]
    ds_read_b128 a[88:91], v2 offset:6144
    v_sub_f32 v163, v163, v16
    v_sub_f32 v164, v164, v17
    v_cndmask_b32 v249, v12, v229, s[50:51]
    v_cndmask_b32 v250, v12, v230, s[50:51]
    v_cndmask_b32 v251, v12, v231, s[50:51]
    v_mov_b32 v244, v12
    v_mov_b32 v245, v12
    v_mov_b32 v246, v12
    v_mov_b32 v247, v12
    v_cndmask_b32 v252, v12, v228, s[34:35]
    v_cndmask_b32 v253, v12, v229, s[36:37]
    v_cndmask_b32 v254, v12, v230, s[84:85]
    v_cndmask_b32 v255, v12, v231, s[86:87]
    v_mfma_f32_16x16x32_bf16 v[188:191], a[92:95], a[60:63], v[188:191]
    ds_read_b128 a[92:95], v2 offset:7168
    v_sub_f32 v165, v165, v17
    v_sub_f32 v166, v166, v17
    v_sub_f32 v167, v167, v17
    v_sub_f32 v176, v176, v18
    v_sub_f32 v177, v177, v18
    v_sub_f32 v178, v178, v18
    v_sub_f32 v179, v179, v18
    v_sub_f32 v180, v180, v19
    v_sub_f32 v181, v181, v19
    v_sub_f32 v182, v182, v19
    v_sub_f32 v183, v183, v19
    s_waitcnt lgkmcnt(4)
    v_mfma_f32_16x16x32_bf16 v[192:195], a[64:67], a[0:3], v[240:243]
    s_add_u32 s44, s44, 16384
    v_exp_f32 v160, v160
    v_mfma_f32_16x16x32_bf16 v[192:195], a[68:71], a[4:7], v[192:195]
    v_exp_f32 v161, v161
    v_exp_f32 v162, v162
    v_mfma_f32_16x16x32_bf16 v[192:195], a[72:75], a[8:11], v[192:195]
    v_exp_f32 v163, v163
    v_exp_f32 v164, v164
    v_mfma_f32_16x16x32_bf16 v[192:195], a[76:79], a[12:15], v[192:195]
    v_exp_f32 v165, v165
    v_cvt_pk_bf16_f32 v160, v160, v161
    v_mfma_f32_16x16x32_bf16 v[196:199], a[64:67], a[16:19], v[248:251]
    v_exp_f32 v166, v166
    v_cvt_pk_bf16_f32 v161, v162, v163
    v_mfma_f32_16x16x32_bf16 v[196:199], a[68:71], a[20:23], v[196:199]
    v_exp_f32 v167, v167
    v_cvt_pk_bf16_f32 v164, v164, v165
    v_mfma_f32_16x16x32_bf16 v[196:199], a[72:75], a[24:27], v[196:199]
    v_exp_f32 v176, v176
    v_cvt_pk_bf16_f32 v165, v166, v167
    v_mfma_f32_16x16x32_bf16 v[196:199], a[76:79], a[28:31], v[196:199]
    v_exp_f32 v177, v177
    v_mfma_f32_16x16x32_bf16 v[208:211], a[64:67], a[32:35], v[232:235]
    v_exp_f32 v178, v178
    v_cvt_pk_bf16_f32 v176, v176, v177
    v_mfma_f32_16x16x32_bf16 v[208:211], a[68:71], a[36:39], v[208:211]
    v_exp_f32 v179, v179
    v_mfma_f32_16x16x32_bf16 v[208:211], a[72:75], a[40:43], v[208:211]
    v_exp_f32 v180, v180
    v_cvt_pk_bf16_f32 v177, v178, v179
    v_mfma_f32_16x16x32_bf16 v[208:211], a[76:79], a[44:47], v[208:211]
    v_exp_f32 v181, v181
    v_mfma_f32_16x16x32_bf16 v[212:215], a[64:67], a[48:51], v[236:239]
    ds_read_b128 a[64:67], v2 offset:8192
    v_exp_f32 v182, v182
    v_mfma_f32_16x16x32_bf16 v[212:215], a[68:71], a[52:55], v[212:215]
    ds_read_b128 a[68:71], v2 offset:9216
    v_exp_f32 v183, v183
    v_mfma_f32_16x16x32_bf16 v[212:215], a[72:75], a[56:59], v[212:215]
    ds_read_b128 a[72:75], v2 offset:10240
    v_exp_f32 v168, v168
    v_mfma_f32_16x16x32_bf16 v[212:215], a[76:79], a[60:63], v[212:215]
    ds_read_b128 a[76:79], v2 offset:11264
    v_cvt_pk_bf16_f32 v180, v180, v181
    s_waitcnt lgkmcnt(4)
    v_mfma_f32_16x16x32_bf16 v[200:203], a[80:83], a[0:3], v[244:247]
    v_exp_f32 v169, v169
    v_cvt_pk_bf16_f32 v181, v182, v183
    v_mfma_f32_16x16x32_bf16 v[200:203], a[84:87], a[4:7], v[200:203]
    v_exp_f32 v170, v170
    v_cvt_pk_bf16_f32 v162, v168, v169
    v_mfma_f32_16x16x32_bf16 v[200:203], a[88:91], a[8:11], v[200:203]
    v_exp_f32 v171, v171
    v_mfma_f32_16x16x32_bf16 v[200:203], a[92:95], a[12:15], v[200:203]
    v_exp_f32 v172, v172
    v_cvt_pk_bf16_f32 v163, v170, v171
    v_mfma_f32_16x16x32_bf16 v[204:207], a[80:83], a[16:19], v[252:255]
    v_exp_f32 v173, v173
    v_mfma_f32_16x16x32_bf16 v[204:207], a[84:87], a[20:23], v[204:207]
    v_exp_f32 v174, v174
    v_mfma_f32_16x16x32_bf16 v[204:207], a[88:91], a[24:27], v[204:207]
    v_exp_f32 v175, v175
    v_mfma_f32_16x16x32_bf16 v[204:207], a[92:95], a[28:31], v[204:207]
    v_exp_f32 v184, v184
    v_mfma_f32_16x16x32_bf16 v[216:219], a[80:83], a[32:35], v[232:235]
    v_exp_f32 v185, v185
    v_mfma_f32_16x16x32_bf16 v[216:219], a[84:87], a[36:39], v[216:219]
    v_exp_f32 v186, v186
    v_mfma_f32_16x16x32_bf16 v[216:219], a[88:91], a[40:43], v[216:219]
    v_exp_f32 v187, v187
    v_mfma_f32_16x16x32_bf16 v[216:219], a[92:95], a[44:47], v[216:219]
    v_exp_f32 v188, v188
    v_mfma_f32_16x16x32_bf16 v[220:223], a[80:83], a[48:51], v[236:239]
    ds_read_b128 a[80:83], v2 offset:12288
    v_exp_f32 v189, v189
    v_mfma_f32_16x16x32_bf16 v[220:223], a[84:87], a[52:55], v[220:223]
    ds_read_b128 a[84:87], v2 offset:13312
    v_exp_f32 v190, v190
    v_mfma_f32_16x16x32_bf16 v[220:223], a[88:91], a[56:59], v[220:223]
    ds_read_b128 a[88:91], v2 offset:14336
    v_exp_f32 v191, v191
    v_mfma_f32_16x16x32_bf16 v[220:223], a[92:95], a[60:63], v[220:223]
    ds_read_b128 a[92:95], v2 offset:15360
    v_cvt_pk_bf16_f32 v166, v172, v173
    v_cvt_pk_bf16_f32 v167, v174, v175
    v_cvt_pk_bf16_f32 v178, v184, v185
    v_cvt_pk_bf16_f32 v179, v186, v187
    v_cvt_pk_bf16_f32 v182, v188, v189
    v_cvt_pk_bf16_f32 v183, v190, v191
    s_add_u32 m0, s10, 98304
    s_waitcnt vmcnt(8) lgkmcnt(8)
    s_xor_b32 s6, s5, 6
    s_cmp_lg_u32 s6, 0
    s_cbranch_scc1 L_sg4
    buffer_load_dword v9, v14, s[16:19], 0 offen offset:128 sc1
L_sg4:
    s_mov_b32 s91, m0
    v_mfma_f32_16x16x32_bf16 v[32:35], a[128:131], v[160:163], 0
    s_barrier
    v_xor_b32 v10, m0, v15
    v_mfma_f32_16x16x32_bf16 v[36:39], a[128:131], v[164:167], 0
    buffer_load_dwordx4 v2, s[20:23], s44 offen offset:0 sc1 lds
    v_mfma_f32_16x16x32_bf16 v[96:99], a[128:131], v[176:179], 0
    v_exp_f32 v192, v192
    v_mfma_f32_16x16x32_bf16 v[100:103], a[128:131], v[180:183], 0
    ds_read_b128 a[128:131], v10 offset:16384
    v_exp_f32 v193, v193
    v_mfma_f32_16x16x32_bf16 v[40:43], a[132:135], v[160:163], 0
    v_exp_f32 v194, v194
    v_cvt_pk_bf16_f32 v192, v192, v193
    v_mfma_f32_16x16x32_bf16 v[44:47], a[132:135], v[164:167], 0
    v_exp_f32 v195, v195
    v_mfma_f32_16x16x32_bf16 v[104:107], a[132:135], v[176:179], 0
    v_exp_f32 v196, v196
    v_cvt_pk_bf16_f32 v193, v194, v195
    v_mfma_f32_16x16x32_bf16 v[108:111], a[132:135], v[180:183], 0
    ds_read_b128 a[132:135], v10 offset:17408
    v_exp_f32 v197, v197
    v_mfma_f32_16x16x32_bf16 v[48:51], a[136:139], v[160:163], 0
    v_exp_f32 v198, v198
    v_cvt_pk_bf16_f32 v196, v196, v197
    v_mfma_f32_16x16x32_bf16 v[52:55], a[136:139], v[164:167], 0
    v_exp_f32 v199, v199
    v_mfma_f32_16x16x32_bf16 v[112:115], a[136:139], v[176:179], 0
    v_exp_f32 v208, v208
    v_cvt_pk_bf16_f32 v197, v198, v199
    v_mfma_f32_16x16x32_bf16 v[116:119], a[136:139], v[180:183], 0
    ds_read_b128 a[136:139], v10 offset:18432
    v_exp_f32 v209, v209
    v_mfma_f32_16x16x32_bf16 v[56:59], a[140:143], v[160:163], 0
    buffer_load_dwordx4 v2, s[20:23], s44 offen offset:1024 sc1 lds
    v_cvt_pk_bf16_f32 v208, v208, v209
    v_mfma_f32_16x16x32_bf16 v[60:63], a[140:143], v[164:167], 0
    v_exp_f32 v210, v210
    v_mfma_f32_16x16x32_bf16 v[120:123], a[140:143], v[176:179], 0
    v_exp_f32 v211, v211
    v_mfma_f32_16x16x32_bf16 v[124:127], a[140:143], v[180:183], 0
    ds_read_b128 a[140:143], v10 offset:19456
    v_exp_f32 v212, v212
    v_mfma_f32_16x16x32_bf16 v[64:67], a[144:147], v[160:163], 0
    v_exp_f32 v213, v213
    v_mfma_f32_16x16x32_bf16 v[68:71], a[144:147], v[164:167], 0
    v_exp_f32 v214, v214
    v_mfma_f32_16x16x32_bf16 v[128:131], a[144:147], v[176:179], 0
    v_exp_f32 v215, v215
    v_mfma_f32_16x16x32_bf16 v[132:135], a[144:147], v[180:183], 0
    ds_read_b128 a[144:147], v10 offset:20480
    v_exp_f32 v200, v200
    v_mfma_f32_16x16x32_bf16 v[72:75], a[148:151], v[160:163], 0
    v_exp_f32 v201, v201
    v_mfma_f32_16x16x32_bf16 v[76:79], a[148:151], v[164:167], 0
    v_exp_f32 v202, v202
    v_mfma_f32_16x16x32_bf16 v[136:139], a[148:151], v[176:179], 0
    v_exp_f32 v203, v203
    v_mfma_f32_16x16x32_bf16 v[140:143], a[148:151], v[180:183], 0
    ds_read_b128 a[148:151], v10 offset:21504
    v_cvt_pk_bf16_f32 v209, v210, v211
    v_mfma_f32_16x16x32_bf16 v[80:83], a[152:155], v[160:163], 0
    buffer_load_dwordx4 v2, s[20:23], s44 offen offset:2048 sc1 lds
    v_mfma_f32_16x16x32_bf16 v[84:87], a[152:155], v[164:167], 0
    v_exp_f32 v204, v204
    v_mfma_f32_16x16x32_bf16 v[144:147], a[152:155], v[176:179], 0
    v_exp_f32 v205, v205
    v_mfma_f32_16x16x32_bf16 v[148:151], a[152:155], v[180:183], 0
    ds_read_b128 a[152:155], v10 offset:22528
    v_cvt_pk_bf16_f32 v212, v212, v213
    v_mfma_f32_16x16x32_bf16 v[88:91], a[156:159], v[160:163], 0
    v_exp_f32 v206, v206
    v_mfma_f32_16x16x32_bf16 v[92:95], a[156:159], v[164:167], 0
    v_exp_f32 v207, v207
    v_mfma_f32_16x16x32_bf16 v[152:155], a[156:159], v[176:179], 0
    v_exp_f32 v216, v216
    v_mfma_f32_16x16x32_bf16 v[156:159], a[156:159], v[180:183], 0
    ds_read_b128 a[156:159], v10 offset:23552
    v_cvt_pk_bf16_f32 v213, v214, v215
    v_smfmac_f32_16x16x64_bf16 a[96:99], a[116:119], v[160:167], v6
    v_cvt_pk_bf16_f32 v194, v200, v201
    v_smfmac_f32_16x16x64_bf16 a[100:103], a[116:119], v[176:183], v6
    s_waitcnt lgkmcnt(8)
    v_mfma_f32_16x16x32_bf16 v[176:179], a[64:67], a[32:35], v[232:235]
    v_exp_f32 v217, v217
    v_mfma_f32_16x16x32_bf16 v[176:179], a[68:71], a[36:39], v[176:179]
    v_exp_f32 v218, v218
    v_mfma_f32_16x16x32_bf16 v[176:179], a[72:75], a[40:43], v[176:179]
    buffer_load_dwordx4 v2, s[20:23], s44 offen offset:3072 sc1 lds
    s_add_u32 m0, m0, 4096
    v_mfma_f32_16x16x32_bf16 v[176:179], a[76:79], a[44:47], v[176:179]
    v_exp_f32 v219, v219
    v_mfma_f32_16x16x32_bf16 v[180:183], a[64:67], a[48:51], v[236:239]
    ds_read_b128 a[64:67], v10 offset:0
    v_cvt_pk_bf16_f32 v195, v202, v203
    v_mfma_f32_16x16x32_bf16 v[180:183], a[68:71], a[52:55], v[180:183]
    ds_read_b128 a[68:71], v10 offset:1024
    v_cvt_pk_bf16_f32 v198, v204, v205
    v_mfma_f32_16x16x32_bf16 v[180:183], a[72:75], a[56:59], v[180:183]
    ds_read_b128 a[72:75], v10 offset:2048
    v_cvt_pk_bf16_f32 v199, v206, v207
    v_mfma_f32_16x16x32_bf16 v[180:183], a[76:79], a[60:63], v[180:183]
    ds_read_b128 a[76:79], v10 offset:3072
    v_cvt_pk_bf16_f32 v210, v216, v217
    v_mfma_f32_16x16x32_bf16 v[184:187], a[80:83], a[32:35], v[232:235]
    v_exp_f32 v220, v220
    v_mfma_f32_16x16x32_bf16 v[184:187], a[84:87], a[36:39], v[184:187]
    v_exp_f32 v221, v221
    v_mfma_f32_16x16x32_bf16 v[184:187], a[88:91], a[40:43], v[184:187]
    v_exp_f32 v222, v222
    v_mfma_f32_16x16x32_bf16 v[184:187], a[92:95], a[44:47], v[184:187]
    v_exp_f32 v223, v223
    v_mfma_f32_16x16x32_bf16 v[188:191], a[80:83], a[48:51], v[236:239]
    ds_read_b128 a[80:83], v10 offset:4096
    v_cvt_pk_bf16_f32 v211, v218, v219
    v_mfma_f32_16x16x32_bf16 v[188:191], a[84:87], a[52:55], v[188:191]
    ds_read_b128 a[84:87], v10 offset:5120
    v_cvt_pk_bf16_f32 v214, v220, v221
    v_mfma_f32_16x16x32_bf16 v[188:191], a[88:91], a[56:59], v[188:191]
    ds_read_b128 a[88:91], v10 offset:6144
    v_cvt_pk_bf16_f32 v215, v222, v223
    v_mfma_f32_16x16x32_bf16 v[188:191], a[92:95], a[60:63], v[188:191]
    ds_read_b128 a[92:95], v10 offset:7168
    s_waitcnt lgkmcnt(8)
    v_mfma_f32_16x16x32_bf16 v[32:35], a[128:131], v[192:195], v[32:35]
    buffer_load_dwordx4 v3, s[20:23], s44 offen offset:0 sc1 lds
    v_mfma_f32_16x16x32_bf16 v[36:39], a[128:131], v[196:199], v[36:39]
    v_exp_f32 v176, v176
    v_mfma_f32_16x16x32_bf16 v[96:99], a[128:131], v[208:211], v[96:99]
    v_exp_f32 v177, v177
    v_mfma_f32_16x16x32_bf16 v[100:103], a[128:131], v[212:215], v[100:103]
    ds_read_b128 a[128:131], v10 offset:24576
    v_cvt_pk_bf16_f32 v176, v176, v177
    v_mfma_f32_16x16x32_bf16 v[40:43], a[132:135], v[192:195], v[40:43]
    v_mfma_f32_16x16x32_bf16 v[44:47], a[132:135], v[196:199], v[44:47]
    v_exp_f32 v178, v178
    v_mfma_f32_16x16x32_bf16 v[104:107], a[132:135], v[208:211], v[104:107]
    v_mfma_f32_16x16x32_bf16 v[108:111], a[132:135], v[212:215], v[108:111]
    ds_read_b128 a[132:135], v10 offset:25600
    v_mfma_f32_16x16x32_bf16 v[48:51], a[136:139], v[192:195], v[48:51]
    v_exp_f32 v179, v179
    v_mfma_f32_16x16x32_bf16 v[52:55], a[136:139], v[196:199], v[52:55]
    buffer_load_dwordx4 v3, s[20:23], s44 offen offset:1024 sc1 lds
    v_mfma_f32_16x16x32_bf16 v[112:115], a[136:139], v[208:211], v[112:115]
    v_cvt_pk_bf16_f32 v177, v178, v179
    v_mfma_f32_16x16x32_bf16 v[116:119], a[136:139], v[212:215], v[116:119]
    ds_read_b128 a[136:139], v10 offset:26624
    v_mfma_f32_16x16x32_bf16 v[56:59], a[140:143], v[192:195], v[56:59]
    v_exp_f32 v180, v180
    v_mfma_f32_16x16x32_bf16 v[60:63], a[140:143], v[196:199], v[60:63]
    v_exp_f32 v181, v181
    v_mfma_f32_16x16x32_bf16 v[120:123], a[140:143], v[208:211], v[120:123]
    v_cvt_pk_bf16_f32 v180, v180, v181
    v_mfma_f32_16x16x32_bf16 v[124:127], a[140:143], v[212:215], v[124:127]
    ds_read_b128 a[140:143], v10 offset:27648
    v_mfma_f32_16x16x32_bf16 v[64:67], a[144:147], v[192:195], v[64:67]
    v_exp_f32 v182, v182
    v_mfma_f32_16x16x32_bf16 v[68:71], a[144:147], v[196:199], v[68:71]
    v_mfma_f32_16x16x32_bf16 v[128:131], a[144:147], v[208:211], v[128:131]
    v_exp_f32 v183, v183
    v_mfma_f32_16x16x32_bf16 v[132:135], a[144:147], v[212:215], v[132:135]
    ds_read_b128 a[144:147], v10 offset:28672
    v_cvt_pk_bf16_f32 v181, v182, v183
    v_mfma_f32_16x16x32_bf16 v[72:75], a[148:151], v[192:195], v[72:75]
    v_mfma_f32_16x16x32_bf16 v[76:79], a[148:151], v[196:199], v[76:79]
    buffer_load_dwordx4 v3, s[20:23], s44 offen offset:2048 sc1 lds
    v_mfma_f32_16x16x32_bf16 v[136:139], a[148:151], v[208:211], v[136:139]
    v_exp_f32 v184, v184
    v_mfma_f32_16x16x32_bf16 v[140:143], a[148:151], v[212:215], v[140:143]
    ds_read_b128 a[148:151], v10 offset:29696
    v_mfma_f32_16x16x32_bf16 v[80:83], a[152:155], v[192:195], v[80:83]
    v_exp_f32 v185, v185
    v_mfma_f32_16x16x32_bf16 v[84:87], a[152:155], v[196:199], v[84:87]
    v_cvt_pk_bf16_f32 v178, v184, v185
    v_mfma_f32_16x16x32_bf16 v[144:147], a[152:155], v[208:211], v[144:147]
    v_exp_f32 v186, v186
    v_mfma_f32_16x16x32_bf16 v[148:151], a[152:155], v[212:215], v[148:151]
    ds_read_b128 a[152:155], v10 offset:30720
    v_mfma_f32_16x16x32_bf16 v[88:91], a[156:159], v[192:195], v[88:91]
    v_mfma_f32_16x16x32_bf16 v[92:95], a[156:159], v[196:199], v[92:95]
    v_exp_f32 v187, v187
    v_mfma_f32_16x16x32_bf16 v[152:155], a[156:159], v[208:211], v[152:155]
    v_cvt_pk_bf16_f32 v179, v186, v187
    v_mfma_f32_16x16x32_bf16 v[156:159], a[156:159], v[212:215], v[156:159]
    ds_read_b128 a[156:159], v10 offset:31744
    v_smfmac_f32_16x16x64_bf16 a[96:99], a[116:119], v[192:199], v6
    v_smfmac_f32_16x16x64_bf16 a[100:103], a[116:119], v[208:215], v6
    s_waitcnt lgkmcnt(8)
    v_mfma_f32_16x16x32_bf16 v[208:211], a[64:67], a[32:35], v[232:235]
    buffer_load_dwordx4 v3, s[20:23], s44 offen offset:3072 sc1 lds
    v_mfma_f32_16x16x32_bf16 v[208:211], a[68:71], a[36:39], v[208:211]
    v_exp_f32 v188, v188
    v_mfma_f32_16x16x32_bf16 v[208:211], a[72:75], a[40:43], v[208:211]
    v_exp_f32 v189, v189
    v_mfma_f32_16x16x32_bf16 v[208:211], a[76:79], a[44:47], v[208:211]
    v_cvt_pk_bf16_f32 v182, v188, v189
    s_add_u32 s44, s44, 16384
    v_mfma_f32_16x16x32_bf16 v[212:215], a[64:67], a[48:51], v[236:239]
    ds_read_b128 a[64:67], v10 offset:8192
    v_accvgpr_read_b32 v16, a96
    v_mfma_f32_16x16x32_bf16 v[212:215], a[68:71], a[52:55], v[212:215]
    ds_read_b128 a[68:71], v10 offset:9216
    v_accvgpr_read_b32 v18, a97
    v_mfma_f32_16x16x32_bf16 v[212:215], a[72:75], a[56:59], v[212:215]
    ds_read_b128 a[72:75], v10 offset:10240
    v_accvgpr_read_b32 v17, a98
    v_mfma_f32_16x16x32_bf16 v[212:215], a[76:79], a[60:63], v[212:215]
    ds_read_b128 a[76:79], v10 offset:11264
    v_accvgpr_read_b32 v19, a99
    v_mfma_f32_16x16x32_bf16 v[216:219], a[80:83], a[32:35], v[232:235]
    v_exp_f32 v190, v190
    v_mfma_f32_16x16x32_bf16 v[216:219], a[84:87], a[36:39], v[216:219]
    v_add_f32 v16, v16, v18
    v_add_f32 v17, v17, v19
    v_mfma_f32_16x16x32_bf16 v[216:219], a[88:91], a[40:43], v[216:219]
    v_exp_f32 v191, v191
    v_mfma_f32_16x16x32_bf16 v[216:219], a[92:95], a[44:47], v[216:219]
    v_cvt_pk_bf16_f32 v183, v190, v191
    v_add_f32 v5, v16, v17
    v_mfma_f32_16x16x32_bf16 v[220:223], a[80:83], a[48:51], v[236:239]
    ds_read_b128 a[80:83], v10 offset:12288
    v_cmp_nlt_f32 vcc, v5, v13
    v_mfma_f32_16x16x32_bf16 v[220:223], a[84:87], a[52:55], v[220:223]
    ds_read_b128 a[84:87], v10 offset:13312
    v_rcp_f32 v16, v16
    v_mfma_f32_16x16x32_bf16 v[220:223], a[88:91], a[56:59], v[220:223]
    ds_read_b128 a[88:91], v10 offset:14336
    v_rcp_f32 v17, v17
    v_mfma_f32_16x16x32_bf16 v[220:223], a[92:95], a[60:63], v[220:223]
    ds_read_b128 a[92:95], v10 offset:15360
    s_add_u32 m0, m0, 28672
    s_and_b32 m0, m0, 0x1ffff
    s_branch L_TE
    .p2align 6
L_wuDMP:
    s_branch L_wbDMP
L_DMP:
    v_mfma_f32_16x16x32_bf16 v[32:35], a[128:131], v[160:163], v[32:35]
    s_barrier
    v_xor_b32 v10, m0, v15
    v_mfma_f32_16x16x32_bf16 v[36:39], a[128:131], v[164:167], v[36:39]
    v_exp_f32 v192, v192
    s_waitcnt vmcnt(8)
    v_mfma_f32_16x16x32_bf16 v[96:99], a[128:131], v[176:179], v[96:99]
    ds_read_b64_tr_b16 a[160:161], v28 offset:0
    ds_read_b64_tr_b16 a[162:163], v28 offset:1024
    v_xor_b32 v28, 64, v28
    s_add_u32 s72, s75, s43
    v_mfma_f32_16x16x32_bf16 v[100:103], a[128:131], v[180:183], v[100:103]
    ds_read_b128 a[128:131], v10 offset:16384
    v_exp_f32 v193, v193
    v_mfma_f32_16x16x32_bf16 v[40:43], a[132:135], v[160:163], v[40:43]
    ds_read_b64_tr_b16 a[164:165], v29 offset:0
    ds_read_b64_tr_b16 a[166:167], v29 offset:1024
    v_xor_b32 v29, 64, v29
    v_mfma_f32_16x16x32_bf16 v[44:47], a[132:135], v[164:167], v[44:47]
    ds_read_b64_tr_b16 a[168:169], v28 offset:0
    ds_read_b64_tr_b16 a[170:171], v28 offset:1024
    v_xor_b32 v28, 192, v28
    v_mfma_f32_16x16x32_bf16 v[104:107], a[132:135], v[176:179], v[104:107]
    ds_read_b64_tr_b16 a[172:173], v29 offset:0
    ds_read_b64_tr_b16 a[174:175], v29 offset:1024
    v_xor_b32 v29, 192, v29
    v_mfma_f32_16x16x32_bf16 v[108:111], a[132:135], v[180:183], v[108:111]
    ds_read_b128 a[132:135], v10 offset:17408
    v_exp_f32 v194, v194
    v_mfma_f32_16x16x32_bf16 v[48:51], a[136:139], v[160:163], v[48:51]
    ds_read_b64_tr_b16 a[176:177], v28 offset:0
    ds_read_b64_tr_b16 a[178:179], v28 offset:1024
    v_xor_b32 v28, 64, v28
    v_mfma_f32_16x16x32_bf16 v[52:55], a[136:139], v[164:167], v[52:55]
    ds_read_b64_tr_b16 a[180:181], v29 offset:0
    ds_read_b64_tr_b16 a[182:183], v29 offset:1024
    v_xor_b32 v29, 64, v29
    v_mfma_f32_16x16x32_bf16 v[112:115], a[136:139], v[176:179], v[112:115]
    ds_read_b64_tr_b16 a[184:185], v28 offset:0
    ds_read_b64_tr_b16 a[186:187], v28 offset:1024
    v_cvt_pk_bf16_f32 v192, v192, v193
    v_mfma_f32_16x16x32_bf16 v[116:119], a[136:139], v[180:183], v[116:119]
    ds_read_b128 a[136:139], v10 offset:18432
    v_exp_f32 v195, v195
    v_mfma_f32_16x16x32_bf16 v[56:59], a[140:143], v[160:163], v[56:59]
    ds_read_b64_tr_b16 a[188:189], v29 offset:0
    ds_read_b64_tr_b16 a[190:191], v29 offset:1024
    v_mfma_f32_16x16x32_bf16 v[60:63], a[140:143], v[164:167], v[60:63]
    v_exp_f32 v196, v196
    v_mfma_f32_16x16x32_bf16 v[120:123], a[140:143], v[176:179], v[120:123]
    v_exp_f32 v197, v197
    v_mfma_f32_16x16x32_bf16 v[124:127], a[140:143], v[180:183], v[124:127]
    ds_read_b128 a[140:143], v10 offset:19456
    v_cvt_pk_bf16_f32 v193, v194, v195
    v_mfma_f32_16x16x32_bf16 v[64:67], a[144:147], v[160:163], v[64:67]
    v_exp_f32 v198, v198
    v_mfma_f32_16x16x32_bf16 v[68:71], a[144:147], v[164:167], v[68:71]
    v_exp_f32 v199, v199
    v_mfma_f32_16x16x32_bf16 v[128:131], a[144:147], v[176:179], v[128:131]
    v_exp_f32 v208, v208
    v_mfma_f32_16x16x32_bf16 v[132:135], a[144:147], v[180:183], v[132:135]
    ds_read_b128 a[144:147], v10 offset:20480
    v_cvt_pk_bf16_f32 v196, v196, v197
    v_mfma_f32_16x16x32_bf16 v[72:75], a[148:151], v[160:163], v[72:75]
    v_cvt_pk_bf16_f32 v197, v198, v199
    s_waitcnt lgkmcnt(2)
    v_mfma_f32_16x16x32_bf16 v[76:79], a[148:151], v[164:167], v[76:79]
    buffer_store_dwordx4 a[160:163], v2, s[68:71], s75 offen sc1
    v_mfma_f32_16x16x32_bf16 v[136:139], a[148:151], v[176:179], v[136:139]
    s_add_u32 s73, s75, s76
    v_cndmask_b32 v240, v12, v224, s[60:61]
    v_mfma_f32_16x16x32_bf16 v[140:143], a[148:151], v[180:183], v[140:143]
    ds_read_b128 a[148:151], v10 offset:21504
    v_cndmask_b32 v241, v12, v225, s[62:63]
    v_cndmask_b32 v242, v12, v226, s[30:31]
    v_mfma_f32_16x16x32_bf16 v[80:83], a[152:155], v[160:163], v[80:83]
    v_exp_f32 v209, v209
    v_cndmask_b32 v243, v12, v227, s[32:33]
    v_mfma_f32_16x16x32_bf16 v[84:87], a[152:155], v[164:167], v[84:87]
    v_exp_f32 v210, v210
    v_cndmask_b32 v244, v12, v224, s[50:51]
    v_mfma_f32_16x16x32_bf16 v[144:147], a[152:155], v[176:179], v[144:147]
    v_exp_f32 v211, v211
    v_cndmask_b32 v245, v12, v225, s[50:51]
    v_mfma_f32_16x16x32_bf16 v[148:151], a[152:155], v[180:183], v[148:151]
    ds_read_b128 a[152:155], v10 offset:22528
    v_cvt_pk_bf16_f32 v208, v208, v209
    v_cndmask_b32 v246, v12, v226, s[50:51]
    v_mfma_f32_16x16x32_bf16 v[88:91], a[156:159], v[160:163], v[88:91]
    v_exp_f32 v212, v212
    v_cndmask_b32 v247, v12, v227, s[50:51]
    v_mfma_f32_16x16x32_bf16 v[92:95], a[156:159], v[164:167], v[92:95]
    v_exp_f32 v213, v213
    v_cndmask_b32 v252, v12, v228, s[60:61]
    v_mfma_f32_16x16x32_bf16 v[152:155], a[156:159], v[176:179], v[152:155]
    buffer_store_dwordx4 a[164:167], v2, s[68:71], s73 offen sc1
    v_cndmask_b32 v253, v12, v229, s[62:63]
    v_mfma_f32_16x16x32_bf16 v[156:159], a[156:159], v[180:183], v[156:159]
    ds_read_b128 a[156:159], v10 offset:23552
    s_add_u32 s75, s75, s77
    v_cndmask_b32 v254, v12, v230, s[30:31]
    v_cndmask_b32 v255, v12, v231, s[32:33]
    v_smfmac_f32_16x16x64_bf16 a[96:99], a[116:119], v[160:167], v6
    v_cvt_pk_bf16_f32 v209, v210, v211
    v_smfmac_f32_16x16x64_bf16 a[100:103], a[116:119], v[176:183], v6
    s_waitcnt lgkmcnt(8)
    v_mfma_f32_16x16x32_bf16 v[160:163], a[64:67], a[0:3], v[240:243]
    v_exp_f32 v214, v214
    v_mfma_f32_16x16x32_bf16 v[160:163], a[68:71], a[4:7], v[160:163]
    v_exp_f32 v215, v215
    v_mfma_f32_16x16x32_bf16 v[160:163], a[72:75], a[8:11], v[160:163]
    v_exp_f32 v200, v200
    v_mfma_f32_16x16x32_bf16 v[160:163], a[76:79], a[12:15], v[160:163]
    v_exp_f32 v201, v201
    v_mfma_f32_16x16x32_bf16 v[164:167], a[64:67], a[16:19], v[228:231]
    v_exp_f32 v202, v202
    v_mfma_f32_16x16x32_bf16 v[164:167], a[68:71], a[20:23], v[164:167]
    buffer_store_dwordx4 a[168:171], v2, s[68:71], s75 offen sc1
    v_mfma_f32_16x16x32_bf16 v[164:167], a[72:75], a[24:27], v[164:167]
    s_add_u32 s73, s75, s76
    v_cvt_pk_bf16_f32 v212, v212, v213
    v_mfma_f32_16x16x32_bf16 v[164:167], a[76:79], a[28:31], v[164:167]
    v_exp_f32 v203, v203
    v_mfma_f32_16x16x32_bf16 v[176:179], a[64:67], a[32:35], v[232:235]
    v_exp_f32 v204, v204
    v_mfma_f32_16x16x32_bf16 v[176:179], a[68:71], a[36:39], v[176:179]
    v_exp_f32 v205, v205
    v_mfma_f32_16x16x32_bf16 v[176:179], a[72:75], a[40:43], v[176:179]
    v_exp_f32 v206, v206
    v_mfma_f32_16x16x32_bf16 v[176:179], a[76:79], a[44:47], v[176:179]
    v_exp_f32 v207, v207
    v_mfma_f32_16x16x32_bf16 v[180:183], a[64:67], a[48:51], v[236:239]
    ds_read_b128 a[64:67], v10 offset:0
    v_cvt_pk_bf16_f32 v213, v214, v215
    v_mfma_f32_16x16x32_bf16 v[180:183], a[68:71], a[52:55], v[180:183]
    ds_read_b128 a[68:71], v10 offset:1024
    v_cvt_pk_bf16_f32 v194, v200, v201
    v_mfma_f32_16x16x32_bf16 v[180:183], a[72:75], a[56:59], v[180:183]
    ds_read_b128 a[72:75], v10 offset:2048
    v_cvt_pk_bf16_f32 v195, v202, v203
    v_mfma_f32_16x16x32_bf16 v[180:183], a[76:79], a[60:63], v[180:183]
    ds_read_b128 a[76:79], v10 offset:3072
    v_cvt_pk_bf16_f32 v198, v204, v205
    v_mfma_f32_16x16x32_bf16 v[168:171], a[80:83], a[0:3], v[244:247]
    buffer_store_dwordx4 a[172:175], v2, s[68:71], s73 offen sc1
    v_mfma_f32_16x16x32_bf16 v[168:171], a[84:87], a[4:7], v[168:171]
    s_mov_b32 s75, s72
    v_cvt_pk_bf16_f32 v199, v206, v207
    v_mfma_f32_16x16x32_bf16 v[168:171], a[88:91], a[8:11], v[168:171]
    v_exp_f32 v216, v216
    v_mfma_f32_16x16x32_bf16 v[168:171], a[92:95], a[12:15], v[168:171]
    v_exp_f32 v217, v217
    v_mfma_f32_16x16x32_bf16 v[172:175], a[80:83], a[16:19], v[252:255]
    v_exp_f32 v218, v218
    v_mfma_f32_16x16x32_bf16 v[172:175], a[84:87], a[20:23], v[172:175]
    v_exp_f32 v219, v219
    v_mfma_f32_16x16x32_bf16 v[172:175], a[88:91], a[24:27], v[172:175]
    v_exp_f32 v220, v220
    v_mfma_f32_16x16x32_bf16 v[172:175], a[92:95], a[28:31], v[172:175]
    buffer_store_dwordx4 a[176:179], v2, s[68:71], s75 offen sc1
    v_mfma_f32_16x16x32_bf16 v[184:187], a[80:83], a[32:35], v[232:235]
    s_add_u32 s73, s75, s76
    v_cvt_pk_bf16_f32 v210, v216, v217
    v_mfma_f32_16x16x32_bf16 v[184:187], a[84:87], a[36:39], v[184:187]
    v_exp_f32 v221, v221
    v_mfma_f32_16x16x32_bf16 v[184:187], a[88:91], a[40:43], v[184:187]
    v_exp_f32 v222, v222
    v_mfma_f32_16x16x32_bf16 v[184:187], a[92:95], a[44:47], v[184:187]
    v_exp_f32 v223, v223
    v_mfma_f32_16x16x32_bf16 v[188:191], a[80:83], a[48:51], v[236:239]
    ds_read_b128 a[80:83], v10 offset:4096
    v_cvt_pk_bf16_f32 v211, v218, v219
    v_mfma_f32_16x16x32_bf16 v[188:191], a[84:87], a[52:55], v[188:191]
    ds_read_b128 a[84:87], v10 offset:5120
    v_cvt_pk_bf16_f32 v214, v220, v221
    v_mfma_f32_16x16x32_bf16 v[188:191], a[88:91], a[56:59], v[188:191]
    ds_read_b128 a[88:91], v10 offset:6144
    v_cvt_pk_bf16_f32 v215, v222, v223
    v_mfma_f32_16x16x32_bf16 v[188:191], a[92:95], a[60:63], v[188:191]
    ds_read_b128 a[92:95], v10 offset:7168
    s_waitcnt lgkmcnt(8)
    v_mfma_f32_16x16x32_bf16 v[32:35], a[128:131], v[192:195], v[32:35]
    buffer_store_dwordx4 a[180:183], v2, s[68:71], s73 offen sc1
    v_mfma_f32_16x16x32_bf16 v[36:39], a[128:131], v[196:199], v[36:39]
    s_add_u32 s75, s75, s77
    v_cndmask_b32 v240, v12, v224, s[34:35]
    v_mfma_f32_16x16x32_bf16 v[96:99], a[128:131], v[208:211], v[96:99]
    v_exp_f32 v160, v160
    v_mfma_f32_16x16x32_bf16 v[100:103], a[128:131], v[212:215], v[100:103]
    ds_read_b128 a[128:131], v10 offset:24576
    v_cndmask_b32 v241, v12, v225, s[36:37]
    v_mfma_f32_16x16x32_bf16 v[40:43], a[132:135], v[192:195], v[40:43]
    v_exp_f32 v161, v161
    v_mfma_f32_16x16x32_bf16 v[44:47], a[132:135], v[196:199], v[44:47]
    v_exp_f32 v162, v162
    v_mfma_f32_16x16x32_bf16 v[104:107], a[132:135], v[208:211], v[104:107]
    v_exp_f32 v163, v163
    v_mfma_f32_16x16x32_bf16 v[108:111], a[132:135], v[212:215], v[108:111]
    ds_read_b128 a[132:135], v10 offset:25600
    v_cvt_pk_bf16_f32 v160, v160, v161
    v_mfma_f32_16x16x32_bf16 v[48:51], a[136:139], v[192:195], v[48:51]
    v_exp_f32 v164, v164
    v_mfma_f32_16x16x32_bf16 v[52:55], a[136:139], v[196:199], v[52:55]
    buffer_store_dwordx4 a[184:187], v2, s[68:71], s75 offen sc1
    v_mfma_f32_16x16x32_bf16 v[112:115], a[136:139], v[208:211], v[112:115]
    s_add_u32 s73, s75, s76
    v_cvt_pk_bf16_f32 v161, v162, v163
    v_mfma_f32_16x16x32_bf16 v[116:119], a[136:139], v[212:215], v[116:119]
    ds_read_b128 a[136:139], v10 offset:26624
    v_cndmask_b32 v242, v12, v226, s[84:85]
    v_mfma_f32_16x16x32_bf16 v[56:59], a[140:143], v[192:195], v[56:59]
    v_exp_f32 v165, v165
    v_mfma_f32_16x16x32_bf16 v[60:63], a[140:143], v[196:199], v[60:63]
    v_exp_f32 v166, v166
    v_mfma_f32_16x16x32_bf16 v[120:123], a[140:143], v[208:211], v[120:123]
    v_exp_f32 v167, v167
    v_mfma_f32_16x16x32_bf16 v[124:127], a[140:143], v[212:215], v[124:127]
    ds_read_b128 a[140:143], v10 offset:27648
    v_cvt_pk_bf16_f32 v164, v164, v165
    v_mfma_f32_16x16x32_bf16 v[64:67], a[144:147], v[192:195], v[64:67]
    v_exp_f32 v176, v176
    v_mfma_f32_16x16x32_bf16 v[68:71], a[144:147], v[196:199], v[68:71]
    v_exp_f32 v177, v177
    v_mfma_f32_16x16x32_bf16 v[128:131], a[144:147], v[208:211], v[128:131]
    buffer_store_dwordx4 a[188:191], v2, s[68:71], s73 offen sc1
    v_mfma_f32_16x16x32_bf16 v[132:135], a[144:147], v[212:215], v[132:135]
    ds_read_b128 a[144:147], v10 offset:28672
    v_cvt_pk_bf16_f32 v165, v166, v167
    v_mfma_f32_16x16x32_bf16 v[72:75], a[148:151], v[192:195], v[72:75]
    v_exp_f32 v178, v178
    v_mfma_f32_16x16x32_bf16 v[76:79], a[148:151], v[196:199], v[76:79]
    buffer_load_dwordx4 v2, s[20:23], s44 offen offset:0 sc1 lds
    v_mfma_f32_16x16x32_bf16 v[136:139], a[148:151], v[208:211], v[136:139]
    v_cvt_pk_bf16_f32 v176, v176, v177
    v_cndmask_b32 v243, v12, v227, s[86:87]
    v_mfma_f32_16x16x32_bf16 v[140:143], a[148:151], v[212:215], v[140:143]
    ds_read_b128 a[148:151], v10 offset:29696
    v_cndmask_b32 v248, v12, v228, s[50:51]
    v_cndmask_b32 v249, v12, v229, s[50:51]
    v_mfma_f32_16x16x32_bf16 v[80:83], a[152:155], v[192:195], v[80:83]
    v_exp_f32 v179, v179
    v_cndmask_b32 v250, v12, v230, s[50:51]
    v_mfma_f32_16x16x32_bf16 v[84:87], a[152:155], v[196:199], v[84:87]
    v_exp_f32 v180, v180
    v_cndmask_b32 v251, v12, v231, s[50:51]
    v_mfma_f32_16x16x32_bf16 v[144:147], a[152:155], v[208:211], v[144:147]
    buffer_load_dwordx4 v2, s[20:23], s44 offen offset:1024 sc1 lds
    v_mov_b32 v244, v12
    v_mfma_f32_16x16x32_bf16 v[148:151], a[152:155], v[212:215], v[148:151]
    ds_read_b128 a[152:155], v10 offset:30720
    v_cvt_pk_bf16_f32 v177, v178, v179
    v_mov_b32 v245, v12
    v_mfma_f32_16x16x32_bf16 v[88:91], a[156:159], v[192:195], v[88:91]
    v_exp_f32 v181, v181
    v_mov_b32 v246, v12
    v_mfma_f32_16x16x32_bf16 v[92:95], a[156:159], v[196:199], v[92:95]
    v_exp_f32 v182, v182
    v_mov_b32 v247, v12
    v_mfma_f32_16x16x32_bf16 v[152:155], a[156:159], v[208:211], v[152:155]
    v_exp_f32 v183, v183
    v_cndmask_b32 v252, v12, v228, s[34:35]
    v_mfma_f32_16x16x32_bf16 v[156:159], a[156:159], v[212:215], v[156:159]
    ds_read_b128 a[156:159], v10 offset:31744
    v_cvt_pk_bf16_f32 v180, v180, v181
    v_cndmask_b32 v253, v12, v229, s[36:37]
    v_cndmask_b32 v254, v12, v230, s[84:85]
    v_cndmask_b32 v255, v12, v231, s[86:87]
    v_smfmac_f32_16x16x64_bf16 a[96:99], a[116:119], v[192:199], v6
    v_cvt_pk_bf16_f32 v181, v182, v183
    v_smfmac_f32_16x16x64_bf16 a[100:103], a[116:119], v[208:215], v6
    s_waitcnt lgkmcnt(8)
    v_mfma_f32_16x16x32_bf16 v[192:195], a[64:67], a[0:3], v[240:243]
    buffer_load_dwordx4 v2, s[20:23], s44 offen offset:2048 sc1 lds
    v_mfma_f32_16x16x32_bf16 v[192:195], a[68:71], a[4:7], v[192:195]
    v_exp_f32 v168, v168
    v_mfma_f32_16x16x32_bf16 v[192:195], a[72:75], a[8:11], v[192:195]
    buffer_load_dwordx4 v2, s[20:23], s44 offen offset:3072 sc1 lds
    s_add_u32 m0, m0, 4096
    v_mfma_f32_16x16x32_bf16 v[192:195], a[76:79], a[12:15], v[192:195]
    v_exp_f32 v169, v169
    v_mfma_f32_16x16x32_bf16 v[196:199], a[64:67], a[16:19], v[248:251]
    v_exp_f32 v170, v170
    v_mfma_f32_16x16x32_bf16 v[196:199], a[68:71], a[20:23], v[196:199]
    v_exp_f32 v171, v171
    v_mfma_f32_16x16x32_bf16 v[196:199], a[72:75], a[24:27], v[196:199]
    v_exp_f32 v172, v172
    v_mfma_f32_16x16x32_bf16 v[196:199], a[76:79], a[28:31], v[196:199]
    buffer_load_dwordx4 v3, s[20:23], s44 offen offset:0 sc1 lds
    v_mfma_f32_16x16x32_bf16 v[208:211], a[64:67], a[32:35], v[232:235]
    v_exp_f32 v173, v173
    v_mfma_f32_16x16x32_bf16 v[208:211], a[68:71], a[36:39], v[208:211]
    v_cvt_pk_bf16_f32 v162, v168, v169
    v_cvt_pk_bf16_f32 v163, v170, v171
    v_mfma_f32_16x16x32_bf16 v[208:211], a[72:75], a[40:43], v[208:211]
    v_exp_f32 v174, v174
    v_mfma_f32_16x16x32_bf16 v[208:211], a[76:79], a[44:47], v[208:211]
    v_exp_f32 v175, v175
    v_mfma_f32_16x16x32_bf16 v[212:215], a[64:67], a[48:51], v[236:239]
    ds_read_b128 a[64:67], v10 offset:8192
    v_cvt_pk_bf16_f32 v166, v172, v173
    v_mfma_f32_16x16x32_bf16 v[212:215], a[68:71], a[52:55], v[212:215]
    ds_read_b128 a[68:71], v10 offset:9216
    v_cvt_pk_bf16_f32 v167, v174, v175
    v_mfma_f32_16x16x32_bf16 v[212:215], a[72:75], a[56:59], v[212:215]
    ds_read_b128 a[72:75], v10 offset:10240
    v_mfma_f32_16x16x32_bf16 v[212:215], a[76:79], a[60:63], v[212:215]
    ds_read_b128 a[76:79], v10 offset:11264
    v_mfma_f32_16x16x32_bf16 v[200:203], a[80:83], a[0:3], v[244:247]
    buffer_load_dwordx4 v3, s[20:23], s44 offen offset:1024 sc1 lds
    v_mfma_f32_16x16x32_bf16 v[200:203], a[84:87], a[4:7], v[200:203]
    buffer_load_dwordx4 v3, s[20:23], s44 offen offset:2048 sc1 lds
    v_mfma_f32_16x16x32_bf16 v[200:203], a[88:91], a[8:11], v[200:203]
    v_exp_f32 v184, v184
    v_mfma_f32_16x16x32_bf16 v[200:203], a[92:95], a[12:15], v[200:203]
    v_exp_f32 v185, v185
    v_mfma_f32_16x16x32_bf16 v[204:207], a[80:83], a[16:19], v[252:255]
    v_exp_f32 v186, v186
    v_mfma_f32_16x16x32_bf16 v[204:207], a[84:87], a[20:23], v[204:207]
    v_exp_f32 v187, v187
    v_mfma_f32_16x16x32_bf16 v[204:207], a[88:91], a[24:27], v[204:207]
    buffer_load_dwordx4 v3, s[20:23], s44 offen offset:3072 sc1 lds
    v_mfma_f32_16x16x32_bf16 v[204:207], a[92:95], a[28:31], v[204:207]
    v_exp_f32 v188, v188
    v_mfma_f32_16x16x32_bf16 v[216:219], a[80:83], a[32:35], v[232:235]
    v_exp_f32 v189, v189
    v_mfma_f32_16x16x32_bf16 v[216:219], a[84:87], a[36:39], v[216:219]
    v_exp_f32 v190, v190
    v_mfma_f32_16x16x32_bf16 v[216:219], a[88:91], a[40:43], v[216:219]
    v_exp_f32 v191, v191
    v_mfma_f32_16x16x32_bf16 v[216:219], a[92:95], a[44:47], v[216:219]
    v_cvt_pk_bf16_f32 v178, v184, v185
    v_cvt_pk_bf16_f32 v179, v186, v187
    v_mfma_f32_16x16x32_bf16 v[220:223], a[80:83], a[48:51], v[236:239]
    ds_read_b128 a[80:83], v10 offset:12288
    v_cvt_pk_bf16_f32 v182, v188, v189
    v_mfma_f32_16x16x32_bf16 v[220:223], a[84:87], a[52:55], v[220:223]
    ds_read_b128 a[84:87], v10 offset:13312
    v_cvt_pk_bf16_f32 v183, v190, v191
    v_mfma_f32_16x16x32_bf16 v[220:223], a[88:91], a[56:59], v[220:223]
    ds_read_b128 a[88:91], v10 offset:14336
    s_add_u32 s44, s44, 16384
    v_mfma_f32_16x16x32_bf16 v[220:223], a[92:95], a[60:63], v[220:223]
    ds_read_b128 a[92:95], v10 offset:15360
    s_add_u32 m0, m0, 28672
    s_and_b32 m0, m0, 0x1ffff
    s_waitcnt vmcnt(8) lgkmcnt(8)
    buffer_atomic_add v8, v7, s[16:19], s8 offen offset:128
    s_branch L_T
    .p2align 6
L_wuDM7:
    s_branch L_wbDM7
L_DM7:
    v_cmp_gt_u32 vcc, 28, v9
    s_nop 0
    s_cbranch_vccnz L_spinpa7
L_backpa7:
    v_mfma_f32_16x16x32_bf16 v[32:35], a[128:131], v[160:163], v[32:35]
    s_barrier
    v_xor_b32 v10, m0, v15
    v_mfma_f32_16x16x32_bf16 v[36:39], a[128:131], v[164:167], v[36:39]
    buffer_load_dwordx4 v2, s[20:23], s44 offen offset:0 sc1 lds
    v_cndmask_b32 v240, v12, v224, s[60:61]
    v_mfma_f32_16x16x32_bf16 v[96:99], a[128:131], v[176:179], v[96:99]
    v_exp_f32 v192, v192
    v_cndmask_b32 v241, v12, v225, s[62:63]
    v_mfma_f32_16x16x32_bf16 v[100:103], a[128:131], v[180:183], v[100:103]
    ds_read_b128 a[128:131], v10 offset:16384
    v_exp_f32 v193, v193
    v_mfma_f32_16x16x32_bf16 v[40:43], a[132:135], v[160:163], v[40:43]
    buffer_load_dwordx4 a[160:163], v2, s[24:27], s28 offen offset:0 sc1
    v_cvt_pk_bf16_f32 v192, v192, v193
    v_mfma_f32_16x16x32_bf16 v[44:47], a[132:135], v[164:167], v[44:47]
    v_exp_f32 v194, v194
    v_cndmask_b32 v242, v12, v226, s[30:31]
    v_mfma_f32_16x16x32_bf16 v[104:107], a[132:135], v[176:179], v[104:107]
    v_exp_f32 v195, v195
    v_cndmask_b32 v243, v12, v227, s[32:33]
    v_mfma_f32_16x16x32_bf16 v[108:111], a[132:135], v[180:183], v[108:111]
    ds_read_b128 a[132:135], v10 offset:17408
    v_exp_f32 v196, v196
    v_mfma_f32_16x16x32_bf16 v[48:51], a[136:139], v[160:163], v[48:51]
    v_exp_f32 v197, v197
    v_cvt_pk_bf16_f32 v193, v194, v195
    v_mfma_f32_16x16x32_bf16 v[52:55], a[136:139], v[164:167], v[52:55]
    buffer_load_dwordx4 a[164:167], v2, s[24:27], s28 offen offset:1024 sc1
    v_cndmask_b32 v244, v12, v224, s[50:51]
    v_mfma_f32_16x16x32_bf16 v[112:115], a[136:139], v[176:179], v[112:115]
    v_exp_f32 v198, v198
    v_cndmask_b32 v245, v12, v225, s[50:51]
    v_mfma_f32_16x16x32_bf16 v[116:119], a[136:139], v[180:183], v[116:119]
    ds_read_b128 a[136:139], v10 offset:18432
    v_exp_f32 v199, v199
    v_mfma_f32_16x16x32_bf16 v[56:59], a[140:143], v[160:163], v[56:59]
    v_exp_f32 v208, v208
    v_cndmask_b32 v246, v12, v226, s[50:51]
    v_mfma_f32_16x16x32_bf16 v[60:63], a[140:143], v[164:167], v[60:63]
    v_exp_f32 v209, v209
    v_cndmask_b32 v247, v12, v227, s[50:51]
    v_mfma_f32_16x16x32_bf16 v[120:123], a[140:143], v[176:179], v[120:123]
    buffer_load_dwordx4 a[168:171], v2, s[24:27], s28 offen offset:2048 sc1
    v_cndmask_b32 v252, v12, v228, s[60:61]
    v_mfma_f32_16x16x32_bf16 v[124:127], a[140:143], v[180:183], v[124:127]
    ds_read_b128 a[140:143], v10 offset:19456
    v_exp_f32 v210, v210
    v_mfma_f32_16x16x32_bf16 v[64:67], a[144:147], v[160:163], v[64:67]
    buffer_load_dwordx4 v2, s[20:23], s44 offen offset:1024 sc1 lds
    v_cndmask_b32 v253, v12, v229, s[62:63]
    v_mfma_f32_16x16x32_bf16 v[68:71], a[144:147], v[164:167], v[68:71]
    v_exp_f32 v211, v211
    v_cndmask_b32 v254, v12, v230, s[30:31]
    v_mfma_f32_16x16x32_bf16 v[128:131], a[144:147], v[176:179], v[128:131]
    v_exp_f32 v212, v212
    v_cndmask_b32 v255, v12, v231, s[32:33]
    v_mfma_f32_16x16x32_bf16 v[132:135], a[144:147], v[180:183], v[132:135]
    ds_read_b128 a[144:147], v10 offset:20480
    v_cvt_pk_bf16_f32 v196, v196, v197
    v_mfma_f32_16x16x32_bf16 v[72:75], a[148:151], v[160:163], v[72:75]
    buffer_load_dwordx4 a[172:175], v2, s[24:27], s28 offen offset:3072 sc1
    v_mfma_f32_16x16x32_bf16 v[76:79], a[148:151], v[164:167], v[76:79]
    s_xor_b32 s28, s28, 4096
    v_cvt_pk_bf16_f32 v197, v198, v199
    v_mfma_f32_16x16x32_bf16 v[136:139], a[148:151], v[176:179], v[136:139]
    v_exp_f32 v213, v213
    v_mfma_f32_16x16x32_bf16 v[140:143], a[148:151], v[180:183], v[140:143]
    ds_read_b128 a[148:151], v10 offset:21504
    v_cvt_pk_bf16_f32 v208, v208, v209
    v_mfma_f32_16x16x32_bf16 v[80:83], a[152:155], v[160:163], v[80:83]
    buffer_load_dwordx4 a[176:179], v2, s[24:27], s28 offen offset:0 sc1
    v_mfma_f32_16x16x32_bf16 v[84:87], a[152:155], v[164:167], v[84:87]
    v_exp_f32 v214, v214
    v_mfma_f32_16x16x32_bf16 v[144:147], a[152:155], v[176:179], v[144:147]
    v_exp_f32 v215, v215
    v_mfma_f32_16x16x32_bf16 v[148:151], a[152:155], v[180:183], v[148:151]
    ds_read_b128 a[152:155], v10 offset:22528
    v_cvt_pk_bf16_f32 v209, v210, v211
    v_mfma_f32_16x16x32_bf16 v[88:91], a[156:159], v[160:163], v[88:91]
    v_exp_f32 v200, v200
    v_mfma_f32_16x16x32_bf16 v[92:95], a[156:159], v[164:167], v[92:95]
    buffer_load_dwordx4 a[180:183], v2, s[24:27], s28 offen offset:1024 sc1
    v_mfma_f32_16x16x32_bf16 v[152:155], a[156:159], v[176:179], v[152:155]
    v_exp_f32 v201, v201
    v_mfma_f32_16x16x32_bf16 v[156:159], a[156:159], v[180:183], v[156:159]
    ds_read_b128 a[156:159], v10 offset:23552
    v_cvt_pk_bf16_f32 v212, v212, v213
    v_smfmac_f32_16x16x64_bf16 a[96:99], a[116:119], v[160:167], v6
    v_cvt_pk_bf16_f32 v213, v214, v215
    v_smfmac_f32_16x16x64_bf16 a[100:103], a[116:119], v[176:183], v6
    s_waitcnt lgkmcnt(8)
    v_mfma_f32_16x16x32_bf16 v[160:163], a[64:67], a[0:3], v[240:243]
    buffer_load_dwordx4 v2, s[20:23], s44 offen offset:2048 sc1 lds
    v_mfma_f32_16x16x32_bf16 v[160:163], a[68:71], a[4:7], v[160:163]
    buffer_load_dwordx4 a[184:187], v2, s[24:27], s28 offen offset:2048 sc1
    v_mfma_f32_16x16x32_bf16 v[160:163], a[72:75], a[8:11], v[160:163]
    v_exp_f32 v202, v202
    v_mfma_f32_16x16x32_bf16 v[160:163], a[76:79], a[12:15], v[160:163]
    v_exp_f32 v203, v203
    v_mfma_f32_16x16x32_bf16 v[164:167], a[64:67], a[16:19], v[228:231]
    v_exp_f32 v204, v204
    v_mfma_f32_16x16x32_bf16 v[164:167], a[68:71], a[20:23], v[164:167]
    buffer_load_dwordx4 a[188:191], v2, s[24:27], s28 offen offset:3072 sc1
    v_mfma_f32_16x16x32_bf16 v[164:167], a[72:75], a[24:27], v[164:167]
    s_xor_b32 s28, s28, 12288
    v_cvt_pk_bf16_f32 v194, v200, v201
    v_mfma_f32_16x16x32_bf16 v[164:167], a[76:79], a[28:31], v[164:167]
    v_exp_f32 v205, v205
    v_mfma_f32_16x16x32_bf16 v[176:179], a[64:67], a[32:35], v[232:235]
    v_exp_f32 v206, v206
    v_mfma_f32_16x16x32_bf16 v[176:179], a[68:71], a[36:39], v[176:179]
    v_exp_f32 v207, v207
    v_mfma_f32_16x16x32_bf16 v[176:179], a[72:75], a[40:43], v[176:179]
    buffer_load_dwordx4 a[192:195], v2, s[24:27], s28 offen offset:0 sc1
    v_mfma_f32_16x16x32_bf16 v[176:179], a[76:79], a[44:47], v[176:179]
    v_exp_f32 v216, v216
    v_mfma_f32_16x16x32_bf16 v[180:183], a[64:67], a[48:51], v[236:239]
    ds_read_b128 a[64:67], v10 offset:0
    v_cvt_pk_bf16_f32 v195, v202, v203
    v_mfma_f32_16x16x32_bf16 v[180:183], a[68:71], a[52:55], v[180:183]
    ds_read_b128 a[68:71], v10 offset:1024
    v_cvt_pk_bf16_f32 v198, v204, v205
    v_mfma_f32_16x16x32_bf16 v[180:183], a[72:75], a[56:59], v[180:183]
    ds_read_b128 a[72:75], v10 offset:2048
    v_cvt_pk_bf16_f32 v199, v206, v207
    v_mfma_f32_16x16x32_bf16 v[180:183], a[76:79], a[60:63], v[180:183]
    ds_read_b128 a[76:79], v10 offset:3072
    v_mfma_f32_16x16x32_bf16 v[168:171], a[80:83], a[0:3], v[244:247]
    buffer_load_dwordx4 v2, s[20:23], s44 offen offset:3072 sc1 lds
    s_add_u32 m0, m0, 4096
    v_mfma_f32_16x16x32_bf16 v[168:171], a[84:87], a[4:7], v[168:171]
    buffer_load_dwordx4 a[196:199], v2, s[24:27], s28 offen offset:1024 sc1
    v_mfma_f32_16x16x32_bf16 v[168:171], a[88:91], a[8:11], v[168:171]
    v_exp_f32 v217, v217
    v_mfma_f32_16x16x32_bf16 v[168:171], a[92:95], a[12:15], v[168:171]
    v_exp_f32 v218, v218
    v_mfma_f32_16x16x32_bf16 v[172:175], a[80:83], a[16:19], v[252:255]
    buffer_load_dwordx4 a[200:203], v2, s[24:27], s28 offen offset:2048 sc1
    v_mfma_f32_16x16x32_bf16 v[172:175], a[84:87], a[20:23], v[172:175]
    v_exp_f32 v219, v219
    v_mfma_f32_16x16x32_bf16 v[172:175], a[88:91], a[24:27], v[172:175]
    v_exp_f32 v220, v220
    v_mfma_f32_16x16x32_bf16 v[172:175], a[92:95], a[28:31], v[172:175]
    v_exp_f32 v221, v221
    v_mfma_f32_16x16x32_bf16 v[184:187], a[80:83], a[32:35], v[232:235]
    v_exp_f32 v222, v222
    v_mfma_f32_16x16x32_bf16 v[184:187], a[84:87], a[36:39], v[184:187]
    buffer_load_dwordx4 a[204:207], v2, s[24:27], s28 offen offset:3072 sc1
    v_mfma_f32_16x16x32_bf16 v[184:187], a[88:91], a[40:43], v[184:187]
    s_xor_b32 s28, s28, 4096
    v_cvt_pk_bf16_f32 v210, v216, v217
    v_mfma_f32_16x16x32_bf16 v[184:187], a[92:95], a[44:47], v[184:187]
    v_exp_f32 v223, v223
    v_mfma_f32_16x16x32_bf16 v[188:191], a[80:83], a[48:51], v[236:239]
    ds_read_b128 a[80:83], v10 offset:4096
    v_cvt_pk_bf16_f32 v211, v218, v219
    v_mfma_f32_16x16x32_bf16 v[188:191], a[84:87], a[52:55], v[188:191]
    ds_read_b128 a[84:87], v10 offset:5120
    v_cvt_pk_bf16_f32 v214, v220, v221
    v_mfma_f32_16x16x32_bf16 v[188:191], a[88:91], a[56:59], v[188:191]
    ds_read_b128 a[88:91], v10 offset:6144
    v_cvt_pk_bf16_f32 v215, v222, v223
    v_mfma_f32_16x16x32_bf16 v[188:191], a[92:95], a[60:63], v[188:191]
    ds_read_b128 a[92:95], v10 offset:7168
    s_waitcnt lgkmcnt(8)
    v_mfma_f32_16x16x32_bf16 v[32:35], a[128:131], v[192:195], v[32:35]
    buffer_load_dwordx4 v3, s[20:23], s44 offen offset:0 sc1 lds
    v_mfma_f32_16x16x32_bf16 v[36:39], a[128:131], v[196:199], v[36:39]
    buffer_load_dwordx4 a[208:211], v2, s[24:27], s28 offen offset:0 sc1
    v_cndmask_b32 v240, v12, v224, s[34:35]
    v_mfma_f32_16x16x32_bf16 v[96:99], a[128:131], v[208:211], v[96:99]
    v_exp_f32 v160, v160
    v_cndmask_b32 v241, v12, v225, s[36:37]
    v_mfma_f32_16x16x32_bf16 v[100:103], a[128:131], v[212:215], v[100:103]
    ds_read_b128 a[128:131], v10 offset:24576
    v_exp_f32 v161, v161
    v_mfma_f32_16x16x32_bf16 v[40:43], a[132:135], v[192:195], v[40:43]
    buffer_load_dwordx4 a[212:215], v2, s[24:27], s28 offen offset:1024 sc1
    v_cndmask_b32 v242, v12, v226, s[84:85]
    v_mfma_f32_16x16x32_bf16 v[44:47], a[132:135], v[196:199], v[44:47]
    v_exp_f32 v162, v162
    v_cndmask_b32 v243, v12, v227, s[86:87]
    v_mfma_f32_16x16x32_bf16 v[104:107], a[132:135], v[208:211], v[104:107]
    v_exp_f32 v163, v163
    v_cndmask_b32 v248, v12, v228, s[50:51]
    v_mfma_f32_16x16x32_bf16 v[108:111], a[132:135], v[212:215], v[108:111]
    ds_read_b128 a[132:135], v10 offset:25600
    v_exp_f32 v164, v164
    v_mfma_f32_16x16x32_bf16 v[48:51], a[136:139], v[192:195], v[48:51]
    buffer_load_dwordx4 a[216:219], v2, s[24:27], s28 offen offset:2048 sc1
    v_cndmask_b32 v249, v12, v229, s[50:51]
    v_mfma_f32_16x16x32_bf16 v[52:55], a[136:139], v[196:199], v[52:55]
    v_exp_f32 v165, v165
    v_cndmask_b32 v250, v12, v230, s[50:51]
    v_mfma_f32_16x16x32_bf16 v[112:115], a[136:139], v[208:211], v[112:115]
    v_exp_f32 v166, v166
    v_cndmask_b32 v251, v12, v231, s[50:51]
    v_mfma_f32_16x16x32_bf16 v[116:119], a[136:139], v[212:215], v[116:119]
    ds_read_b128 a[136:139], v10 offset:26624
    v_cvt_pk_bf16_f32 v160, v160, v161
    v_mov_b32 v244, v12
    v_mfma_f32_16x16x32_bf16 v[56:59], a[140:143], v[192:195], v[56:59]
    v_exp_f32 v167, v167
    v_mov_b32 v245, v12
    v_mfma_f32_16x16x32_bf16 v[60:63], a[140:143], v[196:199], v[60:63]
    buffer_load_dwordx4 v3, s[20:23], s44 offen offset:1024 sc1 lds
    v_mov_b32 v246, v12
    v_mfma_f32_16x16x32_bf16 v[120:123], a[140:143], v[208:211], v[120:123]
    buffer_load_dwordx4 a[220:223], v2, s[24:27], s28 offen offset:3072 sc1
    v_mov_b32 v247, v12
    v_mfma_f32_16x16x32_bf16 v[124:127], a[140:143], v[212:215], v[124:127]
    ds_read_b128 a[140:143], v10 offset:27648
    s_xor_b32 s28, s28, 28672
    v_cndmask_b32 v252, v12, v228, s[34:35]
    v_mfma_f32_16x16x32_bf16 v[64:67], a[144:147], v[192:195], v[64:67]
    v_exp_f32 v176, v176
    v_cndmask_b32 v253, v12, v229, s[36:37]
    v_mfma_f32_16x16x32_bf16 v[68:71], a[144:147], v[196:199], v[68:71]
    v_exp_f32 v177, v177
    v_cndmask_b32 v254, v12, v230, s[84:85]
    v_mfma_f32_16x16x32_bf16 v[128:131], a[144:147], v[208:211], v[128:131]
    buffer_load_dwordx4 a[224:227], v2, s[24:27], s28 offen offset:0 sc1
    v_cndmask_b32 v255, v12, v231, s[86:87]
    v_mfma_f32_16x16x32_bf16 v[132:135], a[144:147], v[212:215], v[132:135]
    ds_read_b128 a[144:147], v10 offset:28672
    v_cvt_pk_bf16_f32 v161, v162, v163
    v_mfma_f32_16x16x32_bf16 v[72:75], a[148:151], v[192:195], v[72:75]
    v_exp_f32 v178, v178
    v_mfma_f32_16x16x32_bf16 v[76:79], a[148:151], v[196:199], v[76:79]
    v_exp_f32 v179, v179
    v_mfma_f32_16x16x32_bf16 v[136:139], a[148:151], v[208:211], v[136:139]
    v_exp_f32 v180, v180
    v_mfma_f32_16x16x32_bf16 v[140:143], a[148:151], v[212:215], v[140:143]
    ds_read_b128 a[148:151], v10 offset:29696
    v_cvt_pk_bf16_f32 v164, v164, v165
    v_mfma_f32_16x16x32_bf16 v[80:83], a[152:155], v[192:195], v[80:83]
    buffer_load_dwordx4 a[228:231], v2, s[24:27], s28 offen offset:1024 sc1
    v_mfma_f32_16x16x32_bf16 v[84:87], a[152:155], v[196:199], v[84:87]
    v_exp_f32 v181, v181
    v_mfma_f32_16x16x32_bf16 v[144:147], a[152:155], v[208:211], v[144:147]
    v_exp_f32 v182, v182
    v_mfma_f32_16x16x32_bf16 v[148:151], a[152:155], v[212:215], v[148:151]
    ds_read_b128 a[152:155], v10 offset:30720
    v_cvt_pk_bf16_f32 v165, v166, v167
    v_mfma_f32_16x16x32_bf16 v[88:91], a[156:159], v[192:195], v[88:91]
    buffer_load_dwordx4 a[232:235], v2, s[24:27], s28 offen offset:2048 sc1
    v_mfma_f32_16x16x32_bf16 v[92:95], a[156:159], v[196:199], v[92:95]
    buffer_load_dwordx4 v3, s[20:23], s44 offen offset:2048 sc1 lds
    v_mfma_f32_16x16x32_bf16 v[152:155], a[156:159], v[208:211], v[152:155]
    v_exp_f32 v183, v183
    v_mfma_f32_16x16x32_bf16 v[156:159], a[156:159], v[212:215], v[156:159]
    ds_read_b128 a[156:159], v10 offset:31744
    v_cvt_pk_bf16_f32 v176, v176, v177
    v_smfmac_f32_16x16x64_bf16 a[96:99], a[116:119], v[192:199], v6
    v_cvt_pk_bf16_f32 v177, v178, v179
    v_smfmac_f32_16x16x64_bf16 a[100:103], a[116:119], v[208:215], v6
    s_waitcnt lgkmcnt(8)
    v_mfma_f32_16x16x32_bf16 v[192:195], a[64:67], a[0:3], v[240:243]
    buffer_load_dwordx4 a[236:239], v2, s[24:27], s28 offen offset:3072 sc1
    v_mfma_f32_16x16x32_bf16 v[192:195], a[68:71], a[4:7], v[192:195]
    s_xor_b32 s28, s28, 4096
    v_cvt_pk_bf16_f32 v180, v180, v181
    v_cvt_pk_bf16_f32 v181, v182, v183
    v_mfma_f32_16x16x32_bf16 v[192:195], a[72:75], a[8:11], v[192:195]
    v_exp_f32 v168, v168
    v_mfma_f32_16x16x32_bf16 v[192:195], a[76:79], a[12:15], v[192:195]
    v_exp_f32 v169, v169
    v_mfma_f32_16x16x32_bf16 v[196:199], a[64:67], a[16:19], v[248:251]
    buffer_load_dwordx4 a[240:243], v2, s[24:27], s28 offen offset:0 sc1
    v_mfma_f32_16x16x32_bf16 v[196:199], a[68:71], a[20:23], v[196:199]
    v_exp_f32 v170, v170
    v_mfma_f32_16x16x32_bf16 v[196:199], a[72:75], a[24:27], v[196:199]
    v_exp_f32 v171, v171
    v_mfma_f32_16x16x32_bf16 v[196:199], a[76:79], a[28:31], v[196:199]
    v_exp_f32 v172, v172
    v_mfma_f32_16x16x32_bf16 v[208:211], a[64:67], a[32:35], v[232:235]
    v_exp_f32 v173, v173
    v_mfma_f32_16x16x32_bf16 v[208:211], a[68:71], a[36:39], v[208:211]
    buffer_load_dwordx4 a[244:247], v2, s[24:27], s28 offen offset:1024 sc1
    v_mfma_f32_16x16x32_bf16 v[208:211], a[72:75], a[40:43], v[208:211]
    v_exp_f32 v174, v174
    v_mfma_f32_16x16x32_bf16 v[208:211], a[76:79], a[44:47], v[208:211]
    buffer_load_dwordx4 v3, s[20:23], s44 offen offset:3072 sc1 lds
    v_mfma_f32_16x16x32_bf16 v[212:215], a[64:67], a[48:51], v[236:239]
    ds_read_b128 a[64:67], v10 offset:8192
    v_cvt_pk_bf16_f32 v162, v168, v169
    v_mfma_f32_16x16x32_bf16 v[212:215], a[68:71], a[52:55], v[212:215]
    ds_read_b128 a[68:71], v10 offset:9216
    v_cvt_pk_bf16_f32 v163, v170, v171
    v_mfma_f32_16x16x32_bf16 v[212:215], a[72:75], a[56:59], v[212:215]
    ds_read_b128 a[72:75], v10 offset:10240
    v_cvt_pk_bf16_f32 v166, v172, v173
    v_mfma_f32_16x16x32_bf16 v[212:215], a[76:79], a[60:63], v[212:215]
    ds_read_b128 a[76:79], v10 offset:11264
    s_add_u32 s44, s44, 16384
    v_mfma_f32_16x16x32_bf16 v[200:203], a[80:83], a[0:3], v[244:247]
    buffer_load_dwordx4 a[248:251], v2, s[24:27], s28 offen offset:2048 sc1
    v_mfma_f32_16x16x32_bf16 v[200:203], a[84:87], a[4:7], v[200:203]
    v_exp_f32 v175, v175
    v_mfma_f32_16x16x32_bf16 v[200:203], a[88:91], a[8:11], v[200:203]
    v_exp_f32 v184, v184
    v_mfma_f32_16x16x32_bf16 v[200:203], a[92:95], a[12:15], v[200:203]
    buffer_load_dwordx4 a[252:255], v2, s[24:27], s28 offen offset:3072 sc1
    v_mfma_f32_16x16x32_bf16 v[204:207], a[80:83], a[16:19], v[252:255]
    s_xor_b32 s28, s28, 12288
    v_cvt_pk_bf16_f32 v167, v174, v175
    v_mfma_f32_16x16x32_bf16 v[204:207], a[84:87], a[20:23], v[204:207]
    v_exp_f32 v185, v185
    v_mfma_f32_16x16x32_bf16 v[204:207], a[88:91], a[24:27], v[204:207]
    v_exp_f32 v186, v186
    v_mfma_f32_16x16x32_bf16 v[204:207], a[92:95], a[28:31], v[204:207]
    v_exp_f32 v187, v187
    v_mfma_f32_16x16x32_bf16 v[216:219], a[80:83], a[32:35], v[232:235]
    v_exp_f32 v188, v188
    v_mfma_f32_16x16x32_bf16 v[216:219], a[84:87], a[36:39], v[216:219]
    v_exp_f32 v189, v189
    v_mfma_f32_16x16x32_bf16 v[216:219], a[88:91], a[40:43], v[216:219]
    v_exp_f32 v190, v190
    v_mfma_f32_16x16x32_bf16 v[216:219], a[92:95], a[44:47], v[216:219]
    v_exp_f32 v191, v191
    v_mfma_f32_16x16x32_bf16 v[220:223], a[80:83], a[48:51], v[236:239]
    ds_read_b128 a[80:83], v10 offset:12288
    v_cvt_pk_bf16_f32 v178, v184, v185
    v_mfma_f32_16x16x32_bf16 v[220:223], a[84:87], a[52:55], v[220:223]
    ds_read_b128 a[84:87], v10 offset:13312
    v_cvt_pk_bf16_f32 v179, v186, v187
    v_mfma_f32_16x16x32_bf16 v[220:223], a[88:91], a[56:59], v[220:223]
    ds_read_b128 a[88:91], v10 offset:14336
    v_cvt_pk_bf16_f32 v182, v188, v189
    v_cvt_pk_bf16_f32 v183, v190, v191
    v_mfma_f32_16x16x32_bf16 v[220:223], a[92:95], a[60:63], v[220:223]
    ds_read_b128 a[92:95], v10 offset:15360
    s_add_u32 m0, m0, 28672
    s_and_b32 m0, m0, 0x1ffff
    s_waitcnt vmcnt(32) lgkmcnt(8)
    s_branch L_T
    .p2align 6
L_wuD1:
    s_branch L_wbD1
L_D1:
    v_mfma_f32_16x16x32_bf16 v[32:35], a[128:131], v[160:163], 0
    s_barrier
    v_xor_b32 v10, m0, v15
    v_mfma_f32_16x16x32_bf16 v[36:39], a[128:131], v[164:167], 0
    s_mov_b32 s6, m0
    s_add_u32 m0, s29, 0
    v_mfma_f32_16x16x32_bf16 v[96:99], a[128:131], v[176:179], 0
    buffer_load_dwordx4 v24, s[64:67], s72 offen lds
    v_mfma_f32_16x16x32_bf16 v[100:103], a[128:131], v[180:183], 0
    ds_read_b128 a[128:131], v10 offset:16384
    v_mfma_f32_16x16x32_bf16 v[40:43], a[132:135], v[160:163], 0
    v_exp_f32 v192, v192
    v_mfma_f32_16x16x32_bf16 v[44:47], a[132:135], v[164:167], 0
    v_exp_f32 v193, v193
    v_mfma_f32_16x16x32_bf16 v[104:107], a[132:135], v[176:179], 0
    v_exp_f32 v194, v194
    v_mfma_f32_16x16x32_bf16 v[108:111], a[132:135], v[180:183], 0
    ds_read_b128 a[132:135], v10 offset:17408
    v_cvt_pk_bf16_f32 v192, v192, v193
    v_mfma_f32_16x16x32_bf16 v[48:51], a[136:139], v[160:163], 0
    v_exp_f32 v195, v195
    v_mfma_f32_16x16x32_bf16 v[52:55], a[136:139], v[164:167], 0
    v_exp_f32 v196, v196
    v_mfma_f32_16x16x32_bf16 v[112:115], a[136:139], v[176:179], 0
    v_exp_f32 v197, v197
    v_mfma_f32_16x16x32_bf16 v[116:119], a[136:139], v[180:183], 0
    ds_read_b128 a[136:139], v10 offset:18432
    s_add_u32 m0, s29, 1024
    s_add_u32 s81, s72, s73
    v_mfma_f32_16x16x32_bf16 v[56:59], a[140:143], v[160:163], 0
    buffer_load_dwordx4 v24, s[64:67], s81 offen lds
    v_mfma_f32_16x16x32_bf16 v[60:63], a[140:143], v[164:167], 0
    v_exp_f32 v198, v198
    v_mfma_f32_16x16x32_bf16 v[120:123], a[140:143], v[176:179], 0
    v_exp_f32 v199, v199
    v_mfma_f32_16x16x32_bf16 v[124:127], a[140:143], v[180:183], 0
    ds_read_b128 a[140:143], v10 offset:19456
    v_cvt_pk_bf16_f32 v193, v194, v195
    v_mfma_f32_16x16x32_bf16 v[64:67], a[144:147], v[160:163], 0
    v_cvt_pk_bf16_f32 v196, v196, v197
    v_cvt_pk_bf16_f32 v197, v198, v199
    v_mfma_f32_16x16x32_bf16 v[68:71], a[144:147], v[164:167], 0
    v_exp_f32 v208, v208
    v_mfma_f32_16x16x32_bf16 v[128:131], a[144:147], v[176:179], 0
    v_exp_f32 v209, v209
    v_mfma_f32_16x16x32_bf16 v[132:135], a[144:147], v[180:183], 0
    ds_read_b128 a[144:147], v10 offset:20480
    s_add_u32 m0, s29, 2048
    s_add_u32 s72, s72, s74
    v_mfma_f32_16x16x32_bf16 v[72:75], a[148:151], v[160:163], 0
    buffer_load_dwordx4 v25, s[64:67], s72 offen lds
    v_mfma_f32_16x16x32_bf16 v[76:79], a[148:151], v[164:167], 0
    v_exp_f32 v210, v210
    v_mfma_f32_16x16x32_bf16 v[136:139], a[148:151], v[176:179], 0
    v_exp_f32 v211, v211
    v_mfma_f32_16x16x32_bf16 v[140:143], a[148:151], v[180:183], 0
    ds_read_b128 a[148:151], v10 offset:21504
    v_cvt_pk_bf16_f32 v208, v208, v209
    v_mfma_f32_16x16x32_bf16 v[80:83], a[152:155], v[160:163], 0
    v_exp_f32 v212, v212
    v_mfma_f32_16x16x32_bf16 v[84:87], a[152:155], v[164:167], 0
    v_exp_f32 v213, v213
    v_mfma_f32_16x16x32_bf16 v[144:147], a[152:155], v[176:179], 0
    v_exp_f32 v214, v214
    v_mfma_f32_16x16x32_bf16 v[148:151], a[152:155], v[180:183], 0
    ds_read_b128 a[152:155], v10 offset:22528
    v_cvt_pk_bf16_f32 v209, v210, v211
    v_mfma_f32_16x16x32_bf16 v[88:91], a[156:159], v[160:163], 0
    s_add_u32 m0, s29, 3072
    s_add_u32 s81, s72, s73
    v_mfma_f32_16x16x32_bf16 v[92:95], a[156:159], v[164:167], 0
    buffer_load_dwordx4 v25, s[64:67], s81 offen lds
    v_mfma_f32_16x16x32_bf16 v[152:155], a[156:159], v[176:179], 0
    v_exp_f32 v215, v215
    v_mfma_f32_16x16x32_bf16 v[156:159], a[156:159], v[180:183], 0
    ds_read_b128 a[156:159], v10 offset:23552
    v_cvt_pk_bf16_f32 v212, v212, v213
    v_smfmac_f32_16x16x64_bf16 a[96:99], a[116:119], v[160:167], v6
    v_cvt_pk_bf16_f32 v213, v214, v215
    v_smfmac_f32_16x16x64_bf16 a[100:103], a[116:119], v[176:183], v6
    s_waitcnt lgkmcnt(8)
    v_mfma_f32_16x16x32_bf16 v[160:163], a[64:67], a[0:3], v[224:227]
    v_mfma_f32_16x16x32_bf16 v[160:163], a[68:71], a[4:7], v[160:163]
    v_exp_f32 v200, v200
    v_mfma_f32_16x16x32_bf16 v[160:163], a[72:75], a[8:11], v[160:163]
    v_exp_f32 v201, v201
    v_mfma_f32_16x16x32_bf16 v[160:163], a[76:79], a[12:15], v[160:163]
    s_add_u32 m0, s29, 4096
    s_add_u32 s72, s72, s74
    v_mfma_f32_16x16x32_bf16 v[164:167], a[64:67], a[16:19], v[228:231]
    buffer_load_dwordx4 v24, s[64:67], s72 offen lds
    v_mfma_f32_16x16x32_bf16 v[164:167], a[68:71], a[20:23], v[164:167]
    v_exp_f32 v202, v202
    v_mfma_f32_16x16x32_bf16 v[164:167], a[72:75], a[24:27], v[164:167]
    v_exp_f32 v203, v203
    v_mfma_f32_16x16x32_bf16 v[164:167], a[76:79], a[28:31], v[164:167]
    v_exp_f32 v204, v204
    v_mfma_f32_16x16x32_bf16 v[176:179], a[64:67], a[32:35], v[232:235]
    v_exp_f32 v205, v205
    v_mfma_f32_16x16x32_bf16 v[176:179], a[68:71], a[36:39], v[176:179]
    v_exp_f32 v206, v206
    v_mfma_f32_16x16x32_bf16 v[176:179], a[72:75], a[40:43], v[176:179]
    v_exp_f32 v207, v207
    v_mfma_f32_16x16x32_bf16 v[176:179], a[76:79], a[44:47], v[176:179]
    v_cvt_pk_bf16_f32 v194, v200, v201
    v_cvt_pk_bf16_f32 v195, v202, v203
    v_mfma_f32_16x16x32_bf16 v[180:183], a[64:67], a[48:51], v[236:239]
    ds_read_b128 a[64:67], v10 offset:0
    v_cvt_pk_bf16_f32 v198, v204, v205
    v_mfma_f32_16x16x32_bf16 v[180:183], a[68:71], a[52:55], v[180:183]
    ds_read_b128 a[68:71], v10 offset:1024
    v_cvt_pk_bf16_f32 v199, v206, v207
    v_mfma_f32_16x16x32_bf16 v[180:183], a[72:75], a[56:59], v[180:183]
    ds_read_b128 a[72:75], v10 offset:2048
    v_mfma_f32_16x16x32_bf16 v[180:183], a[76:79], a[60:63], v[180:183]
    ds_read_b128 a[76:79], v10 offset:3072
    s_add_u32 m0, s29, 5120
    s_add_u32 s81, s72, s73
    v_mfma_f32_16x16x32_bf16 v[168:171], a[80:83], a[0:3], v[224:227]
    buffer_load_dwordx4 v24, s[64:67], s81 offen lds
    v_mfma_f32_16x16x32_bf16 v[168:171], a[84:87], a[4:7], v[168:171]
    v_exp_f32 v216, v216
    v_mfma_f32_16x16x32_bf16 v[168:171], a[88:91], a[8:11], v[168:171]
    v_exp_f32 v217, v217
    v_mfma_f32_16x16x32_bf16 v[168:171], a[92:95], a[12:15], v[168:171]
    v_exp_f32 v218, v218
    v_mfma_f32_16x16x32_bf16 v[172:175], a[80:83], a[16:19], v[228:231]
    v_exp_f32 v219, v219
    v_mfma_f32_16x16x32_bf16 v[172:175], a[84:87], a[20:23], v[172:175]
    s_add_u32 m0, s29, 6144
    s_add_u32 s72, s72, s74
    v_mfma_f32_16x16x32_bf16 v[172:175], a[88:91], a[24:27], v[172:175]
    buffer_load_dwordx4 v25, s[64:67], s72 offen lds
    v_mfma_f32_16x16x32_bf16 v[172:175], a[92:95], a[28:31], v[172:175]
    v_exp_f32 v220, v220
    v_mfma_f32_16x16x32_bf16 v[184:187], a[80:83], a[32:35], v[232:235]
    v_exp_f32 v221, v221
    v_mfma_f32_16x16x32_bf16 v[184:187], a[84:87], a[36:39], v[184:187]
    v_exp_f32 v222, v222
    v_mfma_f32_16x16x32_bf16 v[184:187], a[88:91], a[40:43], v[184:187]
    v_exp_f32 v223, v223
    v_mfma_f32_16x16x32_bf16 v[184:187], a[92:95], a[44:47], v[184:187]
    v_cvt_pk_bf16_f32 v210, v216, v217
    v_cvt_pk_bf16_f32 v211, v218, v219
    v_mfma_f32_16x16x32_bf16 v[188:191], a[80:83], a[48:51], v[236:239]
    ds_read_b128 a[80:83], v10 offset:4096
    v_cvt_pk_bf16_f32 v214, v220, v221
    v_mfma_f32_16x16x32_bf16 v[188:191], a[84:87], a[52:55], v[188:191]
    ds_read_b128 a[84:87], v10 offset:5120
    v_cvt_pk_bf16_f32 v215, v222, v223
    v_mfma_f32_16x16x32_bf16 v[188:191], a[88:91], a[56:59], v[188:191]
    ds_read_b128 a[88:91], v10 offset:6144
    v_mfma_f32_16x16x32_bf16 v[188:191], a[92:95], a[60:63], v[188:191]
    ds_read_b128 a[92:95], v10 offset:7168
    s_add_u32 m0, s29, 7168
    s_add_u32 s81, s72, s73
    s_waitcnt lgkmcnt(8)
    v_mfma_f32_16x16x32_bf16 v[32:35], a[128:131], v[192:195], v[32:35]
    buffer_load_dwordx4 v25, s[64:67], s81 offen lds
    v_mfma_f32_16x16x32_bf16 v[36:39], a[128:131], v[196:199], v[36:39]
    s_mov_b32 m0, s6
    v_mfma_f32_16x16x32_bf16 v[96:99], a[128:131], v[208:211], v[96:99]
    v_exp_f32 v160, v160
    v_mfma_f32_16x16x32_bf16 v[100:103], a[128:131], v[212:215], v[100:103]
    ds_read_b128 a[128:131], v10 offset:24576
    v_mfma_f32_16x16x32_bf16 v[40:43], a[132:135], v[192:195], v[40:43]
    v_exp_f32 v161, v161
    v_mfma_f32_16x16x32_bf16 v[44:47], a[132:135], v[196:199], v[44:47]
    buffer_load_dwordx4 v2, s[20:23], s44 offen offset:0 sc1 lds
    v_mfma_f32_16x16x32_bf16 v[104:107], a[132:135], v[208:211], v[104:107]
    v_exp_f32 v162, v162
    v_mfma_f32_16x16x32_bf16 v[108:111], a[132:135], v[212:215], v[108:111]
    ds_read_b128 a[132:135], v10 offset:25600
    v_cvt_pk_bf16_f32 v160, v160, v161
    v_mfma_f32_16x16x32_bf16 v[48:51], a[136:139], v[192:195], v[48:51]
    v_exp_f32 v163, v163
    v_mfma_f32_16x16x32_bf16 v[52:55], a[136:139], v[196:199], v[52:55]
    v_exp_f32 v164, v164
    v_mfma_f32_16x16x32_bf16 v[112:115], a[136:139], v[208:211], v[112:115]
    v_exp_f32 v165, v165
    v_mfma_f32_16x16x32_bf16 v[116:119], a[136:139], v[212:215], v[116:119]
    ds_read_b128 a[136:139], v10 offset:26624
    v_cvt_pk_bf16_f32 v161, v162, v163
    v_mfma_f32_16x16x32_bf16 v[56:59], a[140:143], v[192:195], v[56:59]
    buffer_load_dwordx4 v2, s[20:23], s44 offen offset:1024 sc1 lds
    v_mfma_f32_16x16x32_bf16 v[60:63], a[140:143], v[196:199], v[60:63]
    v_cvt_pk_bf16_f32 v164, v164, v165
    v_mfma_f32_16x16x32_bf16 v[120:123], a[140:143], v[208:211], v[120:123]
    v_exp_f32 v166, v166
    v_mfma_f32_16x16x32_bf16 v[124:127], a[140:143], v[212:215], v[124:127]
    ds_read_b128 a[140:143], v10 offset:27648
    v_mfma_f32_16x16x32_bf16 v[64:67], a[144:147], v[192:195], v[64:67]
    v_exp_f32 v167, v167
    v_mfma_f32_16x16x32_bf16 v[68:71], a[144:147], v[196:199], v[68:71]
    v_exp_f32 v176, v176
    v_mfma_f32_16x16x32_bf16 v[128:131], a[144:147], v[208:211], v[128:131]
    v_exp_f32 v177, v177
    v_mfma_f32_16x16x32_bf16 v[132:135], a[144:147], v[212:215], v[132:135]
    ds_read_b128 a[144:147], v10 offset:28672
    v_cvt_pk_bf16_f32 v165, v166, v167
    v_mfma_f32_16x16x32_bf16 v[72:75], a[148:151], v[192:195], v[72:75]
    buffer_load_dwordx4 v2, s[20:23], s44 offen offset:2048 sc1 lds
    v_mfma_f32_16x16x32_bf16 v[76:79], a[148:151], v[196:199], v[76:79]
    v_exp_f32 v178, v178
    v_mfma_f32_16x16x32_bf16 v[136:139], a[148:151], v[208:211], v[136:139]
    v_cvt_pk_bf16_f32 v176, v176, v177
    v_mfma_f32_16x16x32_bf16 v[140:143], a[148:151], v[212:215], v[140:143]
    ds_read_b128 a[148:151], v10 offset:29696
    v_mfma_f32_16x16x32_bf16 v[80:83], a[152:155], v[192:195], v[80:83]
    v_exp_f32 v179, v179
    v_mfma_f32_16x16x32_bf16 v[84:87], a[152:155], v[196:199], v[84:87]
    v_exp_f32 v180, v180
    v_mfma_f32_16x16x32_bf16 v[144:147], a[152:155], v[208:211], v[144:147]
    buffer_load_dwordx4 v2, s[20:23], s44 offen offset:3072 sc1 lds
    s_add_u32 m0, m0, 4096
    v_mfma_f32_16x16x32_bf16 v[148:151], a[152:155], v[212:215], v[148:151]
    ds_read_b128 a[152:155], v10 offset:30720
    v_cvt_pk_bf16_f32 v177, v178, v179
    v_mfma_f32_16x16x32_bf16 v[88:91], a[156:159], v[192:195], v[88:91]
    v_exp_f32 v181, v181
    v_mfma_f32_16x16x32_bf16 v[92:95], a[156:159], v[196:199], v[92:95]
    v_exp_f32 v182, v182
    v_mfma_f32_16x16x32_bf16 v[152:155], a[156:159], v[208:211], v[152:155]
    v_exp_f32 v183, v183
    v_mfma_f32_16x16x32_bf16 v[156:159], a[156:159], v[212:215], v[156:159]
    ds_read_b128 a[156:159], v10 offset:31744
    v_cvt_pk_bf16_f32 v180, v180, v181
    v_smfmac_f32_16x16x64_bf16 a[96:99], a[116:119], v[192:199], v6
    v_cvt_pk_bf16_f32 v181, v182, v183
    v_smfmac_f32_16x16x64_bf16 a[100:103], a[116:119], v[208:215], v6
    s_waitcnt lgkmcnt(8)
    v_mfma_f32_16x16x32_bf16 v[192:195], a[64:67], a[0:3], v[224:227]
    buffer_load_dwordx4 v3, s[20:23], s44 offen offset:0 sc1 lds
    v_mfma_f32_16x16x32_bf16 v[192:195], a[68:71], a[4:7], v[192:195]
    v_mfma_f32_16x16x32_bf16 v[192:195], a[72:75], a[8:11], v[192:195]
    v_exp_f32 v168, v168
    v_mfma_f32_16x16x32_bf16 v[192:195], a[76:79], a[12:15], v[192:195]
    v_exp_f32 v169, v169
    v_mfma_f32_16x16x32_bf16 v[196:199], a[64:67], a[16:19], v[228:231]
    v_exp_f32 v170, v170
    v_mfma_f32_16x16x32_bf16 v[196:199], a[68:71], a[20:23], v[196:199]
    v_exp_f32 v171, v171
    v_mfma_f32_16x16x32_bf16 v[196:199], a[72:75], a[24:27], v[196:199]
    buffer_load_dwordx4 v3, s[20:23], s44 offen offset:1024 sc1 lds
    v_mfma_f32_16x16x32_bf16 v[196:199], a[76:79], a[28:31], v[196:199]
    v_exp_f32 v172, v172
    v_mfma_f32_16x16x32_bf16 v[208:211], a[64:67], a[32:35], v[232:235]
    v_exp_f32 v173, v173
    v_mfma_f32_16x16x32_bf16 v[208:211], a[68:71], a[36:39], v[208:211]
    v_cvt_pk_bf16_f32 v162, v168, v169
    v_cvt_pk_bf16_f32 v163, v170, v171
    v_mfma_f32_16x16x32_bf16 v[208:211], a[72:75], a[40:43], v[208:211]
    v_exp_f32 v174, v174
    v_mfma_f32_16x16x32_bf16 v[208:211], a[76:79], a[44:47], v[208:211]
    v_exp_f32 v175, v175
    v_mfma_f32_16x16x32_bf16 v[212:215], a[64:67], a[48:51], v[236:239]
    ds_read_b128 a[64:67], v10 offset:8192
    v_cvt_pk_bf16_f32 v166, v172, v173
    v_mfma_f32_16x16x32_bf16 v[212:215], a[68:71], a[52:55], v[212:215]
    ds_read_b128 a[68:71], v10 offset:9216
    v_cvt_pk_bf16_f32 v167, v174, v175
    v_mfma_f32_16x16x32_bf16 v[212:215], a[72:75], a[56:59], v[212:215]
    ds_read_b128 a[72:75], v10 offset:10240
    v_mfma_f32_16x16x32_bf16 v[212:215], a[76:79], a[60:63], v[212:215]
    ds_read_b128 a[76:79], v10 offset:11264
    v_mfma_f32_16x16x32_bf16 v[200:203], a[80:83], a[0:3], v[224:227]
    buffer_load_dwordx4 v3, s[20:23], s44 offen offset:2048 sc1 lds
    v_mfma_f32_16x16x32_bf16 v[200:203], a[84:87], a[4:7], v[200:203]
    v_exp_f32 v184, v184
    v_mfma_f32_16x16x32_bf16 v[200:203], a[88:91], a[8:11], v[200:203]
    v_exp_f32 v185, v185
    v_mfma_f32_16x16x32_bf16 v[200:203], a[92:95], a[12:15], v[200:203]
    v_exp_f32 v186, v186
    v_mfma_f32_16x16x32_bf16 v[204:207], a[80:83], a[16:19], v[228:231]
    buffer_load_dwordx4 v3, s[20:23], s44 offen offset:3072 sc1 lds
    v_mfma_f32_16x16x32_bf16 v[204:207], a[84:87], a[20:23], v[204:207]
    v_cvt_pk_bf16_f32 v178, v184, v185
    s_add_u32 s44, s44, 16384
    v_mfma_f32_16x16x32_bf16 v[204:207], a[88:91], a[24:27], v[204:207]
    v_exp_f32 v187, v187
    v_mfma_f32_16x16x32_bf16 v[204:207], a[92:95], a[28:31], v[204:207]
    v_exp_f32 v188, v188
    v_mfma_f32_16x16x32_bf16 v[216:219], a[80:83], a[32:35], v[232:235]
    v_exp_f32 v189, v189
    v_mfma_f32_16x16x32_bf16 v[216:219], a[84:87], a[36:39], v[216:219]
    v_exp_f32 v190, v190
    v_mfma_f32_16x16x32_bf16 v[216:219], a[88:91], a[40:43], v[216:219]
    v_exp_f32 v191, v191
    v_mfma_f32_16x16x32_bf16 v[216:219], a[92:95], a[44:47], v[216:219]
    v_cvt_pk_bf16_f32 v179, v186, v187
    v_cvt_pk_bf16_f32 v182, v188, v189
    v_mfma_f32_16x16x32_bf16 v[220:223], a[80:83], a[48:51], v[236:239]
    ds_read_b128 a[80:83], v10 offset:12288
    v_cvt_pk_bf16_f32 v183, v190, v191
    v_mfma_f32_16x16x32_bf16 v[220:223], a[84:87], a[52:55], v[220:223]
    ds_read_b128 a[84:87], v10 offset:13312
    s_add_u32 m0, m0, 28672
    v_mfma_f32_16x16x32_bf16 v[220:223], a[88:91], a[56:59], v[220:223]
    ds_read_b128 a[88:91], v10 offset:14336
    s_and_b32 m0, m0, 0x1ffff
    v_mfma_f32_16x16x32_bf16 v[220:223], a[92:95], a[60:63], v[220:223]
    ds_read_b128 a[92:95], v10 offset:15360
    s_waitcnt vmcnt(16) lgkmcnt(8)
    s_cmp_eq_u32 s46, 3
    s_cbranch_scc1 L_DMP
    s_sub_u32 s46, s46, 4
    s_lshr_b32 s45, s46, 1
    s_sub_u32 s46, s46, s45
    s_sub_u32 s45, s45, 1
    s_cbranch_scc1 L_P2
    .p2align 6
L_D:
    v_mfma_f32_16x16x32_bf16 v[32:35], a[128:131], v[160:163], v[32:35]
    s_barrier
    v_xor_b32 v10, m0, v15
    v_mfma_f32_16x16x32_bf16 v[36:39], a[128:131], v[164:167], v[36:39]
    s_or_b32 s6, s45, s82
    s_cmp_lg_u32 s6, 0
    s_cbranch_scc1 L_sg5
    buffer_load_dword v9, v14, s[16:19], 0 offen offset:128 sc1
L_sg5:
    v_mfma_f32_16x16x32_bf16 v[96:99], a[128:131], v[176:179], v[96:99]
    buffer_load_dwordx4 v2, s[20:23], s44 offen offset:0 sc1 lds
    v_mfma_f32_16x16x32_bf16 v[100:103], a[128:131], v[180:183], v[100:103]
    ds_read_b128 a[128:131], v10 offset:16384
    v_mfma_f32_16x16x32_bf16 v[40:43], a[132:135], v[160:163], v[40:43]
    v_exp_f32 v192, v192
    v_mfma_f32_16x16x32_bf16 v[44:47], a[132:135], v[164:167], v[44:47]
    v_exp_f32 v193, v193
    v_mfma_f32_16x16x32_bf16 v[104:107], a[132:135], v[176:179], v[104:107]
    v_exp_f32 v194, v194
    v_mfma_f32_16x16x32_bf16 v[108:111], a[132:135], v[180:183], v[108:111]
    ds_read_b128 a[132:135], v10 offset:17408
    v_cvt_pk_bf16_f32 v192, v192, v193
    v_mfma_f32_16x16x32_bf16 v[48:51], a[136:139], v[160:163], v[48:51]
    v_exp_f32 v195, v195
    v_mfma_f32_16x16x32_bf16 v[52:55], a[136:139], v[164:167], v[52:55]
    v_cvt_pk_bf16_f32 v193, v194, v195
    v_mfma_f32_16x16x32_bf16 v[112:115], a[136:139], v[176:179], v[112:115]
    v_exp_f32 v196, v196
    v_mfma_f32_16x16x32_bf16 v[116:119], a[136:139], v[180:183], v[116:119]
    ds_read_b128 a[136:139], v10 offset:18432
    v_mfma_f32_16x16x32_bf16 v[56:59], a[140:143], v[160:163], v[56:59]
    v_exp_f32 v197, v197
    v_mfma_f32_16x16x32_bf16 v[60:63], a[140:143], v[164:167], v[60:63]
    v_exp_f32 v198, v198
    v_mfma_f32_16x16x32_bf16 v[120:123], a[140:143], v[176:179], v[120:123]
    v_cvt_pk_bf16_f32 v196, v196, v197
    v_mfma_f32_16x16x32_bf16 v[124:127], a[140:143], v[180:183], v[124:127]
    ds_read_b128 a[140:143], v10 offset:19456
    v_mfma_f32_16x16x32_bf16 v[64:67], a[144:147], v[160:163], v[64:67]
    buffer_load_dwordx4 v2, s[20:23], s44 offen offset:1024 sc1 lds
    v_mfma_f32_16x16x32_bf16 v[68:71], a[144:147], v[164:167], v[68:71]
    v_exp_f32 v199, v199
    v_mfma_f32_16x16x32_bf16 v[128:131], a[144:147], v[176:179], v[128:131]
    v_exp_f32 v208, v208
    v_mfma_f32_16x16x32_bf16 v[132:135], a[144:147], v[180:183], v[132:135]
    ds_read_b128 a[144:147], v10 offset:20480
    v_cvt_pk_bf16_f32 v197, v198, v199
    v_mfma_f32_16x16x32_bf16 v[72:75], a[148:151], v[160:163], v[72:75]
    v_exp_f32 v209, v209
    v_mfma_f32_16x16x32_bf16 v[76:79], a[148:151], v[164:167], v[76:79]
    v_cvt_pk_bf16_f32 v208, v208, v209
    v_mfma_f32_16x16x32_bf16 v[136:139], a[148:151], v[176:179], v[136:139]
    v_exp_f32 v210, v210
    v_mfma_f32_16x16x32_bf16 v[140:143], a[148:151], v[180:183], v[140:143]
    ds_read_b128 a[148:151], v10 offset:21504
    v_mfma_f32_16x16x32_bf16 v[80:83], a[152:155], v[160:163], v[80:83]
    v_exp_f32 v211, v211
    v_mfma_f32_16x16x32_bf16 v[84:87], a[152:155], v[164:167], v[84:87]
    v_exp_f32 v212, v212
    v_mfma_f32_16x16x32_bf16 v[144:147], a[152:155], v[176:179], v[144:147]
    v_cvt_pk_bf16_f32 v209, v210, v211
    v_mfma_f32_16x16x32_bf16 v[148:151], a[152:155], v[180:183], v[148:151]
    ds_read_b128 a[152:155], v10 offset:22528
    v_mfma_f32_16x16x32_bf16 v[88:91], a[156:159], v[160:163], v[88:91]
    v_exp_f32 v213, v213
    v_mfma_f32_16x16x32_bf16 v[92:95], a[156:159], v[164:167], v[92:95]
    v_exp_f32 v214, v214
    v_mfma_f32_16x16x32_bf16 v[152:155], a[156:159], v[176:179], v[152:155]
    v_exp_f32 v215, v215
    v_mfma_f32_16x16x32_bf16 v[156:159], a[156:159], v[180:183], v[156:159]
    ds_read_b128 a[156:159], v10 offset:23552
    v_cvt_pk_bf16_f32 v212, v212, v213
    v_smfmac_f32_16x16x64_bf16 a[96:99], a[116:119], v[160:167], v6
    v_cvt_pk_bf16_f32 v213, v214, v215
    v_smfmac_f32_16x16x64_bf16 a[100:103], a[116:119], v[176:183], v6
    s_waitcnt lgkmcnt(8)
    v_mfma_f32_16x16x32_bf16 v[160:163], a[64:67], a[0:3], v[224:227]
    buffer_load_dwordx4 v2, s[20:23], s44 offen offset:2048 sc1 lds
    v_mfma_f32_16x16x32_bf16 v[160:163], a[68:71], a[4:7], v[160:163]
    v_mfma_f32_16x16x32_bf16 v[160:163], a[72:75], a[8:11], v[160:163]
    v_exp_f32 v200, v200
    v_mfma_f32_16x16x32_bf16 v[160:163], a[76:79], a[12:15], v[160:163]
    v_exp_f32 v201, v201
    v_mfma_f32_16x16x32_bf16 v[164:167], a[64:67], a[16:19], v[228:231]
    v_exp_f32 v202, v202
    v_mfma_f32_16x16x32_bf16 v[164:167], a[68:71], a[20:23], v[164:167]
    v_exp_f32 v203, v203
    v_mfma_f32_16x16x32_bf16 v[164:167], a[72:75], a[24:27], v[164:167]
    v_cvt_pk_bf16_f32 v194, v200, v201
    v_cvt_pk_bf16_f32 v195, v202, v203
    v_mfma_f32_16x16x32_bf16 v[164:167], a[76:79], a[28:31], v[164:167]
    v_exp_f32 v204, v204
    v_mfma_f32_16x16x32_bf16 v[176:179], a[64:67], a[32:35], v[232:235]
    v_exp_f32 v205, v205
    v_mfma_f32_16x16x32_bf16 v[176:179], a[68:71], a[36:39], v[176:179]
    v_exp_f32 v206, v206
    v_mfma_f32_16x16x32_bf16 v[176:179], a[72:75], a[40:43], v[176:179]
    v_cvt_pk_bf16_f32 v198, v204, v205
    v_mfma_f32_16x16x32_bf16 v[176:179], a[76:79], a[44:47], v[176:179]
    v_exp_f32 v207, v207
    v_mfma_f32_16x16x32_bf16 v[180:183], a[64:67], a[48:51], v[236:239]
    ds_read_b128 a[64:67], v10 offset:0
    v_cvt_pk_bf16_f32 v199, v206, v207
    v_mfma_f32_16x16x32_bf16 v[180:183], a[68:71], a[52:55], v[180:183]
    ds_read_b128 a[68:71], v10 offset:1024
    v_mfma_f32_16x16x32_bf16 v[180:183], a[72:75], a[56:59], v[180:183]
    ds_read_b128 a[72:75], v10 offset:2048
    v_mfma_f32_16x16x32_bf16 v[180:183], a[76:79], a[60:63], v[180:183]
    ds_read_b128 a[76:79], v10 offset:3072
    v_mfma_f32_16x16x32_bf16 v[168:171], a[80:83], a[0:3], v[224:227]
    buffer_load_dwordx4 v2, s[20:23], s44 offen offset:3072 sc1 lds
    v_mfma_f32_16x16x32_bf16 v[168:171], a[84:87], a[4:7], v[168:171]
    v_exp_f32 v216, v216
    v_mfma_f32_16x16x32_bf16 v[168:171], a[88:91], a[8:11], v[168:171]
    v_exp_f32 v217, v217
    v_mfma_f32_16x16x32_bf16 v[168:171], a[92:95], a[12:15], v[168:171]
    v_cvt_pk_bf16_f32 v210, v216, v217
    s_add_u32 m0, m0, 4096
    v_mfma_f32_16x16x32_bf16 v[172:175], a[80:83], a[16:19], v[228:231]
    v_exp_f32 v218, v218
    v_mfma_f32_16x16x32_bf16 v[172:175], a[84:87], a[20:23], v[172:175]
    v_exp_f32 v219, v219
    v_mfma_f32_16x16x32_bf16 v[172:175], a[88:91], a[24:27], v[172:175]
    v_exp_f32 v220, v220
    v_mfma_f32_16x16x32_bf16 v[172:175], a[92:95], a[28:31], v[172:175]
    v_cvt_pk_bf16_f32 v211, v218, v219
    v_mfma_f32_16x16x32_bf16 v[184:187], a[80:83], a[32:35], v[232:235]
    v_exp_f32 v221, v221
    v_mfma_f32_16x16x32_bf16 v[184:187], a[84:87], a[36:39], v[184:187]
    v_exp_f32 v222, v222
    v_mfma_f32_16x16x32_bf16 v[184:187], a[88:91], a[40:43], v[184:187]
    v_exp_f32 v223, v223
    v_mfma_f32_16x16x32_bf16 v[184:187], a[92:95], a[44:47], v[184:187]
    v_cvt_pk_bf16_f32 v214, v220, v221
    v_cvt_pk_bf16_f32 v215, v222, v223
    v_mfma_f32_16x16x32_bf16 v[188:191], a[80:83], a[48:51], v[236:239]
    ds_read_b128 a[80:83], v10 offset:4096
    v_mfma_f32_16x16x32_bf16 v[188:191], a[84:87], a[52:55], v[188:191]
    ds_read_b128 a[84:87], v10 offset:5120
    v_mfma_f32_16x16x32_bf16 v[188:191], a[88:91], a[56:59], v[188:191]
    ds_read_b128 a[88:91], v10 offset:6144
    v_mfma_f32_16x16x32_bf16 v[188:191], a[92:95], a[60:63], v[188:191]
    ds_read_b128 a[92:95], v10 offset:7168
    s_waitcnt lgkmcnt(8)
    v_mfma_f32_16x16x32_bf16 v[32:35], a[128:131], v[192:195], v[32:35]
    buffer_load_dwordx4 v3, s[20:23], s44 offen offset:0 sc1 lds
    v_mfma_f32_16x16x32_bf16 v[36:39], a[128:131], v[196:199], v[36:39]
    v_exp_f32 v160, v160
    v_mfma_f32_16x16x32_bf16 v[96:99], a[128:131], v[208:211], v[96:99]
    v_exp_f32 v161, v161
    v_mfma_f32_16x16x32_bf16 v[100:103], a[128:131], v[212:215], v[100:103]
    ds_read_b128 a[128:131], v10 offset:24576
    v_cvt_pk_bf16_f32 v160, v160, v161
    v_mfma_f32_16x16x32_bf16 v[40:43], a[132:135], v[192:195], v[40:43]
    v_exp_f32 v162, v162
    v_mfma_f32_16x16x32_bf16 v[44:47], a[132:135], v[196:199], v[44:47]
    v_mfma_f32_16x16x32_bf16 v[104:107], a[132:135], v[208:211], v[104:107]
    v_exp_f32 v163, v163
    v_mfma_f32_16x16x32_bf16 v[108:111], a[132:135], v[212:215], v[108:111]
    ds_read_b128 a[132:135], v10 offset:25600
    v_cvt_pk_bf16_f32 v161, v162, v163
    v_mfma_f32_16x16x32_bf16 v[48:51], a[136:139], v[192:195], v[48:51]
    v_exp_f32 v164, v164
    v_mfma_f32_16x16x32_bf16 v[52:55], a[136:139], v[196:199], v[52:55]
    v_exp_f32 v165, v165
    v_mfma_f32_16x16x32_bf16 v[112:115], a[136:139], v[208:211], v[112:115]
    v_cvt_pk_bf16_f32 v164, v164, v165
    v_mfma_f32_16x16x32_bf16 v[116:119], a[136:139], v[212:215], v[116:119]
    ds_read_b128 a[136:139], v10 offset:26624
    v_mfma_f32_16x16x32_bf16 v[56:59], a[140:143], v[192:195], v[56:59]
    v_exp_f32 v166, v166
    v_mfma_f32_16x16x32_bf16 v[60:63], a[140:143], v[196:199], v[60:63]
    buffer_load_dwordx4 v3, s[20:23], s44 offen offset:1024 sc1 lds
    v_mfma_f32_16x16x32_bf16 v[120:123], a[140:143], v[208:211], v[120:123]
    v_exp_f32 v167, v167
    v_mfma_f32_16x16x32_bf16 v[124:127], a[140:143], v[212:215], v[124:127]
    ds_read_b128 a[140:143], v10 offset:27648
    v_cvt_pk_bf16_f32 v165, v166, v167
    v_mfma_f32_16x16x32_bf16 v[64:67], a[144:147], v[192:195], v[64:67]
    v_mfma_f32_16x16x32_bf16 v[68:71], a[144:147], v[196:199], v[68:71]
    v_exp_f32 v176, v176
    v_mfma_f32_16x16x32_bf16 v[128:131], a[144:147], v[208:211], v[128:131]
    v_exp_f32 v177, v177
    v_mfma_f32_16x16x32_bf16 v[132:135], a[144:147], v[212:215], v[132:135]
    ds_read_b128 a[144:147], v10 offset:28672
    v_cvt_pk_bf16_f32 v176, v176, v177
    v_mfma_f32_16x16x32_bf16 v[72:75], a[148:151], v[192:195], v[72:75]
    v_exp_f32 v178, v178
    v_mfma_f32_16x16x32_bf16 v[76:79], a[148:151], v[196:199], v[76:79]
    v_mfma_f32_16x16x32_bf16 v[136:139], a[148:151], v[208:211], v[136:139]
    v_exp_f32 v179, v179
    v_mfma_f32_16x16x32_bf16 v[140:143], a[148:151], v[212:215], v[140:143]
    ds_read_b128 a[148:151], v10 offset:29696
    v_cvt_pk_bf16_f32 v177, v178, v179
    v_mfma_f32_16x16x32_bf16 v[80:83], a[152:155], v[192:195], v[80:83]
    v_exp_f32 v180, v180
    v_mfma_f32_16x16x32_bf16 v[84:87], a[152:155], v[196:199], v[84:87]
    v_exp_f32 v181, v181
    v_mfma_f32_16x16x32_bf16 v[144:147], a[152:155], v[208:211], v[144:147]
    v_cvt_pk_bf16_f32 v180, v180, v181
    v_mfma_f32_16x16x32_bf16 v[148:151], a[152:155], v[212:215], v[148:151]
    ds_read_b128 a[152:155], v10 offset:30720
    v_mfma_f32_16x16x32_bf16 v[88:91], a[156:159], v[192:195], v[88:91]
    v_exp_f32 v182, v182
    v_mfma_f32_16x16x32_bf16 v[92:95], a[156:159], v[196:199], v[92:95]
    buffer_load_dwordx4 v3, s[20:23], s44 offen offset:2048 sc1 lds
    v_mfma_f32_16x16x32_bf16 v[152:155], a[156:159], v[208:211], v[152:155]
    v_exp_f32 v183, v183
    v_mfma_f32_16x16x32_bf16 v[156:159], a[156:159], v[212:215], v[156:159]
    ds_read_b128 a[156:159], v10 offset:31744
    v_cvt_pk_bf16_f32 v181, v182, v183
    v_smfmac_f32_16x16x64_bf16 a[96:99], a[116:119], v[192:199], v6
    v_smfmac_f32_16x16x64_bf16 a[100:103], a[116:119], v[208:215], v6
    s_waitcnt lgkmcnt(8)
    v_mfma_f32_16x16x32_bf16 v[192:195], a[64:67], a[0:3], v[224:227]
    v_mfma_f32_16x16x32_bf16 v[192:195], a[68:71], a[4:7], v[192:195]
    v_exp_f32 v168, v168
    v_mfma_f32_16x16x32_bf16 v[192:195], a[72:75], a[8:11], v[192:195]
    v_exp_f32 v169, v169
    v_mfma_f32_16x16x32_bf16 v[192:195], a[76:79], a[12:15], v[192:195]
    v_exp_f32 v170, v170
    v_mfma_f32_16x16x32_bf16 v[196:199], a[64:67], a[16:19], v[228:231]
    v_cvt_pk_bf16_f32 v162, v168, v169
    v_mfma_f32_16x16x32_bf16 v[196:199], a[68:71], a[20:23], v[196:199]
    v_exp_f32 v171, v171
    v_mfma_f32_16x16x32_bf16 v[196:199], a[72:75], a[24:27], v[196:199]
    v_exp_f32 v172, v172
    v_mfma_f32_16x16x32_bf16 v[196:199], a[76:79], a[28:31], v[196:199]
    v_exp_f32 v173, v173
    v_mfma_f32_16x16x32_bf16 v[208:211], a[64:67], a[32:35], v[232:235]
    v_cvt_pk_bf16_f32 v163, v170, v171
    v_cvt_pk_bf16_f32 v166, v172, v173
    v_mfma_f32_16x16x32_bf16 v[208:211], a[68:71], a[36:39], v[208:211]
    v_exp_f32 v174, v174
    v_mfma_f32_16x16x32_bf16 v[208:211], a[72:75], a[40:43], v[208:211]
    v_exp_f32 v175, v175
    v_mfma_f32_16x16x32_bf16 v[208:211], a[76:79], a[44:47], v[208:211]
    buffer_load_dwordx4 v3, s[20:23], s44 offen offset:3072 sc1 lds
    v_mfma_f32_16x16x32_bf16 v[212:215], a[64:67], a[48:51], v[236:239]
    ds_read_b128 a[64:67], v10 offset:8192
    v_cvt_pk_bf16_f32 v167, v174, v175
    v_mfma_f32_16x16x32_bf16 v[212:215], a[68:71], a[52:55], v[212:215]
    ds_read_b128 a[68:71], v10 offset:9216
    s_add_u32 s44, s44, 16384
    v_mfma_f32_16x16x32_bf16 v[212:215], a[72:75], a[56:59], v[212:215]
    ds_read_b128 a[72:75], v10 offset:10240
    s_add_u32 m0, m0, 28672
    v_mfma_f32_16x16x32_bf16 v[212:215], a[76:79], a[60:63], v[212:215]
    ds_read_b128 a[76:79], v10 offset:11264
    s_and_b32 m0, m0, 0x1ffff
    v_mfma_f32_16x16x32_bf16 v[200:203], a[80:83], a[0:3], v[224:227]
    s_sub_u32 s45, s45, 1
    v_mfma_f32_16x16x32_bf16 v[200:203], a[84:87], a[4:7], v[200:203]
    v_exp_f32 v184, v184
    v_mfma_f32_16x16x32_bf16 v[200:203], a[88:91], a[8:11], v[200:203]
    v_exp_f32 v185, v185
    v_mfma_f32_16x16x32_bf16 v[200:203], a[92:95], a[12:15], v[200:203]
    v_exp_f32 v186, v186
    v_mfma_f32_16x16x32_bf16 v[204:207], a[80:83], a[16:19], v[228:231]
    v_cvt_pk_bf16_f32 v178, v184, v185
    v_mfma_f32_16x16x32_bf16 v[204:207], a[84:87], a[20:23], v[204:207]
    v_exp_f32 v187, v187
    v_mfma_f32_16x16x32_bf16 v[204:207], a[88:91], a[24:27], v[204:207]
    v_exp_f32 v188, v188
    v_mfma_f32_16x16x32_bf16 v[204:207], a[92:95], a[28:31], v[204:207]
    v_exp_f32 v189, v189
    v_mfma_f32_16x16x32_bf16 v[216:219], a[80:83], a[32:35], v[232:235]
    v_cvt_pk_bf16_f32 v179, v186, v187
    v_cvt_pk_bf16_f32 v182, v188, v189
    v_mfma_f32_16x16x32_bf16 v[216:219], a[84:87], a[36:39], v[216:219]
    v_exp_f32 v190, v190
    v_mfma_f32_16x16x32_bf16 v[216:219], a[88:91], a[40:43], v[216:219]
    v_exp_f32 v191, v191
    v_mfma_f32_16x16x32_bf16 v[216:219], a[92:95], a[44:47], v[216:219]
    v_cvt_pk_bf16_f32 v183, v190, v191
    v_mfma_f32_16x16x32_bf16 v[220:223], a[80:83], a[48:51], v[236:239]
    ds_read_b128 a[80:83], v10 offset:12288
    v_mfma_f32_16x16x32_bf16 v[220:223], a[84:87], a[52:55], v[220:223]
    ds_read_b128 a[84:87], v10 offset:13312
    v_mfma_f32_16x16x32_bf16 v[220:223], a[88:91], a[56:59], v[220:223]
    ds_read_b128 a[88:91], v10 offset:14336
    v_mfma_f32_16x16x32_bf16 v[220:223], a[92:95], a[60:63], v[220:223]
    ds_read_b128 a[92:95], v10 offset:15360
    s_waitcnt vmcnt(8) lgkmcnt(8)
    s_cbranch_scc0 L_D
    s_cmp_eq_u32 s46, -1
    s_cbranch_scc1 L_DM
L_P2:
    v_mfma_f32_16x16x32_bf16 v[32:35], a[128:131], v[160:163], v[32:35]
    s_barrier
    v_xor_b32 v10, m0, v15
    v_mfma_f32_16x16x32_bf16 v[36:39], a[128:131], v[164:167], v[36:39]
    v_exp_f32 v192, v192
    s_waitcnt vmcnt(8)
    v_mfma_f32_16x16x32_bf16 v[96:99], a[128:131], v[176:179], v[96:99]
    ds_read_b64_tr_b16 a[160:161], v28 offset:0
    ds_read_b64_tr_b16 a[162:163], v28 offset:1024
    v_xor_b32 v28, 64, v28
    s_add_u32 s72, s75, s43
    v_mfma_f32_16x16x32_bf16 v[100:103], a[128:131], v[180:183], v[100:103]
    ds_read_b128 a[128:131], v10 offset:16384
    v_exp_f32 v193, v193
    v_mfma_f32_16x16x32_bf16 v[40:43], a[132:135], v[160:163], v[40:43]
    ds_read_b64_tr_b16 a[164:165], v29 offset:0
    ds_read_b64_tr_b16 a[166:167], v29 offset:1024
    v_xor_b32 v29, 64, v29
    v_mfma_f32_16x16x32_bf16 v[44:47], a[132:135], v[164:167], v[44:47]
    ds_read_b64_tr_b16 a[168:169], v28 offset:0
    ds_read_b64_tr_b16 a[170:171], v28 offset:1024
    v_xor_b32 v28, 192, v28
    v_mfma_f32_16x16x32_bf16 v[104:107], a[132:135], v[176:179], v[104:107]
    ds_read_b64_tr_b16 a[172:173], v29 offset:0
    ds_read_b64_tr_b16 a[174:175], v29 offset:1024
    v_xor_b32 v29, 192, v29
    v_mfma_f32_16x16x32_bf16 v[108:111], a[132:135], v[180:183], v[108:111]
    ds_read_b128 a[132:135], v10 offset:17408
    v_exp_f32 v194, v194
    v_mfma_f32_16x16x32_bf16 v[48:51], a[136:139], v[160:163], v[48:51]
    ds_read_b64_tr_b16 a[176:177], v28 offset:0
    ds_read_b64_tr_b16 a[178:179], v28 offset:1024
    v_xor_b32 v28, 64, v28
    v_mfma_f32_16x16x32_bf16 v[52:55], a[136:139], v[164:167], v[52:55]
    ds_read_b64_tr_b16 a[180:181], v29 offset:0
    ds_read_b64_tr_b16 a[182:183], v29 offset:1024
    v_xor_b32 v29, 64, v29
    v_mfma_f32_16x16x32_bf16 v[112:115], a[136:139], v[176:179], v[112:115]
    ds_read_b64_tr_b16 a[184:185], v28 offset:0
    ds_read_b64_tr_b16 a[186:187], v28 offset:1024
    v_cvt_pk_bf16_f32 v192, v192, v193
    v_mfma_f32_16x16x32_bf16 v[116:119], a[136:139], v[180:183], v[116:119]
    ds_read_b128 a[136:139], v10 offset:18432
    v_exp_f32 v195, v195
    v_mfma_f32_16x16x32_bf16 v[56:59], a[140:143], v[160:163], v[56:59]
    ds_read_b64_tr_b16 a[188:189], v29 offset:0
    ds_read_b64_tr_b16 a[190:191], v29 offset:1024
    v_mfma_f32_16x16x32_bf16 v[60:63], a[140:143], v[164:167], v[60:63]
    v_exp_f32 v196, v196
    v_mfma_f32_16x16x32_bf16 v[120:123], a[140:143], v[176:179], v[120:123]
    v_exp_f32 v197, v197
    v_mfma_f32_16x16x32_bf16 v[124:127], a[140:143], v[180:183], v[124:127]
    ds_read_b128 a[140:143], v10 offset:19456
    v_cvt_pk_bf16_f32 v193, v194, v195
    v_mfma_f32_16x16x32_bf16 v[64:67], a[144:147], v[160:163], v[64:67]
    v_exp_f32 v198, v198
    v_mfma_f32_16x16x32_bf16 v[68:71], a[144:147], v[164:167], v[68:71]
    v_exp_f32 v199, v199
    v_mfma_f32_16x16x32_bf16 v[128:131], a[144:147], v[176:179], v[128:131]
    v_exp_f32 v208, v208
    v_mfma_f32_16x16x32_bf16 v[132:135], a[144:147], v[180:183], v[132:135]
    ds_read_b128 a[144:147], v10 offset:20480
    v_cvt_pk_bf16_f32 v196, v196, v197
    v_mfma_f32_16x16x32_bf16 v[72:75], a[148:151], v[160:163], v[72:75]
    v_cvt_pk_bf16_f32 v197, v198, v199
    s_waitcnt lgkmcnt(2)
    v_mfma_f32_16x16x32_bf16 v[76:79], a[148:151], v[164:167], v[76:79]
    buffer_store_dwordx4 a[160:163], v2, s[68:71], s75 offen sc1
    v_mfma_f32_16x16x32_bf16 v[136:139], a[148:151], v[176:179], v[136:139]
    s_add_u32 s73, s75, s76
    v_mfma_f32_16x16x32_bf16 v[140:143], a[148:151], v[180:183], v[140:143]
    ds_read_b128 a[148:151], v10 offset:21504
    v_mfma_f32_16x16x32_bf16 v[80:83], a[152:155], v[160:163], v[80:83]
    v_exp_f32 v209, v209
    v_mfma_f32_16x16x32_bf16 v[84:87], a[152:155], v[164:167], v[84:87]
    v_exp_f32 v210, v210
    v_mfma_f32_16x16x32_bf16 v[144:147], a[152:155], v[176:179], v[144:147]
    v_exp_f32 v211, v211
    v_mfma_f32_16x16x32_bf16 v[148:151], a[152:155], v[180:183], v[148:151]
    ds_read_b128 a[152:155], v10 offset:22528
    v_cvt_pk_bf16_f32 v208, v208, v209
    v_mfma_f32_16x16x32_bf16 v[88:91], a[156:159], v[160:163], v[88:91]
    v_exp_f32 v212, v212
    v_mfma_f32_16x16x32_bf16 v[92:95], a[156:159], v[164:167], v[92:95]
    v_exp_f32 v213, v213
    v_mfma_f32_16x16x32_bf16 v[152:155], a[156:159], v[176:179], v[152:155]
    buffer_store_dwordx4 a[164:167], v2, s[68:71], s73 offen sc1
    v_mfma_f32_16x16x32_bf16 v[156:159], a[156:159], v[180:183], v[156:159]
    ds_read_b128 a[156:159], v10 offset:23552
    s_add_u32 s75, s75, s77
    v_smfmac_f32_16x16x64_bf16 a[96:99], a[116:119], v[160:167], v6
    v_cvt_pk_bf16_f32 v209, v210, v211
    v_smfmac_f32_16x16x64_bf16 a[100:103], a[116:119], v[176:183], v6
    s_waitcnt lgkmcnt(8)
    v_mfma_f32_16x16x32_bf16 v[160:163], a[64:67], a[0:3], v[224:227]
    v_exp_f32 v214, v214
    v_mfma_f32_16x16x32_bf16 v[160:163], a[68:71], a[4:7], v[160:163]
    v_exp_f32 v215, v215
    v_mfma_f32_16x16x32_bf16 v[160:163], a[72:75], a[8:11], v[160:163]
    v_exp_f32 v200, v200
    v_mfma_f32_16x16x32_bf16 v[160:163], a[76:79], a[12:15], v[160:163]
    v_exp_f32 v201, v201
    v_mfma_f32_16x16x32_bf16 v[164:167], a[64:67], a[16:19], v[228:231]
    v_exp_f32 v202, v202
    v_mfma_f32_16x16x32_bf16 v[164:167], a[68:71], a[20:23], v[164:167]
    buffer_store_dwordx4 a[168:171], v2, s[68:71], s75 offen sc1
    v_mfma_f32_16x16x32_bf16 v[164:167], a[72:75], a[24:27], v[164:167]
    s_add_u32 s73, s75, s76
    v_cvt_pk_bf16_f32 v212, v212, v213
    v_mfma_f32_16x16x32_bf16 v[164:167], a[76:79], a[28:31], v[164:167]
    v_exp_f32 v203, v203
    v_mfma_f32_16x16x32_bf16 v[176:179], a[64:67], a[32:35], v[232:235]
    v_exp_f32 v204, v204
    v_mfma_f32_16x16x32_bf16 v[176:179], a[68:71], a[36:39], v[176:179]
    v_exp_f32 v205, v205
    v_mfma_f32_16x16x32_bf16 v[176:179], a[72:75], a[40:43], v[176:179]
    v_exp_f32 v206, v206
    v_mfma_f32_16x16x32_bf16 v[176:179], a[76:79], a[44:47], v[176:179]
    v_exp_f32 v207, v207
    v_mfma_f32_16x16x32_bf16 v[180:183], a[64:67], a[48:51], v[236:239]
    ds_read_b128 a[64:67], v10 offset:0
    v_cvt_pk_bf16_f32 v213, v214, v215
    v_mfma_f32_16x16x32_bf16 v[180:183], a[68:71], a[52:55], v[180:183]
    ds_read_b128 a[68:71], v10 offset:1024
    v_cvt_pk_bf16_f32 v194, v200, v201
    v_mfma_f32_16x16x32_bf16 v[180:183], a[72:75], a[56:59], v[180:183]
    ds_read_b128 a[72:75], v10 offset:2048
    v_cvt_pk_bf16_f32 v195, v202, v203
    v_mfma_f32_16x16x32_bf16 v[180:183], a[76:79], a[60:63], v[180:183]
    ds_read_b128 a[76:79], v10 offset:3072
    v_cvt_pk_bf16_f32 v198, v204, v205
    v_mfma_f32_16x16x32_bf16 v[168:171], a[80:83], a[0:3], v[224:227]
    buffer_store_dwordx4 a[172:175], v2, s[68:71], s73 offen sc1
    v_mfma_f32_16x16x32_bf16 v[168:171], a[84:87], a[4:7], v[168:171]
    s_mov_b32 s75, s72
    v_cvt_pk_bf16_f32 v199, v206, v207
    v_mfma_f32_16x16x32_bf16 v[168:171], a[88:91], a[8:11], v[168:171]
    v_exp_f32 v216, v216
    v_mfma_f32_16x16x32_bf16 v[168:171], a[92:95], a[12:15], v[168:171]
    v_exp_f32 v217, v217
    v_mfma_f32_16x16x32_bf16 v[172:175], a[80:83], a[16:19], v[228:231]
    v_exp_f32 v218, v218
    v_mfma_f32_16x16x32_bf16 v[172:175], a[84:87], a[20:23], v[172:175]
    v_exp_f32 v219, v219
    v_mfma_f32_16x16x32_bf16 v[172:175], a[88:91], a[24:27], v[172:175]
    v_exp_f32 v220, v220
    v_mfma_f32_16x16x32_bf16 v[172:175], a[92:95], a[28:31], v[172:175]
    buffer_store_dwordx4 a[176:179], v2, s[68:71], s75 offen sc1
    v_mfma_f32_16x16x32_bf16 v[184:187], a[80:83], a[32:35], v[232:235]
    s_add_u32 s73, s75, s76
    v_cvt_pk_bf16_f32 v210, v216, v217
    v_mfma_f32_16x16x32_bf16 v[184:187], a[84:87], a[36:39], v[184:187]
    v_exp_f32 v221, v221
    v_mfma_f32_16x16x32_bf16 v[184:187], a[88:91], a[40:43], v[184:187]
    v_exp_f32 v222, v222
    v_mfma_f32_16x16x32_bf16 v[184:187], a[92:95], a[44:47], v[184:187]
    v_exp_f32 v223, v223
    v_mfma_f32_16x16x32_bf16 v[188:191], a[80:83], a[48:51], v[236:239]
    ds_read_b128 a[80:83], v10 offset:4096
    v_cvt_pk_bf16_f32 v211, v218, v219
    v_mfma_f32_16x16x32_bf16 v[188:191], a[84:87], a[52:55], v[188:191]
    ds_read_b128 a[84:87], v10 offset:5120
    v_cvt_pk_bf16_f32 v214, v220, v221
    v_mfma_f32_16x16x32_bf16 v[188:191], a[88:91], a[56:59], v[188:191]
    ds_read_b128 a[88:91], v10 offset:6144
    v_cvt_pk_bf16_f32 v215, v222, v223
    v_mfma_f32_16x16x32_bf16 v[188:191], a[92:95], a[60:63], v[188:191]
    ds_read_b128 a[92:95], v10 offset:7168
    s_waitcnt lgkmcnt(8)
    v_mfma_f32_16x16x32_bf16 v[32:35], a[128:131], v[192:195], v[32:35]
    buffer_store_dwordx4 a[180:183], v2, s[68:71], s73 offen sc1
    v_mfma_f32_16x16x32_bf16 v[36:39], a[128:131], v[196:199], v[36:39]
    s_add_u32 s75, s75, s77
    v_mfma_f32_16x16x32_bf16 v[96:99], a[128:131], v[208:211], v[96:99]
    v_exp_f32 v160, v160
    v_mfma_f32_16x16x32_bf16 v[100:103], a[128:131], v[212:215], v[100:103]
    ds_read_b128 a[128:131], v10 offset:24576
    v_mfma_f32_16x16x32_bf16 v[40:43], a[132:135], v[192:195], v[40:43]
    v_exp_f32 v161, v161
    v_mfma_f32_16x16x32_bf16 v[44:47], a[132:135], v[196:199], v[44:47]
    v_exp_f32 v162, v162
    v_mfma_f32_16x16x32_bf16 v[104:107], a[132:135], v[208:211], v[104:107]
    v_exp_f32 v163, v163
    v_mfma_f32_16x16x32_bf16 v[108:111], a[132:135], v[212:215], v[108:111]
    ds_read_b128 a[132:135], v10 offset:25600
    v_cvt_pk_bf16_f32 v160, v160, v161
    v_mfma_f32_16x16x32_bf16 v[48:51], a[136:139], v[192:195], v[48:51]
    v_exp_f32 v164, v164
    v_mfma_f32_16x16x32_bf16 v[52:55], a[136:139], v[196:199], v[52:55]
    buffer_store_dwordx4 a[184:187], v2, s[68:71], s75 offen sc1
    v_mfma_f32_16x16x32_bf16 v[112:115], a[136:139], v[208:211], v[112:115]
    s_add_u32 s73, s75, s76
    v_cvt_pk_bf16_f32 v161, v162, v163
    v_mfma_f32_16x16x32_bf16 v[116:119], a[136:139], v[212:215], v[116:119]
    ds_read_b128 a[136:139], v10 offset:26624
    v_mfma_f32_16x16x32_bf16 v[56:59], a[140:143], v[192:195], v[56:59]
    v_exp_f32 v165, v165
    v_mfma_f32_16x16x32_bf16 v[60:63], a[140:143], v[196:199], v[60:63]
    v_exp_f32 v166, v166
    v_mfma_f32_16x16x32_bf16 v[120:123], a[140:143], v[208:211], v[120:123]
    v_exp_f32 v167, v167
    v_mfma_f32_16x16x32_bf16 v[124:127], a[140:143], v[212:215], v[124:127]
    ds_read_b128 a[140:143], v10 offset:27648
    v_cvt_pk_bf16_f32 v164, v164, v165
    v_mfma_f32_16x16x32_bf16 v[64:67], a[144:147], v[192:195], v[64:67]
    v_exp_f32 v176, v176
    v_mfma_f32_16x16x32_bf16 v[68:71], a[144:147], v[196:199], v[68:71]
    v_exp_f32 v177, v177
    v_mfma_f32_16x16x32_bf16 v[128:131], a[144:147], v[208:211], v[128:131]
    buffer_store_dwordx4 a[188:191], v2, s[68:71], s73 offen sc1
    v_mfma_f32_16x16x32_bf16 v[132:135], a[144:147], v[212:215], v[132:135]
    ds_read_b128 a[144:147], v10 offset:28672
    v_cvt_pk_bf16_f32 v165, v166, v167
    v_mfma_f32_16x16x32_bf16 v[72:75], a[148:151], v[192:195], v[72:75]
    v_exp_f32 v178, v178
    v_mfma_f32_16x16x32_bf16 v[76:79], a[148:151], v[196:199], v[76:79]
    buffer_load_dwordx4 v2, s[20:23], s44 offen offset:0 sc1 lds
    v_mfma_f32_16x16x32_bf16 v[136:139], a[148:151], v[208:211], v[136:139]
    v_cvt_pk_bf16_f32 v176, v176, v177
    v_mfma_f32_16x16x32_bf16 v[140:143], a[148:151], v[212:215], v[140:143]
    ds_read_b128 a[148:151], v10 offset:29696
    v_mfma_f32_16x16x32_bf16 v[80:83], a[152:155], v[192:195], v[80:83]
    v_exp_f32 v179, v179
    v_mfma_f32_16x16x32_bf16 v[84:87], a[152:155], v[196:199], v[84:87]
    v_exp_f32 v180, v180
    v_mfma_f32_16x16x32_bf16 v[144:147], a[152:155], v[208:211], v[144:147]
    buffer_load_dwordx4 v2, s[20:23], s44 offen offset:1024 sc1 lds
    v_mfma_f32_16x16x32_bf16 v[148:151], a[152:155], v[212:215], v[148:151]
    ds_read_b128 a[152:155], v10 offset:30720
    v_cvt_pk_bf16_f32 v177, v178, v179
    v_mfma_f32_16x16x32_bf16 v[88:91], a[156:159], v[192:195], v[88:91]
    v_exp_f32 v181, v181
    v_mfma_f32_16x16x32_bf16 v[92:95], a[156:159], v[196:199], v[92:95]
    v_exp_f32 v182, v182
    v_mfma_f32_16x16x32_bf16 v[152:155], a[156:159], v[208:211], v[152:155]
    v_exp_f32 v183, v183
    v_mfma_f32_16x16x32_bf16 v[156:159], a[156:159], v[212:215], v[156:159]
    ds_read_b128 a[156:159], v10 offset:31744
    v_cvt_pk_bf16_f32 v180, v180, v181
    v_smfmac_f32_16x16x64_bf16 a[96:99], a[116:119], v[192:199], v6
    v_cvt_pk_bf16_f32 v181, v182, v183
    v_smfmac_f32_16x16x64_bf16 a[100:103], a[116:119], v[208:215], v6
    s_waitcnt lgkmcnt(8)
    v_mfma_f32_16x16x32_bf16 v[192:195], a[64:67], a[0:3], v[224:227]
    buffer_load_dwordx4 v2, s[20:23], s44 offen offset:2048 sc1 lds
    v_mfma_f32_16x16x32_bf16 v[192:195], a[68:71], a[4:7], v[192:195]
    v_exp_f32 v168, v168
    v_mfma_f32_16x16x32_bf16 v[192:195], a[72:75], a[8:11], v[192:195]
    buffer_load_dwordx4 v2, s[20:23], s44 offen offset:3072 sc1 lds
    s_add_u32 m0, m0, 4096
    v_mfma_f32_16x16x32_bf16 v[192:195], a[76:79], a[12:15], v[192:195]
    v_exp_f32 v169, v169
    v_mfma_f32_16x16x32_bf16 v[196:199], a[64:67], a[16:19], v[228:231]
    v_exp_f32 v170, v170
    v_mfma_f32_16x16x32_bf16 v[196:199], a[68:71], a[20:23], v[196:199]
    v_exp_f32 v171, v171
    v_mfma_f32_16x16x32_bf16 v[196:199], a[72:75], a[24:27], v[196:199]
    v_exp_f32 v172, v172
    v_mfma_f32_16x16x32_bf16 v[196:199], a[76:79], a[28:31], v[196:199]
    buffer_load_dwordx4 v3, s[20:23], s44 offen offset:0 sc1 lds
    v_mfma_f32_16x16x32_bf16 v[208:211], a[64:67], a[32:35], v[232:235]
    v_exp_f32 v173, v173
    v_mfma_f32_16x16x32_bf16 v[208:211], a[68:71], a[36:39], v[208:211]
    v_cvt_pk_bf16_f32 v162, v168, v169
    v_cvt_pk_bf16_f32 v163, v170, v171
    v_mfma_f32_16x16x32_bf16 v[208:211], a[72:75], a[40:43], v[208:211]
    v_exp_f32 v174, v174
    v_mfma_f32_16x16x32_bf16 v[208:211], a[76:79], a[44:47], v[208:211]
    v_exp_f32 v175, v175
    v_mfma_f32_16x16x32_bf16 v[212:215], a[64:67], a[48:51], v[236:239]
    ds_read_b128 a[64:67], v10 offset:8192
    v_cvt_pk_bf16_f32 v166, v172, v173
    v_mfma_f32_16x16x32_bf16 v[212:215], a[68:71], a[52:55], v[212:215]
    ds_read_b128 a[68:71], v10 offset:9216
    v_cvt_pk_bf16_f32 v167, v174, v175
    v_mfma_f32_16x16x32_bf16 v[212:215], a[72:75], a[56:59], v[212:215]
    ds_read_b128 a[72:75], v10 offset:10240
    v_mfma_f32_16x16x32_bf16 v[212:215], a[76:79], a[60:63], v[212:215]
    ds_read_b128 a[76:79], v10 offset:11264
    v_mfma_f32_16x16x32_bf16 v[200:203], a[80:83], a[0:3], v[224:227]
    buffer_load_dwordx4 v3, s[20:23], s44 offen offset:1024 sc1 lds
    v_mfma_f32_16x16x32_bf16 v[200:203], a[84:87], a[4:7], v[200:203]
    buffer_load_dwordx4 v3, s[20:23], s44 offen offset:2048 sc1 lds
    v_mfma_f32_16x16x32_bf16 v[200:203], a[88:91], a[8:11], v[200:203]
    v_exp_f32 v184, v184
    v_mfma_f32_16x16x32_bf16 v[200:203], a[92:95], a[12:15], v[200:203]
    v_exp_f32 v185, v185
    v_mfma_f32_16x16x32_bf16 v[204:207], a[80:83], a[16:19], v[228:231]
    v_exp_f32 v186, v186
    v_mfma_f32_16x16x32_bf16 v[204:207], a[84:87], a[20:23], v[204:207]
    v_exp_f32 v187, v187
    v_mfma_f32_16x16x32_bf16 v[204:207], a[88:91], a[24:27], v[204:207]
    buffer_load_dwordx4 v3, s[20:23], s44 offen offset:3072 sc1 lds
    v_mfma_f32_16x16x32_bf16 v[204:207], a[92:95], a[28:31], v[204:207]
    v_exp_f32 v188, v188
    v_mfma_f32_16x16x32_bf16 v[216:219], a[80:83], a[32:35], v[232:235]
    v_exp_f32 v189, v189
    v_mfma_f32_16x16x32_bf16 v[216:219], a[84:87], a[36:39], v[216:219]
    v_exp_f32 v190, v190
    v_mfma_f32_16x16x32_bf16 v[216:219], a[88:91], a[40:43], v[216:219]
    v_exp_f32 v191, v191
    v_mfma_f32_16x16x32_bf16 v[216:219], a[92:95], a[44:47], v[216:219]
    v_cvt_pk_bf16_f32 v178, v184, v185
    v_cvt_pk_bf16_f32 v179, v186, v187
    v_mfma_f32_16x16x32_bf16 v[220:223], a[80:83], a[48:51], v[236:239]
    ds_read_b128 a[80:83], v10 offset:12288
    v_cvt_pk_bf16_f32 v182, v188, v189
    v_mfma_f32_16x16x32_bf16 v[220:223], a[84:87], a[52:55], v[220:223]
    ds_read_b128 a[84:87], v10 offset:13312
    v_cvt_pk_bf16_f32 v183, v190, v191
    v_mfma_f32_16x16x32_bf16 v[220:223], a[88:91], a[56:59], v[220:223]
    ds_read_b128 a[88:91], v10 offset:14336
    s_add_u32 s44, s44, 16384
    v_mfma_f32_16x16x32_bf16 v[220:223], a[92:95], a[60:63], v[220:223]
    ds_read_b128 a[92:95], v10 offset:15360
    s_add_u32 m0, m0, 28672
    s_and_b32 m0, m0, 0x1ffff
    s_waitcnt vmcnt(8) lgkmcnt(8)
    buffer_atomic_add v8, v7, s[16:19], s8 offen offset:128
    s_xor_b32 s82, s5, 7
    s_sub_u32 s45, s46, 1
    s_mov_b32 s46, -1
    s_cbranch_scc0 L_D
    s_branch L_DM
    .p2align 6
L_wuDM:
    s_branch L_wbDM
L_DM:
    s_cmp_eq_u32 s5, 7
    s_cbranch_scc1 L_DM7
    v_mfma_f32_16x16x32_bf16 v[32:35], a[128:131], v[160:163], v[32:35]
    s_barrier
    v_xor_b32 v10, m0, v15
    v_mfma_f32_16x16x32_bf16 v[36:39], a[128:131], v[164:167], v[36:39]
    buffer_load_dwordx4 v2, s[20:23], s44 offen offset:0 sc1 lds
    v_mfma_f32_16x16x32_bf16 v[96:99], a[128:131], v[176:179], v[96:99]
    v_exp_f32 v192, v192
    v_mfma_f32_16x16x32_bf16 v[100:103], a[128:131], v[180:183], v[100:103]
    ds_read_b128 a[128:131], v10 offset:16384
    v_cndmask_b32 v240, v12, v224, s[60:61]
    v_mfma_f32_16x16x32_bf16 v[40:43], a[132:135], v[160:163], v[40:43]
    v_exp_f32 v193, v193
    v_mfma_f32_16x16x32_bf16 v[44:47], a[132:135], v[164:167], v[44:47]
    v_exp_f32 v194, v194
    v_mfma_f32_16x16x32_bf16 v[104:107], a[132:135], v[176:179], v[104:107]
    v_cvt_pk_bf16_f32 v192, v192, v193
    v_cndmask_b32 v241, v12, v225, s[62:63]
    v_mfma_f32_16x16x32_bf16 v[108:111], a[132:135], v[180:183], v[108:111]
    ds_read_b128 a[132:135], v10 offset:17408
    v_cndmask_b32 v242, v12, v226, s[30:31]
    v_mfma_f32_16x16x32_bf16 v[48:51], a[136:139], v[160:163], v[48:51]
    v_exp_f32 v195, v195
    v_mfma_f32_16x16x32_bf16 v[52:55], a[136:139], v[164:167], v[52:55]
    v_exp_f32 v196, v196
    v_mfma_f32_16x16x32_bf16 v[112:115], a[136:139], v[176:179], v[112:115]
    v_exp_f32 v197, v197
    v_mfma_f32_16x16x32_bf16 v[116:119], a[136:139], v[180:183], v[116:119]
    ds_read_b128 a[136:139], v10 offset:18432
    v_cvt_pk_bf16_f32 v193, v194, v195
    v_mfma_f32_16x16x32_bf16 v[56:59], a[140:143], v[160:163], v[56:59]
    v_cvt_pk_bf16_f32 v196, v196, v197
    v_cndmask_b32 v243, v12, v227, s[32:33]
    v_mfma_f32_16x16x32_bf16 v[60:63], a[140:143], v[164:167], v[60:63]
    v_exp_f32 v198, v198
    v_mfma_f32_16x16x32_bf16 v[120:123], a[140:143], v[176:179], v[120:123]
    v_exp_f32 v199, v199
    v_mfma_f32_16x16x32_bf16 v[124:127], a[140:143], v[180:183], v[124:127]
    ds_read_b128 a[140:143], v10 offset:19456
    v_cvt_pk_bf16_f32 v197, v198, v199
    v_mfma_f32_16x16x32_bf16 v[64:67], a[144:147], v[160:163], v[64:67]
    buffer_load_dwordx4 v2, s[20:23], s44 offen offset:1024 sc1 lds
    v_mfma_f32_16x16x32_bf16 v[68:71], a[144:147], v[164:167], v[68:71]
    v_exp_f32 v208, v208
    v_mfma_f32_16x16x32_bf16 v[128:131], a[144:147], v[176:179], v[128:131]
    v_cndmask_b32 v244, v12, v224, s[50:51]
    v_cndmask_b32 v245, v12, v225, s[50:51]
    v_mfma_f32_16x16x32_bf16 v[132:135], a[144:147], v[180:183], v[132:135]
    ds_read_b128 a[144:147], v10 offset:20480
    v_cndmask_b32 v246, v12, v226, s[50:51]
    v_mfma_f32_16x16x32_bf16 v[72:75], a[148:151], v[160:163], v[72:75]
    v_exp_f32 v209, v209
    v_mfma_f32_16x16x32_bf16 v[76:79], a[148:151], v[164:167], v[76:79]
    v_exp_f32 v210, v210
    v_mfma_f32_16x16x32_bf16 v[136:139], a[148:151], v[176:179], v[136:139]
    v_exp_f32 v211, v211
    v_mfma_f32_16x16x32_bf16 v[140:143], a[148:151], v[180:183], v[140:143]
    ds_read_b128 a[148:151], v10 offset:21504
    v_cvt_pk_bf16_f32 v208, v208, v209
    v_mfma_f32_16x16x32_bf16 v[80:83], a[152:155], v[160:163], v[80:83]
    v_cvt_pk_bf16_f32 v209, v210, v211
    v_cndmask_b32 v247, v12, v227, s[50:51]
    v_mfma_f32_16x16x32_bf16 v[84:87], a[152:155], v[164:167], v[84:87]
    v_exp_f32 v212, v212
    v_mfma_f32_16x16x32_bf16 v[144:147], a[152:155], v[176:179], v[144:147]
    v_exp_f32 v213, v213
    v_mfma_f32_16x16x32_bf16 v[148:151], a[152:155], v[180:183], v[148:151]
    ds_read_b128 a[152:155], v10 offset:22528
    v_cvt_pk_bf16_f32 v212, v212, v213
    v_mfma_f32_16x16x32_bf16 v[88:91], a[156:159], v[160:163], v[88:91]
    v_exp_f32 v214, v214
    v_mfma_f32_16x16x32_bf16 v[92:95], a[156:159], v[164:167], v[92:95]
    v_cndmask_b32 v252, v12, v228, s[60:61]
    v_cndmask_b32 v253, v12, v229, s[62:63]
    v_cndmask_b32 v254, v12, v230, s[30:31]
    v_mfma_f32_16x16x32_bf16 v[152:155], a[156:159], v[176:179], v[152:155]
    v_exp_f32 v215, v215
    v_cndmask_b32 v255, v12, v231, s[32:33]
    v_mfma_f32_16x16x32_bf16 v[156:159], a[156:159], v[180:183], v[156:159]
    ds_read_b128 a[156:159], v10 offset:23552
    v_cvt_pk_bf16_f32 v213, v214, v215
    v_smfmac_f32_16x16x64_bf16 a[96:99], a[116:119], v[160:167], v6
    v_smfmac_f32_16x16x64_bf16 a[100:103], a[116:119], v[176:183], v6
    s_waitcnt lgkmcnt(8)
    v_mfma_f32_16x16x32_bf16 v[160:163], a[64:67], a[0:3], v[240:243]
    buffer_load_dwordx4 v2, s[20:23], s44 offen offset:2048 sc1 lds
    v_mfma_f32_16x16x32_bf16 v[160:163], a[68:71], a[4:7], v[160:163]
    v_exp_f32 v200, v200
    v_mfma_f32_16x16x32_bf16 v[160:163], a[72:75], a[8:11], v[160:163]
    v_exp_f32 v201, v201
    v_mfma_f32_16x16x32_bf16 v[160:163], a[76:79], a[12:15], v[160:163]
    v_cvt_pk_bf16_f32 v194, v200, v201
    v_mfma_f32_16x16x32_bf16 v[164:167], a[64:67], a[16:19], v[228:231]
    v_exp_f32 v202, v202
    v_mfma_f32_16x16x32_bf16 v[164:167], a[68:71], a[20:23], v[164:167]
    v_exp_f32 v203, v203
    v_mfma_f32_16x16x32_bf16 v[164:167], a[72:75], a[24:27], v[164:167]
    v_exp_f32 v204, v204
    v_mfma_f32_16x16x32_bf16 v[164:167], a[76:79], a[28:31], v[164:167]
    v_cvt_pk_bf16_f32 v195, v202, v203
    v_mfma_f32_16x16x32_bf16 v[176:179], a[64:67], a[32:35], v[232:235]
    v_exp_f32 v205, v205
    v_mfma_f32_16x16x32_bf16 v[176:179], a[68:71], a[36:39], v[176:179]
    v_exp_f32 v206, v206
    v_mfma_f32_16x16x32_bf16 v[176:179], a[72:75], a[40:43], v[176:179]
    v_exp_f32 v207, v207
    v_mfma_f32_16x16x32_bf16 v[176:179], a[76:79], a[44:47], v[176:179]
    v_cvt_pk_bf16_f32 v198, v204, v205
    v_cvt_pk_bf16_f32 v199, v206, v207
    v_mfma_f32_16x16x32_bf16 v[180:183], a[64:67], a[48:51], v[236:239]
    ds_read_b128 a[64:67], v10 offset:0
    v_mfma_f32_16x16x32_bf16 v[180:183], a[68:71], a[52:55], v[180:183]
    ds_read_b128 a[68:71], v10 offset:1024
    v_mfma_f32_16x16x32_bf16 v[180:183], a[72:75], a[56:59], v[180:183]
    ds_read_b128 a[72:75], v10 offset:2048
    v_mfma_f32_16x16x32_bf16 v[180:183], a[76:79], a[60:63], v[180:183]
    ds_read_b128 a[76:79], v10 offset:3072
    v_mfma_f32_16x16x32_bf16 v[168:171], a[80:83], a[0:3], v[244:247]
    buffer_load_dwordx4 v2, s[20:23], s44 offen offset:3072 sc1 lds
    v_mfma_f32_16x16x32_bf16 v[168:171], a[84:87], a[4:7], v[168:171]
    v_exp_f32 v216, v216
    v_mfma_f32_16x16x32_bf16 v[168:171], a[88:91], a[8:11], v[168:171]
    v_exp_f32 v217, v217
    v_mfma_f32_16x16x32_bf16 v[168:171], a[92:95], a[12:15], v[168:171]
    v_exp_f32 v218, v218
    v_mfma_f32_16x16x32_bf16 v[172:175], a[80:83], a[16:19], v[252:255]
    v_cvt_pk_bf16_f32 v210, v216, v217
    s_add_u32 m0, m0, 4096
    v_mfma_f32_16x16x32_bf16 v[172:175], a[84:87], a[20:23], v[172:175]
    v_exp_f32 v219, v219
    v_mfma_f32_16x16x32_bf16 v[172:175], a[88:91], a[24:27], v[172:175]
    v_exp_f32 v220, v220
    v_mfma_f32_16x16x32_bf16 v[172:175], a[92:95], a[28:31], v[172:175]
    v_exp_f32 v221, v221
    v_mfma_f32_16x16x32_bf16 v[184:187], a[80:83], a[32:35], v[232:235]
    v_cvt_pk_bf16_f32 v211, v218, v219
    v_cvt_pk_bf16_f32 v214, v220, v221
    v_mfma_f32_16x16x32_bf16 v[184:187], a[84:87], a[36:39], v[184:187]
    v_exp_f32 v222, v222
    v_mfma_f32_16x16x32_bf16 v[184:187], a[88:91], a[40:43], v[184:187]
    v_exp_f32 v223, v223
    v_mfma_f32_16x16x32_bf16 v[184:187], a[92:95], a[44:47], v[184:187]
    v_cvt_pk_bf16_f32 v215, v222, v223
    v_mfma_f32_16x16x32_bf16 v[188:191], a[80:83], a[48:51], v[236:239]
    ds_read_b128 a[80:83], v10 offset:4096
    v_mfma_f32_16x16x32_bf16 v[188:191], a[84:87], a[52:55], v[188:191]
    ds_read_b128 a[84:87], v10 offset:5120
    v_mfma_f32_16x16x32_bf16 v[188:191], a[88:91], a[56:59], v[188:191]
    ds_read_b128 a[88:91], v10 offset:6144
    v_mfma_f32_16x16x32_bf16 v[188:191], a[92:95], a[60:63], v[188:191]
    ds_read_b128 a[92:95], v10 offset:7168
    s_waitcnt lgkmcnt(8)
    v_mfma_f32_16x16x32_bf16 v[32:35], a[128:131], v[192:195], v[32:35]
    buffer_load_dwordx4 v3, s[20:23], s44 offen offset:0 sc1 lds
    v_mfma_f32_16x16x32_bf16 v[36:39], a[128:131], v[196:199], v[36:39]
    v_exp_f32 v160, v160
    v_mfma_f32_16x16x32_bf16 v[96:99], a[128:131], v[208:211], v[96:99]
    v_exp_f32 v161, v161
    v_mfma_f32_16x16x32_bf16 v[100:103], a[128:131], v[212:215], v[100:103]
    ds_read_b128 a[128:131], v10 offset:24576
    v_cvt_pk_bf16_f32 v160, v160, v161
    v_mfma_f32_16x16x32_bf16 v[40:43], a[132:135], v[192:195], v[40:43]
    v_exp_f32 v162, v162
    v_mfma_f32_16x16x32_bf16 v[44:47], a[132:135], v[196:199], v[44:47]
    v_cndmask_b32 v240, v12, v224, s[34:35]
    v_cndmask_b32 v241, v12, v225, s[36:37]
    v_mfma_f32_16x16x32_bf16 v[104:107], a[132:135], v[208:211], v[104:107]
    v_exp_f32 v163, v163
    v_mfma_f32_16x16x32_bf16 v[108:111], a[132:135], v[212:215], v[108:111]
    ds_read_b128 a[132:135], v10 offset:25600
    v_cvt_pk_bf16_f32 v161, v162, v163
    v_mfma_f32_16x16x32_bf16 v[48:51], a[136:139], v[192:195], v[48:51]
    v_exp_f32 v164, v164
    v_mfma_f32_16x16x32_bf16 v[52:55], a[136:139], v[196:199], v[52:55]
    v_exp_f32 v165, v165
    v_mfma_f32_16x16x32_bf16 v[112:115], a[136:139], v[208:211], v[112:115]
    v_cvt_pk_bf16_f32 v164, v164, v165
    v_cndmask_b32 v242, v12, v226, s[84:85]
    v_mfma_f32_16x16x32_bf16 v[116:119], a[136:139], v[212:215], v[116:119]
    ds_read_b128 a[136:139], v10 offset:26624
    v_cndmask_b32 v243, v12, v227, s[86:87]
    v_mfma_f32_16x16x32_bf16 v[56:59], a[140:143], v[192:195], v[56:59]
    v_exp_f32 v166, v166
    v_mfma_f32_16x16x32_bf16 v[60:63], a[140:143], v[196:199], v[60:63]
    buffer_load_dwordx4 v3, s[20:23], s44 offen offset:1024 sc1 lds
    v_mfma_f32_16x16x32_bf16 v[120:123], a[140:143], v[208:211], v[120:123]
    v_exp_f32 v167, v167
    v_mfma_f32_16x16x32_bf16 v[124:127], a[140:143], v[212:215], v[124:127]
    ds_read_b128 a[140:143], v10 offset:27648
    v_cvt_pk_bf16_f32 v165, v166, v167
    v_mfma_f32_16x16x32_bf16 v[64:67], a[144:147], v[192:195], v[64:67]
    v_cndmask_b32 v248, v12, v228, s[50:51]
    v_cndmask_b32 v249, v12, v229, s[50:51]
    v_mfma_f32_16x16x32_bf16 v[68:71], a[144:147], v[196:199], v[68:71]
    v_exp_f32 v176, v176
    v_mfma_f32_16x16x32_bf16 v[128:131], a[144:147], v[208:211], v[128:131]
    v_exp_f32 v177, v177
    v_mfma_f32_16x16x32_bf16 v[132:135], a[144:147], v[212:215], v[132:135]
    ds_read_b128 a[144:147], v10 offset:28672
    v_cvt_pk_bf16_f32 v176, v176, v177
    v_mfma_f32_16x16x32_bf16 v[72:75], a[148:151], v[192:195], v[72:75]
    v_exp_f32 v178, v178
    v_mfma_f32_16x16x32_bf16 v[76:79], a[148:151], v[196:199], v[76:79]
    v_cndmask_b32 v250, v12, v230, s[50:51]
    v_cndmask_b32 v251, v12, v231, s[50:51]
    v_mfma_f32_16x16x32_bf16 v[136:139], a[148:151], v[208:211], v[136:139]
    v_exp_f32 v179, v179
    v_mfma_f32_16x16x32_bf16 v[140:143], a[148:151], v[212:215], v[140:143]
    ds_read_b128 a[148:151], v10 offset:29696
    v_cvt_pk_bf16_f32 v177, v178, v179
    v_mfma_f32_16x16x32_bf16 v[80:83], a[152:155], v[192:195], v[80:83]
    v_exp_f32 v180, v180
    v_mfma_f32_16x16x32_bf16 v[84:87], a[152:155], v[196:199], v[84:87]
    v_exp_f32 v181, v181
    v_mfma_f32_16x16x32_bf16 v[144:147], a[152:155], v[208:211], v[144:147]
    v_cvt_pk_bf16_f32 v180, v180, v181
    v_mov_b32 v244, v12
    v_mfma_f32_16x16x32_bf16 v[148:151], a[152:155], v[212:215], v[148:151]
    ds_read_b128 a[152:155], v10 offset:30720
    v_mov_b32 v245, v12
    v_mov_b32 v246, v12
    v_mfma_f32_16x16x32_bf16 v[88:91], a[156:159], v[192:195], v[88:91]
    v_exp_f32 v182, v182
    v_mov_b32 v247, v12
    v_mfma_f32_16x16x32_bf16 v[92:95], a[156:159], v[196:199], v[92:95]
    buffer_load_dwordx4 v3, s[20:23], s44 offen offset:2048 sc1 lds
    v_cndmask_b32 v252, v12, v228, s[34:35]
    v_mfma_f32_16x16x32_bf16 v[152:155], a[156:159], v[208:211], v[152:155]
    v_exp_f32 v183, v183
    v_cndmask_b32 v253, v12, v229, s[36:37]
    v_mfma_f32_16x16x32_bf16 v[156:159], a[156:159], v[212:215], v[156:159]
    ds_read_b128 a[156:159], v10 offset:31744
    v_cvt_pk_bf16_f32 v181, v182, v183
    v_cndmask_b32 v254, v12, v230, s[84:85]
    v_cndmask_b32 v255, v12, v231, s[86:87]
    v_smfmac_f32_16x16x64_bf16 a[96:99], a[116:119], v[192:199], v6
    v_smfmac_f32_16x16x64_bf16 a[100:103], a[116:119], v[208:215], v6
    s_waitcnt lgkmcnt(8)
    v_mfma_f32_16x16x32_bf16 v[192:195], a[64:67], a[0:3], v[240:243]
    v_mfma_f32_16x16x32_bf16 v[192:195], a[68:71], a[4:7], v[192:195]
    v_exp_f32 v168, v168
    v_mfma_f32_16x16x32_bf16 v[192:195], a[72:75], a[8:11], v[192:195]
    v_exp_f32 v169, v169
    v_mfma_f32_16x16x32_bf16 v[192:195], a[76:79], a[12:15], v[192:195]
    v_exp_f32 v170, v170
    v_mfma_f32_16x16x32_bf16 v[196:199], a[64:67], a[16:19], v[248:251]
    v_cvt_pk_bf16_f32 v162, v168, v169
    v_mfma_f32_16x16x32_bf16 v[196:199], a[68:71], a[20:23], v[196:199]
    v_exp_f32 v171, v171
    v_mfma_f32_16x16x32_bf16 v[196:199], a[72:75], a[24:27], v[196:199]
    v_exp_f32 v172, v172
    v_mfma_f32_16x16x32_bf16 v[196:199], a[76:79], a[28:31], v[196:199]
    v_exp_f32 v173, v173
    v_mfma_f32_16x16x32_bf16 v[208:211], a[64:67], a[32:35], v[232:235]
    v_cvt_pk_bf16_f32 v163, v170, v171
    v_cvt_pk_bf16_f32 v166, v172, v173
    v_mfma_f32_16x16x32_bf16 v[208:211], a[68:71], a[36:39], v[208:211]
    v_exp_f32 v174, v174
    v_mfma_f32_16x16x32_bf16 v[208:211], a[72:75], a[40:43], v[208:211]
    v_exp_f32 v175, v175
    v_mfma_f32_16x16x32_bf16 v[208:211], a[76:79], a[44:47], v[208:211]
    buffer_load_dwordx4 v3, s[20:23], s44 offen offset:3072 sc1 lds
    v_mfma_f32_16x16x32_bf16 v[212:215], a[64:67], a[48:51], v[236:239]
    ds_read_b128 a[64:67], v10 offset:8192
    v_cvt_pk_bf16_f32 v167, v174, v175
    v_mfma_f32_16x16x32_bf16 v[212:215], a[68:71], a[52:55], v[212:215]
    ds_read_b128 a[68:71], v10 offset:9216
    s_add_u32 s44, s44, 16384
    v_mfma_f32_16x16x32_bf16 v[212:215], a[72:75], a[56:59], v[212:215]
    ds_read_b128 a[72:75], v10 offset:10240
    s_add_u32 m0, m0, 28672
    v_mfma_f32_16x16x32_bf16 v[212:215], a[76:79], a[60:63], v[212:215]
    ds_read_b128 a[76:79], v10 offset:11264
    s_and_b32 m0, m0, 0x1ffff
    v_mfma_f32_16x16x32_bf16 v[200:203], a[80:83], a[0:3], v[244:247]
    v_mfma_f32_16x16x32_bf16 v[200:203], a[84:87], a[4:7], v[200:203]
    v_exp_f32 v184, v184
    v_mfma_f32_16x16x32_bf16 v[200:203], a[88:91], a[8:11], v[200:203]
    v_exp_f32 v185, v185
    v_mfma_f32_16x16x32_bf16 v[200:203], a[92:95], a[12:15], v[200:203]
    v_exp_f32 v186, v186
    v_mfma_f32_16x16x32_bf16 v[204:207], a[80:83], a[16:19], v[252:255]
    v_cvt_pk_bf16_f32 v178, v184, v185
    v_mfma_f32_16x16x32_bf16 v[204:207], a[84:87], a[20:23], v[204:207]
    v_exp_f32 v187, v187
    v_mfma_f32_16x16x32_bf16 v[204:207], a[88:91], a[24:27], v[204:207]
    v_exp_f32 v188, v188
    v_mfma_f32_16x16x32_bf16 v[204:207], a[92:95], a[28:31], v[204:207]
    v_exp_f32 v189, v189
    v_mfma_f32_16x16x32_bf16 v[216:219], a[80:83], a[32:35], v[232:235]
    v_cvt_pk_bf16_f32 v179, v186, v187
    v_cvt_pk_bf16_f32 v182, v188, v189
    v_mfma_f32_16x16x32_bf16 v[216:219], a[84:87], a[36:39], v[216:219]
    v_exp_f32 v190, v190
    v_mfma_f32_16x16x32_bf16 v[216:219], a[88:91], a[40:43], v[216:219]
    v_exp_f32 v191, v191
    v_mfma_f32_16x16x32_bf16 v[216:219], a[92:95], a[44:47], v[216:219]
    v_cvt_pk_bf16_f32 v183, v190, v191
    v_mfma_f32_16x16x32_bf16 v[220:223], a[80:83], a[48:51], v[236:239]
    ds_read_b128 a[80:83], v10 offset:12288
    v_mfma_f32_16x16x32_bf16 v[220:223], a[84:87], a[52:55], v[220:223]
    ds_read_b128 a[84:87], v10 offset:13312
    v_mfma_f32_16x16x32_bf16 v[220:223], a[88:91], a[56:59], v[220:223]
    ds_read_b128 a[88:91], v10 offset:14336
    v_mfma_f32_16x16x32_bf16 v[220:223], a[92:95], a[60:63], v[220:223]
    ds_read_b128 a[92:95], v10 offset:15360
    s_waitcnt vmcnt(8) lgkmcnt(8)
    s_branch L_T
L_spinpa:
    s_mov_b32 s11, 200000
L_splpa:
    buffer_load_dword v9, v14, s[16:19], 0 offen offset:128 sc1
    s_waitcnt vmcnt(0)
    v_cmp_gt_u32 vcc, 28, v9
    s_nop 0
    s_cbranch_vccz L_backpa
    s_sub_u32 s11, s11, 1
    s_cbranch_scc0 L_splpa
    s_branch L_backpa
L_fallback:
    s_waitcnt vmcnt(0) lgkmcnt(0)
    v_and_b32 v4, 15, v1
    v_lshrrev_b32 v5, 4, v1
    v_lshlrev_b32 v5, 2, v5
    v_sub_u32 v4, v4, v5
    v_cmp_le_i32 s[60:61], 0, v4
    v_cmp_le_i32 s[62:63], 1, v4
    v_cmp_le_i32 s[30:31], 2, v4
    v_cmp_le_i32 s[32:33], 3, v4
    s_and_b32 s6, s47, 1
    s_cbranch_scc0 L_fbdone0
    v_mov_b32 v32, 0
    v_mov_b32 v33, 0
    v_mov_b32 v34, 0
    v_mov_b32 v35, 0
    v_mov_b32 v36, 0
    v_mov_b32 v37, 0
    v_mov_b32 v38, 0
    v_mov_b32 v39, 0
    v_mov_b32 v40, 0
    v_mov_b32 v41, 0
    v_mov_b32 v42, 0
    v_mov_b32 v43, 0
    v_mov_b32 v44, 0
    v_mov_b32 v45, 0
    v_mov_b32 v46, 0
    v_mov_b32 v47, 0
    v_mov_b32 v48, 0
    v_mov_b32 v49, 0
    v_mov_b32 v50, 0
    v_mov_b32 v51, 0
    v_mov_b32 v52, 0
    v_mov_b32 v53, 0
    v_mov_b32 v54, 0
    v_mov_b32 v55, 0
    v_mov_b32 v56, 0
    v_mov_b32 v57, 0
    v_mov_b32 v58, 0
    v_mov_b32 v59, 0
    v_mov_b32 v60, 0
    v_mov_b32 v61, 0
    v_mov_b32 v62, 0
    v_mov_b32 v63, 0
    v_mov_b32 v64, 0
    v_mov_b32 v65, 0
    v_mov_b32 v66, 0
    v_mov_b32 v67, 0
    v_mov_b32 v68, 0
    v_mov_b32 v69, 0
    v_mov_b32 v70, 0
    v_mov_b32 v71, 0
    v_mov_b32 v72, 0
    v_mov_b32 v73, 0
    v_mov_b32 v74, 0
    v_mov_b32 v75, 0
    v_mov_b32 v76, 0
    v_mov_b32 v77, 0
    v_mov_b32 v78, 0
    v_mov_b32 v79, 0
    v_mov_b32 v80, 0
    v_mov_b32 v81, 0
    v_mov_b32 v82, 0
    v_mov_b32 v83, 0
    v_mov_b32 v84, 0
    v_mov_b32 v85, 0
    v_mov_b32 v86, 0
    v_mov_b32 v87, 0
    v_mov_b32 v88, 0
    v_mov_b32 v89, 0
    v_mov_b32 v90, 0
    v_mov_b32 v91, 0
    v_mov_b32 v92, 0
    v_mov_b32 v93, 0
    v_mov_b32 v94, 0
    v_mov_b32 v95, 0
    v_mov_b32 v224, v12
    v_mov_b32 v228, 0
    v_mov_b32 v229, 0
    v_mov_b32 v230, 0
    v_mov_b32 v231, 0
    v_mov_b32 v225, v12
    v_mov_b32 v232, 0
    v_mov_b32 v233, 0
    v_mov_b32 v234, 0
    v_mov_b32 v235, 0
    v_mov_b32 v6, 0
    s_mov_b32 s45, 0
L_fb0:
    s_lshl_b32 s6, s45, 13
    s_add_u32 s7, s6, 524288
    buffer_load_dwordx4 v[96:99], v2, s[20:23], s6 offen offset:0 sc1
    buffer_load_dwordx4 v[100:103], v2, s[20:23], s6 offen offset:1024 sc1
    buffer_load_dwordx4 v[104:107], v2, s[20:23], s6 offen offset:2048 sc1
    buffer_load_dwordx4 v[108:111], v2, s[20:23], s6 offen offset:3072 sc1
    buffer_load_dwordx4 v[112:115], v3, s[20:23], s6 offen offset:0 sc1
    buffer_load_dwordx4 v[116:119], v3, s[20:23], s6 offen offset:1024 sc1
    buffer_load_dwordx4 v[120:123], v3, s[20:23], s6 offen offset:2048 sc1
    buffer_load_dwordx4 v[124:127], v3, s[20:23], s6 offen offset:3072 sc1
    buffer_load_dwordx4 v[128:131], v2, s[20:23], s7 offen offset:0 sc1
    buffer_load_dwordx4 v[132:135], v2, s[20:23], s7 offen offset:1024 sc1
    buffer_load_dwordx4 v[136:139], v2, s[20:23], s7 offen offset:2048 sc1
    buffer_load_dwordx4 v[140:143], v2, s[20:23], s7 offen offset:3072 sc1
    buffer_load_dwordx4 v[144:147], v3, s[20:23], s7 offen offset:0 sc1
    buffer_load_dwordx4 v[148:151], v3, s[20:23], s7 offen offset:1024 sc1
    buffer_load_dwordx4 v[152:155], v3, s[20:23], s7 offen offset:2048 sc1
    buffer_load_dwordx4 v[156:159], v3, s[20:23], s7 offen offset:3072 sc1
    s_cmp_eq_u32 s45, s12
    s_cselect_b64 s[96:97], 0, -1
    s_or_b64 s[88:89], s[60:61], s[96:97]
    s_or_b64 s[90:91], s[62:63], s[96:97]
    s_or_b64 s[92:93], s[30:31], s[96:97]
    s_or_b64 s[94:95], s[32:33], s[96:97]
    v_cndmask_b32 v240, v12, v6, s[88:89]
    v_cndmask_b32 v241, v12, v6, s[90:91]
    v_cndmask_b32 v242, v12, v6, s[92:93]
    v_cndmask_b32 v243, v12, v6, s[94:95]
    v_mov_b32 v248, v6
    v_mov_b32 v249, v6
    v_mov_b32 v250, v6
    v_mov_b32 v251, v6
    v_cndmask_b32 v244, v12, v6, s[96:97]
    v_cndmask_b32 v245, v12, v6, s[96:97]
    v_cndmask_b32 v246, v12, v6, s[96:97]
    v_cndmask_b32 v247, v12, v6, s[96:97]
    v_cndmask_b32 v252, v12, v6, s[88:89]
    v_cndmask_b32 v253, v12, v6, s[90:91]
    v_cndmask_b32 v254, v12, v6, s[92:93]
    v_cndmask_b32 v255, v12, v6, s[94:95]
    s_waitcnt vmcnt(0)
    v_mfma_f32_16x16x32_bf16 v[160:163], v[96:99], a[0:3], v[240:243]
    v_mfma_f32_16x16x32_bf16 v[160:163], v[100:103], a[4:7], v[160:163]
    v_mfma_f32_16x16x32_bf16 v[160:163], v[104:107], a[8:11], v[160:163]
    v_mfma_f32_16x16x32_bf16 v[160:163], v[108:111], a[12:15], v[160:163]
    v_mfma_f32_16x16x32_bf16 v[168:171], v[96:99], a[16:19], v[248:251]
    v_mfma_f32_16x16x32_bf16 v[168:171], v[100:103], a[20:23], v[168:171]
    v_mfma_f32_16x16x32_bf16 v[168:171], v[104:107], a[24:27], v[168:171]
    v_mfma_f32_16x16x32_bf16 v[168:171], v[108:111], a[28:31], v[168:171]
    v_mfma_f32_16x16x32_bf16 v[164:167], v[112:115], a[0:3], v[244:247]
    v_mfma_f32_16x16x32_bf16 v[164:167], v[116:119], a[4:7], v[164:167]
    v_mfma_f32_16x16x32_bf16 v[164:167], v[120:123], a[8:11], v[164:167]
    v_mfma_f32_16x16x32_bf16 v[164:167], v[124:127], a[12:15], v[164:167]
    v_mfma_f32_16x16x32_bf16 v[172:175], v[112:115], a[16:19], v[252:255]
    v_mfma_f32_16x16x32_bf16 v[172:175], v[116:119], a[20:23], v[172:175]
    v_mfma_f32_16x16x32_bf16 v[172:175], v[120:123], a[24:27], v[172:175]
    v_mfma_f32_16x16x32_bf16 v[172:175], v[124:127], a[28:31], v[172:175]
    s_nop 7
    v_max3_f32 v236, v160, v161, v162
    v_max3_f32 v236, v236, v163, v164
    v_max3_f32 v236, v236, v165, v166
    v_max3_f32 v236, v236, v167, v224
    v_max3_f32 v237, v168, v169, v170
    v_max3_f32 v237, v237, v171, v172
    v_max3_f32 v237, v237, v173, v174
    v_max3_f32 v237, v237, v175, v225
    v_mov_b32 v238, v236
    v_mov_b32 v239, v237
    s_nop 1
    v_permlane16_swap_b32 v236, v238
    v_permlane16_swap_b32 v237, v239
    v_max_f32 v236, v236, v238
    v_max_f32 v237, v237, v239
    v_mov_b32 v238, v236
    v_mov_b32 v239, v237
    s_nop 1
    v_permlane32_swap_b32 v236, v238
    v_permlane32_swap_b32 v237, v239
    v_max_f32 v236, v236, v238
    v_max_f32 v237, v237, v239
    v_sub_f32 v226, v224, v236
    v_exp_f32 v226, v226
    v_mov_b32 v224, v236
    v_sub_f32 v160, v160, v236
    v_sub_f32 v161, v161, v236
    v_sub_f32 v162, v162, v236
    v_sub_f32 v163, v163, v236
    v_sub_f32 v164, v164, v236
    v_sub_f32 v165, v165, v236
    v_sub_f32 v166, v166, v236
    v_sub_f32 v167, v167, v236
    v_exp_f32 v160, v160
    v_exp_f32 v161, v161
    v_exp_f32 v162, v162
    v_exp_f32 v163, v163
    v_exp_f32 v164, v164
    v_exp_f32 v165, v165
    v_exp_f32 v166, v166
    v_exp_f32 v167, v167
    v_mul_f32 v32, v32, v226
    v_mul_f32 v33, v33, v226
    v_mul_f32 v34, v34, v226
    v_mul_f32 v35, v35, v226
    v_mul_f32 v40, v40, v226
    v_mul_f32 v41, v41, v226
    v_mul_f32 v42, v42, v226
    v_mul_f32 v43, v43, v226
    v_mul_f32 v48, v48, v226
    v_mul_f32 v49, v49, v226
    v_mul_f32 v50, v50, v226
    v_mul_f32 v51, v51, v226
    v_mul_f32 v56, v56, v226
    v_mul_f32 v57, v57, v226
    v_mul_f32 v58, v58, v226
    v_mul_f32 v59, v59, v226
    v_mul_f32 v64, v64, v226
    v_mul_f32 v65, v65, v226
    v_mul_f32 v66, v66, v226
    v_mul_f32 v67, v67, v226
    v_mul_f32 v72, v72, v226
    v_mul_f32 v73, v73, v226
    v_mul_f32 v74, v74, v226
    v_mul_f32 v75, v75, v226
    v_mul_f32 v80, v80, v226
    v_mul_f32 v81, v81, v226
    v_mul_f32 v82, v82, v226
    v_mul_f32 v83, v83, v226
    v_mul_f32 v88, v88, v226
    v_mul_f32 v89, v89, v226
    v_mul_f32 v90, v90, v226
    v_mul_f32 v91, v91, v226
    v_mul_f32 v228, v228, v226
    v_mul_f32 v229, v229, v226
    v_mul_f32 v230, v230, v226
    v_mul_f32 v231, v231, v226
    v_cvt_pk_bf16_f32 v160, v160, v161
    v_cvt_pk_bf16_f32 v161, v162, v163
    v_cvt_pk_bf16_f32 v162, v164, v165
    v_cvt_pk_bf16_f32 v163, v166, v167
    v_sub_f32 v227, v225, v237
    v_exp_f32 v227, v227
    v_mov_b32 v225, v237
    v_sub_f32 v168, v168, v237
    v_sub_f32 v169, v169, v237
    v_sub_f32 v170, v170, v237
    v_sub_f32 v171, v171, v237
    v_sub_f32 v172, v172, v237
    v_sub_f32 v173, v173, v237
    v_sub_f32 v174, v174, v237
    v_sub_f32 v175, v175, v237
    v_exp_f32 v168, v168
    v_exp_f32 v169, v169
    v_exp_f32 v170, v170
    v_exp_f32 v171, v171
    v_exp_f32 v172, v172
    v_exp_f32 v173, v173
    v_exp_f32 v174, v174
    v_exp_f32 v175, v175
    v_mul_f32 v36, v36, v227
    v_mul_f32 v37, v37, v227
    v_mul_f32 v38, v38, v227
    v_mul_f32 v39, v39, v227
    v_mul_f32 v44, v44, v227
    v_mul_f32 v45, v45, v227
    v_mul_f32 v46, v46, v227
    v_mul_f32 v47, v47, v227
    v_mul_f32 v52, v52, v227
    v_mul_f32 v53, v53, v227
    v_mul_f32 v54, v54, v227
    v_mul_f32 v55, v55, v227
    v_mul_f32 v60, v60, v227
    v_mul_f32 v61, v61, v227
    v_mul_f32 v62, v62, v227
    v_mul_f32 v63, v63, v227
    v_mul_f32 v68, v68, v227
    v_mul_f32 v69, v69, v227
    v_mul_f32 v70, v70, v227
    v_mul_f32 v71, v71, v227
    v_mul_f32 v76, v76, v227
    v_mul_f32 v77, v77, v227
    v_mul_f32 v78, v78, v227
    v_mul_f32 v79, v79, v227
    v_mul_f32 v84, v84, v227
    v_mul_f32 v85, v85, v227
    v_mul_f32 v86, v86, v227
    v_mul_f32 v87, v87, v227
    v_mul_f32 v92, v92, v227
    v_mul_f32 v93, v93, v227
    v_mul_f32 v94, v94, v227
    v_mul_f32 v95, v95, v227
    v_mul_f32 v232, v232, v227
    v_mul_f32 v233, v233, v227
    v_mul_f32 v234, v234, v227
    v_mul_f32 v235, v235, v227
    v_cvt_pk_bf16_f32 v168, v168, v169
    v_cvt_pk_bf16_f32 v169, v170, v171
    v_cvt_pk_bf16_f32 v170, v172, v173
    v_cvt_pk_bf16_f32 v171, v174, v175
    s_nop 1
    v_mfma_f32_16x16x32_bf16 v[32:35], v[128:131], v[160:163], v[32:35]
    v_mfma_f32_16x16x32_bf16 v[40:43], v[132:135], v[160:163], v[40:43]
    v_mfma_f32_16x16x32_bf16 v[48:51], v[136:139], v[160:163], v[48:51]
    v_mfma_f32_16x16x32_bf16 v[56:59], v[140:143], v[160:163], v[56:59]
    v_mfma_f32_16x16x32_bf16 v[64:67], v[144:147], v[160:163], v[64:67]
    v_mfma_f32_16x16x32_bf16 v[72:75], v[148:151], v[160:163], v[72:75]
    v_mfma_f32_16x16x32_bf16 v[80:83], v[152:155], v[160:163], v[80:83]
    v_mfma_f32_16x16x32_bf16 v[88:91], v[156:159], v[160:163], v[88:91]
    v_mfma_f32_16x16x32_bf16 v[228:231], a[112:115], v[160:163], v[228:231]
    v_mfma_f32_16x16x32_bf16 v[36:39], v[128:131], v[168:171], v[36:39]
    v_mfma_f32_16x16x32_bf16 v[44:47], v[132:135], v[168:171], v[44:47]
    v_mfma_f32_16x16x32_bf16 v[52:55], v[136:139], v[168:171], v[52:55]
    v_mfma_f32_16x16x32_bf16 v[60:63], v[140:143], v[168:171], v[60:63]
    v_mfma_f32_16x16x32_bf16 v[68:71], v[144:147], v[168:171], v[68:71]
    v_mfma_f32_16x16x32_bf16 v[76:79], v[148:151], v[168:171], v[76:79]
    v_mfma_f32_16x16x32_bf16 v[84:87], v[152:155], v[168:171], v[84:87]
    v_mfma_f32_16x16x32_bf16 v[92:95], v[156:159], v[168:171], v[92:95]
    v_mfma_f32_16x16x32_bf16 v[232:235], a[112:115], v[168:171], v[232:235]
    s_nop 7
    s_add_u32 s45, s45, 1
    s_cmp_le_u32 s45, s12
    s_cbranch_scc1 L_fb0
    v_rcp_f32 v16, v228
    v_rcp_f32 v17, v232
    s_add_u32 s9, s48, 0
    v_pk_mul_f32 v[32:33], v[32:33], v[16:17] op_sel_hi:[1,0]
    v_pk_mul_f32 v[34:35], v[34:35], v[16:17] op_sel_hi:[1,0]
    v_pk_mul_f32 v[40:41], v[40:41], v[16:17] op_sel_hi:[1,0]
    v_pk_mul_f32 v[42:43], v[42:43], v[16:17] op_sel_hi:[1,0]
    v_cvt_pk_bf16_f32 v20, v32, v33
    v_cvt_pk_bf16_f32 v21, v34, v35
    v_cvt_pk_bf16_f32 v22, v40, v41
    v_cvt_pk_bf16_f32 v23, v42, v43
    buffer_store_dwordx4 v[20:23], v2, s[52:55], s9 offen offset:0 sc1
    v_pk_mul_f32 v[36:37], v[36:37], v[16:17] op_sel:[0,1]
    v_pk_mul_f32 v[38:39], v[38:39], v[16:17] op_sel:[0,1]
    v_pk_mul_f32 v[44:45], v[44:45], v[16:17] op_sel:[0,1]
    v_pk_mul_f32 v[46:47], v[46:47], v[16:17] op_sel:[0,1]
    v_cvt_pk_bf16_f32 v24, v36, v37
    v_cvt_pk_bf16_f32 v25, v38, v39
    v_cvt_pk_bf16_f32 v26, v44, v45
    v_cvt_pk_bf16_f32 v27, v46, v47
    buffer_store_dwordx4 v[24:27], v2, s[52:55], s9 offen offset:1024 sc1
    s_add_u32 s9, s48, 4096
    v_pk_mul_f32 v[48:49], v[48:49], v[16:17] op_sel_hi:[1,0]
    v_pk_mul_f32 v[50:51], v[50:51], v[16:17] op_sel_hi:[1,0]
    v_pk_mul_f32 v[56:57], v[56:57], v[16:17] op_sel_hi:[1,0]
    v_pk_mul_f32 v[58:59], v[58:59], v[16:17] op_sel_hi:[1,0]
    v_cvt_pk_bf16_f32 v28, v48, v49
    v_cvt_pk_bf16_f32 v29, v50, v51
    v_cvt_pk_bf16_f32 v30, v56, v57
    v_cvt_pk_bf16_f32 v31, v58, v59
    buffer_store_dwordx4 v[28:31], v2, s[52:55], s9 offen offset:0 sc1
    v_pk_mul_f32 v[52:53], v[52:53], v[16:17] op_sel:[0,1]
    v_pk_mul_f32 v[54:55], v[54:55], v[16:17] op_sel:[0,1]
    v_pk_mul_f32 v[60:61], v[60:61], v[16:17] op_sel:[0,1]
    v_pk_mul_f32 v[62:63], v[62:63], v[16:17] op_sel:[0,1]
    v_cvt_pk_bf16_f32 v20, v52, v53
    v_cvt_pk_bf16_f32 v21, v54, v55
    v_cvt_pk_bf16_f32 v22, v60, v61
    v_cvt_pk_bf16_f32 v23, v62, v63
    buffer_store_dwordx4 v[20:23], v2, s[52:55], s9 offen offset:1024 sc1
    s_add_u32 s9, s48, 8192
    v_pk_mul_f32 v[64:65], v[64:65], v[16:17] op_sel_hi:[1,0]
    v_pk_mul_f32 v[66:67], v[66:67], v[16:17] op_sel_hi:[1,0]
    v_pk_mul_f32 v[72:73], v[72:73], v[16:17] op_sel_hi:[1,0]
    v_pk_mul_f32 v[74:75], v[74:75], v[16:17] op_sel_hi:[1,0]
    v_cvt_pk_bf16_f32 v24, v64, v65
    v_cvt_pk_bf16_f32 v25, v66, v67
    v_cvt_pk_bf16_f32 v26, v72, v73
    v_cvt_pk_bf16_f32 v27, v74, v75
    buffer_store_dwordx4 v[24:27], v2, s[52:55], s9 offen offset:0 sc1
    v_pk_mul_f32 v[68:69], v[68:69], v[16:17] op_sel:[0,1]
    v_pk_mul_f32 v[70:71], v[70:71], v[16:17] op_sel:[0,1]
    v_pk_mul_f32 v[76:77], v[76:77], v[16:17] op_sel:[0,1]
    v_pk_mul_f32 v[78:79], v[78:79], v[16:17] op_sel:[0,1]
    v_cvt_pk_bf16_f32 v28, v68, v69
    v_cvt_pk_bf16_f32 v29, v70, v71
    v_cvt_pk_bf16_f32 v30, v76, v77
    v_cvt_pk_bf16_f32 v31, v78, v79
    buffer_store_dwordx4 v[28:31], v2, s[52:55], s9 offen offset:1024 sc1
    s_add_u32 s9, s48, 12288
    v_pk_mul_f32 v[80:81], v[80:81], v[16:17] op_sel_hi:[1,0]
    v_pk_mul_f32 v[82:83], v[82:83], v[16:17] op_sel_hi:[1,0]
    v_pk_mul_f32 v[88:89], v[88:89], v[16:17] op_sel_hi:[1,0]
    v_pk_mul_f32 v[90:91], v[90:91], v[16:17] op_sel_hi:[1,0]
    v_cvt_pk_bf16_f32 v20, v80, v81
    v_cvt_pk_bf16_f32 v21, v82, v83
    v_cvt_pk_bf16_f32 v22, v88, v89
    v_cvt_pk_bf16_f32 v23, v90, v91
    buffer_store_dwordx4 v[20:23], v2, s[52:55], s9 offen offset:0 sc1
    v_pk_mul_f32 v[84:85], v[84:85], v[16:17] op_sel:[0,1]
    v_pk_mul_f32 v[86:87], v[86:87], v[16:17] op_sel:[0,1]
    v_pk_mul_f32 v[92:93], v[92:93], v[16:17] op_sel:[0,1]
    v_pk_mul_f32 v[94:95], v[94:95], v[16:17] op_sel:[0,1]
    v_cvt_pk_bf16_f32 v24, v84, v85
    v_cvt_pk_bf16_f32 v25, v86, v87
    v_cvt_pk_bf16_f32 v26, v92, v93
    v_cvt_pk_bf16_f32 v27, v94, v95
    buffer_store_dwordx4 v[24:27], v2, s[52:55], s9 offen offset:1024 sc1
L_fbdone0:
    s_and_b32 s6, s47, 2
    s_cbranch_scc0 L_fbdone1
    v_mov_b32 v96, 0
    v_mov_b32 v97, 0
    v_mov_b32 v98, 0
    v_mov_b32 v99, 0
    v_mov_b32 v100, 0
    v_mov_b32 v101, 0
    v_mov_b32 v102, 0
    v_mov_b32 v103, 0
    v_mov_b32 v104, 0
    v_mov_b32 v105, 0
    v_mov_b32 v106, 0
    v_mov_b32 v107, 0
    v_mov_b32 v108, 0
    v_mov_b32 v109, 0
    v_mov_b32 v110, 0
    v_mov_b32 v111, 0
    v_mov_b32 v112, 0
    v_mov_b32 v113, 0
    v_mov_b32 v114, 0
    v_mov_b32 v115, 0
    v_mov_b32 v116, 0
    v_mov_b32 v117, 0
    v_mov_b32 v118, 0
    v_mov_b32 v119, 0
    v_mov_b32 v120, 0
    v_mov_b32 v121, 0
    v_mov_b32 v122, 0
    v_mov_b32 v123, 0
    v_mov_b32 v124, 0
    v_mov_b32 v125, 0
    v_mov_b32 v126, 0
    v_mov_b32 v127, 0
    v_mov_b32 v128, 0
    v_mov_b32 v129, 0
    v_mov_b32 v130, 0
    v_mov_b32 v131, 0
    v_mov_b32 v132, 0
    v_mov_b32 v133, 0
    v_mov_b32 v134, 0
    v_mov_b32 v135, 0
    v_mov_b32 v136, 0
    v_mov_b32 v137, 0
    v_mov_b32 v138, 0
    v_mov_b32 v139, 0
    v_mov_b32 v140, 0
    v_mov_b32 v141, 0
    v_mov_b32 v142, 0
    v_mov_b32 v143, 0
    v_mov_b32 v144, 0
    v_mov_b32 v145, 0
    v_mov_b32 v146, 0
    v_mov_b32 v147, 0
    v_mov_b32 v148, 0
    v_mov_b32 v149, 0
    v_mov_b32 v150, 0
    v_mov_b32 v151, 0
    v_mov_b32 v152, 0
    v_mov_b32 v153, 0
    v_mov_b32 v154, 0
    v_mov_b32 v155, 0
    v_mov_b32 v156, 0
    v_mov_b32 v157, 0
    v_mov_b32 v158, 0
    v_mov_b32 v159, 0
    v_mov_b32 v224, v12
    v_mov_b32 v228, 0
    v_mov_b32 v229, 0
    v_mov_b32 v230, 0
    v_mov_b32 v231, 0
    v_mov_b32 v225, v12
    v_mov_b32 v232, 0
    v_mov_b32 v233, 0
    v_mov_b32 v234, 0
    v_mov_b32 v235, 0
    v_mov_b32 v6, 0
    s_mov_b32 s45, 0
L_fb1:
    s_lshl_b32 s6, s45, 13
    s_add_u32 s7, s6, 524288
    buffer_load_dwordx4 v[32:35], v2, s[20:23], s6 offen offset:0 sc1
    buffer_load_dwordx4 v[36:39], v2, s[20:23], s6 offen offset:1024 sc1
    buffer_load_dwordx4 v[40:43], v2, s[20:23], s6 offen offset:2048 sc1
    buffer_load_dwordx4 v[44:47], v2, s[20:23], s6 offen offset:3072 sc1
    buffer_load_dwordx4 v[48:51], v3, s[20:23], s6 offen offset:0 sc1
    buffer_load_dwordx4 v[52:55], v3, s[20:23], s6 offen offset:1024 sc1
    buffer_load_dwordx4 v[56:59], v3, s[20:23], s6 offen offset:2048 sc1
    buffer_load_dwordx4 v[60:63], v3, s[20:23], s6 offen offset:3072 sc1
    buffer_load_dwordx4 v[64:67], v2, s[20:23], s7 offen offset:0 sc1
    buffer_load_dwordx4 v[68:71], v2, s[20:23], s7 offen offset:1024 sc1
    buffer_load_dwordx4 v[72:75], v2, s[20:23], s7 offen offset:2048 sc1
    buffer_load_dwordx4 v[76:79], v2, s[20:23], s7 offen offset:3072 sc1
    buffer_load_dwordx4 v[80:83], v3, s[20:23], s7 offen offset:0 sc1
    buffer_load_dwordx4 v[84:87], v3, s[20:23], s7 offen offset:1024 sc1
    buffer_load_dwordx4 v[88:91], v3, s[20:23], s7 offen offset:2048 sc1
    buffer_load_dwordx4 v[92:95], v3, s[20:23], s7 offen offset:3072 sc1
    s_cmp_eq_u32 s45, s13
    s_cselect_b64 s[96:97], 0, -1
    s_or_b64 s[88:89], s[60:61], s[96:97]
    s_or_b64 s[90:91], s[62:63], s[96:97]
    s_or_b64 s[92:93], s[30:31], s[96:97]
    s_or_b64 s[94:95], s[32:33], s[96:97]
    v_cndmask_b32 v240, v12, v6, s[88:89]
    v_cndmask_b32 v241, v12, v6, s[90:91]
    v_cndmask_b32 v242, v12, v6, s[92:93]
    v_cndmask_b32 v243, v12, v6, s[94:95]
    v_mov_b32 v248, v6
    v_mov_b32 v249, v6
    v_mov_b32 v250, v6
    v_mov_b32 v251, v6
    v_cndmask_b32 v244, v12, v6, s[96:97]
    v_cndmask_b32 v245, v12, v6, s[96:97]
    v_cndmask_b32 v246, v12, v6, s[96:97]
    v_cndmask_b32 v247, v12, v6, s[96:97]
    v_cndmask_b32 v252, v12, v6, s[88:89]
    v_cndmask_b32 v253, v12, v6, s[90:91]
    v_cndmask_b32 v254, v12, v6, s[92:93]
    v_cndmask_b32 v255, v12, v6, s[94:95]
    s_waitcnt vmcnt(0)
    v_mfma_f32_16x16x32_bf16 v[160:163], v[32:35], a[32:35], v[240:243]
    v_mfma_f32_16x16x32_bf16 v[160:163], v[36:39], a[36:39], v[160:163]
    v_mfma_f32_16x16x32_bf16 v[160:163], v[40:43], a[40:43], v[160:163]
    v_mfma_f32_16x16x32_bf16 v[160:163], v[44:47], a[44:47], v[160:163]
    v_mfma_f32_16x16x32_bf16 v[168:171], v[32:35], a[48:51], v[248:251]
    v_mfma_f32_16x16x32_bf16 v[168:171], v[36:39], a[52:55], v[168:171]
    v_mfma_f32_16x16x32_bf16 v[168:171], v[40:43], a[56:59], v[168:171]
    v_mfma_f32_16x16x32_bf16 v[168:171], v[44:47], a[60:63], v[168:171]
    v_mfma_f32_16x16x32_bf16 v[164:167], v[48:51], a[32:35], v[244:247]
    v_mfma_f32_16x16x32_bf16 v[164:167], v[52:55], a[36:39], v[164:167]
    v_mfma_f32_16x16x32_bf16 v[164:167], v[56:59], a[40:43], v[164:167]
    v_mfma_f32_16x16x32_bf16 v[164:167], v[60:63], a[44:47], v[164:167]
    v_mfma_f32_16x16x32_bf16 v[172:175], v[48:51], a[48:51], v[252:255]
    v_mfma_f32_16x16x32_bf16 v[172:175], v[52:55], a[52:55], v[172:175]
    v_mfma_f32_16x16x32_bf16 v[172:175], v[56:59], a[56:59], v[172:175]
    v_mfma_f32_16x16x32_bf16 v[172:175], v[60:63], a[60:63], v[172:175]
    s_nop 7
    v_max3_f32 v236, v160, v161, v162
    v_max3_f32 v236, v236, v163, v164
    v_max3_f32 v236, v236, v165, v166
    v_max3_f32 v236, v236, v167, v224
    v_max3_f32 v237, v168, v169, v170
    v_max3_f32 v237, v237, v171, v172
    v_max3_f32 v237, v237, v173, v174
    v_max3_f32 v237, v237, v175, v225
    v_mov_b32 v238, v236
    v_mov_b32 v239, v237
    s_nop 1
    v_permlane16_swap_b32 v236, v238
    v_permlane16_swap_b32 v237, v239
    v_max_f32 v236, v236, v238
    v_max_f32 v237, v237, v239
    v_mov_b32 v238, v236
    v_mov_b32 v239, v237
    s_nop 1
    v_permlane32_swap_b32 v236, v238
    v_permlane32_swap_b32 v237, v239
    v_max_f32 v236, v236, v238
    v_max_f32 v237, v237, v239
    v_sub_f32 v226, v224, v236
    v_exp_f32 v226, v226
    v_mov_b32 v224, v236
    v_sub_f32 v160, v160, v236
    v_sub_f32 v161, v161, v236
    v_sub_f32 v162, v162, v236
    v_sub_f32 v163, v163, v236
    v_sub_f32 v164, v164, v236
    v_sub_f32 v165, v165, v236
    v_sub_f32 v166, v166, v236
    v_sub_f32 v167, v167, v236
    v_exp_f32 v160, v160
    v_exp_f32 v161, v161
    v_exp_f32 v162, v162
    v_exp_f32 v163, v163
    v_exp_f32 v164, v164
    v_exp_f32 v165, v165
    v_exp_f32 v166, v166
    v_exp_f32 v167, v167
    v_mul_f32 v96, v96, v226
    v_mul_f32 v97, v97, v226
    v_mul_f32 v98, v98, v226
    v_mul_f32 v99, v99, v226
    v_mul_f32 v104, v104, v226
    v_mul_f32 v105, v105, v226
    v_mul_f32 v106, v106, v226
    v_mul_f32 v107, v107, v226
    v_mul_f32 v112, v112, v226
    v_mul_f32 v113, v113, v226
    v_mul_f32 v114, v114, v226
    v_mul_f32 v115, v115, v226
    v_mul_f32 v120, v120, v226
    v_mul_f32 v121, v121, v226
    v_mul_f32 v122, v122, v226
    v_mul_f32 v123, v123, v226
    v_mul_f32 v128, v128, v226
    v_mul_f32 v129, v129, v226
    v_mul_f32 v130, v130, v226
    v_mul_f32 v131, v131, v226
    v_mul_f32 v136, v136, v226
    v_mul_f32 v137, v137, v226
    v_mul_f32 v138, v138, v226
    v_mul_f32 v139, v139, v226
    v_mul_f32 v144, v144, v226
    v_mul_f32 v145, v145, v226
    v_mul_f32 v146, v146, v226
    v_mul_f32 v147, v147, v226
    v_mul_f32 v152, v152, v226
    v_mul_f32 v153, v153, v226
    v_mul_f32 v154, v154, v226
    v_mul_f32 v155, v155, v226
    v_mul_f32 v228, v228, v226
    v_mul_f32 v229, v229, v226
    v_mul_f32 v230, v230, v226
    v_mul_f32 v231, v231, v226
    v_cvt_pk_bf16_f32 v160, v160, v161
    v_cvt_pk_bf16_f32 v161, v162, v163
    v_cvt_pk_bf16_f32 v162, v164, v165
    v_cvt_pk_bf16_f32 v163, v166, v167
    v_sub_f32 v227, v225, v237
    v_exp_f32 v227, v227
    v_mov_b32 v225, v237
    v_sub_f32 v168, v168, v237
    v_sub_f32 v169, v169, v237
    v_sub_f32 v170, v170, v237
    v_sub_f32 v171, v171, v237
    v_sub_f32 v172, v172, v237
    v_sub_f32 v173, v173, v237
    v_sub_f32 v174, v174, v237
    v_sub_f32 v175, v175, v237
    v_exp_f32 v168, v168
    v_exp_f32 v169, v169
    v_exp_f32 v170, v170
    v_exp_f32 v171, v171
    v_exp_f32 v172, v172
    v_exp_f32 v173, v173
    v_exp_f32 v174, v174
    v_exp_f32 v175, v175
    v_mul_f32 v100, v100, v227
    v_mul_f32 v101, v101, v227
    v_mul_f32 v102, v102, v227
    v_mul_f32 v103, v103, v227
    v_mul_f32 v108, v108, v227
    v_mul_f32 v109, v109, v227
    v_mul_f32 v110, v110, v227
    v_mul_f32 v111, v111, v227
    v_mul_f32 v116, v116, v227
    v_mul_f32 v117, v117, v227
    v_mul_f32 v118, v118, v227
    v_mul_f32 v119, v119, v227
    v_mul_f32 v124, v124, v227
    v_mul_f32 v125, v125, v227
    v_mul_f32 v126, v126, v227
    v_mul_f32 v127, v127, v227
    v_mul_f32 v132, v132, v227
    v_mul_f32 v133, v133, v227
    v_mul_f32 v134, v134, v227
    v_mul_f32 v135, v135, v227
    v_mul_f32 v140, v140, v227
    v_mul_f32 v141, v141, v227
    v_mul_f32 v142, v142, v227
    v_mul_f32 v143, v143, v227
    v_mul_f32 v148, v148, v227
    v_mul_f32 v149, v149, v227
    v_mul_f32 v150, v150, v227
    v_mul_f32 v151, v151, v227
    v_mul_f32 v156, v156, v227
    v_mul_f32 v157, v157, v227
    v_mul_f32 v158, v158, v227
    v_mul_f32 v159, v159, v227
    v_mul_f32 v232, v232, v227
    v_mul_f32 v233, v233, v227
    v_mul_f32 v234, v234, v227
    v_mul_f32 v235, v235, v227
    v_cvt_pk_bf16_f32 v168, v168, v169
    v_cvt_pk_bf16_f32 v169, v170, v171
    v_cvt_pk_bf16_f32 v170, v172, v173
    v_cvt_pk_bf16_f32 v171, v174, v175
    s_nop 1
    v_mfma_f32_16x16x32_bf16 v[96:99], v[64:67], v[160:163], v[96:99]
    v_mfma_f32_16x16x32_bf16 v[104:107], v[68:71], v[160:163], v[104:107]
    v_mfma_f32_16x16x32_bf16 v[112:115], v[72:75], v[160:163], v[112:115]
    v_mfma_f32_16x16x32_bf16 v[120:123], v[76:79], v[160:163], v[120:123]
    v_mfma_f32_16x16x32_bf16 v[128:131], v[80:83], v[160:163], v[128:131]
    v_mfma_f32_16x16x32_bf16 v[136:139], v[84:87], v[160:163], v[136:139]
    v_mfma_f32_16x16x32_bf16 v[144:147], v[88:91], v[160:163], v[144:147]
    v_mfma_f32_16x16x32_bf16 v[152:155], v[92:95], v[160:163], v[152:155]
    v_mfma_f32_16x16x32_bf16 v[228:231], a[112:115], v[160:163], v[228:231]
    v_mfma_f32_16x16x32_bf16 v[100:103], v[64:67], v[168:171], v[100:103]
    v_mfma_f32_16x16x32_bf16 v[108:111], v[68:71], v[168:171], v[108:111]
    v_mfma_f32_16x16x32_bf16 v[116:119], v[72:75], v[168:171], v[116:119]
    v_mfma_f32_16x16x32_bf16 v[124:127], v[76:79], v[168:171], v[124:127]
    v_mfma_f32_16x16x32_bf16 v[132:135], v[80:83], v[168:171], v[132:135]
    v_mfma_f32_16x16x32_bf16 v[140:143], v[84:87], v[168:171], v[140:143]
    v_mfma_f32_16x16x32_bf16 v[148:151], v[88:91], v[168:171], v[148:151]
    v_mfma_f32_16x16x32_bf16 v[156:159], v[92:95], v[168:171], v[156:159]
    v_mfma_f32_16x16x32_bf16 v[232:235], a[112:115], v[168:171], v[232:235]
    s_nop 7
    s_add_u32 s45, s45, 1
    s_cmp_le_u32 s45, s13
    s_cbranch_scc1 L_fb1
    v_rcp_f32 v16, v228
    v_rcp_f32 v17, v232
    s_add_u32 s9, s49, 0
    v_pk_mul_f32 v[96:97], v[96:97], v[16:17] op_sel_hi:[1,0]
    v_pk_mul_f32 v[98:99], v[98:99], v[16:17] op_sel_hi:[1,0]
    v_pk_mul_f32 v[104:105], v[104:105], v[16:17] op_sel_hi:[1,0]
    v_pk_mul_f32 v[106:107], v[106:107], v[16:17] op_sel_hi:[1,0]
    v_cvt_pk_bf16_f32 v20, v96, v97
    v_cvt_pk_bf16_f32 v21, v98, v99
    v_cvt_pk_bf16_f32 v22, v104, v105
    v_cvt_pk_bf16_f32 v23, v106, v107
    buffer_store_dwordx4 v[20:23], v2, s[52:55], s9 offen offset:0 sc1
    v_pk_mul_f32 v[100:101], v[100:101], v[16:17] op_sel:[0,1]
    v_pk_mul_f32 v[102:103], v[102:103], v[16:17] op_sel:[0,1]
    v_pk_mul_f32 v[108:109], v[108:109], v[16:17] op_sel:[0,1]
    v_pk_mul_f32 v[110:111], v[110:111], v[16:17] op_sel:[0,1]
    v_cvt_pk_bf16_f32 v24, v100, v101
    v_cvt_pk_bf16_f32 v25, v102, v103
    v_cvt_pk_bf16_f32 v26, v108, v109
    v_cvt_pk_bf16_f32 v27, v110, v111
    buffer_store_dwordx4 v[24:27], v2, s[52:55], s9 offen offset:1024 sc1
    s_add_u32 s9, s49, 4096
    v_pk_mul_f32 v[112:113], v[112:113], v[16:17] op_sel_hi:[1,0]
    v_pk_mul_f32 v[114:115], v[114:115], v[16:17] op_sel_hi:[1,0]
    v_pk_mul_f32 v[120:121], v[120:121], v[16:17] op_sel_hi:[1,0]
    v_pk_mul_f32 v[122:123], v[122:123], v[16:17] op_sel_hi:[1,0]
    v_cvt_pk_bf16_f32 v28, v112, v113
    v_cvt_pk_bf16_f32 v29, v114, v115
    v_cvt_pk_bf16_f32 v30, v120, v121
    v_cvt_pk_bf16_f32 v31, v122, v123
    buffer_store_dwordx4 v[28:31], v2, s[52:55], s9 offen offset:0 sc1
    v_pk_mul_f32 v[116:117], v[116:117], v[16:17] op_sel:[0,1]
    v_pk_mul_f32 v[118:119], v[118:119], v[16:17] op_sel:[0,1]
    v_pk_mul_f32 v[124:125], v[124:125], v[16:17] op_sel:[0,1]
    v_pk_mul_f32 v[126:127], v[126:127], v[16:17] op_sel:[0,1]
    v_cvt_pk_bf16_f32 v20, v116, v117
    v_cvt_pk_bf16_f32 v21, v118, v119
    v_cvt_pk_bf16_f32 v22, v124, v125
    v_cvt_pk_bf16_f32 v23, v126, v127
    buffer_store_dwordx4 v[20:23], v2, s[52:55], s9 offen offset:1024 sc1
    s_add_u32 s9, s49, 8192
    v_pk_mul_f32 v[128:129], v[128:129], v[16:17] op_sel_hi:[1,0]
    v_pk_mul_f32 v[130:131], v[130:131], v[16:17] op_sel_hi:[1,0]
    v_pk_mul_f32 v[136:137], v[136:137], v[16:17] op_sel_hi:[1,0]
    v_pk_mul_f32 v[138:139], v[138:139], v[16:17] op_sel_hi:[1,0]
    v_cvt_pk_bf16_f32 v24, v128, v129
    v_cvt_pk_bf16_f32 v25, v130, v131
    v_cvt_pk_bf16_f32 v26, v136, v137
    v_cvt_pk_bf16_f32 v27, v138, v139
    buffer_store_dwordx4 v[24:27], v2, s[52:55], s9 offen offset:0 sc1
    v_pk_mul_f32 v[132:133], v[132:133], v[16:17] op_sel:[0,1]
    v_pk_mul_f32 v[134:135], v[134:135], v[16:17] op_sel:[0,1]
    v_pk_mul_f32 v[140:141], v[140:141], v[16:17] op_sel:[0,1]
    v_pk_mul_f32 v[142:143], v[142:143], v[16:17] op_sel:[0,1]
    v_cvt_pk_bf16_f32 v28, v132, v133
    v_cvt_pk_bf16_f32 v29, v134, v135
    v_cvt_pk_bf16_f32 v30, v140, v141
    v_cvt_pk_bf16_f32 v31, v142, v143
    buffer_store_dwordx4 v[28:31], v2, s[52:55], s9 offen offset:1024 sc1
    s_add_u32 s9, s49, 12288
    v_pk_mul_f32 v[144:145], v[144:145], v[16:17] op_sel_hi:[1,0]
    v_pk_mul_f32 v[146:147], v[146:147], v[16:17] op_sel_hi:[1,0]
    v_pk_mul_f32 v[152:153], v[152:153], v[16:17] op_sel_hi:[1,0]
    v_pk_mul_f32 v[154:155], v[154:155], v[16:17] op_sel_hi:[1,0]
    v_cvt_pk_bf16_f32 v20, v144, v145
    v_cvt_pk_bf16_f32 v21, v146, v147
    v_cvt_pk_bf16_f32 v22, v152, v153
    v_cvt_pk_bf16_f32 v23, v154, v155
    buffer_store_dwordx4 v[20:23], v2, s[52:55], s9 offen offset:0 sc1
    v_pk_mul_f32 v[148:149], v[148:149], v[16:17] op_sel:[0,1]
    v_pk_mul_f32 v[150:151], v[150:151], v[16:17] op_sel:[0,1]
    v_pk_mul_f32 v[156:157], v[156:157], v[16:17] op_sel:[0,1]
    v_pk_mul_f32 v[158:159], v[158:159], v[16:17] op_sel:[0,1]
    v_cvt_pk_bf16_f32 v24, v148, v149
    v_cvt_pk_bf16_f32 v25, v150, v151
    v_cvt_pk_bf16_f32 v26, v156, v157
    v_cvt_pk_bf16_f32 v27, v158, v159
    buffer_store_dwordx4 v[24:27], v2, s[52:55], s9 offen offset:1024 sc1
L_fbdone1:
    s_waitcnt vmcnt(0)
    s_xor_b32 s28, s28, 49152
    buffer_load_dwordx4 v[32:35], v2, s[24:27], s28 offen offset:0 sc1
    buffer_load_dwordx4 v[36:39], v2, s[24:27], s28 offen offset:1024 sc1
    buffer_load_dwordx4 v[40:43], v2, s[24:27], s28 offen offset:2048 sc1
    buffer_load_dwordx4 v[44:47], v2, s[24:27], s28 offen offset:3072 sc1
    s_xor_b32 s28, s28, 4096
    buffer_load_dwordx4 v[48:51], v2, s[24:27], s28 offen offset:0 sc1
    buffer_load_dwordx4 v[52:55], v2, s[24:27], s28 offen offset:1024 sc1
    buffer_load_dwordx4 v[56:59], v2, s[24:27], s28 offen offset:2048 sc1
    buffer_load_dwordx4 v[60:63], v2, s[24:27], s28 offen offset:3072 sc1
    s_xor_b32 s28, s28, 61440
    buffer_load_dwordx4 v[64:67], v2, s[24:27], s28 offen offset:0 sc1
    buffer_load_dwordx4 v[68:71], v2, s[24:27], s28 offen offset:1024 sc1
    buffer_load_dwordx4 v[72:75], v2, s[24:27], s28 offen offset:2048 sc1
    buffer_load_dwordx4 v[76:79], v2, s[24:27], s28 offen offset:3072 sc1
    s_xor_b32 s28, s28, 4096
    buffer_load_dwordx4 v[80:83], v2, s[24:27], s28 offen offset:0 sc1
    buffer_load_dwordx4 v[84:87], v2, s[24:27], s28 offen offset:1024 sc1
    buffer_load_dwordx4 v[88:91], v2, s[24:27], s28 offen offset:2048 sc1
    buffer_load_dwordx4 v[92:95], v2, s[24:27], s28 offen offset:3072 sc1
    s_xor_b32 s28, s28, 12288
    s_andn2_b32 s46, 1, s47
    s_cmp_lg_u32 s46, 0
    s_cbranch_scc1 L_sg11
    buffer_atomic_add v8, v11, s[16:19], s83 offen
    s_mov_b32 s46, 1
L_sg11:
    s_waitcnt vmcnt(0)
    s_load_dwordx2 s[56:57], s[0:1], 0
    s_load_dwordx4 s[60:63], s[0:1], 80
    s_load_dwordx2 s[64:65], s[0:1], 64
    s_bfe_u32 s33, s2, 0x20001
    s_lshr_b32 s31, s2, 5
    s_lshl_b32 s31, s31, 1
    s_and_b32 s6, s2, 1
    s_add_u32 s31, s31, s6
    s_lshl_b32 s38, s31, 11
    s_and_b32 s34, s5, 3
    s_lshl_b32 s40, s34, 7
    s_add_u32 s40, s40, s38
    s_lshl_b32 s36, s33, 9
    s_add_u32 s36, s36, s40
    s_add_u32 s68, s14, 35651584
    s_addc_u32 s69, s15, 0
    s_mov_b32 s70, 16777216
    s_mov_b32 s71, 0x20000
    s_lshl_b32 s35, s31, 19
    s_lshl_b32 s6, s33, 17
    s_add_u32 s35, s35, s6
    s_add_u32 s35, s35, s10
    s_and_b32 s6, s5, 0
    s_lshl_b32 s6, s6, 15
    s_add_u32 s35, s35, s6
    s_xor_b32 s6, s33, 0
    s_lshl_b32 s6, s6, 10
    v_add_u32 v172, s6, v2
    v_add_u32 v173, 65536, v172
    v_add_u32 v174, 131072, v172
    s_xor_b32 s6, s33, 1
    s_lshl_b32 s6, s6, 10
    v_add_u32 v175, s6, v2
    v_add_u32 v176, 65536, v175
    v_add_u32 v177, 131072, v175
    s_xor_b32 s6, s33, 2
    s_lshl_b32 s6, s6, 10
    v_add_u32 v178, s6, v2
    v_add_u32 v179, 65536, v178
    v_add_u32 v180, 131072, v178
    s_xor_b32 s6, s33, 3
    s_lshl_b32 s6, s6, 10
    v_add_u32 v181, s6, v2
    v_add_u32 v182, 65536, v181
    v_add_u32 v183, 131072, v181
    s_branch L_fbret
L_codeend:
    s_endpgm
.section .rodata,"a"
.p2align 6
.amdhsa_kernel sequential_preLN__compressed_kv_cla__mixer_channel_mlp__prompt_kernel
  .amdhsa_next_free_vgpr 512
  .amdhsa_next_free_sgpr 102
  .amdhsa_accum_offset 256
  .amdhsa_group_segment_fixed_size 0
  .amdhsa_kernarg_size 112
  .amdhsa_user_sgpr_count 2
  .amdhsa_user_sgpr_kernarg_segment_ptr 1
  .amdhsa_system_sgpr_workgroup_id_x 1
.end_amdhsa_kernel
```
